```python
import torch

def _softmax(x, axis=-1):
    return torch.softmax(x, dim=axis)
def _gelu(x):
    return torch.nn.functional.gelu(x, approximate="tanh")
def _silu(x):
    return torch.nn.functional.silu(x)
def _sigmoid(x):
    return torch.sigmoid(x)
def _layernorm(x, axis=-1, eps=1e-5):
    m = x.mean(dim=axis, keepdim=True)
    v = x.var(dim=axis, keepdim=True, unbiased=False)
    return (x - m) / torch.sqrt(v + eps)
def _scatter_add(tgt, idx, src, axis=0):
    return tgt.clone().index_add_(axis, idx, src)
def _segment_sum(src, seg, n):
    out = torch.zeros((n,) + src.shape[1:], dtype=src.dtype)
    return out.index_add_(0, seg, src)
def _pad(x, pw):
    flat = tuple(v for pair in reversed(pw) for v in pair)
    return torch.nn.functional.pad(x, flat)

kernel_name = 'concat_heads__mha_block__ssm_conv_s5__prompt'

def setup_inputs():

    _w = (lambda a: (lambda t: t.to(torch.bfloat16) if t.is_floating_point() else t)(torch.as_tensor(a)))
    def _A_setup():
        B, S, D, H = 1, 2048, 576, 32
        return {
            "x": _w((lambda *s: torch.randn(*s, dtype=torch.bfloat16) * 0.2)(B, S, D)),
            "wqkv": _w((lambda *s: torch.randn(*s, dtype=torch.bfloat16) * 0.2)(D, 3 * D)),
            "wo": _w((lambda *s: torch.randn(*s, dtype=torch.bfloat16) * 0.05)(D, D)),
        }
    _A_in = _A_setup()

    def _B_setup():
        B, S, D = 1, 2048, 576
        P = D
        Lambda_re = -0.5 * (lambda _x: torch.exp(torch.as_tensor(_x)))((lambda *s: torch.randn(*s, dtype=torch.bfloat16) * 0.8)(P))
        Lambda_im = (lambda *s: torch.randn(*s, dtype=torch.bfloat16) * 0.8)(P) * 1.0
        B_re = (lambda *s: torch.randn(*s, dtype=torch.bfloat16) * 0.8)(P, D) * (D ** -0.5)
        B_im = (lambda *s: torch.randn(*s, dtype=torch.bfloat16) * 0.8)(P, D) * (D ** -0.5)
        C_re = (lambda *s: torch.randn(*s, dtype=torch.bfloat16) * 0.8)(D, P) * (P ** -0.5)
        C_im = (lambda *s: torch.randn(*s, dtype=torch.bfloat16) * 0.8)(D, P) * (P ** -0.5)
        log_dt = (lambda *s: torch.randn(*s, dtype=torch.bfloat16) * 0.8)(P) * 0.3 - 2.0
        Dskip = (lambda *s: torch.randn(*s, dtype=torch.bfloat16) * 0.8)(D)
        return {
            "x": _w((lambda *s: torch.randn(*s, dtype=torch.bfloat16) * 0.05)(B, S, D)),
            "Lambda_re": _w(Lambda_re),
            "Lambda_im": _w(Lambda_im),
            "B_re": _w(B_re),
            "B_im": _w(B_im),
            "C_re": _w(C_re),
            "C_im": _w(C_im),
            "log_dt": _w(log_dt),
            "Dskip": _w(Dskip),
        }
    _B_in = _B_setup()

    return {
        "A_x": _A_in["x"],
        "A_wqkv": _A_in["wqkv"],
        "A_wo": _A_in["wo"],
        "B_x": _B_in["x"],
        "B_Lambda_re": _B_in["Lambda_re"],
        "B_Lambda_im": _B_in["Lambda_im"],
        "B_B_re": _B_in["B_re"],
        "B_B_im": _B_in["B_im"],
        "B_C_re": _B_in["C_re"],
        "B_C_im": _B_in["C_im"],
        "B_log_dt": _B_in["log_dt"],
        "B_Dskip": _B_in["Dskip"],
    }

def reference(A_x, A_wqkv, A_wo, B_x, B_Lambda_re, B_Lambda_im, B_B_re, B_B_im, B_C_re, B_C_im, B_log_dt, B_Dskip):
    def _A_ref(x, wqkv, wo):
        B, S, D = x.shape
        H = 32
        Dh = D // H
        qkv = (lambda x, *d: x.permute(*d))((x @ wqkv).reshape(B, S, 3, H, Dh), 2, 0, 3, 1, 4)
        q, k, v = qkv[0], qkv[1], qkv[2]
        scores = torch.einsum("bhqd,bhkd->bhqk", q, k) * (Dh ** -0.5)
        p = _softmax(scores, axis=-1)
        o = torch.einsum("bhqk,bhkd->bhqd", p, v)
        return (lambda x, *d: x.permute(*d))(o, 0, 2, 1, 3).reshape(B, S, D) @ wo

    def _B_ref(x, Lambda_re, Lambda_im, B_re, B_im, C_re, C_im, log_dt, Dskip):
        Bsz, L, H = x.shape
        Lam = Lambda_re + 1j * Lambda_im
        Bmat = B_re + 1j * B_im
        Cmat = C_re + 1j * C_im
        dt = torch.exp(log_dt)
        Lam_bar = torch.exp(dt * Lam)
        B_bar = ((Lam_bar - 1.0) / Lam)[:, None] * Bmat
        Bu = torch.einsum("bld,pd->blp", x + 0j, B_bar)
        h = torch.zeros_like(Bu[:, 0, :])
        hs = []
        for t in range(L):
            h = Lam_bar[None, :] * h + Bu[:, t, :]
            hs.append(h)
        hseq = torch.stack(hs, 1)
        y = 2.0 * torch.einsum("blp,dp->bld", hseq, Cmat).real + x * Dskip[None, None, :]
        return y

    a = _A_ref(A_x, A_wqkv, A_wo)
    b = _B_ref(B_x, B_Lambda_re, B_Lambda_im, B_B_re, B_B_im, B_C_re, B_C_im, B_log_dt, B_Dskip)
    return torch.concatenate([a, b], axis=-1)
```

```asm
; @launch grid=(256,1,1) block=(512,1,1) lds=163840
.amdgcn_target "amdgcn-amd-amdhsa--gfx950"
.text
.globl concat_heads__mha_block__ssm_conv_s5__prompt_kernel
.p2align 8
.type concat_heads__mha_block__ssm_conv_s5__prompt_kernel,@function
concat_heads__mha_block__ssm_conv_s5__prompt_kernel:
    s_load_dwordx16 s[8:23], s[0:1], 0
    s_load_dwordx8 s[24:31], s[0:1], 64
    s_load_dwordx4 s[32:35], s[0:1], 96
    s_load_dwordx2 s[36:37], s[0:1], 112
    s_cmp_ge_u32 s2, 256
    s_cbranch_scc1 L_exit
    v_lshrrev_b32 v4, 6, v0
    v_and_b32 v1, 63, v0
    v_readfirstlane_b32 s64, v4
    v_and_b32 v2, 15, v0
    v_mov_b32 v15, 0
    v_mov_b32 v254, 0
    v_bfe_u32 v3, v0, 4, 2
    s_and_b32 s65, s2, 7
    s_lshr_b32 s66, s2, 3
    s_and_b32 s69, s64, 3
    s_lshr_b32 s70, s64, 2
    s_cmp_ge_u32 s2, 192
    s_cbranch_scc1 L_nofront
    s_and_b32 s72, s65, 1
    s_lshl_b32 s72, s72, 3
    s_and_b32 s73, s66, 7
    s_add_u32 s89, s72, s73
    s_lshr_b32 s72, s65, 1
    s_mul_i32 s72, s72, 3
    s_lshr_b32 s77, s66, 3
    s_add_u32 s72, s72, s77
    s_lshr_b32 s90, s72, 2
    s_and_b32 s91, s72, 3
    s_cmp_lt_u32 s64, 4
    s_cbranch_scc1 L_compute
    s_mul_i32 s77, s77, 3
    s_add_u32 s77, s77, s73
    s_add_u32 s85, s77, s65
    s_lshl_b32 s72, s89, 7
    s_lshl_b32 s77, s69, 5
    s_add_u32 s72, s72, s77
    v_lshrrev_b32 v4, 3, v1
    v_add_u32 v4, s72, v4
    v_mul_u32_u24 v4, 1152, v4
    v_and_b32 v5, 7, v1
    v_xor_b32 v5, v5, v3
    v_lshl_add_u32 v40, v5, 4, v4
    v_xor_b32 v41, 64, v40
    v_add_u32 v41, 9216, v41
    s_mul_i32 s73, s85, 57
    s_lshr_b32 s73, s73, 9
    s_mul_i32 s73, s73, 9
    s_sub_u32 s85, s85, s73
    s_lshl_b32 s84, s85, 7
    s_mul_i32 s85, s85, 221184
    s_lshl_b32 s80, s69, 12
    s_waitcnt lgkmcnt(0)
    s_mov_b32 s40, s8
    s_mov_b32 s41, s9
    s_mov_b32 s42, 2359296
    s_mov_b32 s43, 0x20000
    s_add_u32 s92, s84, 18432
    s_add_u32 m0, s80, 0
    s_nop 0
    buffer_load_dwordx4 v40, s[40:43], s84 offen lds
    s_add_u32 m0, s80, 1024
    s_nop 0
    buffer_load_dwordx4 v41, s[40:43], s84 offen lds
    s_add_u32 m0, s80, 2048
    s_nop 0
    buffer_load_dwordx4 v40, s[40:43], s92 offen lds
    s_add_u32 m0, s80, 3072
    s_nop 0
    buffer_load_dwordx4 v41, s[40:43], s92 offen lds
    s_mov_b32 s44, s10
    s_mov_b32 s45, s11
    s_mov_b32 s46, 1990656
    s_mov_b32 s47, 0x20000
    s_mul_i32 s72, s90, 1152
    s_mul_i32 s73, s91, 288
    s_add_u32 s72, s72, s73
    s_mul_i32 s73, s69, 55296
    s_add_u32 s77, s72, s73
    s_mul_i32 s81, s69, 6144
    s_add_u32 s81, s81, 16384
    v_add_u32 v4, 0, v1
    v_mul_u32_u24 v5, 2731, v4
    v_lshrrev_b32 v5, 16, v5
    v_mul_u32_u24 v6, 24, v5
    v_sub_u32 v4, v4, v6
    v_bfe_u32 v6, v5, 1, 1
    v_mul_u32_u24 v5, 3456, v5
    v_add_u32 v5, s77, v5
    v_xor_b32 v7, v4, v6
    v_lshlrev_b32 v6, 2, v6
    v_and_b32 v8, 7, v4
    v_xor_b32 v8, v8, v6
    v_mul_u32_u24 v8, 36, v8
    v_add_u32 v8, 20, v8
    v_cmp_gt_u32 vcc, 16, v4
    v_and_b32 v9, 1, v7
    v_lshlrev_b32 v9, 4, v9
    v_lshrrev_b32 v7, 1, v7
    v_mad_u32_u24 v10, v7, 36, v9
    v_cndmask_b32 v10, v8, v10, vcc
    v_add_u32 v42, v5, v10
    s_add_u32 m0, s81, 0
    s_nop 0
    buffer_load_dwordx4 v42, s[44:47], s85 offen lds
    v_xor_b32 v7, 1, v7
    v_mad_u32_u24 v10, v7, 36, v9
    v_cndmask_b32 v10, v8, v10, vcc
    v_add_u32 v5, 27648, v5
    v_add_u32 v45, v5, v10
    s_add_u32 m0, s81, 3072
    s_nop 0
    buffer_load_dwordx4 v45, s[44:47], s85 offen lds
    v_add_u32 v4, 64, v1
    v_mul_u32_u24 v5, 2731, v4
    v_lshrrev_b32 v5, 16, v5
    v_mul_u32_u24 v6, 24, v5
    v_sub_u32 v4, v4, v6
    v_bfe_u32 v6, v5, 1, 1
    v_mul_u32_u24 v5, 3456, v5
    v_add_u32 v5, s77, v5
    v_xor_b32 v7, v4, v6
    v_lshlrev_b32 v6, 2, v6
    v_and_b32 v8, 7, v4
    v_xor_b32 v8, v8, v6
    v_mul_u32_u24 v8, 36, v8
    v_add_u32 v8, 20, v8
    v_cmp_gt_u32 vcc, 16, v4
    v_and_b32 v9, 1, v7
    v_lshlrev_b32 v9, 4, v9
    v_lshrrev_b32 v7, 1, v7
    v_mad_u32_u24 v10, v7, 36, v9
    v_cndmask_b32 v10, v8, v10, vcc
    v_add_u32 v43, v5, v10
    s_add_u32 m0, s81, 1024
    s_nop 0
    buffer_load_dwordx4 v43, s[44:47], s85 offen lds
    v_xor_b32 v7, 1, v7
    v_mad_u32_u24 v10, v7, 36, v9
    v_cndmask_b32 v10, v8, v10, vcc
    v_add_u32 v5, 27648, v5
    v_add_u32 v46, v5, v10
    s_add_u32 m0, s81, 4096
    s_nop 0
    buffer_load_dwordx4 v46, s[44:47], s85 offen lds
    v_add_u32 v4, 128, v1
    v_mul_u32_u24 v5, 2731, v4
    v_lshrrev_b32 v5, 16, v5
    v_mul_u32_u24 v6, 24, v5
    v_sub_u32 v4, v4, v6
    v_bfe_u32 v6, v5, 1, 1
    v_mul_u32_u24 v5, 3456, v5
    v_add_u32 v5, s77, v5
    v_xor_b32 v7, v4, v6
    v_lshlrev_b32 v6, 2, v6
    v_and_b32 v8, 7, v4
    v_xor_b32 v8, v8, v6
    v_mul_u32_u24 v8, 36, v8
    v_add_u32 v8, 20, v8
    v_cmp_gt_u32 vcc, 16, v4
    v_and_b32 v9, 1, v7
    v_lshlrev_b32 v9, 4, v9
    v_lshrrev_b32 v7, 1, v7
    v_mad_u32_u24 v10, v7, 36, v9
    v_cndmask_b32 v10, v8, v10, vcc
    v_add_u32 v44, v5, v10
    s_add_u32 m0, s81, 2048
    s_nop 0
    buffer_load_dwordx4 v44, s[44:47], s85 offen lds
    v_xor_b32 v7, 1, v7
    v_mad_u32_u24 v10, v7, 36, v9
    v_cndmask_b32 v10, v8, v10, vcc
    v_add_u32 v5, 27648, v5
    v_add_u32 v47, v5, v10
    s_add_u32 m0, s81, 5120
    s_nop 0
    buffer_load_dwordx4 v47, s[44:47], s85 offen lds
    s_add_u32 s84, s84, 128
    s_add_u32 s85, s85, 221184
    s_cmp_eq_u32 s84, 1152
    s_cselect_b32 s84, 0, s84
    s_cselect_b32 s85, 0, s85
    s_add_u32 s92, s84, 18432
    s_add_u32 m0, s80, 40960
    s_nop 0
    buffer_load_dwordx4 v40, s[40:43], s84 offen lds
    s_add_u32 m0, s80, 41984
    s_nop 0
    buffer_load_dwordx4 v41, s[40:43], s84 offen lds
    s_add_u32 m0, s80, 43008
    s_nop 0
    buffer_load_dwordx4 v40, s[40:43], s92 offen lds
    s_add_u32 m0, s80, 44032
    s_nop 0
    buffer_load_dwordx4 v41, s[40:43], s92 offen lds
    s_add_u32 m0, s81, 40960
    s_nop 0
    buffer_load_dwordx4 v42, s[44:47], s85 offen lds
    s_add_u32 m0, s81, 41984
    s_nop 0
    buffer_load_dwordx4 v43, s[44:47], s85 offen lds
    s_mov_b32 s67, 0
    s_mov_b32 s68, 0
    s_and_b32 s72, s64, 1
    s_lshl_b32 s72, s72, 1
    s_add_u32 s71, s72, s70
    s_bfe_u32 s3, s64, 0x10001
    s_and_b32 s72, s65, 3
    s_lshl_b32 s72, s72, 2
    s_and_b32 s73, s66, 3
    s_add_u32 s38, s72, s73
    s_lshl_b32 s73, s73, 3
    s_add_u32 s4, s73, s65
    s_lshr_b32 s5, s66, 2
    s_mul_i32 s6, s4, 163968
    s_mul_i32 s7, s4, 82048
    s_lshl_b32 s72, s5, 3
    s_lshl_b32 s73, s69, 1
    s_add_u32 s72, s72, s73
    s_mul_i32 s72, s72, 1280
    s_add_u32 s7, s7, s72
    s_add_u32 s7, s7, 5246976
    s_lshr_b32 s72, s65, 2
    s_mul_i32 s72, s72, 6
    s_add_u32 s39, s72, s5
    s_lshl_b32 s97, s39, 5
    s_mov_b32 s52, s36
    s_mov_b32 s53, s37
    s_mov_b32 s54, 268435456
    s_mov_b32 s55, 0x20000
    s_mov_b32 s60, s34
    s_mov_b32 s61, s35
    s_mov_b32 s62, 256
    s_mov_b32 s63, 0x20000
    s_mul_i32 s73, s3, 16
    s_add_u32 s72, s97, s73
    v_and_b32 v4, 7, v2
    v_lshl_add_u32 v4, v3, 3, v4
    v_add_lshl_u32 v4, s72, v4, 1
    s_mov_b32 s60, s16
    s_mov_b32 s61, s17
    s_mov_b32 s62, 1152
    s_mov_b32 s63, 0x20000
    buffer_load_ushort v64, v4, s[60:63], 0 offen offset:0
    s_mov_b32 s60, s18
    s_mov_b32 s61, s19
    s_mov_b32 s62, 1152
    s_mov_b32 s63, 0x20000
    buffer_load_ushort v65, v4, s[60:63], 0 offen offset:0
    s_mov_b32 s60, s28
    s_mov_b32 s61, s29
    s_mov_b32 s62, 1152
    s_mov_b32 s63, 0x20000
    buffer_load_ushort v66, v4, s[60:63], 0 offen offset:0
    s_mov_b32 s60, s34
    s_mov_b32 s61, s35
    s_mov_b32 s62, 256
    s_mov_b32 s63, 0x20000
    s_mul_i32 s72, s70, 20480
    s_add_u32 s72, s72, 81920
    v_lshlrev_b32 v19, 4, v1
    v_add_u32 v16, s72, v19
    v_and_b32 v4, 31, v1
    v_and_b32 v7, 7, v1
    v_bfe_u32 v5, v1, 3, 1
    v_lshl_add_u32 v7, v5, 4, v7
    v_bfe_u32 v5, v1, 4, 1
    v_lshl_add_u32 v7, v5, 3, v7
    v_lshlrev_b32 v7, 3, v7
    v_add_u32 v7, 1024, v7
    v_add_u32 v17, s72, v7
    v_lshrrev_b32 v5, 5, v1
    v_mul_u32_u24 v6, 1280, v5
    v_add_u32 v21, v7, v6
    v_min_u32 v4, 19, v4
    v_lshlrev_b32 v4, 4, v4
    v_cmp_gt_u32 vcc, 0x100, v4
    v_lshl_add_u32 v6, v5, 8, v4
    v_lshl_add_u32 v4, v5, 6, v4
    v_add_u32 v4, 768, v4
    v_cndmask_b32 v4, v4, v6, vcc
    s_add_u32 s72, s72, 1280
    v_add_u32 v18, s72, v4
    v_mov_b32 v4, 128
    v_mov_b32 v5, 512
    v_cndmask_b32 v4, v4, v5, vcc
    v_add_u32 v20, v18, v4
    s_and_b32 s72, s65, 3
    s_lshl_b32 s72, s72, 2
    s_and_b32 s73, s66, 3
    s_add_u32 s74, s72, s73
    s_lshr_b32 s72, s65, 2
    s_lshl_b32 s72, s72, 2
    s_bfe_u32 s73, s66, 0x20002
    s_add_u32 s75, s72, s73
    s_lshl_b32 s72, s5, 1
    s_lshr_b32 s73, s69, 1
    s_add_u32 s72, s72, s73
    s_and_b32 s73, s72, 3
    s_lshl_b32 s73, s73, 3
    s_lshr_b32 s72, s72, 2
    s_add_u32 s72, s72, s73
    s_lshl_b32 s79, s72, 1
    s_and_b32 s73, s69, 1
    s_add_u32 s79, s79, s73
    s_lshl_b32 s79, s79, 5
    s_add_u32 s79, s79, s4
    s_lshl_b32 s79, s79, 1
    s_add_u32 s79, s79, s70
    s_lshl_b32 s79, s79, 2
    s_add_u32 s79, s79, 15380480
    v_mov_b32 v22, 0
    v_mov_b32 v23, 0
    v_mov_b32 v24, 0
    v_mov_b32 v25, 0
    v_mov_b32 v26, 0
    v_mov_b32 v27, 0
    v_mov_b32 v28, 0
    v_mov_b32 v29, 0
    v_mov_b32 v30, 0
    v_mov_b32 v31, 0
    s_cmp_ge_u32 s66, 16
    s_cbranch_scc1 Lta_1
    v_and_b32 v4, 7, v1
    v_lshrrev_b32 v6, 3, v1
    s_lshl_b32 s72, s69, 4
    v_add_u32 v7, s72, v6
    s_mul_i32 s72, s69, 36864
    v_lshl_add_u32 v22, v1, 4, s72
    v_xor_b32 v4, v4, v3
    s_mul_i32 s73, s75, 72
    v_add_u32 v23, s73, v7
    v_mul_u32_u24 v23, 1152, v23
    v_lshl_add_u32 v23, v4, 4, v23
    s_add_u32 s73, s73, 64
    v_add_u32 v24, s73, v6
    v_mul_u32_u24 v24, 1152, v24
    v_lshl_add_u32 v24, v4, 4, v24
    s_branch Lta_2
Lta_1:
    s_cmp_lt_u32 s64, 4
    s_cbranch_scc1 Lta_2
    v_lshrrev_b32 v4, 5, v1
    v_and_b32 v5, 31, v1
    v_lshlrev_b32 v5, 4, v5
    s_lshl_b32 s72, s69, 16
    s_lshl_b32 s73, s74, 12
    s_add_u32 s73, s72, s73
    v_lshl_add_u32 v6, v4, 10, v5
    v_add_u32 v25, s73, v6
    s_lshl_b32 s73, s74, 9
    s_add_u32 s72, s72, s73
    s_add_u32 s72, s72, 14692352
    v_lshl_add_u32 v4, v4, 13, v5
    v_add_u32 v26, s72, v4
    s_lshl_b32 s72, s69, 7
    s_add_u32 s72, s72, 0
    v_add_u32 v4, s72, v1
    v_mul_u32_u24 v5, 7282, v4
    v_lshrrev_b32 v5, 16, v5
    v_mul_u32_u24 v6, 9, v5
    v_sub_u32 v4, v4, v6
    s_mul_i32 s73, s75, 144
    v_lshl_add_u32 v4, v4, 4, s73
    v_and_b32 v6, 1, v5
    v_bfe_u32 v7, v5, 1, 2
    v_lshl_add_u32 v7, v6, 3, v7
    v_bfe_u32 v8, v5, 3, 1
    v_lshl_add_u32 v7, v8, 2, v7
    v_lshrrev_b32 v8, 4, v5
    v_mul_u32_u24 v8, 18, v8
    v_add_u32 v7, v7, v8
    v_mul_u32_u24 v7, 1152, v7
    v_add_u32 v27, v7, v4
    v_lshrrev_b32 v7, 3, v5
    v_lshlrev_b32 v7, 2, v7
    v_lshl_add_u32 v7, v6, 1, v7
    v_bfe_u32 v6, v5, 2, 1
    v_add_u32 v7, v7, v6
    v_mul_u32_u24 v7, 18, v7
    v_bfe_u32 v6, v5, 1, 1
    v_add3_u32 v7, v7, v6, 16
    v_mul_u32_u24 v7, 1152, v7
    v_add_u32 v30, v7, v4
    s_lshl_b32 s72, s69, 7
    s_add_u32 s72, s72, 64
    v_add_u32 v4, s72, v1
    v_mul_u32_u24 v5, 7282, v4
    v_lshrrev_b32 v5, 16, v5
    v_mul_u32_u24 v6, 9, v5
    v_sub_u32 v4, v4, v6
    s_mul_i32 s73, s75, 144
    v_lshl_add_u32 v4, v4, 4, s73
    v_and_b32 v6, 1, v5
    v_bfe_u32 v7, v5, 1, 2
    v_lshl_add_u32 v7, v6, 3, v7
    v_bfe_u32 v8, v5, 3, 1
    v_lshl_add_u32 v7, v8, 2, v7
    v_lshrrev_b32 v8, 4, v5
    v_mul_u32_u24 v8, 18, v8
    v_add_u32 v7, v7, v8
    v_mul_u32_u24 v7, 1152, v7
    v_add_u32 v28, v7, v4
    v_lshrrev_b32 v7, 3, v5
    v_lshlrev_b32 v7, 2, v7
    v_lshl_add_u32 v7, v6, 1, v7
    v_bfe_u32 v6, v5, 2, 1
    v_add_u32 v7, v7, v6
    v_mul_u32_u24 v7, 18, v7
    v_bfe_u32 v6, v5, 1, 1
    v_add3_u32 v7, v7, v6, 16
    v_mul_u32_u24 v7, 1152, v7
    v_add_u32 v31, v7, v4
    v_add_u32 v4, 512, v1
    v_mul_u32_u24 v5, 7282, v4
    v_lshrrev_b32 v5, 16, v5
    v_mul_u32_u24 v6, 9, v5
    v_sub_u32 v4, v4, v6
    s_mul_i32 s73, s75, 144
    v_lshl_add_u32 v4, v4, 4, s73
    v_and_b32 v6, 1, v5
    v_bfe_u32 v7, v5, 1, 2
    v_lshl_add_u32 v7, v6, 3, v7
    v_bfe_u32 v8, v5, 3, 1
    v_lshl_add_u32 v7, v8, 2, v7
    v_lshrrev_b32 v8, 4, v5
    v_mul_u32_u24 v8, 18, v8
    v_add_u32 v7, v7, v8
    v_mul_u32_u24 v7, 1152, v7
    v_add_u32 v29, v7, v4
    v_lshrrev_b32 v7, 3, v5
    v_lshlrev_b32 v7, 2, v7
    v_lshl_add_u32 v7, v6, 1, v7
    v_bfe_u32 v6, v5, 2, 1
    v_add_u32 v7, v7, v6
    v_mul_u32_u24 v7, 18, v7
    v_bfe_u32 v6, v5, 1, 1
    v_add3_u32 v7, v7, v6, 16
    v_mul_u32_u24 v7, 1152, v7
    v_add_u32 v0, v7, v4
Lta_2:
    s_lshl_b32 s72, s2, 8
    s_add_u32 s72, s72, 15085568
    v_min_u32 v15, 33, v1
    v_lshl_add_u32 v15, v15, 2, s72
    s_mul_i32 s72, s3, 2048
    s_add_u32 s72, s72, 75776
    v_lshl_add_u32 v52, v2, 4, s72
    s_lshl_b32 s72, s3, 2
    s_add_u32 s72, s72, s71
    s_mul_i32 s72, s72, 1024
    s_add_u32 s72, s72, 151552
    v_mul_u32_u24 v53, 256, v3
    v_lshl_add_u32 v53, v2, 3, v53
    v_add_u32 v53, s72, v53
    s_add_u32 m0, s81, 43008
    s_nop 0
    buffer_load_dwordx4 v44, s[44:47], s85 offen lds
    s_add_u32 m0, s81, 44032
    s_nop 0
    buffer_load_dwordx4 v45, s[44:47], s85 offen lds
    s_add_u32 m0, s81, 45056
    s_nop 0
    buffer_load_dwordx4 v46, s[44:47], s85 offen lds
    s_add_u32 m0, s81, 46080
    s_nop 0
    buffer_load_dwordx4 v47, s[44:47], s85 offen lds
    s_add_u32 s84, s84, 128
    s_add_u32 s85, s85, 221184
    s_cmp_eq_u32 s84, 1152
    s_cselect_b32 s84, 0, s84
    s_cselect_b32 s85, 0, s85
    s_lshl_b32 s72, s38, 7
    s_lshl_b32 s73, s69, 5
    s_add_u32 s72, s72, s73
    v_bfe_u32 v4, v1, 3, 2
    v_lshrrev_b32 v5, 5, v1
    v_lshl_add_u32 v4, v5, 3, v4
    v_add_u32 v4, s72, v4
    v_mul_u32_u24 v4, 1152, v4
    v_and_b32 v5, 7, v1
    v_xor_b32 v5, v5, v3
    v_lshl_add_u32 v48, v5, 4, v4
    v_xor_b32 v49, 64, v48
    v_add_u32 v49, 18432, v49
    s_lshr_b32 s73, s69, 1
    s_lshl_b32 s73, s73, 3
    s_add_u32 s72, s97, s73
    v_lshrrev_b32 v4, 3, v1
    v_add_u32 v4, s72, v4
    v_mul_u32_u24 v4, 1152, v4
    s_and_b32 s73, s64, 1
    s_lshl_b32 s72, s73, 2
    v_xor_b32 v5, s72, v5
    v_lshl_add_u32 v50, v5, 4, v4
    s_cmp_eq_u32 s73, 0
    s_cselect_b32 s48, s20, s22
    s_cselect_b32 s49, s21, s23
    s_mov_b32 s50, 663552
    s_mov_b32 s51, 0x20000
    s_lshl_b32 s80, s69, 12
    s_lshl_b32 s83, s69, 10
    s_add_u32 s83, s83, 16384
    s_and_b32 s72, s66, 3
    s_lshl_b32 s72, s72, 1
    s_add_u32 s72, s72, s5
    s_add_u32 s82, s72, s65
    s_mul_i32 s73, s82, 57
    s_lshr_b32 s73, s73, 9
    s_mul_i32 s73, s73, 9
    s_sub_u32 s82, s82, s73
    s_lshl_b32 s82, s82, 7
    s_mov_b32 s56, s14
    s_mov_b32 s57, s15
    s_mov_b32 s58, 2359296
    s_mov_b32 s59, 0x20000
    s_lshl_b32 s94, s69, 10
    s_waitcnt vmcnt(13)
    s_barrier
    s_add_u32 s92, s84, 18432
    s_add_u32 m0, s80, 81920
    s_nop 0
    buffer_load_dwordx4 v40, s[40:43], s84 offen lds
    s_add_u32 m0, s80, 82944
    s_nop 0
    buffer_load_dwordx4 v41, s[40:43], s84 offen lds
    s_add_u32 m0, s80, 83968
    s_nop 0
    buffer_load_dwordx4 v40, s[40:43], s92 offen lds
    s_add_u32 m0, s80, 84992
    s_nop 0
    buffer_load_dwordx4 v41, s[40:43], s92 offen lds
    s_add_u32 m0, s81, 81920
    s_nop 0
    buffer_load_dwordx4 v42, s[44:47], s85 offen lds
    s_add_u32 m0, s81, 82944
    s_nop 0
    buffer_load_dwordx4 v43, s[44:47], s85 offen lds
    s_add_u32 m0, s81, 83968
    s_nop 0
    buffer_load_dwordx4 v44, s[44:47], s85 offen lds
    s_add_u32 m0, s81, 84992
    s_nop 0
    buffer_load_dwordx4 v45, s[44:47], s85 offen lds
    s_add_u32 m0, s81, 86016
    s_nop 0
    buffer_load_dwordx4 v46, s[44:47], s85 offen lds
    s_add_u32 m0, s81, 87040
    s_nop 0
    buffer_load_dwordx4 v47, s[44:47], s85 offen lds
    s_add_u32 s84, s84, 128
    s_add_u32 s85, s85, 221184
    s_cmp_eq_u32 s84, 1152
    s_cselect_b32 s84, 0, s84
    s_cselect_b32 s85, 0, s85
    s_waitcnt vmcnt(10)
    s_barrier
    s_add_u32 s92, s84, 18432
    s_add_u32 m0, s80, 122880
    s_nop 0
    buffer_load_dwordx4 v40, s[40:43], s84 offen lds
    s_add_u32 m0, s80, 123904
    s_nop 0
    buffer_load_dwordx4 v41, s[40:43], s84 offen lds
    s_add_u32 m0, s80, 124928
    s_nop 0
    buffer_load_dwordx4 v40, s[40:43], s92 offen lds
    s_add_u32 m0, s80, 125952
    s_nop 0
    buffer_load_dwordx4 v41, s[40:43], s92 offen lds
    s_add_u32 m0, s81, 122880
    s_nop 0
    buffer_load_dwordx4 v42, s[44:47], s85 offen lds
    s_add_u32 m0, s81, 123904
    s_nop 0
    buffer_load_dwordx4 v43, s[44:47], s85 offen lds
    s_add_u32 m0, s81, 124928
    s_nop 0
    buffer_load_dwordx4 v44, s[44:47], s85 offen lds
    s_add_u32 m0, s81, 125952
    s_nop 0
    buffer_load_dwordx4 v45, s[44:47], s85 offen lds
    s_add_u32 m0, s81, 126976
    s_nop 0
    buffer_load_dwordx4 v46, s[44:47], s85 offen lds
    s_add_u32 m0, s81, 128000
    s_nop 0
    buffer_load_dwordx4 v47, s[44:47], s85 offen lds
    s_add_u32 s84, s84, 128
    s_add_u32 s85, s85, 221184
    s_cmp_eq_u32 s84, 1152
    s_cselect_b32 s84, 0, s84
    s_cselect_b32 s85, 0, s85
    s_waitcnt vmcnt(10)
    s_barrier
    v_cmp_gt_u32 vcc, 8, v2
    v_mov_b32 v67, 1.0
    v_mov_b32 v70, -1.0
    v_cndmask_b32 v67, v67, v70, vcc
    v_lshlrev_b32 v66, 16, v66
    v_mul_f32 v66, 0x3fb8aa3b, v66
    v_exp_f32 v66, v66
    v_lshlrev_b32 v64, 16, v64
    v_lshlrev_b32 v65, 16, v65
    v_cvt_pk_bf16_f32 v66, v66, v66
    v_lshlrev_b32 v66, 16, v66
    v_mul_f32 v68, v66, v64
    v_mul_f32 v69, v66, v65
    v_mul_f32 v68, 0x3fb8aa3b, v68
    v_mul_f32 v69, 0x3e22f983, v69
    s_add_u32 s92, s84, 18432
    s_add_u32 m0, s80, 0
    s_nop 0
    buffer_load_dwordx4 v40, s[40:43], s84 offen lds
    s_add_u32 m0, s80, 1024
    s_nop 0
    buffer_load_dwordx4 v41, s[40:43], s84 offen lds
    s_add_u32 m0, s80, 2048
    s_nop 0
    buffer_load_dwordx4 v40, s[40:43], s92 offen lds
    s_add_u32 m0, s80, 3072
    s_nop 0
    buffer_load_dwordx4 v41, s[40:43], s92 offen lds
    s_add_u32 m0, s81, 0
    s_nop 0
    buffer_load_dwordx4 v42, s[44:47], s85 offen lds
    s_add_u32 m0, s81, 1024
    s_nop 0
    buffer_load_dwordx4 v43, s[44:47], s85 offen lds
    s_add_u32 m0, s81, 2048
    s_nop 0
    buffer_load_dwordx4 v44, s[44:47], s85 offen lds
    s_add_u32 m0, s81, 3072
    s_nop 0
    buffer_load_dwordx4 v45, s[44:47], s85 offen lds
    s_add_u32 m0, s81, 4096
    s_nop 0
    buffer_load_dwordx4 v46, s[44:47], s85 offen lds
    s_add_u32 m0, s81, 5120
    s_nop 0
    buffer_load_dwordx4 v47, s[44:47], s85 offen lds
    s_add_u32 s84, s84, 128
    s_add_u32 s85, s85, 221184
    s_cmp_eq_u32 s84, 1152
    s_cselect_b32 s84, 0, s84
    s_cselect_b32 s85, 0, s85
    s_waitcnt vmcnt(10)
    s_barrier
    s_bitcmp1_b32 s64, 0
    s_cbranch_scc1 Lp_3
    v_mul_f32 v70, 0x3f800000, v68
    v_mul_f32 v71, 0x3f800000, v69
    v_exp_f32 v70, v70
    v_rndne_f32 v72, v71
    v_sub_f32 v71, v71, v72
    v_cos_f32 v72, v71
    v_sin_f32 v71, v71
    v_mul_f32 v76, v70, v72
    v_mul_f32 v70, v70, v67
    v_mul_f32 v77, v70, v71
    v_mul_f32 v70, 0x43000000, v68
    v_mul_f32 v71, 0x43000000, v69
    v_exp_f32 v70, v70
    v_rndne_f32 v72, v71
    v_sub_f32 v71, v71, v72
    v_cos_f32 v72, v71
    v_sin_f32 v71, v71
    v_mul_f32 v80, v70, v72
    v_mul_f32 v70, v70, v67
    v_mul_f32 v81, v70, v71
    v_mul_f32 v70, 0x44000000, v68
    v_mul_f32 v71, 0x44000000, v69
    s_branch Lp_4
Lp_3:
    v_mul_f32 v70, 0x41000000, v68
    v_mul_f32 v71, 0x41000000, v69
    v_exp_f32 v70, v70
    v_rndne_f32 v72, v71
    v_sub_f32 v71, v71, v72
    v_cos_f32 v72, v71
    v_sin_f32 v71, v71
    v_mul_f32 v78, v70, v72
    v_mul_f32 v70, v70, v67
    v_mul_f32 v79, v70, v71
    v_mov_b32 v76, 1.0
    v_mov_b32 v77, 0
    v_mul_f32 v80, v78, v78
    v_mul_f32 v81, v78, v79
    v_fma_f32 v80, -v79, v79, v80
    v_fmac_f32 v81, v79, v78
    v_mul_f32 v82, v80, v78
Lp_4:
    s_add_u32 s92, s84, 18432
    s_add_u32 m0, s80, 40960
    s_nop 0
    buffer_load_dwordx4 v40, s[40:43], s84 offen lds
    s_add_u32 m0, s80, 41984
    s_nop 0
    buffer_load_dwordx4 v41, s[40:43], s84 offen lds
    s_add_u32 m0, s80, 43008
    s_nop 0
    buffer_load_dwordx4 v40, s[40:43], s92 offen lds
    s_add_u32 m0, s80, 44032
    s_nop 0
    buffer_load_dwordx4 v41, s[40:43], s92 offen lds
    s_add_u32 m0, s81, 40960
    s_nop 0
    buffer_load_dwordx4 v42, s[44:47], s85 offen lds
    s_add_u32 m0, s81, 41984
    s_nop 0
    buffer_load_dwordx4 v43, s[44:47], s85 offen lds
    s_add_u32 m0, s81, 43008
    s_nop 0
    buffer_load_dwordx4 v44, s[44:47], s85 offen lds
    s_add_u32 m0, s81, 44032
    s_nop 0
    buffer_load_dwordx4 v45, s[44:47], s85 offen lds
    s_add_u32 m0, s81, 45056
    s_nop 0
    buffer_load_dwordx4 v46, s[44:47], s85 offen lds
    s_add_u32 m0, s81, 46080
    s_nop 0
    buffer_load_dwordx4 v47, s[44:47], s85 offen lds
    s_add_u32 s84, s84, 128
    s_add_u32 s85, s85, 221184
    s_cmp_eq_u32 s84, 1152
    s_cselect_b32 s84, 0, s84
    s_cselect_b32 s85, 0, s85
    s_waitcnt vmcnt(10)
    s_barrier
    s_bitcmp1_b32 s64, 0
    s_cbranch_scc1 Lp_5
    v_exp_f32 v70, v70
    v_rndne_f32 v72, v71
    v_sub_f32 v71, v71, v72
    v_cos_f32 v72, v71
    v_sin_f32 v71, v71
    v_mul_f32 v82, v70, v72
    v_mul_f32 v70, v70, v67
    v_mul_f32 v83, v70, v71
    v_mul_f32 v70, 0x44800000, v68
    v_mul_f32 v71, 0x44800000, v69
    v_exp_f32 v70, v70
    v_rndne_f32 v72, v71
    v_sub_f32 v71, v71, v72
    v_cos_f32 v72, v71
    v_sin_f32 v71, v71
    v_mul_f32 v84, v70, v72
    v_mul_f32 v70, v70, v67
    v_mul_f32 v85, v70, v71
    v_mul_f32 v70, 0x41000000, v68
    v_mul_f32 v71, 0x41000000, v69
    v_exp_f32 v70, v70
    v_rndne_f32 v72, v71
    s_branch Lp_6
Lp_5:
    v_mul_f32 v83, v80, v79
    v_fma_f32 v82, -v81, v79, v82
    v_fmac_f32 v83, v81, v78
    v_mul_f32 v84, v82, v78
    v_mul_f32 v85, v82, v79
    v_fma_f32 v84, -v83, v79, v84
    v_fmac_f32 v85, v83, v78
    v_mul_f32 v86, v84, v78
    v_mul_f32 v87, v84, v79
    v_fma_f32 v86, -v85, v79, v86
    v_fmac_f32 v87, v85, v78
    v_mul_f32 v88, v86, v78
    v_mul_f32 v89, v86, v79
    v_fma_f32 v88, -v87, v79, v88
    v_fmac_f32 v89, v87, v78
    v_mul_f32 v90, v88, v78
    v_mul_f32 v91, v88, v79
Lp_6:
    s_add_u32 s92, s84, 18432
    s_add_u32 m0, s80, 81920
    s_nop 0
    buffer_load_dwordx4 v40, s[40:43], s84 offen lds
    s_add_u32 m0, s80, 82944
    s_nop 0
    buffer_load_dwordx4 v41, s[40:43], s84 offen lds
    s_add_u32 m0, s80, 83968
    s_nop 0
    buffer_load_dwordx4 v40, s[40:43], s92 offen lds
    s_add_u32 m0, s80, 84992
    s_nop 0
    buffer_load_dwordx4 v41, s[40:43], s92 offen lds
    s_add_u32 m0, s81, 81920
    s_nop 0
    buffer_load_dwordx4 v42, s[44:47], s85 offen lds
    s_add_u32 m0, s81, 82944
    s_nop 0
    buffer_load_dwordx4 v43, s[44:47], s85 offen lds
    s_add_u32 m0, s81, 83968
    s_nop 0
    buffer_load_dwordx4 v44, s[44:47], s85 offen lds
    s_add_u32 m0, s81, 84992
    s_nop 0
    buffer_load_dwordx4 v45, s[44:47], s85 offen lds
    s_add_u32 m0, s81, 86016
    s_nop 0
    buffer_load_dwordx4 v46, s[44:47], s85 offen lds
    s_add_u32 m0, s81, 87040
    s_nop 0
    buffer_load_dwordx4 v47, s[44:47], s85 offen lds
    s_add_u32 s84, s84, 128
    s_add_u32 s85, s85, 221184
    s_cmp_eq_u32 s84, 1152
    s_cselect_b32 s84, 0, s84
    s_cselect_b32 s85, 0, s85
    s_waitcnt vmcnt(10)
    s_barrier
    s_bitcmp1_b32 s64, 0
    s_cbranch_scc1 Lp_7
    v_sub_f32 v71, v71, v72
    v_cos_f32 v72, v71
    v_sin_f32 v71, v71
    v_mul_f32 v86, v70, v72
    v_mul_f32 v70, v70, v67
    v_mul_f32 v87, v70, v71
    v_mul_f32 v70, 0x42000000, v68
    v_mul_f32 v71, 0x42000000, v69
    v_exp_f32 v70, v70
    v_rndne_f32 v72, v71
    v_sub_f32 v71, v71, v72
    v_cos_f32 v72, v71
    v_sin_f32 v71, v71
    v_mul_f32 v88, v70, v72
    v_mul_f32 v70, v70, v67
    v_mul_f32 v89, v70, v71
    v_mul_f32 v70, 0x42800000, v68
    v_mul_f32 v71, 0x42800000, v69
    v_exp_f32 v70, v70
    v_rndne_f32 v72, v71
    v_sub_f32 v71, v71, v72
    v_cos_f32 v72, v71
    s_branch Lp_8
Lp_7:
    v_fma_f32 v90, -v89, v79, v90
    v_fmac_f32 v91, v89, v78
    v_mul_f32 v92, v90, v78
    v_mul_f32 v93, v90, v79
    v_fma_f32 v92, -v91, v79, v92
    v_fmac_f32 v93, v91, v78
    v_mul_f32 v94, v92, v78
    v_mul_f32 v95, v92, v79
    v_fma_f32 v94, -v93, v79, v94
    v_fmac_f32 v95, v93, v78
    v_mul_f32 v96, v94, v78
    v_mul_f32 v97, v94, v79
    v_fma_f32 v96, -v95, v79, v96
    v_fmac_f32 v97, v95, v78
    v_mul_f32 v98, v96, v78
    v_mul_f32 v99, v96, v79
    v_fma_f32 v98, -v97, v79, v98
Lp_8:
    s_add_u32 s92, s84, 18432
    s_add_u32 m0, s80, 122880
    s_nop 0
    buffer_load_dwordx4 v40, s[40:43], s84 offen lds
    s_add_u32 m0, s80, 123904
    s_nop 0
    buffer_load_dwordx4 v41, s[40:43], s84 offen lds
    s_add_u32 m0, s80, 124928
    s_nop 0
    buffer_load_dwordx4 v40, s[40:43], s92 offen lds
    s_add_u32 m0, s80, 125952
    s_nop 0
    buffer_load_dwordx4 v41, s[40:43], s92 offen lds
    s_add_u32 m0, s81, 122880
    s_nop 0
    buffer_load_dwordx4 v42, s[44:47], s85 offen lds
    s_add_u32 m0, s81, 123904
    s_nop 0
    buffer_load_dwordx4 v43, s[44:47], s85 offen lds
    s_add_u32 m0, s81, 124928
    s_nop 0
    buffer_load_dwordx4 v44, s[44:47], s85 offen lds
    s_add_u32 m0, s81, 125952
    s_nop 0
    buffer_load_dwordx4 v45, s[44:47], s85 offen lds
    s_add_u32 m0, s81, 126976
    s_nop 0
    buffer_load_dwordx4 v46, s[44:47], s85 offen lds
    s_add_u32 m0, s81, 128000
    s_nop 0
    buffer_load_dwordx4 v47, s[44:47], s85 offen lds
    s_add_u32 s84, s84, 128
    s_add_u32 s85, s85, 221184
    s_cmp_eq_u32 s84, 1152
    s_cselect_b32 s84, 0, s84
    s_cselect_b32 s85, 0, s85
    s_waitcnt vmcnt(10)
    s_barrier
    s_bitcmp1_b32 s64, 0
    s_cbranch_scc1 Lp_9
    v_sin_f32 v71, v71
    v_mul_f32 v90, v70, v72
    v_mul_f32 v70, v70, v67
    v_mul_f32 v91, v70, v71
    v_max_f32 v70, |v64|, |v65|
    v_rcp_f32 v70, v70
    v_add_f32 v68, -1.0, v76
    v_mul_f32 v64, v64, v70
    v_mul_f32 v65, v65, v70
    v_mul_f32 v71, v64, v64
    v_fmac_f32 v71, v65, v65
    v_rcp_f32 v71, v71
    v_mul_f32 v72, v77, v67
    v_mul_f32 v70, v70, v71
    v_mul_f32 v70, -2.0, v70
    v_mul_f32 v66, v68, v64
    v_fmac_f32 v66, v72, v65
    v_mul_f32 v66, v66, v70
    v_mul_f32 v78, v66, v67
    v_mul_f32 v66, v72, v64
    v_fma_f32 v66, -v68, v65, v66
    v_mul_f32 v79, v66, v70
    s_branch Lp_10
Lp_9:
    v_fmac_f32 v99, v97, v78
    v_mul_f32 v100, v98, v78
    v_mul_f32 v101, v98, v79
    v_fma_f32 v100, -v99, v79, v100
    v_fmac_f32 v101, v99, v78
    v_mul_f32 v102, v100, v78
    v_mul_f32 v103, v100, v79
    v_fma_f32 v102, -v101, v79, v102
    v_fmac_f32 v103, v101, v78
    v_mul_f32 v104, v102, v78
    v_mul_f32 v105, v102, v79
    v_fma_f32 v104, -v103, v79, v104
    v_fmac_f32 v105, v103, v78
    v_mul_f32 v106, v104, v78
    v_mul_f32 v107, v104, v79
    v_fma_f32 v106, -v105, v79, v106
    v_fmac_f32 v107, v105, v78
Lp_10:
    s_add_u32 s92, s84, 18432
    s_add_u32 m0, s80, 0
    s_nop 0
    buffer_load_dwordx4 v40, s[40:43], s84 offen lds
    s_add_u32 m0, s80, 1024
    s_nop 0
    buffer_load_dwordx4 v41, s[40:43], s84 offen lds
    s_add_u32 m0, s80, 2048
    s_nop 0
    buffer_load_dwordx4 v40, s[40:43], s92 offen lds
    s_add_u32 m0, s80, 3072
    s_nop 0
    buffer_load_dwordx4 v41, s[40:43], s92 offen lds
    s_add_u32 m0, s81, 0
    s_nop 0
    buffer_load_dwordx4 v42, s[44:47], s85 offen lds
    s_add_u32 m0, s81, 1024
    s_nop 0
    buffer_load_dwordx4 v43, s[44:47], s85 offen lds
    s_add_u32 m0, s81, 2048
    s_nop 0
    buffer_load_dwordx4 v44, s[44:47], s85 offen lds
    s_add_u32 m0, s81, 3072
    s_nop 0
    buffer_load_dwordx4 v45, s[44:47], s85 offen lds
    s_add_u32 m0, s81, 4096
    s_nop 0
    buffer_load_dwordx4 v46, s[44:47], s85 offen lds
    s_add_u32 m0, s81, 5120
    s_nop 0
    buffer_load_dwordx4 v47, s[44:47], s85 offen lds
    s_add_u32 s84, s84, 128
    s_add_u32 s85, s85, 221184
    s_cmp_eq_u32 s84, 1152
    s_cselect_b32 s84, 0, s84
    s_cselect_b32 s85, 0, s85
    s_waitcnt vmcnt(10)
    s_barrier
    s_add_u32 s92, s82, 4608
    s_add_u32 m0, s80, 40960
    s_nop 0
    buffer_load_dwordx4 v48, s[56:59], s82 offen lds
    s_add_u32 m0, s80, 41984
    s_nop 0
    buffer_load_dwordx4 v49, s[56:59], s82 offen lds
    s_add_u32 m0, s80, 43008
    s_nop 0
    buffer_load_dwordx4 v48, s[56:59], s92 offen lds
    s_add_u32 m0, s80, 44032
    s_nop 0
    buffer_load_dwordx4 v49, s[56:59], s92 offen lds
    s_add_u32 m0, s83, 40960
    s_nop 0
    buffer_load_dwordx4 v50, s[48:51], s82 offen lds
    s_add_u32 s92, s82, 18432
    s_add_u32 m0, s83, 45056
    s_nop 0
    buffer_load_dwordx4 v50, s[48:51], s92 offen lds
    s_add_u32 s82, s82, 128
    s_cmp_eq_u32 s82, 1152
    s_cselect_b32 s82, 0, s82
    s_add_u32 s92, s82, 4608
    s_add_u32 m0, s80, 81920
    s_nop 0
    buffer_load_dwordx4 v48, s[56:59], s82 offen lds
    s_add_u32 m0, s80, 82944
    s_nop 0
    buffer_load_dwordx4 v49, s[56:59], s82 offen lds
    s_add_u32 m0, s80, 83968
    s_nop 0
    buffer_load_dwordx4 v48, s[56:59], s92 offen lds
    s_add_u32 m0, s80, 84992
    s_nop 0
    buffer_load_dwordx4 v49, s[56:59], s92 offen lds
    s_add_u32 m0, s83, 81920
    s_nop 0
    buffer_load_dwordx4 v50, s[48:51], s82 offen lds
    s_add_u32 s92, s82, 18432
    s_add_u32 m0, s83, 86016
    s_nop 0
    buffer_load_dwordx4 v50, s[48:51], s92 offen lds
    s_add_u32 s82, s82, 128
    s_cmp_eq_u32 s82, 1152
    s_cselect_b32 s82, 0, s82
    s_waitcnt vmcnt(12)
    s_barrier
    s_add_u32 s92, s82, 4608
    s_add_u32 m0, s80, 122880
    s_nop 0
    buffer_load_dwordx4 v48, s[56:59], s82 offen lds
    s_add_u32 m0, s80, 123904
    s_nop 0
    buffer_load_dwordx4 v49, s[56:59], s82 offen lds
    s_add_u32 m0, s80, 124928
    s_nop 0
    buffer_load_dwordx4 v48, s[56:59], s92 offen lds
    s_add_u32 m0, s80, 125952
    s_nop 0
    buffer_load_dwordx4 v49, s[56:59], s92 offen lds
    s_add_u32 m0, s83, 122880
    s_nop 0
    buffer_load_dwordx4 v50, s[48:51], s82 offen lds
    s_add_u32 s92, s82, 18432
    s_add_u32 m0, s83, 126976
    s_nop 0
    buffer_load_dwordx4 v50, s[48:51], s92 offen lds
    s_add_u32 s82, s82, 128
    s_cmp_eq_u32 s82, 1152
    s_cselect_b32 s82, 0, s82
    s_waitcnt vmcnt(12)
    s_barrier
    s_add_u32 s92, s82, 4608
    s_add_u32 m0, s80, 0
    s_nop 0
    buffer_load_dwordx4 v48, s[56:59], s82 offen lds
    s_add_u32 m0, s80, 1024
    s_nop 0
    buffer_load_dwordx4 v49, s[56:59], s82 offen lds
    s_add_u32 m0, s80, 2048
    s_nop 0
    buffer_load_dwordx4 v48, s[56:59], s92 offen lds
    s_add_u32 m0, s80, 3072
    s_nop 0
    buffer_load_dwordx4 v49, s[56:59], s92 offen lds
    s_add_u32 m0, s83, 0
    s_nop 0
    buffer_load_dwordx4 v50, s[48:51], s82 offen lds
    s_add_u32 s92, s82, 18432
    s_add_u32 m0, s83, 4096
    s_nop 0
    buffer_load_dwordx4 v50, s[48:51], s92 offen lds
    s_add_u32 s82, s82, 128
    s_cmp_eq_u32 s82, 1152
    s_cselect_b32 s82, 0, s82
    s_waitcnt vmcnt(12)
    s_barrier
    s_add_u32 s92, s82, 4608
    s_add_u32 m0, s80, 40960
    s_nop 0
    buffer_load_dwordx4 v48, s[56:59], s82 offen lds
    s_add_u32 m0, s80, 41984
    s_nop 0
    buffer_load_dwordx4 v49, s[56:59], s82 offen lds
    s_add_u32 m0, s80, 43008
    s_nop 0
    buffer_load_dwordx4 v48, s[56:59], s92 offen lds
    s_add_u32 m0, s80, 44032
    s_nop 0
    buffer_load_dwordx4 v49, s[56:59], s92 offen lds
    s_add_u32 m0, s83, 40960
    s_nop 0
    buffer_load_dwordx4 v50, s[48:51], s82 offen lds
    s_add_u32 s92, s82, 18432
    s_add_u32 m0, s83, 45056
    s_nop 0
    buffer_load_dwordx4 v50, s[48:51], s92 offen lds
    s_add_u32 s82, s82, 128
    s_cmp_eq_u32 s82, 1152
    s_cselect_b32 s82, 0, s82
    s_mov_b32 exec_lo, -1
    s_mov_b32 exec_hi, 0
    s_bitcmp1_b32 s64, 0
    s_cbranch_scc1 Lp_11
    s_mul_i32 s72, s3, 2048
    s_add_u32 s72, s72, 75776
    v_lshlrev_b32 v4, 10, v3
    v_lshl_add_u32 v4, v2, 4, v4
    v_add_u32 v4, s72, v4
    ds_write_b128 v4, v[76:79] offset:0
    ds_write_b128 v4, v[80:83] offset:256
    ds_write_b128 v4, v[84:87] offset:512
    ds_write_b128 v4, v[88:91] offset:768
    s_branch Lp_12
Lp_11:
    s_mul_i32 s72, s3, 4096
    s_add_u32 s72, s72, 151552
    v_lshl_add_u32 v4, v1, 3, s72
    ds_write_b64 v4, v[76:77] offset:0
    ds_write_b64 v4, v[78:79] offset:256
    ds_write_b64 v4, v[80:81] offset:512
    ds_write_b64 v4, v[82:83] offset:768
    ds_write_b64 v4, v[84:85] offset:1024
    ds_write_b64 v4, v[86:87] offset:1280
    ds_write_b64 v4, v[88:89] offset:1536
    ds_write_b64 v4, v[90:91] offset:1792
    ds_write_b64 v4, v[92:93] offset:2048
    ds_write_b64 v4, v[94:95] offset:2304
    ds_write_b64 v4, v[96:97] offset:2560
    ds_write_b64 v4, v[98:99] offset:2816
    ds_write_b64 v4, v[100:101] offset:3072
    ds_write_b64 v4, v[102:103] offset:3328
    ds_write_b64 v4, v[104:105] offset:3584
    ds_write_b64 v4, v[106:107] offset:3840
Lp_12:
    s_mov_b64 exec, -1
    s_waitcnt lgkmcnt(0)
    s_waitcnt vmcnt(12)
    s_barrier
    s_add_u32 s92, s82, 4608
    s_add_u32 m0, s80, 81920
    s_nop 0
    buffer_load_dwordx4 v48, s[56:59], s82 offen lds
    s_add_u32 m0, s80, 82944
    s_nop 0
    buffer_load_dwordx4 v49, s[56:59], s82 offen lds
    s_add_u32 m0, s80, 83968
    s_nop 0
    buffer_load_dwordx4 v48, s[56:59], s92 offen lds
    s_add_u32 m0, s80, 84992
    s_nop 0
    buffer_load_dwordx4 v49, s[56:59], s92 offen lds
    s_add_u32 m0, s83, 81920
    s_nop 0
    buffer_load_dwordx4 v50, s[48:51], s82 offen lds
    s_add_u32 s92, s82, 18432
    s_add_u32 m0, s83, 86016
    s_nop 0
    buffer_load_dwordx4 v50, s[48:51], s92 offen lds
    s_add_u32 s82, s82, 128
    s_cmp_eq_u32 s82, 1152
    s_cselect_b32 s82, 0, s82
    v_mov_b32 v253, 0
    buffer_load_dword v14, v253, s[60:63], 0 offen sc1
    s_waitcnt vmcnt(12)
    s_barrier
    s_add_u32 s92, s82, 4608
    s_add_u32 m0, s80, 122880
    s_nop 0
    buffer_load_dwordx4 v48, s[56:59], s82 offen lds
    s_add_u32 m0, s80, 123904
    s_nop 0
    buffer_load_dwordx4 v49, s[56:59], s82 offen lds
    s_add_u32 m0, s80, 124928
    s_nop 0
    buffer_load_dwordx4 v48, s[56:59], s92 offen lds
    s_add_u32 m0, s80, 125952
    s_nop 0
    buffer_load_dwordx4 v49, s[56:59], s92 offen lds
    s_add_u32 m0, s83, 122880
    s_nop 0
    buffer_load_dwordx4 v50, s[48:51], s82 offen lds
    s_add_u32 s92, s82, 18432
    s_add_u32 m0, s83, 126976
    s_nop 0
    buffer_load_dwordx4 v50, s[48:51], s92 offen lds
    s_add_u32 s82, s82, 128
    s_cmp_eq_u32 s82, 1152
    s_cselect_b32 s82, 0, s82
    ds_read_b128 v[196:199], v52 offset:0
    ds_read_b128 v[212:215], v52 offset:1024
    ds_read_b128 v[200:203], v52 offset:256
    ds_read_b128 v[216:219], v52 offset:1280
    ds_read_b128 v[204:207], v52 offset:512
    ds_read_b128 v[220:223], v52 offset:1536
    ds_read_b128 v[208:211], v52 offset:768
    ds_read_b128 v[224:227], v52 offset:1792
    ds_read_b64 v[244:245], v53 offset:0
    ds_read_b64 v[246:247], v53 offset:128
    s_waitcnt lgkmcnt(0)
    s_waitcnt vmcnt(12)
    s_barrier
    s_add_u32 s92, s82, 4608
    s_add_u32 m0, s80, 0
    s_nop 0
    buffer_load_dwordx4 v48, s[56:59], s82 offen lds
    s_add_u32 m0, s80, 1024
    s_nop 0
    buffer_load_dwordx4 v49, s[56:59], s82 offen lds
    s_add_u32 m0, s80, 2048
    s_nop 0
    buffer_load_dwordx4 v48, s[56:59], s92 offen lds
    s_add_u32 m0, s80, 3072
    s_nop 0
    buffer_load_dwordx4 v49, s[56:59], s92 offen lds
    s_add_u32 m0, s83, 0
    s_nop 0
    buffer_load_dwordx4 v50, s[48:51], s82 offen lds
    s_add_u32 s92, s82, 18432
    s_add_u32 m0, s83, 4096
    s_nop 0
    buffer_load_dwordx4 v50, s[48:51], s92 offen lds
    s_add_u32 s82, s82, 128
    s_cmp_eq_u32 s82, 1152
    s_cselect_b32 s82, 0, s82
    s_waitcnt vmcnt(12)
    s_barrier
    s_add_u32 s92, s82, 4608
    s_add_u32 m0, s80, 40960
    s_nop 0
    buffer_load_dwordx4 v48, s[56:59], s82 offen lds
    s_add_u32 m0, s80, 41984
    s_nop 0
    buffer_load_dwordx4 v49, s[56:59], s82 offen lds
    s_add_u32 m0, s80, 43008
    s_nop 0
    buffer_load_dwordx4 v48, s[56:59], s92 offen lds
    s_add_u32 m0, s80, 44032
    s_nop 0
    buffer_load_dwordx4 v49, s[56:59], s92 offen lds
    s_add_u32 m0, s83, 40960
    s_nop 0
    buffer_load_dwordx4 v50, s[48:51], s82 offen lds
    s_add_u32 s92, s82, 18432
    s_add_u32 m0, s83, 45056
    s_nop 0
    buffer_load_dwordx4 v50, s[48:51], s92 offen lds
    s_add_u32 s82, s82, 128
    s_cmp_eq_u32 s82, 1152
    s_cselect_b32 s82, 0, s82
    s_waitcnt vmcnt(18)
    v_readfirstlane_b32 s67, v14
    s_nop 1
    s_cmp_eq_u32 s67, 0
    s_cbranch_scc1 Ltslow_13
Ltok_14:
    s_waitcnt vmcnt(12)
    s_barrier
    s_waitcnt vmcnt(6)
    s_barrier
    s_waitcnt vmcnt(0)
    s_barrier
    buffer_load_dword v14, v15, s[52:55], 0 offen sc1
    s_barrier
    s_waitcnt vmcnt(0)
    v_cmp_ne_u32 vcc, s67, v14
    s_nop 4
    s_cbranch_vccnz Lslow_16
Lok_17:
    buffer_load_dwordx4 v[144:147], v19, s[52:55], s7 offen sc1
    buffer_load_dwordx4 v[148:151], v19, s[52:55], s7 offen offset:1280 sc1
    buffer_load_dword v152, v21, s[52:55], s7 offen sc1
    s_add_u32 s73, s6, s94
    s_add_u32 s73, s73, 0
    s_add_u32 m0, s94, 81920
    s_nop 0
    buffer_load_dwordx4 v19, s[52:55], s73 offen sc1 lds
    s_add_u32 s73, s73, 4096
    s_add_u32 m0, s94, 86016
    s_nop 0
    buffer_load_dwordx4 v19, s[52:55], s73 offen sc1 lds
    s_add_u32 s73, s73, 4096
    s_add_u32 m0, s94, 90112
    s_nop 0
    buffer_load_dwordx4 v19, s[52:55], s73 offen sc1 lds
    s_add_u32 s73, s73, 4096
    s_add_u32 m0, s94, 94208
    s_nop 0
    buffer_load_dwordx4 v19, s[52:55], s73 offen sc1 lds
    s_add_u32 s73, s73, 4096
    s_add_u32 m0, s94, 98304
    s_nop 0
    buffer_load_dwordx4 v19, s[52:55], s73 offen sc1 lds
    s_add_u32 s73, s73, 4096
    s_add_u32 m0, s94, 102400
    s_nop 0
    buffer_load_dwordx4 v19, s[52:55], s73 offen sc1 lds
    s_add_u32 s73, s73, 4096
    s_add_u32 m0, s94, 106496
    s_nop 0
    buffer_load_dwordx4 v19, s[52:55], s73 offen sc1 lds
    s_add_u32 s73, s73, 4096
    s_add_u32 m0, s94, 110592
    s_nop 0
    buffer_load_dwordx4 v19, s[52:55], s73 offen sc1 lds
    s_add_u32 s73, s73, 4096
    s_add_u32 m0, s94, 114688
    s_nop 0
    buffer_load_dwordx4 v19, s[52:55], s73 offen sc1 lds
    s_add_u32 s73, s73, 4096
    s_add_u32 m0, s94, 118784
    s_nop 0
    buffer_load_dwordx4 v19, s[52:55], s73 offen sc1 lds
    s_waitcnt vmcnt(10)
    s_mov_b32 s72, 0x3eae1a93
    s_mov_b32 s73, s72
    v_lshlrev_b32 v104, 16, v144
    v_and_b32 v105, 0xffff0000, v144
    v_lshlrev_b32 v106, 16, v145
    v_and_b32 v107, 0xffff0000, v145
    v_lshlrev_b32 v108, 16, v146
    v_and_b32 v109, 0xffff0000, v146
    v_lshlrev_b32 v110, 16, v147
    v_and_b32 v111, 0xffff0000, v147
    v_lshlrev_b32 v112, 16, v148
    v_and_b32 v113, 0xffff0000, v148
    v_lshlrev_b32 v114, 16, v149
    v_and_b32 v115, 0xffff0000, v149
    v_lshlrev_b32 v116, 16, v150
    v_and_b32 v117, 0xffff0000, v150
    v_lshlrev_b32 v118, 16, v151
    v_and_b32 v119, 0xffff0000, v151
    v_lshlrev_b32 v120, 16, v152
    v_and_b32 v121, 0xffff0000, v152
    v_pk_mul_f32 v[104:105], v[104:105], s[72:73]
    v_pk_mul_f32 v[106:107], v[106:107], s[72:73]
    v_pk_mul_f32 v[108:109], v[108:109], s[72:73]
    v_pk_mul_f32 v[110:111], v[110:111], s[72:73]
    v_pk_mul_f32 v[112:113], v[112:113], s[72:73]
    v_pk_mul_f32 v[114:115], v[114:115], s[72:73]
    v_pk_mul_f32 v[116:117], v[116:117], s[72:73]
    v_pk_mul_f32 v[118:119], v[118:119], s[72:73]
    v_pk_mul_f32 v[120:121], v[120:121], s[72:73]
    v_cvt_pk_bf16_f32 v144, v104, v105
    v_cvt_pk_bf16_f32 v145, v106, v107
    v_cvt_pk_bf16_f32 v146, v108, v109
    v_cvt_pk_bf16_f32 v147, v110, v111
    v_cvt_pk_bf16_f32 v148, v112, v113
    v_cvt_pk_bf16_f32 v149, v114, v115
    v_cvt_pk_bf16_f32 v150, v116, v117
    v_cvt_pk_bf16_f32 v151, v118, v119
    v_cvt_pk_bf16_f32 v152, v120, v121
    s_waitcnt vmcnt(0)
    s_branch L_front_done
L_compute:
    s_waitcnt lgkmcnt(0)
    s_mov_b32 s67, 0
    s_mov_b32 s68, 0
    s_and_b32 s72, s64, 1
    s_lshl_b32 s72, s72, 1
    s_add_u32 s71, s72, s70
    s_bfe_u32 s3, s64, 0x10001
    s_and_b32 s72, s65, 3
    s_lshl_b32 s72, s72, 2
    s_and_b32 s73, s66, 3
    s_add_u32 s38, s72, s73
    s_lshl_b32 s73, s73, 3
    s_add_u32 s4, s73, s65
    s_lshr_b32 s5, s66, 2
    s_mul_i32 s6, s4, 163968
    s_mul_i32 s7, s4, 82048
    s_lshl_b32 s72, s5, 3
    s_lshl_b32 s73, s69, 1
    s_add_u32 s72, s72, s73
    s_mul_i32 s72, s72, 1280
    s_add_u32 s7, s7, s72
    s_add_u32 s7, s7, 5246976
    s_lshr_b32 s72, s65, 2
    s_mul_i32 s72, s72, 6
    s_add_u32 s39, s72, s5
    s_lshl_b32 s97, s39, 5
    s_mov_b32 s52, s36
    s_mov_b32 s53, s37
    s_mov_b32 s54, 268435456
    s_mov_b32 s55, 0x20000
    s_mov_b32 s60, s34
    s_mov_b32 s61, s35
    s_mov_b32 s62, 256
    s_mov_b32 s63, 0x20000
    v_lshrrev_b32 v4, 1, v2
    v_xor_b32 v4, v4, v3
    v_lshlrev_b32 v4, 4, v4
    v_lshl_add_u32 v4, v2, 7, v4
    s_and_b32 s72, s64, 1
    s_lshl_b32 s72, s72, 13
    v_add_u32 v196, s72, v4
    v_xor_b32 v197, 64, v196
    v_add_u32 v198, 81920, v196
    v_add_u32 v199, 81920, v197
    s_mul_i32 s72, s3, 4096
    s_add_u32 s72, s72, 16384
    v_add_u32 v210, s72, v4
    v_xor_b32 v211, 64, v210
    v_add_u32 v212, 81920, v210
    v_add_u32 v213, 81920, v211
    v_bfe_u32 v4, v1, 2, 2
    v_lshl_add_u32 v5, v3, 3, v4
    v_mul_u32_u24 v5, 384, v5
    v_add_u32 v5, 16384, v5
    v_lshrrev_b32 v4, 1, v4
    v_and_b32 v6, 1, v3
    v_lshl_add_u32 v6, v6, 1, v4
    v_bfe_u32 v7, v1, 1, 1
    v_lshlrev_b32 v7, 6, v7
    v_and_b32 v8, 1, v1
    v_lshl_add_u32 v7, v8, 3, v7
    s_lshl_b32 s72, s3, 7
    v_add3_u32 v7, v7, v5, s72
    v_xor_b32 v8, 0, v6
    v_lshl_add_u32 v200, v8, 4, v7
    v_xor_b32 v8, 1, v6
    v_lshl_add_u32 v201, v8, 4, v7
    v_xor_b32 v8, 2, v6
    v_lshl_add_u32 v202, v8, 4, v7
    v_xor_b32 v8, 3, v6
    v_lshl_add_u32 v203, v8, 4, v7
    v_and_b32 v7, 3, v1
    s_lshl_b32 s72, s3, 2
    v_or_b32 v7, s72, v7
    v_lshlrev_b32 v4, 2, v4
    v_xor_b32 v7, v7, v4
    v_lshl_add_u32 v7, v7, 4, v5
    v_add_u32 v204, 264, v7
    v_add_u32 v205, 81920, v200
    v_add_u32 v206, 81920, v201
    v_add_u32 v207, 81920, v202
    v_add_u32 v208, 81920, v203
    v_add_u32 v209, 81920, v204
    s_mul_i32 s72, s70, 20480
    s_add_u32 s72, s72, 81920
    v_lshlrev_b32 v19, 4, v1
    v_add_u32 v16, s72, v19
    v_and_b32 v4, 31, v1
    v_and_b32 v7, 7, v1
    v_bfe_u32 v5, v1, 3, 1
    v_lshl_add_u32 v7, v5, 4, v7
    v_bfe_u32 v5, v1, 4, 1
    v_lshl_add_u32 v7, v5, 3, v7
    v_lshlrev_b32 v7, 3, v7
    v_add_u32 v7, 1024, v7
    v_add_u32 v17, s72, v7
    v_lshrrev_b32 v5, 5, v1
    v_mul_u32_u24 v6, 1280, v5
    v_add_u32 v21, v7, v6
    v_min_u32 v4, 19, v4
    v_lshlrev_b32 v4, 4, v4
    v_cmp_gt_u32 vcc, 0x100, v4
    v_lshl_add_u32 v6, v5, 8, v4
    v_lshl_add_u32 v4, v5, 6, v4
    v_add_u32 v4, 768, v4
    v_cndmask_b32 v4, v4, v6, vcc
    s_add_u32 s72, s72, 1280
    v_add_u32 v18, s72, v4
    v_mov_b32 v4, 128
    v_mov_b32 v5, 512
    v_cndmask_b32 v4, v4, v5, vcc
    v_add_u32 v20, v18, v4
    s_lshl_b32 s72, s91, 3
    s_lshl_b32 s73, s3, 2
    s_add_u32 s72, s72, s73
    s_lshl_b32 s73, s89, 1
    s_and_b32 s81, s64, 1
    s_add_u32 s73, s73, s81
    s_lshl_b32 s73, s73, 1
    s_cmp_eq_u32 s90, 0
    s_mov_b32 s88, 163968
    s_mov_b32 s81, 2560
    s_cselect_b32 s88, 82048, s88
    s_cselect_b32 s81, 1280, s81
    s_cselect_b32 s82, 5246976, 0
    s_cselect_b32 s80, 1, 15
    s_cselect_b32 s83, 3, s90
    s_mul_i32 s72, s72, s88
    s_mul_i32 s73, s73, s81
    s_add_u32 s84, s72, s73
    s_add_u32 s84, s84, s82
    s_add_u32 s85, s84, s88
    s_add_u32 s86, s84, s81
    s_add_u32 s87, s85, s81
    s_and_b32 s80, s80, s89
    s_lshl_b32 s72, s83, 4
    s_add_u32 s80, s80, s72
    s_lshl_b32 s80, s80, 2
    s_lshl_b32 s72, s91, 11
    s_add_u32 s80, s80, s72
    s_add_u32 s80, s80, 15085504
    v_lshrrev_b32 v4, 1, v3
    v_mul_lo_u32 v4, v4, s88
    v_lshlrev_b32 v4, 1, v4
    v_and_b32 v5, 1, v3
    v_lshl_add_u32 v4, v5, 9, v4
    v_lshrrev_b32 v5, 3, v2
    v_and_b32 v6, 7, v2
    v_lshl_add_u32 v5, v5, 4, v6
    v_lshl_add_u32 v214, v5, 4, v4
    v_mul_lo_u32 v4, v3, s88
    v_lshl_add_u32 v4, v2, 3, v4
    v_add_u32 v215, 1024, v4
    s_cmp_lg_u32 s90, 2
    s_cbranch_scc1 L_qk_addr
    v_lshrrev_b32 v4, 3, v2
    v_mul_u32_u24 v4, 327936, v4
    v_lshlrev_b32 v5, 8, v3
    v_add_u32 v5, 1280, v5
    v_lshlrev_b32 v6, 4, v6
    v_add3_u32 v214, v4, v5, v6
    v_lshrrev_b32 v4, 2, v2
    v_mul_u32_u24 v4, 163968, v4
    v_and_b32 v6, 3, v2
    v_xor_b32 v7, 2, v6
    v_lshlrev_b32 v7, 4, v7
    v_lshl_add_u32 v7, v3, 6, v7
    v_add_u32 v7, 2304, v7
    v_add_u32 v215, v4, v7
    v_cmp_gt_u32 s[82:83], 2, v6
    v_cmp_eq_u32 vcc, 0, v6
    v_mov_b32 v37, 0x3f803f80
    s_nop 0
    v_cndmask_b32 v37, 0, v37, vcc
L_qk_addr:
    s_and_b32 s72, s65, 3
    s_lshl_b32 s72, s72, 2
    s_and_b32 s73, s66, 3
    s_add_u32 s74, s72, s73
    s_lshr_b32 s72, s65, 2
    s_lshl_b32 s72, s72, 2
    s_bfe_u32 s73, s66, 0x20002
    s_add_u32 s75, s72, s73
    s_lshl_b32 s72, s5, 1
    s_lshr_b32 s73, s69, 1
    s_add_u32 s72, s72, s73
    s_and_b32 s73, s72, 3
    s_lshl_b32 s73, s73, 3
    s_lshr_b32 s72, s72, 2
    s_add_u32 s72, s72, s73
    s_lshl_b32 s79, s72, 1
    s_and_b32 s73, s69, 1
    s_add_u32 s79, s79, s73
    s_lshl_b32 s79, s79, 5
    s_add_u32 s79, s79, s4
    s_lshl_b32 s79, s79, 1
    s_add_u32 s79, s79, s70
    s_lshl_b32 s79, s79, 2
    s_add_u32 s79, s79, 15380480
    v_bfe_u32 v4, v1, 2, 2
    v_lshl_add_u32 v5, v3, 3, v4
    v_lshlrev_b32 v5, 4, v5
    v_bfe_u32 v6, v1, 1, 1
    v_mul_u32_u24 v6, 1088, v6
    v_and_b32 v7, 1, v1
    v_lshl_add_u32 v6, v7, 3, v6
    s_lshl_b32 s72, s69, 12
    v_add3_u32 v254, v5, v6, s72
    v_lshlrev_b32 v4, 1, v4
    v_lshl_add_u32 v4, v3, 3, v4
    v_mul_u32_u24 v4, 144, v4
    v_and_b32 v5, 3, v1
    v_lshl_add_u32 v251, v5, 3, v4
    s_lshl_b32 s72, s69, 7
    v_lshlrev_b32 v4, 11, v3
    v_lshl_add_u32 v4, v2, 2, v4
    v_add_u32 v252, s72, v4
    v_lshrrev_b32 v250, 1, v2
    v_xor_b32 v250, v250, v3
    v_lshlrev_b32 v250, 4, v250
    v_lshl_add_u32 v250, v2, 7, v250
    v_mov_b32 v22, 0
    v_mov_b32 v23, 0
    v_mov_b32 v24, 0
    v_mov_b32 v25, 0
    v_mov_b32 v26, 0
    v_mov_b32 v27, 0
    v_mov_b32 v28, 0
    v_mov_b32 v29, 0
    v_mov_b32 v30, 0
    v_mov_b32 v31, 0
    s_cmp_ge_u32 s66, 16
    s_cbranch_scc1 Lta_19
    v_and_b32 v4, 7, v1
    v_lshrrev_b32 v6, 3, v1
    s_lshl_b32 s72, s69, 4
    v_add_u32 v7, s72, v6
    s_mul_i32 s72, s69, 36864
    v_lshl_add_u32 v22, v1, 4, s72
    v_xor_b32 v4, v4, v3
    s_mul_i32 s73, s75, 72
    v_add_u32 v23, s73, v7
    v_mul_u32_u24 v23, 1152, v23
    v_lshl_add_u32 v23, v4, 4, v23
    s_add_u32 s73, s73, 64
    v_add_u32 v24, s73, v6
    v_mul_u32_u24 v24, 1152, v24
    v_lshl_add_u32 v24, v4, 4, v24
    s_branch Lta_20
Lta_19:
    s_cmp_lt_u32 s64, 4
    s_cbranch_scc1 Lta_20
    v_lshrrev_b32 v4, 5, v1
    v_and_b32 v5, 31, v1
    v_lshlrev_b32 v5, 4, v5
    s_lshl_b32 s72, s69, 16
    s_lshl_b32 s73, s74, 12
    s_add_u32 s73, s72, s73
    v_lshl_add_u32 v6, v4, 10, v5
    v_add_u32 v25, s73, v6
    s_lshl_b32 s73, s74, 9
    s_add_u32 s72, s72, s73
    s_add_u32 s72, s72, 14692352
    v_lshl_add_u32 v4, v4, 13, v5
    v_add_u32 v26, s72, v4
    s_lshl_b32 s72, s69, 7
    s_add_u32 s72, s72, 0
    v_add_u32 v4, s72, v1
    v_mul_u32_u24 v5, 7282, v4
    v_lshrrev_b32 v5, 16, v5
    v_mul_u32_u24 v6, 9, v5
    v_sub_u32 v4, v4, v6
    s_mul_i32 s73, s75, 144
    v_lshl_add_u32 v4, v4, 4, s73
    v_and_b32 v6, 1, v5
    v_bfe_u32 v7, v5, 1, 2
    v_lshl_add_u32 v7, v6, 3, v7
    v_bfe_u32 v8, v5, 3, 1
    v_lshl_add_u32 v7, v8, 2, v7
    v_lshrrev_b32 v8, 4, v5
    v_mul_u32_u24 v8, 18, v8
    v_add_u32 v7, v7, v8
    v_mul_u32_u24 v7, 1152, v7
    v_add_u32 v27, v7, v4
    v_lshrrev_b32 v7, 3, v5
    v_lshlrev_b32 v7, 2, v7
    v_lshl_add_u32 v7, v6, 1, v7
    v_bfe_u32 v6, v5, 2, 1
    v_add_u32 v7, v7, v6
    v_mul_u32_u24 v7, 18, v7
    v_bfe_u32 v6, v5, 1, 1
    v_add3_u32 v7, v7, v6, 16
    v_mul_u32_u24 v7, 1152, v7
    v_add_u32 v30, v7, v4
    s_lshl_b32 s72, s69, 7
    s_add_u32 s72, s72, 64
    v_add_u32 v4, s72, v1
    v_mul_u32_u24 v5, 7282, v4
    v_lshrrev_b32 v5, 16, v5
    v_mul_u32_u24 v6, 9, v5
    v_sub_u32 v4, v4, v6
    s_mul_i32 s73, s75, 144
    v_lshl_add_u32 v4, v4, 4, s73
    v_and_b32 v6, 1, v5
    v_bfe_u32 v7, v5, 1, 2
    v_lshl_add_u32 v7, v6, 3, v7
    v_bfe_u32 v8, v5, 3, 1
    v_lshl_add_u32 v7, v8, 2, v7
    v_lshrrev_b32 v8, 4, v5
    v_mul_u32_u24 v8, 18, v8
    v_add_u32 v7, v7, v8
    v_mul_u32_u24 v7, 1152, v7
    v_add_u32 v28, v7, v4
    v_lshrrev_b32 v7, 3, v5
    v_lshlrev_b32 v7, 2, v7
    v_lshl_add_u32 v7, v6, 1, v7
    v_bfe_u32 v6, v5, 2, 1
    v_add_u32 v7, v7, v6
    v_mul_u32_u24 v7, 18, v7
    v_bfe_u32 v6, v5, 1, 1
    v_add3_u32 v7, v7, v6, 16
    v_mul_u32_u24 v7, 1152, v7
    v_add_u32 v31, v7, v4
    v_add_u32 v4, 512, v1
    v_mul_u32_u24 v5, 7282, v4
    v_lshrrev_b32 v5, 16, v5
    v_mul_u32_u24 v6, 9, v5
    v_sub_u32 v4, v4, v6
    s_mul_i32 s73, s75, 144
    v_lshl_add_u32 v4, v4, 4, s73
    v_and_b32 v6, 1, v5
    v_bfe_u32 v7, v5, 1, 2
    v_lshl_add_u32 v7, v6, 3, v7
    v_bfe_u32 v8, v5, 3, 1
    v_lshl_add_u32 v7, v8, 2, v7
    v_lshrrev_b32 v8, 4, v5
    v_mul_u32_u24 v8, 18, v8
    v_add_u32 v7, v7, v8
    v_mul_u32_u24 v7, 1152, v7
    v_add_u32 v29, v7, v4
    v_lshrrev_b32 v7, 3, v5
    v_lshlrev_b32 v7, 2, v7
    v_lshl_add_u32 v7, v6, 1, v7
    v_bfe_u32 v6, v5, 2, 1
    v_add_u32 v7, v7, v6
    v_mul_u32_u24 v7, 18, v7
    v_bfe_u32 v6, v5, 1, 1
    v_add3_u32 v7, v7, v6, 16
    v_mul_u32_u24 v7, 1152, v7
    v_add_u32 v0, v7, v4
Lta_20:
    s_cmp_lg_u32 s64, 1
    s_cbranch_scc1 L_tf0
    s_lshl_b32 s72, s2, 9
    v_and_b32 v4, 3, v1
    v_lshlrev_b32 v4, 7, v4
    v_add_u32 v5, s72, v4
    v_add_u32 v4, 15183872, v5
    buffer_load_dword v253, v4, s[52:55], 0 offen sc1
    v_add_u32 v4, 15314944, v5
    buffer_load_dword v249, v4, s[52:55], 0 offen sc1
    s_lshl_b32 s72, s2, 8
    s_add_u32 s72, s72, 15085568
    v_and_b32 v4, 1, v1
    v_lshlrev_b32 v4, 7, v4
    buffer_load_dword v248, v4, s[52:55], s72 offen sc1
    s_lshl_b32 s72, s2, 7
    s_add_u32 s72, s72, 15151104
    v_mov_b32 v4, 0
    buffer_load_dword v247, v4, s[52:55], s72 offen sc1
L_tf0:
    s_mul_i32 s72, s3, 2048
    s_add_u32 s72, s72, 75776
    v_lshl_add_u32 v32, v2, 4, s72
    s_lshl_b32 s72, s3, 2
    s_add_u32 s72, s72, s71
    s_mul_i32 s72, s72, 1024
    s_add_u32 s72, s72, 151552
    v_mul_u32_u24 v33, 256, v3
    v_lshl_add_u32 v33, v2, 3, v33
    v_add_u32 v33, s72, v33
    s_mul_i32 s72, s3, 2560
    v_mul_u32_u24 v35, 80, v2
    v_add_u32 v35, s72, v35
    s_lshl_b32 s73, s71, 4
    v_lshl_add_u32 v36, v3, 2, v35
    v_add_u32 v36, s73, v36
    s_mul_i32 s72, s69, 4096
    v_add_u32 v34, s72, v19
    s_waitcnt lgkmcnt(0)
    s_barrier
    ds_read_b128 v[120:123], v196 offset:0
    ds_read_b64_tr_b16 v[152:153], v200 offset:0
    ds_read_b64_tr_b16 v[154:155], v200 offset:1536
    ds_read_b128 v[124:127], v196 offset:2048
    ds_read_b128 v[128:131], v196 offset:4096
    ds_read_b128 v[132:135], v196 offset:6144
    ds_read_b64_tr_b16 v[156:157], v201 offset:0
    ds_read_b64_tr_b16 v[158:159], v201 offset:1536
    ds_read_b64_tr_b16 v[160:161], v202 offset:0
    ds_read_b64_tr_b16 v[162:163], v202 offset:1536
    ds_read_b64_tr_b16 v[164:165], v203 offset:0
    ds_read_b64_tr_b16 v[166:167], v203 offset:1536
    ds_read_b64_tr_b16 v[168:169], v204 offset:0
    ds_read_b64_tr_b16 v[170:171], v204 offset:1536
    s_cmp_eq_u32 s90, 2
    s_cbranch_scc1 L_a1_v
    s_waitcnt lgkmcnt(11)
    v_mfma_f32_16x16x32_bf16 v[40:43], v[152:155], v[120:123], 0
    ds_read_b128 v[136:139], v197 offset:0
    s_waitcnt lgkmcnt(11)
    v_mfma_f32_16x16x32_bf16 v[60:63], v[152:155], v[124:127], 0
    ds_read_b64_tr_b16 v[172:173], v200 offset:12288
    s_waitcnt lgkmcnt(11)
    v_mfma_f32_16x16x32_bf16 v[80:83], v[152:155], v[128:131], 0
    ds_read_b64_tr_b16 v[174:175], v200 offset:13824
    s_waitcnt lgkmcnt(11)
    v_mfma_f32_16x16x32_bf16 v[100:103], v[152:155], v[132:135], 0
    s_waitcnt lgkmcnt(9)
    v_mfma_f32_16x16x32_bf16 v[44:47], v[156:159], v[120:123], 0
    ds_read_b128 v[140:143], v197 offset:2048
    v_mfma_f32_16x16x32_bf16 v[64:67], v[156:159], v[124:127], 0
    ds_read_b128 v[144:147], v197 offset:4096
    v_mfma_f32_16x16x32_bf16 v[84:87], v[156:159], v[128:131], 0
    v_mfma_f32_16x16x32_bf16 v[104:107], v[156:159], v[132:135], 0
    ds_read_b128 v[148:151], v197 offset:6144
    s_waitcnt lgkmcnt(10)
    v_mfma_f32_16x16x32_bf16 v[48:51], v[160:163], v[120:123], 0
    ds_read_b64_tr_b16 v[176:177], v201 offset:12288
    v_mfma_f32_16x16x32_bf16 v[68:71], v[160:163], v[124:127], 0
    v_mfma_f32_16x16x32_bf16 v[88:91], v[160:163], v[128:131], 0
    ds_read_b64_tr_b16 v[178:179], v201 offset:13824
    v_mfma_f32_16x16x32_bf16 v[108:111], v[160:163], v[132:135], 0
    ds_read_b64_tr_b16 v[180:181], v202 offset:12288
    s_waitcnt lgkmcnt(11)
    v_mfma_f32_16x16x32_bf16 v[52:55], v[164:167], v[120:123], 0
    ds_read_b64_tr_b16 v[182:183], v202 offset:13824
    v_mfma_f32_16x16x32_bf16 v[72:75], v[164:167], v[124:127], 0
    v_mfma_f32_16x16x32_bf16 v[92:95], v[164:167], v[128:131], 0
    ds_read_b64_tr_b16 v[184:185], v203 offset:12288
    v_mfma_f32_16x16x32_bf16 v[112:115], v[164:167], v[132:135], 0
    ds_read_b64_tr_b16 v[186:187], v203 offset:13824
    s_waitcnt lgkmcnt(12)
    v_mfma_f32_16x16x32_bf16 v[56:59], v[168:171], v[120:123], 0
    v_mfma_f32_16x16x32_bf16 v[76:79], v[168:171], v[124:127], 0
    ds_read_b64_tr_b16 v[188:189], v204 offset:12288
    v_mfma_f32_16x16x32_bf16 v[96:99], v[168:171], v[128:131], 0
    ds_read_b64_tr_b16 v[190:191], v204 offset:13824
    v_mfma_f32_16x16x32_bf16 v[116:119], v[168:171], v[132:135], 0
    s_waitcnt lgkmcnt(0)
    s_barrier
    v_mfma_f32_16x16x32_bf16 v[40:43], v[172:175], v[136:139], v[40:43]
    ds_read_b128 v[120:123], v196 offset:40960
    v_mfma_f32_16x16x32_bf16 v[60:63], v[172:175], v[140:143], v[60:63]
    ds_read_b64_tr_b16 v[152:153], v200 offset:40960
    v_mfma_f32_16x16x32_bf16 v[80:83], v[172:175], v[144:147], v[80:83]
    ds_read_b64_tr_b16 v[154:155], v200 offset:42496
    v_mfma_f32_16x16x32_bf16 v[100:103], v[172:175], v[148:151], v[100:103]
    v_mfma_f32_16x16x32_bf16 v[44:47], v[176:179], v[136:139], v[44:47]
    ds_read_b128 v[124:127], v196 offset:43008
    v_mfma_f32_16x16x32_bf16 v[64:67], v[176:179], v[140:143], v[64:67]
    ds_read_b128 v[128:131], v196 offset:45056
    v_mfma_f32_16x16x32_bf16 v[84:87], v[176:179], v[144:147], v[84:87]
    v_mfma_f32_16x16x32_bf16 v[104:107], v[176:179], v[148:151], v[104:107]
    ds_read_b128 v[132:135], v196 offset:47104
    v_mfma_f32_16x16x32_bf16 v[48:51], v[180:183], v[136:139], v[48:51]
    ds_read_b64_tr_b16 v[156:157], v201 offset:40960
    v_mfma_f32_16x16x32_bf16 v[68:71], v[180:183], v[140:143], v[68:71]
    v_mfma_f32_16x16x32_bf16 v[88:91], v[180:183], v[144:147], v[88:91]
    ds_read_b64_tr_b16 v[158:159], v201 offset:42496
    v_mfma_f32_16x16x32_bf16 v[108:111], v[180:183], v[148:151], v[108:111]
    ds_read_b64_tr_b16 v[160:161], v202 offset:40960
    v_mfma_f32_16x16x32_bf16 v[52:55], v[184:187], v[136:139], v[52:55]
    ds_read_b64_tr_b16 v[162:163], v202 offset:42496
    v_mfma_f32_16x16x32_bf16 v[72:75], v[184:187], v[140:143], v[72:75]
    v_mfma_f32_16x16x32_bf16 v[92:95], v[184:187], v[144:147], v[92:95]
    ds_read_b64_tr_b16 v[164:165], v203 offset:40960
    v_mfma_f32_16x16x32_bf16 v[112:115], v[184:187], v[148:151], v[112:115]
    ds_read_b64_tr_b16 v[166:167], v203 offset:42496
    v_mfma_f32_16x16x32_bf16 v[56:59], v[188:191], v[136:139], v[56:59]
    v_mfma_f32_16x16x32_bf16 v[76:79], v[188:191], v[140:143], v[76:79]
    ds_read_b64_tr_b16 v[168:169], v204 offset:40960
    v_mfma_f32_16x16x32_bf16 v[96:99], v[188:191], v[144:147], v[96:99]
    ds_read_b64_tr_b16 v[170:171], v204 offset:42496
    v_mfma_f32_16x16x32_bf16 v[116:119], v[188:191], v[148:151], v[116:119]
    s_waitcnt lgkmcnt(11)
    v_mfma_f32_16x16x32_bf16 v[40:43], v[152:155], v[120:123], v[40:43]
    ds_read_b128 v[136:139], v197 offset:40960
    s_waitcnt lgkmcnt(11)
    v_mfma_f32_16x16x32_bf16 v[60:63], v[152:155], v[124:127], v[60:63]
    ds_read_b64_tr_b16 v[172:173], v200 offset:53248
    s_waitcnt lgkmcnt(11)
    v_mfma_f32_16x16x32_bf16 v[80:83], v[152:155], v[128:131], v[80:83]
    ds_read_b64_tr_b16 v[174:175], v200 offset:54784
    s_waitcnt lgkmcnt(11)
    v_mfma_f32_16x16x32_bf16 v[100:103], v[152:155], v[132:135], v[100:103]
    s_waitcnt lgkmcnt(9)
    v_mfma_f32_16x16x32_bf16 v[44:47], v[156:159], v[120:123], v[44:47]
    ds_read_b128 v[140:143], v197 offset:43008
    v_mfma_f32_16x16x32_bf16 v[64:67], v[156:159], v[124:127], v[64:67]
    ds_read_b128 v[144:147], v197 offset:45056
    v_mfma_f32_16x16x32_bf16 v[84:87], v[156:159], v[128:131], v[84:87]
    v_mfma_f32_16x16x32_bf16 v[104:107], v[156:159], v[132:135], v[104:107]
    ds_read_b128 v[148:151], v197 offset:47104
    s_waitcnt lgkmcnt(10)
    v_mfma_f32_16x16x32_bf16 v[48:51], v[160:163], v[120:123], v[48:51]
    ds_read_b64_tr_b16 v[176:177], v201 offset:53248
    v_mfma_f32_16x16x32_bf16 v[68:71], v[160:163], v[124:127], v[68:71]
    v_mfma_f32_16x16x32_bf16 v[88:91], v[160:163], v[128:131], v[88:91]
    ds_read_b64_tr_b16 v[178:179], v201 offset:54784
    v_mfma_f32_16x16x32_bf16 v[108:111], v[160:163], v[132:135], v[108:111]
    ds_read_b64_tr_b16 v[180:181], v202 offset:53248
    s_waitcnt lgkmcnt(11)
    v_mfma_f32_16x16x32_bf16 v[52:55], v[164:167], v[120:123], v[52:55]
    ds_read_b64_tr_b16 v[182:183], v202 offset:54784
    v_mfma_f32_16x16x32_bf16 v[72:75], v[164:167], v[124:127], v[72:75]
    v_mfma_f32_16x16x32_bf16 v[92:95], v[164:167], v[128:131], v[92:95]
    ds_read_b64_tr_b16 v[184:185], v203 offset:53248
    v_mfma_f32_16x16x32_bf16 v[112:115], v[164:167], v[132:135], v[112:115]
    ds_read_b64_tr_b16 v[186:187], v203 offset:54784
    s_waitcnt lgkmcnt(12)
    v_mfma_f32_16x16x32_bf16 v[56:59], v[168:171], v[120:123], v[56:59]
    v_mfma_f32_16x16x32_bf16 v[76:79], v[168:171], v[124:127], v[76:79]
    ds_read_b64_tr_b16 v[188:189], v204 offset:53248
    v_mfma_f32_16x16x32_bf16 v[96:99], v[168:171], v[128:131], v[96:99]
    ds_read_b64_tr_b16 v[190:191], v204 offset:54784
    v_mfma_f32_16x16x32_bf16 v[116:119], v[168:171], v[132:135], v[116:119]
    s_waitcnt lgkmcnt(0)
    s_barrier
    v_mfma_f32_16x16x32_bf16 v[40:43], v[172:175], v[136:139], v[40:43]
    ds_read_b128 v[120:123], v198 offset:0
    v_mfma_f32_16x16x32_bf16 v[60:63], v[172:175], v[140:143], v[60:63]
    ds_read_b64_tr_b16 v[152:153], v205 offset:0
    v_mfma_f32_16x16x32_bf16 v[80:83], v[172:175], v[144:147], v[80:83]
    ds_read_b64_tr_b16 v[154:155], v205 offset:1536
    v_mfma_f32_16x16x32_bf16 v[100:103], v[172:175], v[148:151], v[100:103]
    v_mfma_f32_16x16x32_bf16 v[44:47], v[176:179], v[136:139], v[44:47]
    ds_read_b128 v[124:127], v198 offset:2048
    v_mfma_f32_16x16x32_bf16 v[64:67], v[176:179], v[140:143], v[64:67]
    ds_read_b128 v[128:131], v198 offset:4096
    v_mfma_f32_16x16x32_bf16 v[84:87], v[176:179], v[144:147], v[84:87]
    v_mfma_f32_16x16x32_bf16 v[104:107], v[176:179], v[148:151], v[104:107]
    ds_read_b128 v[132:135], v198 offset:6144
    v_mfma_f32_16x16x32_bf16 v[48:51], v[180:183], v[136:139], v[48:51]
    ds_read_b64_tr_b16 v[156:157], v206 offset:0
    v_mfma_f32_16x16x32_bf16 v[68:71], v[180:183], v[140:143], v[68:71]
    v_mfma_f32_16x16x32_bf16 v[88:91], v[180:183], v[144:147], v[88:91]
    ds_read_b64_tr_b16 v[158:159], v206 offset:1536
    v_mfma_f32_16x16x32_bf16 v[108:111], v[180:183], v[148:151], v[108:111]
    ds_read_b64_tr_b16 v[160:161], v207 offset:0
    v_mfma_f32_16x16x32_bf16 v[52:55], v[184:187], v[136:139], v[52:55]
    ds_read_b64_tr_b16 v[162:163], v207 offset:1536
    v_mfma_f32_16x16x32_bf16 v[72:75], v[184:187], v[140:143], v[72:75]
    v_mfma_f32_16x16x32_bf16 v[92:95], v[184:187], v[144:147], v[92:95]
    ds_read_b64_tr_b16 v[164:165], v208 offset:0
    v_mfma_f32_16x16x32_bf16 v[112:115], v[184:187], v[148:151], v[112:115]
    ds_read_b64_tr_b16 v[166:167], v208 offset:1536
    v_mfma_f32_16x16x32_bf16 v[56:59], v[188:191], v[136:139], v[56:59]
    v_mfma_f32_16x16x32_bf16 v[76:79], v[188:191], v[140:143], v[76:79]
    ds_read_b64_tr_b16 v[168:169], v209 offset:0
    v_mfma_f32_16x16x32_bf16 v[96:99], v[188:191], v[144:147], v[96:99]
    ds_read_b64_tr_b16 v[170:171], v209 offset:1536
    v_mfma_f32_16x16x32_bf16 v[116:119], v[188:191], v[148:151], v[116:119]
    s_waitcnt lgkmcnt(11)
    v_mfma_f32_16x16x32_bf16 v[40:43], v[152:155], v[120:123], v[40:43]
    ds_read_b128 v[136:139], v199 offset:0
    s_waitcnt lgkmcnt(11)
    v_mfma_f32_16x16x32_bf16 v[60:63], v[152:155], v[124:127], v[60:63]
    ds_read_b64_tr_b16 v[172:173], v205 offset:12288
    s_waitcnt lgkmcnt(11)
    v_mfma_f32_16x16x32_bf16 v[80:83], v[152:155], v[128:131], v[80:83]
    ds_read_b64_tr_b16 v[174:175], v205 offset:13824
    s_waitcnt lgkmcnt(11)
    v_mfma_f32_16x16x32_bf16 v[100:103], v[152:155], v[132:135], v[100:103]
    s_waitcnt lgkmcnt(9)
    v_mfma_f32_16x16x32_bf16 v[44:47], v[156:159], v[120:123], v[44:47]
    ds_read_b128 v[140:143], v199 offset:2048
    v_mfma_f32_16x16x32_bf16 v[64:67], v[156:159], v[124:127], v[64:67]
    ds_read_b128 v[144:147], v199 offset:4096
    v_mfma_f32_16x16x32_bf16 v[84:87], v[156:159], v[128:131], v[84:87]
    v_mfma_f32_16x16x32_bf16 v[104:107], v[156:159], v[132:135], v[104:107]
    ds_read_b128 v[148:151], v199 offset:6144
    s_waitcnt lgkmcnt(10)
    v_mfma_f32_16x16x32_bf16 v[48:51], v[160:163], v[120:123], v[48:51]
    ds_read_b64_tr_b16 v[176:177], v206 offset:12288
    v_mfma_f32_16x16x32_bf16 v[68:71], v[160:163], v[124:127], v[68:71]
    v_mfma_f32_16x16x32_bf16 v[88:91], v[160:163], v[128:131], v[88:91]
    ds_read_b64_tr_b16 v[178:179], v206 offset:13824
    v_mfma_f32_16x16x32_bf16 v[108:111], v[160:163], v[132:135], v[108:111]
    ds_read_b64_tr_b16 v[180:181], v207 offset:12288
    s_waitcnt lgkmcnt(11)
    v_mfma_f32_16x16x32_bf16 v[52:55], v[164:167], v[120:123], v[52:55]
    ds_read_b64_tr_b16 v[182:183], v207 offset:13824
    v_mfma_f32_16x16x32_bf16 v[72:75], v[164:167], v[124:127], v[72:75]
    v_mfma_f32_16x16x32_bf16 v[92:95], v[164:167], v[128:131], v[92:95]
    ds_read_b64_tr_b16 v[184:185], v208 offset:12288
    v_mfma_f32_16x16x32_bf16 v[112:115], v[164:167], v[132:135], v[112:115]
    ds_read_b64_tr_b16 v[186:187], v208 offset:13824
    s_waitcnt lgkmcnt(12)
    v_mfma_f32_16x16x32_bf16 v[56:59], v[168:171], v[120:123], v[56:59]
    v_mfma_f32_16x16x32_bf16 v[76:79], v[168:171], v[124:127], v[76:79]
    ds_read_b64_tr_b16 v[188:189], v209 offset:12288
    v_mfma_f32_16x16x32_bf16 v[96:99], v[168:171], v[128:131], v[96:99]
    ds_read_b64_tr_b16 v[190:191], v209 offset:13824
    v_mfma_f32_16x16x32_bf16 v[116:119], v[168:171], v[132:135], v[116:119]
    s_waitcnt lgkmcnt(0)
    s_barrier
    v_mfma_f32_16x16x32_bf16 v[40:43], v[172:175], v[136:139], v[40:43]
    ds_read_b128 v[120:123], v198 offset:40960
    v_mfma_f32_16x16x32_bf16 v[60:63], v[172:175], v[140:143], v[60:63]
    ds_read_b64_tr_b16 v[152:153], v205 offset:40960
    v_mfma_f32_16x16x32_bf16 v[80:83], v[172:175], v[144:147], v[80:83]
    ds_read_b64_tr_b16 v[154:155], v205 offset:42496
    v_mfma_f32_16x16x32_bf16 v[100:103], v[172:175], v[148:151], v[100:103]
    v_mfma_f32_16x16x32_bf16 v[44:47], v[176:179], v[136:139], v[44:47]
    ds_read_b128 v[124:127], v198 offset:43008
    v_mfma_f32_16x16x32_bf16 v[64:67], v[176:179], v[140:143], v[64:67]
    ds_read_b128 v[128:131], v198 offset:45056
    v_mfma_f32_16x16x32_bf16 v[84:87], v[176:179], v[144:147], v[84:87]
    v_mfma_f32_16x16x32_bf16 v[104:107], v[176:179], v[148:151], v[104:107]
    ds_read_b128 v[132:135], v198 offset:47104
    v_mfma_f32_16x16x32_bf16 v[48:51], v[180:183], v[136:139], v[48:51]
    ds_read_b64_tr_b16 v[156:157], v206 offset:40960
    v_mfma_f32_16x16x32_bf16 v[68:71], v[180:183], v[140:143], v[68:71]
    v_mfma_f32_16x16x32_bf16 v[88:91], v[180:183], v[144:147], v[88:91]
    ds_read_b64_tr_b16 v[158:159], v206 offset:42496
    v_mfma_f32_16x16x32_bf16 v[108:111], v[180:183], v[148:151], v[108:111]
    ds_read_b64_tr_b16 v[160:161], v207 offset:40960
    v_mfma_f32_16x16x32_bf16 v[52:55], v[184:187], v[136:139], v[52:55]
    ds_read_b64_tr_b16 v[162:163], v207 offset:42496
    v_mfma_f32_16x16x32_bf16 v[72:75], v[184:187], v[140:143], v[72:75]
    v_mfma_f32_16x16x32_bf16 v[92:95], v[184:187], v[144:147], v[92:95]
    ds_read_b64_tr_b16 v[164:165], v208 offset:40960
    v_mfma_f32_16x16x32_bf16 v[112:115], v[184:187], v[148:151], v[112:115]
    ds_read_b64_tr_b16 v[166:167], v208 offset:42496
    v_mfma_f32_16x16x32_bf16 v[56:59], v[188:191], v[136:139], v[56:59]
    v_mfma_f32_16x16x32_bf16 v[76:79], v[188:191], v[140:143], v[76:79]
    ds_read_b64_tr_b16 v[168:169], v209 offset:40960
    v_mfma_f32_16x16x32_bf16 v[96:99], v[188:191], v[144:147], v[96:99]
    ds_read_b64_tr_b16 v[170:171], v209 offset:42496
    v_mfma_f32_16x16x32_bf16 v[116:119], v[188:191], v[148:151], v[116:119]
    s_waitcnt lgkmcnt(11)
    v_mfma_f32_16x16x32_bf16 v[40:43], v[152:155], v[120:123], v[40:43]
    ds_read_b128 v[136:139], v199 offset:40960
    s_waitcnt lgkmcnt(11)
    v_mfma_f32_16x16x32_bf16 v[60:63], v[152:155], v[124:127], v[60:63]
    ds_read_b64_tr_b16 v[172:173], v205 offset:53248
    s_waitcnt lgkmcnt(11)
    v_mfma_f32_16x16x32_bf16 v[80:83], v[152:155], v[128:131], v[80:83]
    ds_read_b64_tr_b16 v[174:175], v205 offset:54784
    s_waitcnt lgkmcnt(11)
    v_mfma_f32_16x16x32_bf16 v[100:103], v[152:155], v[132:135], v[100:103]
    s_waitcnt lgkmcnt(9)
    v_mfma_f32_16x16x32_bf16 v[44:47], v[156:159], v[120:123], v[44:47]
    ds_read_b128 v[140:143], v199 offset:43008
    v_mfma_f32_16x16x32_bf16 v[64:67], v[156:159], v[124:127], v[64:67]
    ds_read_b128 v[144:147], v199 offset:45056
    v_mfma_f32_16x16x32_bf16 v[84:87], v[156:159], v[128:131], v[84:87]
    v_mfma_f32_16x16x32_bf16 v[104:107], v[156:159], v[132:135], v[104:107]
    ds_read_b128 v[148:151], v199 offset:47104
    s_waitcnt lgkmcnt(10)
    v_mfma_f32_16x16x32_bf16 v[48:51], v[160:163], v[120:123], v[48:51]
    ds_read_b64_tr_b16 v[176:177], v206 offset:53248
    v_mfma_f32_16x16x32_bf16 v[68:71], v[160:163], v[124:127], v[68:71]
    v_mfma_f32_16x16x32_bf16 v[88:91], v[160:163], v[128:131], v[88:91]
    ds_read_b64_tr_b16 v[178:179], v206 offset:54784
    v_mfma_f32_16x16x32_bf16 v[108:111], v[160:163], v[132:135], v[108:111]
    ds_read_b64_tr_b16 v[180:181], v207 offset:53248
    s_waitcnt lgkmcnt(11)
    v_mfma_f32_16x16x32_bf16 v[52:55], v[164:167], v[120:123], v[52:55]
    ds_read_b64_tr_b16 v[182:183], v207 offset:54784
    v_mfma_f32_16x16x32_bf16 v[72:75], v[164:167], v[124:127], v[72:75]
    v_mfma_f32_16x16x32_bf16 v[92:95], v[164:167], v[128:131], v[92:95]
    ds_read_b64_tr_b16 v[184:185], v208 offset:53248
    v_mfma_f32_16x16x32_bf16 v[112:115], v[164:167], v[132:135], v[112:115]
    ds_read_b64_tr_b16 v[186:187], v208 offset:54784
    s_waitcnt lgkmcnt(12)
    v_mfma_f32_16x16x32_bf16 v[56:59], v[168:171], v[120:123], v[56:59]
    v_mfma_f32_16x16x32_bf16 v[76:79], v[168:171], v[124:127], v[76:79]
    ds_read_b64_tr_b16 v[188:189], v209 offset:53248
    v_mfma_f32_16x16x32_bf16 v[96:99], v[168:171], v[128:131], v[96:99]
    ds_read_b64_tr_b16 v[190:191], v209 offset:54784
    v_mfma_f32_16x16x32_bf16 v[116:119], v[168:171], v[132:135], v[116:119]
    s_waitcnt lgkmcnt(0)
    s_barrier
    v_mfma_f32_16x16x32_bf16 v[40:43], v[172:175], v[136:139], v[40:43]
    ds_read_b128 v[120:123], v196 offset:0
    v_mfma_f32_16x16x32_bf16 v[60:63], v[172:175], v[140:143], v[60:63]
    ds_read_b64_tr_b16 v[152:153], v200 offset:0
    v_mfma_f32_16x16x32_bf16 v[80:83], v[172:175], v[144:147], v[80:83]
    ds_read_b64_tr_b16 v[154:155], v200 offset:1536
    v_mfma_f32_16x16x32_bf16 v[100:103], v[172:175], v[148:151], v[100:103]
    v_mfma_f32_16x16x32_bf16 v[44:47], v[176:179], v[136:139], v[44:47]
    ds_read_b128 v[124:127], v196 offset:2048
    v_mfma_f32_16x16x32_bf16 v[64:67], v[176:179], v[140:143], v[64:67]
    ds_read_b128 v[128:131], v196 offset:4096
    v_mfma_f32_16x16x32_bf16 v[84:87], v[176:179], v[144:147], v[84:87]
    v_mfma_f32_16x16x32_bf16 v[104:107], v[176:179], v[148:151], v[104:107]
    ds_read_b128 v[132:135], v196 offset:6144
    v_mfma_f32_16x16x32_bf16 v[48:51], v[180:183], v[136:139], v[48:51]
    ds_read_b64_tr_b16 v[156:157], v201 offset:0
    v_mfma_f32_16x16x32_bf16 v[68:71], v[180:183], v[140:143], v[68:71]
    v_mfma_f32_16x16x32_bf16 v[88:91], v[180:183], v[144:147], v[88:91]
    ds_read_b64_tr_b16 v[158:159], v201 offset:1536
    v_mfma_f32_16x16x32_bf16 v[108:111], v[180:183], v[148:151], v[108:111]
    ds_read_b64_tr_b16 v[160:161], v202 offset:0
    v_mfma_f32_16x16x32_bf16 v[52:55], v[184:187], v[136:139], v[52:55]
    ds_read_b64_tr_b16 v[162:163], v202 offset:1536
    v_mfma_f32_16x16x32_bf16 v[72:75], v[184:187], v[140:143], v[72:75]
    v_mfma_f32_16x16x32_bf16 v[92:95], v[184:187], v[144:147], v[92:95]
    ds_read_b64_tr_b16 v[164:165], v203 offset:0
    v_mfma_f32_16x16x32_bf16 v[112:115], v[184:187], v[148:151], v[112:115]
    ds_read_b64_tr_b16 v[166:167], v203 offset:1536
    v_mfma_f32_16x16x32_bf16 v[56:59], v[188:191], v[136:139], v[56:59]
    v_mfma_f32_16x16x32_bf16 v[76:79], v[188:191], v[140:143], v[76:79]
    ds_read_b64_tr_b16 v[168:169], v204 offset:0
    v_mfma_f32_16x16x32_bf16 v[96:99], v[188:191], v[144:147], v[96:99]
    ds_read_b64_tr_b16 v[170:171], v204 offset:1536
    v_mfma_f32_16x16x32_bf16 v[116:119], v[188:191], v[148:151], v[116:119]
    s_waitcnt lgkmcnt(11)
    v_mfma_f32_16x16x32_bf16 v[40:43], v[152:155], v[120:123], v[40:43]
    ds_read_b128 v[136:139], v197 offset:0
    s_waitcnt lgkmcnt(11)
    v_mfma_f32_16x16x32_bf16 v[60:63], v[152:155], v[124:127], v[60:63]
    ds_read_b64_tr_b16 v[172:173], v200 offset:12288
    s_waitcnt lgkmcnt(11)
    v_mfma_f32_16x16x32_bf16 v[80:83], v[152:155], v[128:131], v[80:83]
    ds_read_b64_tr_b16 v[174:175], v200 offset:13824
    s_waitcnt lgkmcnt(11)
    v_mfma_f32_16x16x32_bf16 v[100:103], v[152:155], v[132:135], v[100:103]
    s_waitcnt lgkmcnt(9)
    v_mfma_f32_16x16x32_bf16 v[44:47], v[156:159], v[120:123], v[44:47]
    ds_read_b128 v[140:143], v197 offset:2048
    v_mfma_f32_16x16x32_bf16 v[64:67], v[156:159], v[124:127], v[64:67]
    ds_read_b128 v[144:147], v197 offset:4096
    v_mfma_f32_16x16x32_bf16 v[84:87], v[156:159], v[128:131], v[84:87]
    v_mfma_f32_16x16x32_bf16 v[104:107], v[156:159], v[132:135], v[104:107]
    ds_read_b128 v[148:151], v197 offset:6144
    s_waitcnt lgkmcnt(10)
    v_mfma_f32_16x16x32_bf16 v[48:51], v[160:163], v[120:123], v[48:51]
    ds_read_b64_tr_b16 v[176:177], v201 offset:12288
    v_mfma_f32_16x16x32_bf16 v[68:71], v[160:163], v[124:127], v[68:71]
    v_mfma_f32_16x16x32_bf16 v[88:91], v[160:163], v[128:131], v[88:91]
    ds_read_b64_tr_b16 v[178:179], v201 offset:13824
    v_mfma_f32_16x16x32_bf16 v[108:111], v[160:163], v[132:135], v[108:111]
    ds_read_b64_tr_b16 v[180:181], v202 offset:12288
    s_waitcnt lgkmcnt(11)
    v_mfma_f32_16x16x32_bf16 v[52:55], v[164:167], v[120:123], v[52:55]
    ds_read_b64_tr_b16 v[182:183], v202 offset:13824
    v_mfma_f32_16x16x32_bf16 v[72:75], v[164:167], v[124:127], v[72:75]
    v_mfma_f32_16x16x32_bf16 v[92:95], v[164:167], v[128:131], v[92:95]
    ds_read_b64_tr_b16 v[184:185], v203 offset:12288
    v_mfma_f32_16x16x32_bf16 v[112:115], v[164:167], v[132:135], v[112:115]
    ds_read_b64_tr_b16 v[186:187], v203 offset:13824
    s_waitcnt lgkmcnt(12)
    v_mfma_f32_16x16x32_bf16 v[56:59], v[168:171], v[120:123], v[56:59]
    v_mfma_f32_16x16x32_bf16 v[76:79], v[168:171], v[124:127], v[76:79]
    ds_read_b64_tr_b16 v[188:189], v204 offset:12288
    v_mfma_f32_16x16x32_bf16 v[96:99], v[168:171], v[128:131], v[96:99]
    ds_read_b64_tr_b16 v[190:191], v204 offset:13824
    v_mfma_f32_16x16x32_bf16 v[116:119], v[168:171], v[132:135], v[116:119]
    s_waitcnt lgkmcnt(0)
    s_barrier
    v_mfma_f32_16x16x32_bf16 v[40:43], v[172:175], v[136:139], v[40:43]
    ds_read_b128 v[120:123], v196 offset:40960
    v_mfma_f32_16x16x32_bf16 v[60:63], v[172:175], v[140:143], v[60:63]
    ds_read_b64_tr_b16 v[152:153], v200 offset:40960
    v_mfma_f32_16x16x32_bf16 v[80:83], v[172:175], v[144:147], v[80:83]
    ds_read_b64_tr_b16 v[154:155], v200 offset:42496
    v_mfma_f32_16x16x32_bf16 v[100:103], v[172:175], v[148:151], v[100:103]
    v_mfma_f32_16x16x32_bf16 v[44:47], v[176:179], v[136:139], v[44:47]
    ds_read_b128 v[124:127], v196 offset:43008
    v_mfma_f32_16x16x32_bf16 v[64:67], v[176:179], v[140:143], v[64:67]
    ds_read_b128 v[128:131], v196 offset:45056
    v_mfma_f32_16x16x32_bf16 v[84:87], v[176:179], v[144:147], v[84:87]
    v_mfma_f32_16x16x32_bf16 v[104:107], v[176:179], v[148:151], v[104:107]
    ds_read_b128 v[132:135], v196 offset:47104
    v_mfma_f32_16x16x32_bf16 v[48:51], v[180:183], v[136:139], v[48:51]
    ds_read_b64_tr_b16 v[156:157], v201 offset:40960
    v_mfma_f32_16x16x32_bf16 v[68:71], v[180:183], v[140:143], v[68:71]
    v_mfma_f32_16x16x32_bf16 v[88:91], v[180:183], v[144:147], v[88:91]
    ds_read_b64_tr_b16 v[158:159], v201 offset:42496
    v_mfma_f32_16x16x32_bf16 v[108:111], v[180:183], v[148:151], v[108:111]
    ds_read_b64_tr_b16 v[160:161], v202 offset:40960
    v_mfma_f32_16x16x32_bf16 v[52:55], v[184:187], v[136:139], v[52:55]
    ds_read_b64_tr_b16 v[162:163], v202 offset:42496
    v_mfma_f32_16x16x32_bf16 v[72:75], v[184:187], v[140:143], v[72:75]
    v_mfma_f32_16x16x32_bf16 v[92:95], v[184:187], v[144:147], v[92:95]
    ds_read_b64_tr_b16 v[164:165], v203 offset:40960
    v_mfma_f32_16x16x32_bf16 v[112:115], v[184:187], v[148:151], v[112:115]
    ds_read_b64_tr_b16 v[166:167], v203 offset:42496
    v_mfma_f32_16x16x32_bf16 v[56:59], v[188:191], v[136:139], v[56:59]
    v_mfma_f32_16x16x32_bf16 v[76:79], v[188:191], v[140:143], v[76:79]
    ds_read_b64_tr_b16 v[168:169], v204 offset:40960
    v_mfma_f32_16x16x32_bf16 v[96:99], v[188:191], v[144:147], v[96:99]
    ds_read_b64_tr_b16 v[170:171], v204 offset:42496
    v_mfma_f32_16x16x32_bf16 v[116:119], v[188:191], v[148:151], v[116:119]
    s_waitcnt lgkmcnt(11)
    v_mfma_f32_16x16x32_bf16 v[40:43], v[152:155], v[120:123], v[40:43]
    ds_read_b128 v[136:139], v197 offset:40960
    s_waitcnt lgkmcnt(11)
    v_mfma_f32_16x16x32_bf16 v[60:63], v[152:155], v[124:127], v[60:63]
    ds_read_b64_tr_b16 v[172:173], v200 offset:53248
    s_waitcnt lgkmcnt(11)
    v_mfma_f32_16x16x32_bf16 v[80:83], v[152:155], v[128:131], v[80:83]
    ds_read_b64_tr_b16 v[174:175], v200 offset:54784
    s_waitcnt lgkmcnt(11)
    v_mfma_f32_16x16x32_bf16 v[100:103], v[152:155], v[132:135], v[100:103]
    s_waitcnt lgkmcnt(9)
    v_mfma_f32_16x16x32_bf16 v[44:47], v[156:159], v[120:123], v[44:47]
    ds_read_b128 v[140:143], v197 offset:43008
    v_mfma_f32_16x16x32_bf16 v[64:67], v[156:159], v[124:127], v[64:67]
    ds_read_b128 v[144:147], v197 offset:45056
    v_mfma_f32_16x16x32_bf16 v[84:87], v[156:159], v[128:131], v[84:87]
    v_mfma_f32_16x16x32_bf16 v[104:107], v[156:159], v[132:135], v[104:107]
    ds_read_b128 v[148:151], v197 offset:47104
    s_waitcnt lgkmcnt(10)
    v_mfma_f32_16x16x32_bf16 v[48:51], v[160:163], v[120:123], v[48:51]
    ds_read_b64_tr_b16 v[176:177], v201 offset:53248
    v_mfma_f32_16x16x32_bf16 v[68:71], v[160:163], v[124:127], v[68:71]
    v_mfma_f32_16x16x32_bf16 v[88:91], v[160:163], v[128:131], v[88:91]
    ds_read_b64_tr_b16 v[178:179], v201 offset:54784
    v_mfma_f32_16x16x32_bf16 v[108:111], v[160:163], v[132:135], v[108:111]
    ds_read_b64_tr_b16 v[180:181], v202 offset:53248
    s_waitcnt lgkmcnt(11)
    v_mfma_f32_16x16x32_bf16 v[52:55], v[164:167], v[120:123], v[52:55]
    ds_read_b64_tr_b16 v[182:183], v202 offset:54784
    v_mfma_f32_16x16x32_bf16 v[72:75], v[164:167], v[124:127], v[72:75]
    v_mfma_f32_16x16x32_bf16 v[92:95], v[164:167], v[128:131], v[92:95]
    ds_read_b64_tr_b16 v[184:185], v203 offset:53248
    v_mfma_f32_16x16x32_bf16 v[112:115], v[164:167], v[132:135], v[112:115]
    ds_read_b64_tr_b16 v[186:187], v203 offset:54784
    s_waitcnt lgkmcnt(12)
    v_mfma_f32_16x16x32_bf16 v[56:59], v[168:171], v[120:123], v[56:59]
    v_mfma_f32_16x16x32_bf16 v[76:79], v[168:171], v[124:127], v[76:79]
    ds_read_b64_tr_b16 v[188:189], v204 offset:53248
    v_mfma_f32_16x16x32_bf16 v[96:99], v[168:171], v[128:131], v[96:99]
    ds_read_b64_tr_b16 v[190:191], v204 offset:54784
    v_mfma_f32_16x16x32_bf16 v[116:119], v[168:171], v[132:135], v[116:119]
    s_waitcnt lgkmcnt(0)
    s_barrier
    v_mfma_f32_16x16x32_bf16 v[40:43], v[172:175], v[136:139], v[40:43]
    ds_read_b128 v[120:123], v198 offset:0
    v_mfma_f32_16x16x32_bf16 v[60:63], v[172:175], v[140:143], v[60:63]
    ds_read_b64_tr_b16 v[152:153], v205 offset:0
    v_mfma_f32_16x16x32_bf16 v[80:83], v[172:175], v[144:147], v[80:83]
    ds_read_b64_tr_b16 v[154:155], v205 offset:1536
    v_mfma_f32_16x16x32_bf16 v[100:103], v[172:175], v[148:151], v[100:103]
    v_mfma_f32_16x16x32_bf16 v[44:47], v[176:179], v[136:139], v[44:47]
    ds_read_b128 v[124:127], v198 offset:2048
    v_mfma_f32_16x16x32_bf16 v[64:67], v[176:179], v[140:143], v[64:67]
    ds_read_b128 v[128:131], v198 offset:4096
    v_mfma_f32_16x16x32_bf16 v[84:87], v[176:179], v[144:147], v[84:87]
    v_mfma_f32_16x16x32_bf16 v[104:107], v[176:179], v[148:151], v[104:107]
    ds_read_b128 v[132:135], v198 offset:6144
    v_mfma_f32_16x16x32_bf16 v[48:51], v[180:183], v[136:139], v[48:51]
    ds_read_b64_tr_b16 v[156:157], v206 offset:0
    v_mfma_f32_16x16x32_bf16 v[68:71], v[180:183], v[140:143], v[68:71]
    v_mfma_f32_16x16x32_bf16 v[88:91], v[180:183], v[144:147], v[88:91]
    ds_read_b64_tr_b16 v[158:159], v206 offset:1536
    v_mfma_f32_16x16x32_bf16 v[108:111], v[180:183], v[148:151], v[108:111]
    ds_read_b64_tr_b16 v[160:161], v207 offset:0
    v_mfma_f32_16x16x32_bf16 v[52:55], v[184:187], v[136:139], v[52:55]
    ds_read_b64_tr_b16 v[162:163], v207 offset:1536
    v_mfma_f32_16x16x32_bf16 v[72:75], v[184:187], v[140:143], v[72:75]
    v_mfma_f32_16x16x32_bf16 v[92:95], v[184:187], v[144:147], v[92:95]
    ds_read_b64_tr_b16 v[164:165], v208 offset:0
    v_mfma_f32_16x16x32_bf16 v[112:115], v[184:187], v[148:151], v[112:115]
    ds_read_b64_tr_b16 v[166:167], v208 offset:1536
    v_mfma_f32_16x16x32_bf16 v[56:59], v[188:191], v[136:139], v[56:59]
    v_mfma_f32_16x16x32_bf16 v[76:79], v[188:191], v[140:143], v[76:79]
    ds_read_b64_tr_b16 v[168:169], v209 offset:0
    v_mfma_f32_16x16x32_bf16 v[96:99], v[188:191], v[144:147], v[96:99]
    ds_read_b64_tr_b16 v[170:171], v209 offset:1536
    v_mfma_f32_16x16x32_bf16 v[116:119], v[188:191], v[148:151], v[116:119]
    s_waitcnt lgkmcnt(11)
    v_mfma_f32_16x16x32_bf16 v[40:43], v[152:155], v[120:123], v[40:43]
    ds_read_b128 v[136:139], v199 offset:0
    s_waitcnt lgkmcnt(11)
    v_mfma_f32_16x16x32_bf16 v[60:63], v[152:155], v[124:127], v[60:63]
    ds_read_b64_tr_b16 v[172:173], v205 offset:12288
    s_waitcnt lgkmcnt(11)
    v_mfma_f32_16x16x32_bf16 v[80:83], v[152:155], v[128:131], v[80:83]
    ds_read_b64_tr_b16 v[174:175], v205 offset:13824
    s_waitcnt lgkmcnt(11)
    v_mfma_f32_16x16x32_bf16 v[100:103], v[152:155], v[132:135], v[100:103]
    s_waitcnt lgkmcnt(9)
    v_mfma_f32_16x16x32_bf16 v[44:47], v[156:159], v[120:123], v[44:47]
    ds_read_b128 v[140:143], v199 offset:2048
    v_mfma_f32_16x16x32_bf16 v[64:67], v[156:159], v[124:127], v[64:67]
    ds_read_b128 v[144:147], v199 offset:4096
    v_mfma_f32_16x16x32_bf16 v[84:87], v[156:159], v[128:131], v[84:87]
    v_mfma_f32_16x16x32_bf16 v[104:107], v[156:159], v[132:135], v[104:107]
    ds_read_b128 v[148:151], v199 offset:6144
    s_waitcnt lgkmcnt(10)
    v_mfma_f32_16x16x32_bf16 v[48:51], v[160:163], v[120:123], v[48:51]
    ds_read_b64_tr_b16 v[176:177], v206 offset:12288
    v_mfma_f32_16x16x32_bf16 v[68:71], v[160:163], v[124:127], v[68:71]
    v_mfma_f32_16x16x32_bf16 v[88:91], v[160:163], v[128:131], v[88:91]
    ds_read_b64_tr_b16 v[178:179], v206 offset:13824
    v_mfma_f32_16x16x32_bf16 v[108:111], v[160:163], v[132:135], v[108:111]
    ds_read_b64_tr_b16 v[180:181], v207 offset:12288
    s_waitcnt lgkmcnt(11)
    v_mfma_f32_16x16x32_bf16 v[52:55], v[164:167], v[120:123], v[52:55]
    ds_read_b64_tr_b16 v[182:183], v207 offset:13824
    v_mfma_f32_16x16x32_bf16 v[72:75], v[164:167], v[124:127], v[72:75]
    v_mfma_f32_16x16x32_bf16 v[92:95], v[164:167], v[128:131], v[92:95]
    ds_read_b64_tr_b16 v[184:185], v208 offset:12288
    v_mfma_f32_16x16x32_bf16 v[112:115], v[164:167], v[132:135], v[112:115]
    ds_read_b64_tr_b16 v[186:187], v208 offset:13824
    s_waitcnt lgkmcnt(12)
    v_mfma_f32_16x16x32_bf16 v[56:59], v[168:171], v[120:123], v[56:59]
    v_mfma_f32_16x16x32_bf16 v[76:79], v[168:171], v[124:127], v[76:79]
    ds_read_b64_tr_b16 v[188:189], v209 offset:12288
    v_mfma_f32_16x16x32_bf16 v[96:99], v[168:171], v[128:131], v[96:99]
    ds_read_b64_tr_b16 v[190:191], v209 offset:13824
    v_mfma_f32_16x16x32_bf16 v[116:119], v[168:171], v[132:135], v[116:119]
    s_waitcnt lgkmcnt(0)
    s_barrier
    v_mov_b32 v15, 0
    buffer_load_dword v14, v15, s[60:63], 0 offen sc1
    v_mfma_f32_16x16x32_bf16 v[40:43], v[172:175], v[136:139], v[40:43]
    ds_read_b128 v[120:123], v198 offset:40960
    v_mfma_f32_16x16x32_bf16 v[60:63], v[172:175], v[140:143], v[60:63]
    ds_read_b64_tr_b16 v[152:153], v205 offset:40960
    v_mfma_f32_16x16x32_bf16 v[80:83], v[172:175], v[144:147], v[80:83]
    ds_read_b64_tr_b16 v[154:155], v205 offset:42496
    v_mfma_f32_16x16x32_bf16 v[100:103], v[172:175], v[148:151], v[100:103]
    v_mfma_f32_16x16x32_bf16 v[44:47], v[176:179], v[136:139], v[44:47]
    ds_read_b128 v[124:127], v198 offset:43008
    v_mfma_f32_16x16x32_bf16 v[64:67], v[176:179], v[140:143], v[64:67]
    ds_read_b128 v[128:131], v198 offset:45056
    v_mfma_f32_16x16x32_bf16 v[84:87], v[176:179], v[144:147], v[84:87]
    v_mfma_f32_16x16x32_bf16 v[104:107], v[176:179], v[148:151], v[104:107]
    ds_read_b128 v[132:135], v198 offset:47104
    v_mfma_f32_16x16x32_bf16 v[48:51], v[180:183], v[136:139], v[48:51]
    ds_read_b64_tr_b16 v[156:157], v206 offset:40960
    v_mfma_f32_16x16x32_bf16 v[68:71], v[180:183], v[140:143], v[68:71]
    v_mfma_f32_16x16x32_bf16 v[88:91], v[180:183], v[144:147], v[88:91]
    ds_read_b64_tr_b16 v[158:159], v206 offset:42496
    v_mfma_f32_16x16x32_bf16 v[108:111], v[180:183], v[148:151], v[108:111]
    ds_read_b64_tr_b16 v[160:161], v207 offset:40960
    v_mfma_f32_16x16x32_bf16 v[52:55], v[184:187], v[136:139], v[52:55]
    ds_read_b64_tr_b16 v[162:163], v207 offset:42496
    v_mfma_f32_16x16x32_bf16 v[72:75], v[184:187], v[140:143], v[72:75]
    v_mfma_f32_16x16x32_bf16 v[92:95], v[184:187], v[144:147], v[92:95]
    ds_read_b64_tr_b16 v[164:165], v208 offset:40960
    v_mfma_f32_16x16x32_bf16 v[112:115], v[184:187], v[148:151], v[112:115]
    ds_read_b64_tr_b16 v[166:167], v208 offset:42496
    v_mfma_f32_16x16x32_bf16 v[56:59], v[188:191], v[136:139], v[56:59]
    v_mfma_f32_16x16x32_bf16 v[76:79], v[188:191], v[140:143], v[76:79]
    ds_read_b64_tr_b16 v[168:169], v209 offset:40960
    v_mfma_f32_16x16x32_bf16 v[96:99], v[188:191], v[144:147], v[96:99]
    ds_read_b64_tr_b16 v[170:171], v209 offset:42496
    v_mfma_f32_16x16x32_bf16 v[116:119], v[188:191], v[148:151], v[116:119]
    s_waitcnt lgkmcnt(11)
    v_mfma_f32_16x16x32_bf16 v[40:43], v[152:155], v[120:123], v[40:43]
    ds_read_b128 v[136:139], v199 offset:40960
    s_waitcnt lgkmcnt(11)
    v_mfma_f32_16x16x32_bf16 v[60:63], v[152:155], v[124:127], v[60:63]
    ds_read_b64_tr_b16 v[172:173], v205 offset:53248
    s_waitcnt lgkmcnt(11)
    v_mfma_f32_16x16x32_bf16 v[80:83], v[152:155], v[128:131], v[80:83]
    ds_read_b64_tr_b16 v[174:175], v205 offset:54784
    s_waitcnt lgkmcnt(11)
    v_mfma_f32_16x16x32_bf16 v[100:103], v[152:155], v[132:135], v[100:103]
    s_waitcnt lgkmcnt(9)
    v_mfma_f32_16x16x32_bf16 v[44:47], v[156:159], v[120:123], v[44:47]
    ds_read_b128 v[140:143], v199 offset:43008
    v_mfma_f32_16x16x32_bf16 v[64:67], v[156:159], v[124:127], v[64:67]
    ds_read_b128 v[144:147], v199 offset:45056
    v_mfma_f32_16x16x32_bf16 v[84:87], v[156:159], v[128:131], v[84:87]
    v_mfma_f32_16x16x32_bf16 v[104:107], v[156:159], v[132:135], v[104:107]
    ds_read_b128 v[148:151], v199 offset:47104
    s_waitcnt lgkmcnt(10)
    v_mfma_f32_16x16x32_bf16 v[48:51], v[160:163], v[120:123], v[48:51]
    ds_read_b64_tr_b16 v[176:177], v206 offset:53248
    v_mfma_f32_16x16x32_bf16 v[68:71], v[160:163], v[124:127], v[68:71]
    v_mfma_f32_16x16x32_bf16 v[88:91], v[160:163], v[128:131], v[88:91]
    ds_read_b64_tr_b16 v[178:179], v206 offset:54784
    v_mfma_f32_16x16x32_bf16 v[108:111], v[160:163], v[132:135], v[108:111]
    ds_read_b64_tr_b16 v[180:181], v207 offset:53248
    s_waitcnt lgkmcnt(11)
    v_mfma_f32_16x16x32_bf16 v[52:55], v[164:167], v[120:123], v[52:55]
    ds_read_b64_tr_b16 v[182:183], v207 offset:54784
    v_mfma_f32_16x16x32_bf16 v[72:75], v[164:167], v[124:127], v[72:75]
    v_mfma_f32_16x16x32_bf16 v[92:95], v[164:167], v[128:131], v[92:95]
    ds_read_b64_tr_b16 v[184:185], v208 offset:53248
    v_mfma_f32_16x16x32_bf16 v[112:115], v[164:167], v[132:135], v[112:115]
    ds_read_b64_tr_b16 v[186:187], v208 offset:54784
    s_waitcnt lgkmcnt(12)
    v_mfma_f32_16x16x32_bf16 v[56:59], v[168:171], v[120:123], v[56:59]
    v_mfma_f32_16x16x32_bf16 v[76:79], v[168:171], v[124:127], v[76:79]
    ds_read_b64_tr_b16 v[188:189], v209 offset:53248
    v_mfma_f32_16x16x32_bf16 v[96:99], v[168:171], v[128:131], v[96:99]
    ds_read_b64_tr_b16 v[190:191], v209 offset:54784
    v_mfma_f32_16x16x32_bf16 v[116:119], v[168:171], v[132:135], v[116:119]
    s_waitcnt lgkmcnt(0)
    s_barrier
    v_mfma_f32_16x16x32_bf16 v[40:43], v[172:175], v[136:139], v[40:43]
    ds_read_b128 v[120:123], v196 offset:0
    v_mfma_f32_16x16x32_bf16 v[60:63], v[172:175], v[140:143], v[60:63]
    ds_read_b64_tr_b16 v[152:153], v200 offset:0
    v_mfma_f32_16x16x32_bf16 v[80:83], v[172:175], v[144:147], v[80:83]
    ds_read_b64_tr_b16 v[154:155], v200 offset:1536
    v_mfma_f32_16x16x32_bf16 v[100:103], v[172:175], v[148:151], v[100:103]
    v_mfma_f32_16x16x32_bf16 v[44:47], v[176:179], v[136:139], v[44:47]
    ds_read_b128 v[124:127], v196 offset:2048
    v_mfma_f32_16x16x32_bf16 v[64:67], v[176:179], v[140:143], v[64:67]
    ds_read_b128 v[128:131], v196 offset:4096
    v_mfma_f32_16x16x32_bf16 v[84:87], v[176:179], v[144:147], v[84:87]
    v_mfma_f32_16x16x32_bf16 v[104:107], v[176:179], v[148:151], v[104:107]
    ds_read_b128 v[132:135], v196 offset:6144
    v_mfma_f32_16x16x32_bf16 v[48:51], v[180:183], v[136:139], v[48:51]
    ds_read_b64_tr_b16 v[156:157], v201 offset:0
    v_mfma_f32_16x16x32_bf16 v[68:71], v[180:183], v[140:143], v[68:71]
    v_mfma_f32_16x16x32_bf16 v[88:91], v[180:183], v[144:147], v[88:91]
    ds_read_b64_tr_b16 v[158:159], v201 offset:1536
    v_mfma_f32_16x16x32_bf16 v[108:111], v[180:183], v[148:151], v[108:111]
    ds_read_b64_tr_b16 v[160:161], v202 offset:0
    v_mfma_f32_16x16x32_bf16 v[52:55], v[184:187], v[136:139], v[52:55]
    ds_read_b64_tr_b16 v[162:163], v202 offset:1536
    v_mfma_f32_16x16x32_bf16 v[72:75], v[184:187], v[140:143], v[72:75]
    v_mfma_f32_16x16x32_bf16 v[92:95], v[184:187], v[144:147], v[92:95]
    ds_read_b64_tr_b16 v[164:165], v203 offset:0
    v_mfma_f32_16x16x32_bf16 v[112:115], v[184:187], v[148:151], v[112:115]
    ds_read_b64_tr_b16 v[166:167], v203 offset:1536
    v_mfma_f32_16x16x32_bf16 v[56:59], v[188:191], v[136:139], v[56:59]
    v_mfma_f32_16x16x32_bf16 v[76:79], v[188:191], v[140:143], v[76:79]
    ds_read_b64_tr_b16 v[168:169], v204 offset:0
    v_mfma_f32_16x16x32_bf16 v[96:99], v[188:191], v[144:147], v[96:99]
    ds_read_b64_tr_b16 v[170:171], v204 offset:1536
    v_mfma_f32_16x16x32_bf16 v[116:119], v[188:191], v[148:151], v[116:119]
    s_waitcnt lgkmcnt(11)
    v_mfma_f32_16x16x32_bf16 v[40:43], v[152:155], v[120:123], v[40:43]
    ds_read_b128 v[136:139], v197 offset:0
    s_waitcnt lgkmcnt(11)
    v_mfma_f32_16x16x32_bf16 v[60:63], v[152:155], v[124:127], v[60:63]
    ds_read_b64_tr_b16 v[172:173], v200 offset:12288
    s_waitcnt lgkmcnt(11)
    v_mfma_f32_16x16x32_bf16 v[80:83], v[152:155], v[128:131], v[80:83]
    ds_read_b64_tr_b16 v[174:175], v200 offset:13824
    s_waitcnt lgkmcnt(11)
    v_mfma_f32_16x16x32_bf16 v[100:103], v[152:155], v[132:135], v[100:103]
    s_waitcnt lgkmcnt(9)
    v_mfma_f32_16x16x32_bf16 v[44:47], v[156:159], v[120:123], v[44:47]
    ds_read_b128 v[140:143], v197 offset:2048
    v_mfma_f32_16x16x32_bf16 v[64:67], v[156:159], v[124:127], v[64:67]
    ds_read_b128 v[144:147], v197 offset:4096
    v_mfma_f32_16x16x32_bf16 v[84:87], v[156:159], v[128:131], v[84:87]
    v_mfma_f32_16x16x32_bf16 v[104:107], v[156:159], v[132:135], v[104:107]
    ds_read_b128 v[148:151], v197 offset:6144
    s_waitcnt lgkmcnt(10)
    v_mfma_f32_16x16x32_bf16 v[48:51], v[160:163], v[120:123], v[48:51]
    ds_read_b64_tr_b16 v[176:177], v201 offset:12288
    v_mfma_f32_16x16x32_bf16 v[68:71], v[160:163], v[124:127], v[68:71]
    v_mfma_f32_16x16x32_bf16 v[88:91], v[160:163], v[128:131], v[88:91]
    ds_read_b64_tr_b16 v[178:179], v201 offset:13824
    v_mfma_f32_16x16x32_bf16 v[108:111], v[160:163], v[132:135], v[108:111]
    ds_read_b64_tr_b16 v[180:181], v202 offset:12288
    s_waitcnt lgkmcnt(11)
    v_mfma_f32_16x16x32_bf16 v[52:55], v[164:167], v[120:123], v[52:55]
    ds_read_b64_tr_b16 v[182:183], v202 offset:13824
    v_mfma_f32_16x16x32_bf16 v[72:75], v[164:167], v[124:127], v[72:75]
    v_mfma_f32_16x16x32_bf16 v[92:95], v[164:167], v[128:131], v[92:95]
    ds_read_b64_tr_b16 v[184:185], v203 offset:12288
    v_mfma_f32_16x16x32_bf16 v[112:115], v[164:167], v[132:135], v[112:115]
    ds_read_b64_tr_b16 v[186:187], v203 offset:13824
    s_waitcnt lgkmcnt(12)
    v_mfma_f32_16x16x32_bf16 v[56:59], v[168:171], v[120:123], v[56:59]
    v_mfma_f32_16x16x32_bf16 v[76:79], v[168:171], v[124:127], v[76:79]
    ds_read_b64_tr_b16 v[188:189], v204 offset:12288
    v_mfma_f32_16x16x32_bf16 v[96:99], v[168:171], v[128:131], v[96:99]
    ds_read_b64_tr_b16 v[190:191], v204 offset:13824
    v_mfma_f32_16x16x32_bf16 v[116:119], v[168:171], v[132:135], v[116:119]
    s_waitcnt lgkmcnt(0)
    s_barrier
    ds_read_b128 v[216:219], v196 offset:40960
    ds_read_b128 v[232:235], v210 offset:40960
    ds_read_b128 v[220:223], v196 offset:43008
    ds_read_b128 v[224:227], v196 offset:45056
    ds_read_b128 v[228:231], v196 offset:47104
    ds_read_b128 v[236:239], v210 offset:43008
    v_mfma_f32_16x16x32_bf16 v[40:43], v[172:175], v[136:139], v[40:43]
    v_mfma_f32_16x16x32_bf16 v[44:47], v[176:179], v[136:139], v[44:47]
    v_mfma_f32_16x16x32_bf16 v[48:51], v[180:183], v[136:139], v[48:51]
    v_mfma_f32_16x16x32_bf16 v[52:55], v[184:187], v[136:139], v[52:55]
    v_mfma_f32_16x16x32_bf16 v[56:59], v[188:191], v[136:139], v[56:59]
    v_mfma_f32_16x16x32_bf16 v[60:63], v[172:175], v[140:143], v[60:63]
    v_mfma_f32_16x16x32_bf16 v[64:67], v[176:179], v[140:143], v[64:67]
    s_nop 1
    v_cvt_pk_bf16_f32 v120, v40, v41
    v_cvt_pk_bf16_f32 v121, v42, v43
    v_cvt_pk_bf16_f32 v122, v44, v45
    v_mfma_f32_16x16x32_bf16 v[68:71], v[180:183], v[140:143], v[68:71]
    v_cvt_pk_bf16_f32 v123, v46, v47
    buffer_store_dwordx4 v[120:123], v214, s[52:55], s84 offen offset:0 sc1
    v_cvt_pk_bf16_f32 v124, v48, v49
    v_mfma_f32_16x16x32_bf16 v[72:75], v[184:187], v[140:143], v[72:75]
    v_cvt_pk_bf16_f32 v125, v50, v51
    v_cvt_pk_bf16_f32 v126, v52, v53
    v_cvt_pk_bf16_f32 v127, v54, v55
    v_mfma_f32_16x16x32_bf16 v[76:79], v[188:191], v[140:143], v[76:79]
    buffer_store_dwordx4 v[124:127], v214, s[52:55], s85 offen offset:0 sc1
    v_cvt_pk_bf16_f32 v56, v58, v59
    v_mov_b32 v57, 0x3f803f80
    buffer_store_dwordx2 v[56:57], v215, s[52:55], s84 offen offset:0 sc1
    v_mfma_f32_16x16x32_bf16 v[80:83], v[172:175], v[144:147], v[80:83]
    v_mfma_f32_16x16x32_bf16 v[84:87], v[176:179], v[144:147], v[84:87]
    v_cvt_pk_bf16_f32 v128, v60, v61
    v_cvt_pk_bf16_f32 v129, v62, v63
    v_cvt_pk_bf16_f32 v130, v64, v65
    v_mfma_f32_16x16x32_bf16 v[88:91], v[180:183], v[144:147], v[88:91]
    v_cvt_pk_bf16_f32 v131, v66, v67
    buffer_store_dwordx4 v[128:131], v214, s[52:55], s84 offen offset:128 sc1
    v_cvt_pk_bf16_f32 v132, v68, v69
    v_mfma_f32_16x16x32_bf16 v[92:95], v[184:187], v[144:147], v[92:95]
    v_cvt_pk_bf16_f32 v133, v70, v71
    v_cvt_pk_bf16_f32 v134, v72, v73
    v_cvt_pk_bf16_f32 v135, v74, v75
    v_mfma_f32_16x16x32_bf16 v[96:99], v[188:191], v[144:147], v[96:99]
    buffer_store_dwordx4 v[132:135], v214, s[52:55], s85 offen offset:128 sc1
    v_cvt_pk_bf16_f32 v76, v78, v79
    v_mov_b32 v77, 0x3f803f80
    buffer_store_dwordx2 v[76:77], v215, s[52:55], s84 offen offset:128 sc1
    v_mfma_f32_16x16x32_bf16 v[100:103], v[172:175], v[148:151], v[100:103]
    v_mfma_f32_16x16x32_bf16 v[104:107], v[176:179], v[148:151], v[104:107]
    v_cvt_pk_bf16_f32 v152, v80, v81
    v_cvt_pk_bf16_f32 v153, v82, v83
    v_cvt_pk_bf16_f32 v154, v84, v85
    v_mfma_f32_16x16x32_bf16 v[108:111], v[180:183], v[148:151], v[108:111]
    v_cvt_pk_bf16_f32 v155, v86, v87
    buffer_store_dwordx4 v[152:155], v214, s[52:55], s86 offen offset:0 sc1
    v_cvt_pk_bf16_f32 v156, v88, v89
    v_mfma_f32_16x16x32_bf16 v[112:115], v[184:187], v[148:151], v[112:115]
    v_cvt_pk_bf16_f32 v157, v90, v91
    v_cvt_pk_bf16_f32 v158, v92, v93
    v_cvt_pk_bf16_f32 v159, v94, v95
    v_mfma_f32_16x16x32_bf16 v[116:119], v[188:191], v[148:151], v[116:119]
    buffer_store_dwordx4 v[156:159], v214, s[52:55], s87 offen offset:0 sc1
    v_cvt_pk_bf16_f32 v96, v98, v99
    v_mov_b32 v97, 0x3f803f80
    buffer_store_dwordx2 v[96:97], v215, s[52:55], s86 offen offset:0 sc1
    v_cvt_pk_bf16_f32 v160, v100, v101
    v_cvt_pk_bf16_f32 v161, v102, v103
    v_cvt_pk_bf16_f32 v162, v104, v105
    v_cvt_pk_bf16_f32 v163, v106, v107
    buffer_store_dwordx4 v[160:163], v214, s[52:55], s86 offen offset:128 sc1
    v_cvt_pk_bf16_f32 v164, v108, v109
    v_cvt_pk_bf16_f32 v165, v110, v111
    v_cvt_pk_bf16_f32 v166, v112, v113
    v_cvt_pk_bf16_f32 v167, v114, v115
    buffer_store_dwordx4 v[164:167], v214, s[52:55], s87 offen offset:128 sc1
    v_cvt_pk_bf16_f32 v116, v118, v119
    v_mov_b32 v117, 0x3f803f80
    buffer_store_dwordx2 v[116:117], v215, s[52:55], s86 offen offset:128 sc1
    s_branch L_a1_join
L_a1_v:
    s_waitcnt lgkmcnt(11)
    v_mfma_f32_16x16x32_bf16 v[40:43], v[120:123], v[152:155], 0
    ds_read_b128 v[136:139], v197 offset:0
    s_waitcnt lgkmcnt(11)
    v_mfma_f32_16x16x32_bf16 v[60:63], v[124:127], v[152:155], 0
    ds_read_b64_tr_b16 v[172:173], v200 offset:12288
    s_waitcnt lgkmcnt(11)
    v_mfma_f32_16x16x32_bf16 v[80:83], v[128:131], v[152:155], 0
    ds_read_b64_tr_b16 v[174:175], v200 offset:13824
    s_waitcnt lgkmcnt(11)
    v_mfma_f32_16x16x32_bf16 v[100:103], v[132:135], v[152:155], 0
    s_waitcnt lgkmcnt(9)
    v_mfma_f32_16x16x32_bf16 v[44:47], v[120:123], v[156:159], 0
    ds_read_b128 v[140:143], v197 offset:2048
    v_mfma_f32_16x16x32_bf16 v[64:67], v[124:127], v[156:159], 0
    ds_read_b128 v[144:147], v197 offset:4096
    v_mfma_f32_16x16x32_bf16 v[84:87], v[128:131], v[156:159], 0
    v_mfma_f32_16x16x32_bf16 v[104:107], v[132:135], v[156:159], 0
    ds_read_b128 v[148:151], v197 offset:6144
    s_waitcnt lgkmcnt(10)
    v_mfma_f32_16x16x32_bf16 v[48:51], v[120:123], v[160:163], 0
    ds_read_b64_tr_b16 v[176:177], v201 offset:12288
    v_mfma_f32_16x16x32_bf16 v[68:71], v[124:127], v[160:163], 0
    v_mfma_f32_16x16x32_bf16 v[88:91], v[128:131], v[160:163], 0
    ds_read_b64_tr_b16 v[178:179], v201 offset:13824
    v_mfma_f32_16x16x32_bf16 v[108:111], v[132:135], v[160:163], 0
    ds_read_b64_tr_b16 v[180:181], v202 offset:12288
    s_waitcnt lgkmcnt(11)
    v_mfma_f32_16x16x32_bf16 v[52:55], v[120:123], v[164:167], 0
    ds_read_b64_tr_b16 v[182:183], v202 offset:13824
    v_mfma_f32_16x16x32_bf16 v[72:75], v[124:127], v[164:167], 0
    v_mfma_f32_16x16x32_bf16 v[92:95], v[128:131], v[164:167], 0
    ds_read_b64_tr_b16 v[184:185], v203 offset:12288
    v_mfma_f32_16x16x32_bf16 v[112:115], v[132:135], v[164:167], 0
    ds_read_b64_tr_b16 v[186:187], v203 offset:13824
    s_waitcnt lgkmcnt(12)
    v_mfma_f32_16x16x32_bf16 v[56:59], v[120:123], v[168:171], 0
    v_mfma_f32_16x16x32_bf16 v[76:79], v[124:127], v[168:171], 0
    ds_read_b64_tr_b16 v[188:189], v204 offset:12288
    v_mfma_f32_16x16x32_bf16 v[96:99], v[128:131], v[168:171], 0
    ds_read_b64_tr_b16 v[190:191], v204 offset:13824
    v_mfma_f32_16x16x32_bf16 v[116:119], v[132:135], v[168:171], 0
    s_waitcnt lgkmcnt(0)
    s_barrier
    v_mfma_f32_16x16x32_bf16 v[40:43], v[136:139], v[172:175], v[40:43]
    ds_read_b128 v[120:123], v196 offset:40960
    v_mfma_f32_16x16x32_bf16 v[60:63], v[140:143], v[172:175], v[60:63]
    ds_read_b64_tr_b16 v[152:153], v200 offset:40960
    v_mfma_f32_16x16x32_bf16 v[80:83], v[144:147], v[172:175], v[80:83]
    ds_read_b64_tr_b16 v[154:155], v200 offset:42496
    v_mfma_f32_16x16x32_bf16 v[100:103], v[148:151], v[172:175], v[100:103]
    v_mfma_f32_16x16x32_bf16 v[44:47], v[136:139], v[176:179], v[44:47]
    ds_read_b128 v[124:127], v196 offset:43008
    v_mfma_f32_16x16x32_bf16 v[64:67], v[140:143], v[176:179], v[64:67]
    ds_read_b128 v[128:131], v196 offset:45056
    v_mfma_f32_16x16x32_bf16 v[84:87], v[144:147], v[176:179], v[84:87]
    v_mfma_f32_16x16x32_bf16 v[104:107], v[148:151], v[176:179], v[104:107]
    ds_read_b128 v[132:135], v196 offset:47104
    v_mfma_f32_16x16x32_bf16 v[48:51], v[136:139], v[180:183], v[48:51]
    ds_read_b64_tr_b16 v[156:157], v201 offset:40960
    v_mfma_f32_16x16x32_bf16 v[68:71], v[140:143], v[180:183], v[68:71]
    v_mfma_f32_16x16x32_bf16 v[88:91], v[144:147], v[180:183], v[88:91]
    ds_read_b64_tr_b16 v[158:159], v201 offset:42496
    v_mfma_f32_16x16x32_bf16 v[108:111], v[148:151], v[180:183], v[108:111]
    ds_read_b64_tr_b16 v[160:161], v202 offset:40960
    v_mfma_f32_16x16x32_bf16 v[52:55], v[136:139], v[184:187], v[52:55]
    ds_read_b64_tr_b16 v[162:163], v202 offset:42496
    v_mfma_f32_16x16x32_bf16 v[72:75], v[140:143], v[184:187], v[72:75]
    v_mfma_f32_16x16x32_bf16 v[92:95], v[144:147], v[184:187], v[92:95]
    ds_read_b64_tr_b16 v[164:165], v203 offset:40960
    v_mfma_f32_16x16x32_bf16 v[112:115], v[148:151], v[184:187], v[112:115]
    ds_read_b64_tr_b16 v[166:167], v203 offset:42496
    v_mfma_f32_16x16x32_bf16 v[56:59], v[136:139], v[188:191], v[56:59]
    v_mfma_f32_16x16x32_bf16 v[76:79], v[140:143], v[188:191], v[76:79]
    ds_read_b64_tr_b16 v[168:169], v204 offset:40960
    v_mfma_f32_16x16x32_bf16 v[96:99], v[144:147], v[188:191], v[96:99]
    ds_read_b64_tr_b16 v[170:171], v204 offset:42496
    v_mfma_f32_16x16x32_bf16 v[116:119], v[148:151], v[188:191], v[116:119]
    s_waitcnt lgkmcnt(11)
    v_mfma_f32_16x16x32_bf16 v[40:43], v[120:123], v[152:155], v[40:43]
    ds_read_b128 v[136:139], v197 offset:40960
    s_waitcnt lgkmcnt(11)
    v_mfma_f32_16x16x32_bf16 v[60:63], v[124:127], v[152:155], v[60:63]
    ds_read_b64_tr_b16 v[172:173], v200 offset:53248
    s_waitcnt lgkmcnt(11)
    v_mfma_f32_16x16x32_bf16 v[80:83], v[128:131], v[152:155], v[80:83]
    ds_read_b64_tr_b16 v[174:175], v200 offset:54784
    s_waitcnt lgkmcnt(11)
    v_mfma_f32_16x16x32_bf16 v[100:103], v[132:135], v[152:155], v[100:103]
    s_waitcnt lgkmcnt(9)
    v_mfma_f32_16x16x32_bf16 v[44:47], v[120:123], v[156:159], v[44:47]
    ds_read_b128 v[140:143], v197 offset:43008
    v_mfma_f32_16x16x32_bf16 v[64:67], v[124:127], v[156:159], v[64:67]
    ds_read_b128 v[144:147], v197 offset:45056
    v_mfma_f32_16x16x32_bf16 v[84:87], v[128:131], v[156:159], v[84:87]
    v_mfma_f32_16x16x32_bf16 v[104:107], v[132:135], v[156:159], v[104:107]
    ds_read_b128 v[148:151], v197 offset:47104
    s_waitcnt lgkmcnt(10)
    v_mfma_f32_16x16x32_bf16 v[48:51], v[120:123], v[160:163], v[48:51]
    ds_read_b64_tr_b16 v[176:177], v201 offset:53248
    v_mfma_f32_16x16x32_bf16 v[68:71], v[124:127], v[160:163], v[68:71]
    v_mfma_f32_16x16x32_bf16 v[88:91], v[128:131], v[160:163], v[88:91]
    ds_read_b64_tr_b16 v[178:179], v201 offset:54784
    v_mfma_f32_16x16x32_bf16 v[108:111], v[132:135], v[160:163], v[108:111]
    ds_read_b64_tr_b16 v[180:181], v202 offset:53248
    s_waitcnt lgkmcnt(11)
    v_mfma_f32_16x16x32_bf16 v[52:55], v[120:123], v[164:167], v[52:55]
    ds_read_b64_tr_b16 v[182:183], v202 offset:54784
    v_mfma_f32_16x16x32_bf16 v[72:75], v[124:127], v[164:167], v[72:75]
    v_mfma_f32_16x16x32_bf16 v[92:95], v[128:131], v[164:167], v[92:95]
    ds_read_b64_tr_b16 v[184:185], v203 offset:53248
    v_mfma_f32_16x16x32_bf16 v[112:115], v[132:135], v[164:167], v[112:115]
    ds_read_b64_tr_b16 v[186:187], v203 offset:54784
    s_waitcnt lgkmcnt(12)
    v_mfma_f32_16x16x32_bf16 v[56:59], v[120:123], v[168:171], v[56:59]
    v_mfma_f32_16x16x32_bf16 v[76:79], v[124:127], v[168:171], v[76:79]
    ds_read_b64_tr_b16 v[188:189], v204 offset:53248
    v_mfma_f32_16x16x32_bf16 v[96:99], v[128:131], v[168:171], v[96:99]
    ds_read_b64_tr_b16 v[190:191], v204 offset:54784
    v_mfma_f32_16x16x32_bf16 v[116:119], v[132:135], v[168:171], v[116:119]
    s_waitcnt lgkmcnt(0)
    s_barrier
    v_mfma_f32_16x16x32_bf16 v[40:43], v[136:139], v[172:175], v[40:43]
    ds_read_b128 v[120:123], v198 offset:0
    v_mfma_f32_16x16x32_bf16 v[60:63], v[140:143], v[172:175], v[60:63]
    ds_read_b64_tr_b16 v[152:153], v205 offset:0
    v_mfma_f32_16x16x32_bf16 v[80:83], v[144:147], v[172:175], v[80:83]
    ds_read_b64_tr_b16 v[154:155], v205 offset:1536
    v_mfma_f32_16x16x32_bf16 v[100:103], v[148:151], v[172:175], v[100:103]
    v_mfma_f32_16x16x32_bf16 v[44:47], v[136:139], v[176:179], v[44:47]
    ds_read_b128 v[124:127], v198 offset:2048
    v_mfma_f32_16x16x32_bf16 v[64:67], v[140:143], v[176:179], v[64:67]
    ds_read_b128 v[128:131], v198 offset:4096
    v_mfma_f32_16x16x32_bf16 v[84:87], v[144:147], v[176:179], v[84:87]
    v_mfma_f32_16x16x32_bf16 v[104:107], v[148:151], v[176:179], v[104:107]
    ds_read_b128 v[132:135], v198 offset:6144
    v_mfma_f32_16x16x32_bf16 v[48:51], v[136:139], v[180:183], v[48:51]
    ds_read_b64_tr_b16 v[156:157], v206 offset:0
    v_mfma_f32_16x16x32_bf16 v[68:71], v[140:143], v[180:183], v[68:71]
    v_mfma_f32_16x16x32_bf16 v[88:91], v[144:147], v[180:183], v[88:91]
    ds_read_b64_tr_b16 v[158:159], v206 offset:1536
    v_mfma_f32_16x16x32_bf16 v[108:111], v[148:151], v[180:183], v[108:111]
    ds_read_b64_tr_b16 v[160:161], v207 offset:0
    v_mfma_f32_16x16x32_bf16 v[52:55], v[136:139], v[184:187], v[52:55]
    ds_read_b64_tr_b16 v[162:163], v207 offset:1536
    v_mfma_f32_16x16x32_bf16 v[72:75], v[140:143], v[184:187], v[72:75]
    v_mfma_f32_16x16x32_bf16 v[92:95], v[144:147], v[184:187], v[92:95]
    ds_read_b64_tr_b16 v[164:165], v208 offset:0
    v_mfma_f32_16x16x32_bf16 v[112:115], v[148:151], v[184:187], v[112:115]
    ds_read_b64_tr_b16 v[166:167], v208 offset:1536
    v_mfma_f32_16x16x32_bf16 v[56:59], v[136:139], v[188:191], v[56:59]
    v_mfma_f32_16x16x32_bf16 v[76:79], v[140:143], v[188:191], v[76:79]
    ds_read_b64_tr_b16 v[168:169], v209 offset:0
    v_mfma_f32_16x16x32_bf16 v[96:99], v[144:147], v[188:191], v[96:99]
    ds_read_b64_tr_b16 v[170:171], v209 offset:1536
    v_mfma_f32_16x16x32_bf16 v[116:119], v[148:151], v[188:191], v[116:119]
    s_waitcnt lgkmcnt(11)
    v_mfma_f32_16x16x32_bf16 v[40:43], v[120:123], v[152:155], v[40:43]
    ds_read_b128 v[136:139], v199 offset:0
    s_waitcnt lgkmcnt(11)
    v_mfma_f32_16x16x32_bf16 v[60:63], v[124:127], v[152:155], v[60:63]
    ds_read_b64_tr_b16 v[172:173], v205 offset:12288
    s_waitcnt lgkmcnt(11)
    v_mfma_f32_16x16x32_bf16 v[80:83], v[128:131], v[152:155], v[80:83]
    ds_read_b64_tr_b16 v[174:175], v205 offset:13824
    s_waitcnt lgkmcnt(11)
    v_mfma_f32_16x16x32_bf16 v[100:103], v[132:135], v[152:155], v[100:103]
    s_waitcnt lgkmcnt(9)
    v_mfma_f32_16x16x32_bf16 v[44:47], v[120:123], v[156:159], v[44:47]
    ds_read_b128 v[140:143], v199 offset:2048
    v_mfma_f32_16x16x32_bf16 v[64:67], v[124:127], v[156:159], v[64:67]
    ds_read_b128 v[144:147], v199 offset:4096
    v_mfma_f32_16x16x32_bf16 v[84:87], v[128:131], v[156:159], v[84:87]
    v_mfma_f32_16x16x32_bf16 v[104:107], v[132:135], v[156:159], v[104:107]
    ds_read_b128 v[148:151], v199 offset:6144
    s_waitcnt lgkmcnt(10)
    v_mfma_f32_16x16x32_bf16 v[48:51], v[120:123], v[160:163], v[48:51]
    ds_read_b64_tr_b16 v[176:177], v206 offset:12288
    v_mfma_f32_16x16x32_bf16 v[68:71], v[124:127], v[160:163], v[68:71]
    v_mfma_f32_16x16x32_bf16 v[88:91], v[128:131], v[160:163], v[88:91]
    ds_read_b64_tr_b16 v[178:179], v206 offset:13824
    v_mfma_f32_16x16x32_bf16 v[108:111], v[132:135], v[160:163], v[108:111]
    ds_read_b64_tr_b16 v[180:181], v207 offset:12288
    s_waitcnt lgkmcnt(11)
    v_mfma_f32_16x16x32_bf16 v[52:55], v[120:123], v[164:167], v[52:55]
    ds_read_b64_tr_b16 v[182:183], v207 offset:13824
    v_mfma_f32_16x16x32_bf16 v[72:75], v[124:127], v[164:167], v[72:75]
    v_mfma_f32_16x16x32_bf16 v[92:95], v[128:131], v[164:167], v[92:95]
    ds_read_b64_tr_b16 v[184:185], v208 offset:12288
    v_mfma_f32_16x16x32_bf16 v[112:115], v[132:135], v[164:167], v[112:115]
    ds_read_b64_tr_b16 v[186:187], v208 offset:13824
    s_waitcnt lgkmcnt(12)
    v_mfma_f32_16x16x32_bf16 v[56:59], v[120:123], v[168:171], v[56:59]
    v_mfma_f32_16x16x32_bf16 v[76:79], v[124:127], v[168:171], v[76:79]
    ds_read_b64_tr_b16 v[188:189], v209 offset:12288
    v_mfma_f32_16x16x32_bf16 v[96:99], v[128:131], v[168:171], v[96:99]
    ds_read_b64_tr_b16 v[190:191], v209 offset:13824
    v_mfma_f32_16x16x32_bf16 v[116:119], v[132:135], v[168:171], v[116:119]
    s_waitcnt lgkmcnt(0)
    s_barrier
    v_mfma_f32_16x16x32_bf16 v[40:43], v[136:139], v[172:175], v[40:43]
    ds_read_b128 v[120:123], v198 offset:40960
    v_mfma_f32_16x16x32_bf16 v[60:63], v[140:143], v[172:175], v[60:63]
    ds_read_b64_tr_b16 v[152:153], v205 offset:40960
    v_mfma_f32_16x16x32_bf16 v[80:83], v[144:147], v[172:175], v[80:83]
    ds_read_b64_tr_b16 v[154:155], v205 offset:42496
    v_mfma_f32_16x16x32_bf16 v[100:103], v[148:151], v[172:175], v[100:103]
    v_mfma_f32_16x16x32_bf16 v[44:47], v[136:139], v[176:179], v[44:47]
    ds_read_b128 v[124:127], v198 offset:43008
    v_mfma_f32_16x16x32_bf16 v[64:67], v[140:143], v[176:179], v[64:67]
    ds_read_b128 v[128:131], v198 offset:45056
    v_mfma_f32_16x16x32_bf16 v[84:87], v[144:147], v[176:179], v[84:87]
    v_mfma_f32_16x16x32_bf16 v[104:107], v[148:151], v[176:179], v[104:107]
    ds_read_b128 v[132:135], v198 offset:47104
    v_mfma_f32_16x16x32_bf16 v[48:51], v[136:139], v[180:183], v[48:51]
    ds_read_b64_tr_b16 v[156:157], v206 offset:40960
    v_mfma_f32_16x16x32_bf16 v[68:71], v[140:143], v[180:183], v[68:71]
    v_mfma_f32_16x16x32_bf16 v[88:91], v[144:147], v[180:183], v[88:91]
    ds_read_b64_tr_b16 v[158:159], v206 offset:42496
    v_mfma_f32_16x16x32_bf16 v[108:111], v[148:151], v[180:183], v[108:111]
    ds_read_b64_tr_b16 v[160:161], v207 offset:40960
    v_mfma_f32_16x16x32_bf16 v[52:55], v[136:139], v[184:187], v[52:55]
    ds_read_b64_tr_b16 v[162:163], v207 offset:42496
    v_mfma_f32_16x16x32_bf16 v[72:75], v[140:143], v[184:187], v[72:75]
    v_mfma_f32_16x16x32_bf16 v[92:95], v[144:147], v[184:187], v[92:95]
    ds_read_b64_tr_b16 v[164:165], v208 offset:40960
    v_mfma_f32_16x16x32_bf16 v[112:115], v[148:151], v[184:187], v[112:115]
    ds_read_b64_tr_b16 v[166:167], v208 offset:42496
    v_mfma_f32_16x16x32_bf16 v[56:59], v[136:139], v[188:191], v[56:59]
    v_mfma_f32_16x16x32_bf16 v[76:79], v[140:143], v[188:191], v[76:79]
    ds_read_b64_tr_b16 v[168:169], v209 offset:40960
    v_mfma_f32_16x16x32_bf16 v[96:99], v[144:147], v[188:191], v[96:99]
    ds_read_b64_tr_b16 v[170:171], v209 offset:42496
    v_mfma_f32_16x16x32_bf16 v[116:119], v[148:151], v[188:191], v[116:119]
    s_waitcnt lgkmcnt(11)
    v_mfma_f32_16x16x32_bf16 v[40:43], v[120:123], v[152:155], v[40:43]
    ds_read_b128 v[136:139], v199 offset:40960
    s_waitcnt lgkmcnt(11)
    v_mfma_f32_16x16x32_bf16 v[60:63], v[124:127], v[152:155], v[60:63]
    ds_read_b64_tr_b16 v[172:173], v205 offset:53248
    s_waitcnt lgkmcnt(11)
    v_mfma_f32_16x16x32_bf16 v[80:83], v[128:131], v[152:155], v[80:83]
    ds_read_b64_tr_b16 v[174:175], v205 offset:54784
    s_waitcnt lgkmcnt(11)
    v_mfma_f32_16x16x32_bf16 v[100:103], v[132:135], v[152:155], v[100:103]
    s_waitcnt lgkmcnt(9)
    v_mfma_f32_16x16x32_bf16 v[44:47], v[120:123], v[156:159], v[44:47]
    ds_read_b128 v[140:143], v199 offset:43008
    v_mfma_f32_16x16x32_bf16 v[64:67], v[124:127], v[156:159], v[64:67]
    ds_read_b128 v[144:147], v199 offset:45056
    v_mfma_f32_16x16x32_bf16 v[84:87], v[128:131], v[156:159], v[84:87]
    v_mfma_f32_16x16x32_bf16 v[104:107], v[132:135], v[156:159], v[104:107]
    ds_read_b128 v[148:151], v199 offset:47104
    s_waitcnt lgkmcnt(10)
    v_mfma_f32_16x16x32_bf16 v[48:51], v[120:123], v[160:163], v[48:51]
    ds_read_b64_tr_b16 v[176:177], v206 offset:53248
    v_mfma_f32_16x16x32_bf16 v[68:71], v[124:127], v[160:163], v[68:71]
    v_mfma_f32_16x16x32_bf16 v[88:91], v[128:131], v[160:163], v[88:91]
    ds_read_b64_tr_b16 v[178:179], v206 offset:54784
    v_mfma_f32_16x16x32_bf16 v[108:111], v[132:135], v[160:163], v[108:111]
    ds_read_b64_tr_b16 v[180:181], v207 offset:53248
    s_waitcnt lgkmcnt(11)
    v_mfma_f32_16x16x32_bf16 v[52:55], v[120:123], v[164:167], v[52:55]
    ds_read_b64_tr_b16 v[182:183], v207 offset:54784
    v_mfma_f32_16x16x32_bf16 v[72:75], v[124:127], v[164:167], v[72:75]
    v_mfma_f32_16x16x32_bf16 v[92:95], v[128:131], v[164:167], v[92:95]
    ds_read_b64_tr_b16 v[184:185], v208 offset:53248
    v_mfma_f32_16x16x32_bf16 v[112:115], v[132:135], v[164:167], v[112:115]
    ds_read_b64_tr_b16 v[186:187], v208 offset:54784
    s_waitcnt lgkmcnt(12)
    v_mfma_f32_16x16x32_bf16 v[56:59], v[120:123], v[168:171], v[56:59]
    v_mfma_f32_16x16x32_bf16 v[76:79], v[124:127], v[168:171], v[76:79]
    ds_read_b64_tr_b16 v[188:189], v209 offset:53248
    v_mfma_f32_16x16x32_bf16 v[96:99], v[128:131], v[168:171], v[96:99]
    ds_read_b64_tr_b16 v[190:191], v209 offset:54784
    v_mfma_f32_16x16x32_bf16 v[116:119], v[132:135], v[168:171], v[116:119]
    s_waitcnt lgkmcnt(0)
    s_barrier
    v_mfma_f32_16x16x32_bf16 v[40:43], v[136:139], v[172:175], v[40:43]
    ds_read_b128 v[120:123], v196 offset:0
    v_mfma_f32_16x16x32_bf16 v[60:63], v[140:143], v[172:175], v[60:63]
    ds_read_b64_tr_b16 v[152:153], v200 offset:0
    v_mfma_f32_16x16x32_bf16 v[80:83], v[144:147], v[172:175], v[80:83]
    ds_read_b64_tr_b16 v[154:155], v200 offset:1536
    v_mfma_f32_16x16x32_bf16 v[100:103], v[148:151], v[172:175], v[100:103]
    v_mfma_f32_16x16x32_bf16 v[44:47], v[136:139], v[176:179], v[44:47]
    ds_read_b128 v[124:127], v196 offset:2048
    v_mfma_f32_16x16x32_bf16 v[64:67], v[140:143], v[176:179], v[64:67]
    ds_read_b128 v[128:131], v196 offset:4096
    v_mfma_f32_16x16x32_bf16 v[84:87], v[144:147], v[176:179], v[84:87]
    v_mfma_f32_16x16x32_bf16 v[104:107], v[148:151], v[176:179], v[104:107]
    ds_read_b128 v[132:135], v196 offset:6144
    v_mfma_f32_16x16x32_bf16 v[48:51], v[136:139], v[180:183], v[48:51]
    ds_read_b64_tr_b16 v[156:157], v201 offset:0
    v_mfma_f32_16x16x32_bf16 v[68:71], v[140:143], v[180:183], v[68:71]
    v_mfma_f32_16x16x32_bf16 v[88:91], v[144:147], v[180:183], v[88:91]
    ds_read_b64_tr_b16 v[158:159], v201 offset:1536
    v_mfma_f32_16x16x32_bf16 v[108:111], v[148:151], v[180:183], v[108:111]
    ds_read_b64_tr_b16 v[160:161], v202 offset:0
    v_mfma_f32_16x16x32_bf16 v[52:55], v[136:139], v[184:187], v[52:55]
    ds_read_b64_tr_b16 v[162:163], v202 offset:1536
    v_mfma_f32_16x16x32_bf16 v[72:75], v[140:143], v[184:187], v[72:75]
    v_mfma_f32_16x16x32_bf16 v[92:95], v[144:147], v[184:187], v[92:95]
    ds_read_b64_tr_b16 v[164:165], v203 offset:0
    v_mfma_f32_16x16x32_bf16 v[112:115], v[148:151], v[184:187], v[112:115]
    ds_read_b64_tr_b16 v[166:167], v203 offset:1536
    v_mfma_f32_16x16x32_bf16 v[56:59], v[136:139], v[188:191], v[56:59]
    v_mfma_f32_16x16x32_bf16 v[76:79], v[140:143], v[188:191], v[76:79]
    ds_read_b64_tr_b16 v[168:169], v204 offset:0
    v_mfma_f32_16x16x32_bf16 v[96:99], v[144:147], v[188:191], v[96:99]
    ds_read_b64_tr_b16 v[170:171], v204 offset:1536
    v_mfma_f32_16x16x32_bf16 v[116:119], v[148:151], v[188:191], v[116:119]
    s_waitcnt lgkmcnt(11)
    v_mfma_f32_16x16x32_bf16 v[40:43], v[120:123], v[152:155], v[40:43]
    ds_read_b128 v[136:139], v197 offset:0
    s_waitcnt lgkmcnt(11)
    v_mfma_f32_16x16x32_bf16 v[60:63], v[124:127], v[152:155], v[60:63]
    ds_read_b64_tr_b16 v[172:173], v200 offset:12288
    s_waitcnt lgkmcnt(11)
    v_mfma_f32_16x16x32_bf16 v[80:83], v[128:131], v[152:155], v[80:83]
    ds_read_b64_tr_b16 v[174:175], v200 offset:13824
    s_waitcnt lgkmcnt(11)
    v_mfma_f32_16x16x32_bf16 v[100:103], v[132:135], v[152:155], v[100:103]
    s_waitcnt lgkmcnt(9)
    v_mfma_f32_16x16x32_bf16 v[44:47], v[120:123], v[156:159], v[44:47]
    ds_read_b128 v[140:143], v197 offset:2048
    v_mfma_f32_16x16x32_bf16 v[64:67], v[124:127], v[156:159], v[64:67]
    ds_read_b128 v[144:147], v197 offset:4096
    v_mfma_f32_16x16x32_bf16 v[84:87], v[128:131], v[156:159], v[84:87]
    v_mfma_f32_16x16x32_bf16 v[104:107], v[132:135], v[156:159], v[104:107]
    ds_read_b128 v[148:151], v197 offset:6144
    s_waitcnt lgkmcnt(10)
    v_mfma_f32_16x16x32_bf16 v[48:51], v[120:123], v[160:163], v[48:51]
    ds_read_b64_tr_b16 v[176:177], v201 offset:12288
    v_mfma_f32_16x16x32_bf16 v[68:71], v[124:127], v[160:163], v[68:71]
    v_mfma_f32_16x16x32_bf16 v[88:91], v[128:131], v[160:163], v[88:91]
    ds_read_b64_tr_b16 v[178:179], v201 offset:13824
    v_mfma_f32_16x16x32_bf16 v[108:111], v[132:135], v[160:163], v[108:111]
    ds_read_b64_tr_b16 v[180:181], v202 offset:12288
    s_waitcnt lgkmcnt(11)
    v_mfma_f32_16x16x32_bf16 v[52:55], v[120:123], v[164:167], v[52:55]
    ds_read_b64_tr_b16 v[182:183], v202 offset:13824
    v_mfma_f32_16x16x32_bf16 v[72:75], v[124:127], v[164:167], v[72:75]
    v_mfma_f32_16x16x32_bf16 v[92:95], v[128:131], v[164:167], v[92:95]
    ds_read_b64_tr_b16 v[184:185], v203 offset:12288
    v_mfma_f32_16x16x32_bf16 v[112:115], v[132:135], v[164:167], v[112:115]
    ds_read_b64_tr_b16 v[186:187], v203 offset:13824
    s_waitcnt lgkmcnt(12)
    v_mfma_f32_16x16x32_bf16 v[56:59], v[120:123], v[168:171], v[56:59]
    v_mfma_f32_16x16x32_bf16 v[76:79], v[124:127], v[168:171], v[76:79]
    ds_read_b64_tr_b16 v[188:189], v204 offset:12288
    v_mfma_f32_16x16x32_bf16 v[96:99], v[128:131], v[168:171], v[96:99]
    ds_read_b64_tr_b16 v[190:191], v204 offset:13824
    v_mfma_f32_16x16x32_bf16 v[116:119], v[132:135], v[168:171], v[116:119]
    s_waitcnt lgkmcnt(0)
    s_barrier
    v_mfma_f32_16x16x32_bf16 v[40:43], v[136:139], v[172:175], v[40:43]
    ds_read_b128 v[120:123], v196 offset:40960
    v_mfma_f32_16x16x32_bf16 v[60:63], v[140:143], v[172:175], v[60:63]
    ds_read_b64_tr_b16 v[152:153], v200 offset:40960
    v_mfma_f32_16x16x32_bf16 v[80:83], v[144:147], v[172:175], v[80:83]
    ds_read_b64_tr_b16 v[154:155], v200 offset:42496
    v_mfma_f32_16x16x32_bf16 v[100:103], v[148:151], v[172:175], v[100:103]
    v_mfma_f32_16x16x32_bf16 v[44:47], v[136:139], v[176:179], v[44:47]
    ds_read_b128 v[124:127], v196 offset:43008
    v_mfma_f32_16x16x32_bf16 v[64:67], v[140:143], v[176:179], v[64:67]
    ds_read_b128 v[128:131], v196 offset:45056
    v_mfma_f32_16x16x32_bf16 v[84:87], v[144:147], v[176:179], v[84:87]
    v_mfma_f32_16x16x32_bf16 v[104:107], v[148:151], v[176:179], v[104:107]
    ds_read_b128 v[132:135], v196 offset:47104
    v_mfma_f32_16x16x32_bf16 v[48:51], v[136:139], v[180:183], v[48:51]
    ds_read_b64_tr_b16 v[156:157], v201 offset:40960
    v_mfma_f32_16x16x32_bf16 v[68:71], v[140:143], v[180:183], v[68:71]
    v_mfma_f32_16x16x32_bf16 v[88:91], v[144:147], v[180:183], v[88:91]
    ds_read_b64_tr_b16 v[158:159], v201 offset:42496
    v_mfma_f32_16x16x32_bf16 v[108:111], v[148:151], v[180:183], v[108:111]
    ds_read_b64_tr_b16 v[160:161], v202 offset:40960
    v_mfma_f32_16x16x32_bf16 v[52:55], v[136:139], v[184:187], v[52:55]
    ds_read_b64_tr_b16 v[162:163], v202 offset:42496
    v_mfma_f32_16x16x32_bf16 v[72:75], v[140:143], v[184:187], v[72:75]
    v_mfma_f32_16x16x32_bf16 v[92:95], v[144:147], v[184:187], v[92:95]
    ds_read_b64_tr_b16 v[164:165], v203 offset:40960
    v_mfma_f32_16x16x32_bf16 v[112:115], v[148:151], v[184:187], v[112:115]
    ds_read_b64_tr_b16 v[166:167], v203 offset:42496
    v_mfma_f32_16x16x32_bf16 v[56:59], v[136:139], v[188:191], v[56:59]
    v_mfma_f32_16x16x32_bf16 v[76:79], v[140:143], v[188:191], v[76:79]
    ds_read_b64_tr_b16 v[168:169], v204 offset:40960
    v_mfma_f32_16x16x32_bf16 v[96:99], v[144:147], v[188:191], v[96:99]
    ds_read_b64_tr_b16 v[170:171], v204 offset:42496
    v_mfma_f32_16x16x32_bf16 v[116:119], v[148:151], v[188:191], v[116:119]
    s_waitcnt lgkmcnt(11)
    v_mfma_f32_16x16x32_bf16 v[40:43], v[120:123], v[152:155], v[40:43]
    ds_read_b128 v[136:139], v197 offset:40960
    s_waitcnt lgkmcnt(11)
    v_mfma_f32_16x16x32_bf16 v[60:63], v[124:127], v[152:155], v[60:63]
    ds_read_b64_tr_b16 v[172:173], v200 offset:53248
    s_waitcnt lgkmcnt(11)
    v_mfma_f32_16x16x32_bf16 v[80:83], v[128:131], v[152:155], v[80:83]
    ds_read_b64_tr_b16 v[174:175], v200 offset:54784
    s_waitcnt lgkmcnt(11)
    v_mfma_f32_16x16x32_bf16 v[100:103], v[132:135], v[152:155], v[100:103]
    s_waitcnt lgkmcnt(9)
    v_mfma_f32_16x16x32_bf16 v[44:47], v[120:123], v[156:159], v[44:47]
    ds_read_b128 v[140:143], v197 offset:43008
    v_mfma_f32_16x16x32_bf16 v[64:67], v[124:127], v[156:159], v[64:67]
    ds_read_b128 v[144:147], v197 offset:45056
    v_mfma_f32_16x16x32_bf16 v[84:87], v[128:131], v[156:159], v[84:87]
    v_mfma_f32_16x16x32_bf16 v[104:107], v[132:135], v[156:159], v[104:107]
    ds_read_b128 v[148:151], v197 offset:47104
    s_waitcnt lgkmcnt(10)
    v_mfma_f32_16x16x32_bf16 v[48:51], v[120:123], v[160:163], v[48:51]
    ds_read_b64_tr_b16 v[176:177], v201 offset:53248
    v_mfma_f32_16x16x32_bf16 v[68:71], v[124:127], v[160:163], v[68:71]
    v_mfma_f32_16x16x32_bf16 v[88:91], v[128:131], v[160:163], v[88:91]
    ds_read_b64_tr_b16 v[178:179], v201 offset:54784
    v_mfma_f32_16x16x32_bf16 v[108:111], v[132:135], v[160:163], v[108:111]
    ds_read_b64_tr_b16 v[180:181], v202 offset:53248
    s_waitcnt lgkmcnt(11)
    v_mfma_f32_16x16x32_bf16 v[52:55], v[120:123], v[164:167], v[52:55]
    ds_read_b64_tr_b16 v[182:183], v202 offset:54784
    v_mfma_f32_16x16x32_bf16 v[72:75], v[124:127], v[164:167], v[72:75]
    v_mfma_f32_16x16x32_bf16 v[92:95], v[128:131], v[164:167], v[92:95]
    ds_read_b64_tr_b16 v[184:185], v203 offset:53248
    v_mfma_f32_16x16x32_bf16 v[112:115], v[132:135], v[164:167], v[112:115]
    ds_read_b64_tr_b16 v[186:187], v203 offset:54784
    s_waitcnt lgkmcnt(12)
    v_mfma_f32_16x16x32_bf16 v[56:59], v[120:123], v[168:171], v[56:59]
    v_mfma_f32_16x16x32_bf16 v[76:79], v[124:127], v[168:171], v[76:79]
    ds_read_b64_tr_b16 v[188:189], v204 offset:53248
    v_mfma_f32_16x16x32_bf16 v[96:99], v[128:131], v[168:171], v[96:99]
    ds_read_b64_tr_b16 v[190:191], v204 offset:54784
    v_mfma_f32_16x16x32_bf16 v[116:119], v[132:135], v[168:171], v[116:119]
    s_waitcnt lgkmcnt(0)
    s_barrier
    v_mfma_f32_16x16x32_bf16 v[40:43], v[136:139], v[172:175], v[40:43]
    ds_read_b128 v[120:123], v198 offset:0
    v_mfma_f32_16x16x32_bf16 v[60:63], v[140:143], v[172:175], v[60:63]
    ds_read_b64_tr_b16 v[152:153], v205 offset:0
    v_mfma_f32_16x16x32_bf16 v[80:83], v[144:147], v[172:175], v[80:83]
    ds_read_b64_tr_b16 v[154:155], v205 offset:1536
    v_mfma_f32_16x16x32_bf16 v[100:103], v[148:151], v[172:175], v[100:103]
    v_mfma_f32_16x16x32_bf16 v[44:47], v[136:139], v[176:179], v[44:47]
    ds_read_b128 v[124:127], v198 offset:2048
    v_mfma_f32_16x16x32_bf16 v[64:67], v[140:143], v[176:179], v[64:67]
    ds_read_b128 v[128:131], v198 offset:4096
    v_mfma_f32_16x16x32_bf16 v[84:87], v[144:147], v[176:179], v[84:87]
    v_mfma_f32_16x16x32_bf16 v[104:107], v[148:151], v[176:179], v[104:107]
    ds_read_b128 v[132:135], v198 offset:6144
    v_mfma_f32_16x16x32_bf16 v[48:51], v[136:139], v[180:183], v[48:51]
    ds_read_b64_tr_b16 v[156:157], v206 offset:0
    v_mfma_f32_16x16x32_bf16 v[68:71], v[140:143], v[180:183], v[68:71]
    v_mfma_f32_16x16x32_bf16 v[88:91], v[144:147], v[180:183], v[88:91]
    ds_read_b64_tr_b16 v[158:159], v206 offset:1536
    v_mfma_f32_16x16x32_bf16 v[108:111], v[148:151], v[180:183], v[108:111]
    ds_read_b64_tr_b16 v[160:161], v207 offset:0
    v_mfma_f32_16x16x32_bf16 v[52:55], v[136:139], v[184:187], v[52:55]
    ds_read_b64_tr_b16 v[162:163], v207 offset:1536
    v_mfma_f32_16x16x32_bf16 v[72:75], v[140:143], v[184:187], v[72:75]
    v_mfma_f32_16x16x32_bf16 v[92:95], v[144:147], v[184:187], v[92:95]
    ds_read_b64_tr_b16 v[164:165], v208 offset:0
    v_mfma_f32_16x16x32_bf16 v[112:115], v[148:151], v[184:187], v[112:115]
    ds_read_b64_tr_b16 v[166:167], v208 offset:1536
    v_mfma_f32_16x16x32_bf16 v[56:59], v[136:139], v[188:191], v[56:59]
    v_mfma_f32_16x16x32_bf16 v[76:79], v[140:143], v[188:191], v[76:79]
    ds_read_b64_tr_b16 v[168:169], v209 offset:0
    v_mfma_f32_16x16x32_bf16 v[96:99], v[144:147], v[188:191], v[96:99]
    ds_read_b64_tr_b16 v[170:171], v209 offset:1536
    v_mfma_f32_16x16x32_bf16 v[116:119], v[148:151], v[188:191], v[116:119]
    s_waitcnt lgkmcnt(11)
    v_mfma_f32_16x16x32_bf16 v[40:43], v[120:123], v[152:155], v[40:43]
    ds_read_b128 v[136:139], v199 offset:0
    s_waitcnt lgkmcnt(11)
    v_mfma_f32_16x16x32_bf16 v[60:63], v[124:127], v[152:155], v[60:63]
    ds_read_b64_tr_b16 v[172:173], v205 offset:12288
    s_waitcnt lgkmcnt(11)
    v_mfma_f32_16x16x32_bf16 v[80:83], v[128:131], v[152:155], v[80:83]
    ds_read_b64_tr_b16 v[174:175], v205 offset:13824
    s_waitcnt lgkmcnt(11)
    v_mfma_f32_16x16x32_bf16 v[100:103], v[132:135], v[152:155], v[100:103]
    s_waitcnt lgkmcnt(9)
    v_mfma_f32_16x16x32_bf16 v[44:47], v[120:123], v[156:159], v[44:47]
    ds_read_b128 v[140:143], v199 offset:2048
    v_mfma_f32_16x16x32_bf16 v[64:67], v[124:127], v[156:159], v[64:67]
    ds_read_b128 v[144:147], v199 offset:4096
    v_mfma_f32_16x16x32_bf16 v[84:87], v[128:131], v[156:159], v[84:87]
    v_mfma_f32_16x16x32_bf16 v[104:107], v[132:135], v[156:159], v[104:107]
    ds_read_b128 v[148:151], v199 offset:6144
    s_waitcnt lgkmcnt(10)
    v_mfma_f32_16x16x32_bf16 v[48:51], v[120:123], v[160:163], v[48:51]
    ds_read_b64_tr_b16 v[176:177], v206 offset:12288
    v_mfma_f32_16x16x32_bf16 v[68:71], v[124:127], v[160:163], v[68:71]
    v_mfma_f32_16x16x32_bf16 v[88:91], v[128:131], v[160:163], v[88:91]
    ds_read_b64_tr_b16 v[178:179], v206 offset:13824
    v_mfma_f32_16x16x32_bf16 v[108:111], v[132:135], v[160:163], v[108:111]
    ds_read_b64_tr_b16 v[180:181], v207 offset:12288
    s_waitcnt lgkmcnt(11)
    v_mfma_f32_16x16x32_bf16 v[52:55], v[120:123], v[164:167], v[52:55]
    ds_read_b64_tr_b16 v[182:183], v207 offset:13824
    v_mfma_f32_16x16x32_bf16 v[72:75], v[124:127], v[164:167], v[72:75]
    v_mfma_f32_16x16x32_bf16 v[92:95], v[128:131], v[164:167], v[92:95]
    ds_read_b64_tr_b16 v[184:185], v208 offset:12288
    v_mfma_f32_16x16x32_bf16 v[112:115], v[132:135], v[164:167], v[112:115]
    ds_read_b64_tr_b16 v[186:187], v208 offset:13824
    s_waitcnt lgkmcnt(12)
    v_mfma_f32_16x16x32_bf16 v[56:59], v[120:123], v[168:171], v[56:59]
    v_mfma_f32_16x16x32_bf16 v[76:79], v[124:127], v[168:171], v[76:79]
    ds_read_b64_tr_b16 v[188:189], v209 offset:12288
    v_mfma_f32_16x16x32_bf16 v[96:99], v[128:131], v[168:171], v[96:99]
    ds_read_b64_tr_b16 v[190:191], v209 offset:13824
    v_mfma_f32_16x16x32_bf16 v[116:119], v[132:135], v[168:171], v[116:119]
    s_waitcnt lgkmcnt(0)
    s_barrier
    v_mov_b32 v15, 0
    buffer_load_dword v14, v15, s[60:63], 0 offen sc1
    v_mfma_f32_16x16x32_bf16 v[40:43], v[136:139], v[172:175], v[40:43]
    ds_read_b128 v[120:123], v198 offset:40960
    v_mfma_f32_16x16x32_bf16 v[60:63], v[140:143], v[172:175], v[60:63]
    ds_read_b64_tr_b16 v[152:153], v205 offset:40960
    v_mfma_f32_16x16x32_bf16 v[80:83], v[144:147], v[172:175], v[80:83]
    ds_read_b64_tr_b16 v[154:155], v205 offset:42496
    v_mfma_f32_16x16x32_bf16 v[100:103], v[148:151], v[172:175], v[100:103]
    v_mfma_f32_16x16x32_bf16 v[44:47], v[136:139], v[176:179], v[44:47]
    ds_read_b128 v[124:127], v198 offset:43008
    v_mfma_f32_16x16x32_bf16 v[64:67], v[140:143], v[176:179], v[64:67]
    ds_read_b128 v[128:131], v198 offset:45056
    v_mfma_f32_16x16x32_bf16 v[84:87], v[144:147], v[176:179], v[84:87]
    v_mfma_f32_16x16x32_bf16 v[104:107], v[148:151], v[176:179], v[104:107]
    ds_read_b128 v[132:135], v198 offset:47104
    v_mfma_f32_16x16x32_bf16 v[48:51], v[136:139], v[180:183], v[48:51]
    ds_read_b64_tr_b16 v[156:157], v206 offset:40960
    v_mfma_f32_16x16x32_bf16 v[68:71], v[140:143], v[180:183], v[68:71]
    v_mfma_f32_16x16x32_bf16 v[88:91], v[144:147], v[180:183], v[88:91]
    ds_read_b64_tr_b16 v[158:159], v206 offset:42496
    v_mfma_f32_16x16x32_bf16 v[108:111], v[148:151], v[180:183], v[108:111]
    ds_read_b64_tr_b16 v[160:161], v207 offset:40960
    v_mfma_f32_16x16x32_bf16 v[52:55], v[136:139], v[184:187], v[52:55]
    ds_read_b64_tr_b16 v[162:163], v207 offset:42496
    v_mfma_f32_16x16x32_bf16 v[72:75], v[140:143], v[184:187], v[72:75]
    v_mfma_f32_16x16x32_bf16 v[92:95], v[144:147], v[184:187], v[92:95]
    ds_read_b64_tr_b16 v[164:165], v208 offset:40960
    v_mfma_f32_16x16x32_bf16 v[112:115], v[148:151], v[184:187], v[112:115]
    ds_read_b64_tr_b16 v[166:167], v208 offset:42496
    v_mfma_f32_16x16x32_bf16 v[56:59], v[136:139], v[188:191], v[56:59]
    v_mfma_f32_16x16x32_bf16 v[76:79], v[140:143], v[188:191], v[76:79]
    ds_read_b64_tr_b16 v[168:169], v209 offset:40960
    v_mfma_f32_16x16x32_bf16 v[96:99], v[144:147], v[188:191], v[96:99]
    ds_read_b64_tr_b16 v[170:171], v209 offset:42496
    v_mfma_f32_16x16x32_bf16 v[116:119], v[148:151], v[188:191], v[116:119]
    s_waitcnt lgkmcnt(11)
    v_mfma_f32_16x16x32_bf16 v[40:43], v[120:123], v[152:155], v[40:43]
    ds_read_b128 v[136:139], v199 offset:40960
    s_waitcnt lgkmcnt(11)
    v_mfma_f32_16x16x32_bf16 v[60:63], v[124:127], v[152:155], v[60:63]
    ds_read_b64_tr_b16 v[172:173], v205 offset:53248
    s_waitcnt lgkmcnt(11)
    v_mfma_f32_16x16x32_bf16 v[80:83], v[128:131], v[152:155], v[80:83]
    ds_read_b64_tr_b16 v[174:175], v205 offset:54784
    s_waitcnt lgkmcnt(11)
    v_mfma_f32_16x16x32_bf16 v[100:103], v[132:135], v[152:155], v[100:103]
    s_waitcnt lgkmcnt(9)
    v_mfma_f32_16x16x32_bf16 v[44:47], v[120:123], v[156:159], v[44:47]
    ds_read_b128 v[140:143], v199 offset:43008
    v_mfma_f32_16x16x32_bf16 v[64:67], v[124:127], v[156:159], v[64:67]
    ds_read_b128 v[144:147], v199 offset:45056
    v_mfma_f32_16x16x32_bf16 v[84:87], v[128:131], v[156:159], v[84:87]
    v_mfma_f32_16x16x32_bf16 v[104:107], v[132:135], v[156:159], v[104:107]
    ds_read_b128 v[148:151], v199 offset:47104
    s_waitcnt lgkmcnt(10)
    v_mfma_f32_16x16x32_bf16 v[48:51], v[120:123], v[160:163], v[48:51]
    ds_read_b64_tr_b16 v[176:177], v206 offset:53248
    v_mfma_f32_16x16x32_bf16 v[68:71], v[124:127], v[160:163], v[68:71]
    v_mfma_f32_16x16x32_bf16 v[88:91], v[128:131], v[160:163], v[88:91]
    ds_read_b64_tr_b16 v[178:179], v206 offset:54784
    v_mfma_f32_16x16x32_bf16 v[108:111], v[132:135], v[160:163], v[108:111]
    ds_read_b64_tr_b16 v[180:181], v207 offset:53248
    s_waitcnt lgkmcnt(11)
    v_mfma_f32_16x16x32_bf16 v[52:55], v[120:123], v[164:167], v[52:55]
    ds_read_b64_tr_b16 v[182:183], v207 offset:54784
    v_mfma_f32_16x16x32_bf16 v[72:75], v[124:127], v[164:167], v[72:75]
    v_mfma_f32_16x16x32_bf16 v[92:95], v[128:131], v[164:167], v[92:95]
    ds_read_b64_tr_b16 v[184:185], v208 offset:53248
    v_mfma_f32_16x16x32_bf16 v[112:115], v[132:135], v[164:167], v[112:115]
    ds_read_b64_tr_b16 v[186:187], v208 offset:54784
    s_waitcnt lgkmcnt(12)
    v_mfma_f32_16x16x32_bf16 v[56:59], v[120:123], v[168:171], v[56:59]
    v_mfma_f32_16x16x32_bf16 v[76:79], v[124:127], v[168:171], v[76:79]
    ds_read_b64_tr_b16 v[188:189], v209 offset:53248
    v_mfma_f32_16x16x32_bf16 v[96:99], v[128:131], v[168:171], v[96:99]
    ds_read_b64_tr_b16 v[190:191], v209 offset:54784
    v_mfma_f32_16x16x32_bf16 v[116:119], v[132:135], v[168:171], v[116:119]
    s_waitcnt lgkmcnt(0)
    s_barrier
    v_mfma_f32_16x16x32_bf16 v[40:43], v[136:139], v[172:175], v[40:43]
    ds_read_b128 v[120:123], v196 offset:0
    v_mfma_f32_16x16x32_bf16 v[60:63], v[140:143], v[172:175], v[60:63]
    ds_read_b64_tr_b16 v[152:153], v200 offset:0
    v_mfma_f32_16x16x32_bf16 v[80:83], v[144:147], v[172:175], v[80:83]
    ds_read_b64_tr_b16 v[154:155], v200 offset:1536
    v_mfma_f32_16x16x32_bf16 v[100:103], v[148:151], v[172:175], v[100:103]
    v_mfma_f32_16x16x32_bf16 v[44:47], v[136:139], v[176:179], v[44:47]
    ds_read_b128 v[124:127], v196 offset:2048
    v_mfma_f32_16x16x32_bf16 v[64:67], v[140:143], v[176:179], v[64:67]
    ds_read_b128 v[128:131], v196 offset:4096
    v_mfma_f32_16x16x32_bf16 v[84:87], v[144:147], v[176:179], v[84:87]
    v_mfma_f32_16x16x32_bf16 v[104:107], v[148:151], v[176:179], v[104:107]
    ds_read_b128 v[132:135], v196 offset:6144
    v_mfma_f32_16x16x32_bf16 v[48:51], v[136:139], v[180:183], v[48:51]
    ds_read_b64_tr_b16 v[156:157], v201 offset:0
    v_mfma_f32_16x16x32_bf16 v[68:71], v[140:143], v[180:183], v[68:71]
    v_mfma_f32_16x16x32_bf16 v[88:91], v[144:147], v[180:183], v[88:91]
    ds_read_b64_tr_b16 v[158:159], v201 offset:1536
    v_mfma_f32_16x16x32_bf16 v[108:111], v[148:151], v[180:183], v[108:111]
    ds_read_b64_tr_b16 v[160:161], v202 offset:0
    v_mfma_f32_16x16x32_bf16 v[52:55], v[136:139], v[184:187], v[52:55]
    ds_read_b64_tr_b16 v[162:163], v202 offset:1536
    v_mfma_f32_16x16x32_bf16 v[72:75], v[140:143], v[184:187], v[72:75]
    v_mfma_f32_16x16x32_bf16 v[92:95], v[144:147], v[184:187], v[92:95]
    ds_read_b64_tr_b16 v[164:165], v203 offset:0
    v_mfma_f32_16x16x32_bf16 v[112:115], v[148:151], v[184:187], v[112:115]
    ds_read_b64_tr_b16 v[166:167], v203 offset:1536
    v_mfma_f32_16x16x32_bf16 v[56:59], v[136:139], v[188:191], v[56:59]
    v_mfma_f32_16x16x32_bf16 v[76:79], v[140:143], v[188:191], v[76:79]
    ds_read_b64_tr_b16 v[168:169], v204 offset:0
    v_mfma_f32_16x16x32_bf16 v[96:99], v[144:147], v[188:191], v[96:99]
    ds_read_b64_tr_b16 v[170:171], v204 offset:1536
    v_mfma_f32_16x16x32_bf16 v[116:119], v[148:151], v[188:191], v[116:119]
    s_waitcnt lgkmcnt(11)
    v_mfma_f32_16x16x32_bf16 v[40:43], v[120:123], v[152:155], v[40:43]
    ds_read_b128 v[136:139], v197 offset:0
    s_waitcnt lgkmcnt(11)
    v_mfma_f32_16x16x32_bf16 v[60:63], v[124:127], v[152:155], v[60:63]
    ds_read_b64_tr_b16 v[172:173], v200 offset:12288
    s_waitcnt lgkmcnt(11)
    v_mfma_f32_16x16x32_bf16 v[80:83], v[128:131], v[152:155], v[80:83]
    ds_read_b64_tr_b16 v[174:175], v200 offset:13824
    s_waitcnt lgkmcnt(11)
    v_mfma_f32_16x16x32_bf16 v[100:103], v[132:135], v[152:155], v[100:103]
    s_waitcnt lgkmcnt(9)
    v_mfma_f32_16x16x32_bf16 v[44:47], v[120:123], v[156:159], v[44:47]
    ds_read_b128 v[140:143], v197 offset:2048
    v_mfma_f32_16x16x32_bf16 v[64:67], v[124:127], v[156:159], v[64:67]
    ds_read_b128 v[144:147], v197 offset:4096
    v_mfma_f32_16x16x32_bf16 v[84:87], v[128:131], v[156:159], v[84:87]
    v_mfma_f32_16x16x32_bf16 v[104:107], v[132:135], v[156:159], v[104:107]
    ds_read_b128 v[148:151], v197 offset:6144
    s_waitcnt lgkmcnt(10)
    v_mfma_f32_16x16x32_bf16 v[48:51], v[120:123], v[160:163], v[48:51]
    ds_read_b64_tr_b16 v[176:177], v201 offset:12288
    v_mfma_f32_16x16x32_bf16 v[68:71], v[124:127], v[160:163], v[68:71]
    v_mfma_f32_16x16x32_bf16 v[88:91], v[128:131], v[160:163], v[88:91]
    ds_read_b64_tr_b16 v[178:179], v201 offset:13824
    v_mfma_f32_16x16x32_bf16 v[108:111], v[132:135], v[160:163], v[108:111]
    ds_read_b64_tr_b16 v[180:181], v202 offset:12288
    s_waitcnt lgkmcnt(11)
    v_mfma_f32_16x16x32_bf16 v[52:55], v[120:123], v[164:167], v[52:55]
    ds_read_b64_tr_b16 v[182:183], v202 offset:13824
    v_mfma_f32_16x16x32_bf16 v[72:75], v[124:127], v[164:167], v[72:75]
    v_mfma_f32_16x16x32_bf16 v[92:95], v[128:131], v[164:167], v[92:95]
    ds_read_b64_tr_b16 v[184:185], v203 offset:12288
    v_mfma_f32_16x16x32_bf16 v[112:115], v[132:135], v[164:167], v[112:115]
    ds_read_b64_tr_b16 v[186:187], v203 offset:13824
    s_waitcnt lgkmcnt(12)
    v_mfma_f32_16x16x32_bf16 v[56:59], v[120:123], v[168:171], v[56:59]
    v_mfma_f32_16x16x32_bf16 v[76:79], v[124:127], v[168:171], v[76:79]
    ds_read_b64_tr_b16 v[188:189], v204 offset:12288
    v_mfma_f32_16x16x32_bf16 v[96:99], v[128:131], v[168:171], v[96:99]
    ds_read_b64_tr_b16 v[190:191], v204 offset:13824
    v_mfma_f32_16x16x32_bf16 v[116:119], v[132:135], v[168:171], v[116:119]
    s_waitcnt lgkmcnt(0)
    s_barrier
    ds_read_b128 v[216:219], v196 offset:40960
    ds_read_b128 v[232:235], v210 offset:40960
    ds_read_b128 v[220:223], v196 offset:43008
    ds_read_b128 v[224:227], v196 offset:45056
    ds_read_b128 v[228:231], v196 offset:47104
    ds_read_b128 v[236:239], v210 offset:43008
    v_mfma_f32_16x16x32_bf16 v[40:43], v[136:139], v[172:175], v[40:43]
    v_mfma_f32_16x16x32_bf16 v[44:47], v[136:139], v[176:179], v[44:47]
    v_mfma_f32_16x16x32_bf16 v[48:51], v[136:139], v[180:183], v[48:51]
    v_mfma_f32_16x16x32_bf16 v[52:55], v[136:139], v[184:187], v[52:55]
    v_mfma_f32_16x16x32_bf16 v[56:59], v[136:139], v[188:191], v[56:59]
    v_mfma_f32_16x16x32_bf16 v[60:63], v[140:143], v[172:175], v[60:63]
    v_mfma_f32_16x16x32_bf16 v[64:67], v[140:143], v[176:179], v[64:67]
    v_mfma_f32_16x16x32_bf16 v[68:71], v[140:143], v[180:183], v[68:71]
    v_mfma_f32_16x16x32_bf16 v[72:75], v[140:143], v[184:187], v[72:75]
    v_mfma_f32_16x16x32_bf16 v[76:79], v[140:143], v[188:191], v[76:79]
    v_mfma_f32_16x16x32_bf16 v[80:83], v[144:147], v[172:175], v[80:83]
    v_mfma_f32_16x16x32_bf16 v[84:87], v[144:147], v[176:179], v[84:87]
    v_cvt_pk_bf16_f32 v152, v40, v41
    v_cvt_pk_bf16_f32 v153, v42, v43
    v_cvt_pk_bf16_f32 v154, v60, v61
    v_mfma_f32_16x16x32_bf16 v[88:91], v[144:147], v[180:183], v[88:91]
    v_cvt_pk_bf16_f32 v155, v62, v63
    buffer_store_dwordx4 v[152:155], v214, s[52:55], s84 offen offset:0 sc1
    v_cvt_pk_bf16_f32 v156, v44, v45
    v_mfma_f32_16x16x32_bf16 v[92:95], v[144:147], v[184:187], v[92:95]
    v_cvt_pk_bf16_f32 v157, v46, v47
    v_cvt_pk_bf16_f32 v158, v64, v65
    v_cvt_pk_bf16_f32 v159, v66, v67
    v_mfma_f32_16x16x32_bf16 v[96:99], v[144:147], v[188:191], v[96:99]
    buffer_store_dwordx4 v[156:159], v214, s[52:55], s84 offen offset:128 sc1
    v_cvt_pk_bf16_f32 v160, v48, v49
    v_cvt_pk_bf16_f32 v161, v50, v51
    v_mfma_f32_16x16x32_bf16 v[100:103], v[148:151], v[172:175], v[100:103]
    v_cvt_pk_bf16_f32 v162, v68, v69
    v_cvt_pk_bf16_f32 v163, v70, v71
    buffer_store_dwordx4 v[160:163], v214, s[52:55], s85 offen offset:0 sc1
    v_mfma_f32_16x16x32_bf16 v[104:107], v[148:151], v[176:179], v[104:107]
    v_cvt_pk_bf16_f32 v164, v52, v53
    v_cvt_pk_bf16_f32 v165, v54, v55
    v_cvt_pk_bf16_f32 v166, v72, v73
    v_mfma_f32_16x16x32_bf16 v[108:111], v[148:151], v[180:183], v[108:111]
    v_cvt_pk_bf16_f32 v167, v74, v75
    buffer_store_dwordx4 v[164:167], v214, s[52:55], s85 offen offset:128 sc1
    v_cvt_pk_bf16_f32 v168, v56, v57
    v_mfma_f32_16x16x32_bf16 v[112:115], v[148:151], v[184:187], v[112:115]
    v_cvt_pk_bf16_f32 v169, v58, v59
    v_cvt_pk_bf16_f32 v170, v76, v77
    v_cvt_pk_bf16_f32 v171, v78, v79
    v_mfma_f32_16x16x32_bf16 v[116:119], v[148:151], v[188:191], v[116:119]
    v_cndmask_b32 v168, v168, v37, s[82:83]
    v_cndmask_b32 v169, v169, v37, s[82:83]
    v_cndmask_b32 v170, v170, v37, s[82:83]
    v_cndmask_b32 v171, v171, v37, s[82:83]
    buffer_store_dwordx4 v[168:171], v215, s[52:55], s84 offen sc1
    v_cvt_pk_bf16_f32 v120, v80, v81
    v_cvt_pk_bf16_f32 v121, v82, v83
    v_cvt_pk_bf16_f32 v122, v100, v101
    v_cvt_pk_bf16_f32 v123, v102, v103
    buffer_store_dwordx4 v[120:123], v214, s[52:55], s86 offen offset:0 sc1
    v_cvt_pk_bf16_f32 v124, v84, v85
    v_cvt_pk_bf16_f32 v125, v86, v87
    v_cvt_pk_bf16_f32 v126, v104, v105
    v_cvt_pk_bf16_f32 v127, v106, v107
    buffer_store_dwordx4 v[124:127], v214, s[52:55], s86 offen offset:128 sc1
    v_cvt_pk_bf16_f32 v128, v88, v89
    v_cvt_pk_bf16_f32 v129, v90, v91
    v_cvt_pk_bf16_f32 v130, v108, v109
    v_cvt_pk_bf16_f32 v131, v110, v111
    buffer_store_dwordx4 v[128:131], v214, s[52:55], s87 offen offset:0 sc1
    v_cvt_pk_bf16_f32 v132, v92, v93
    v_cvt_pk_bf16_f32 v133, v94, v95
    v_cvt_pk_bf16_f32 v134, v112, v113
    v_cvt_pk_bf16_f32 v135, v114, v115
    buffer_store_dwordx4 v[132:135], v214, s[52:55], s87 offen offset:128 sc1
    v_cvt_pk_bf16_f32 v136, v96, v97
    v_cvt_pk_bf16_f32 v137, v98, v99
    v_cvt_pk_bf16_f32 v138, v116, v117
    v_cvt_pk_bf16_f32 v139, v118, v119
    v_cndmask_b32 v136, v136, v37, s[82:83]
    v_cndmask_b32 v137, v137, v37, s[82:83]
    v_cndmask_b32 v138, v138, v37, s[82:83]
    v_cndmask_b32 v139, v139, v37, s[82:83]
    buffer_store_dwordx4 v[136:139], v215, s[52:55], s86 offen sc1
L_a1_join:
    s_waitcnt lgkmcnt(4)
    v_mfma_f32_16x16x32_bf16 v[168:171], v[216:219], v[232:235], 0
    ds_read_b128 v[88:91], v197 offset:40960
    s_waitcnt lgkmcnt(4)
    v_mfma_f32_16x16x32_bf16 v[172:175], v[220:223], v[232:235], 0
    ds_read_b128 v[104:107], v211 offset:40960
    s_waitcnt lgkmcnt(4)
    v_mfma_f32_16x16x32_bf16 v[64:67], v[224:227], v[232:235], 0
    ds_read_b128 v[92:95], v197 offset:43008
    s_waitcnt lgkmcnt(4)
    v_mfma_f32_16x16x32_bf16 v[68:71], v[228:231], v[232:235], 0
    s_waitcnt lgkmcnt(3)
    v_mfma_f32_16x16x32_bf16 v[176:179], v[216:219], v[236:239], 0
    ds_read_b128 v[96:99], v197 offset:45056
    v_mfma_f32_16x16x32_bf16 v[180:183], v[220:223], v[236:239], 0
    ds_read_b128 v[100:103], v197 offset:47104
    v_mfma_f32_16x16x32_bf16 v[72:75], v[224:227], v[236:239], 0
    ds_read_b128 v[108:111], v211 offset:43008
    v_mfma_f32_16x16x32_bf16 v[76:79], v[228:231], v[236:239], 0
    s_waitcnt lgkmcnt(0)
    s_barrier
    v_mfma_f32_16x16x32_bf16 v[168:171], v[88:91], v[104:107], v[168:171]
    ds_read_b128 v[216:219], v198 offset:0
    v_mfma_f32_16x16x32_bf16 v[172:175], v[92:95], v[104:107], v[172:175]
    ds_read_b128 v[232:235], v212 offset:0
    v_mfma_f32_16x16x32_bf16 v[64:67], v[96:99], v[104:107], v[64:67]
    ds_read_b128 v[220:223], v198 offset:2048
    v_mfma_f32_16x16x32_bf16 v[68:71], v[100:103], v[104:107], v[68:71]
    v_mfma_f32_16x16x32_bf16 v[176:179], v[88:91], v[108:111], v[176:179]
    ds_read_b128 v[224:227], v198 offset:4096
    v_mfma_f32_16x16x32_bf16 v[180:183], v[92:95], v[108:111], v[180:183]
    ds_read_b128 v[228:231], v198 offset:6144
    v_mfma_f32_16x16x32_bf16 v[72:75], v[96:99], v[108:111], v[72:75]
    ds_read_b128 v[236:239], v212 offset:2048
    v_mfma_f32_16x16x32_bf16 v[76:79], v[100:103], v[108:111], v[76:79]
    s_waitcnt lgkmcnt(4)
    v_mfma_f32_16x16x32_bf16 v[168:171], v[216:219], v[232:235], v[168:171]
    ds_read_b128 v[88:91], v199 offset:0
    s_waitcnt lgkmcnt(4)
    v_mfma_f32_16x16x32_bf16 v[172:175], v[220:223], v[232:235], v[172:175]
    ds_read_b128 v[104:107], v213 offset:0
    s_waitcnt lgkmcnt(4)
    v_mfma_f32_16x16x32_bf16 v[64:67], v[224:227], v[232:235], v[64:67]
    ds_read_b128 v[92:95], v199 offset:2048
    s_waitcnt lgkmcnt(4)
    v_mfma_f32_16x16x32_bf16 v[68:71], v[228:231], v[232:235], v[68:71]
    s_waitcnt lgkmcnt(3)
    v_mfma_f32_16x16x32_bf16 v[176:179], v[216:219], v[236:239], v[176:179]
    ds_read_b128 v[96:99], v199 offset:4096
    v_mfma_f32_16x16x32_bf16 v[180:183], v[220:223], v[236:239], v[180:183]
    ds_read_b128 v[100:103], v199 offset:6144
    v_mfma_f32_16x16x32_bf16 v[72:75], v[224:227], v[236:239], v[72:75]
    ds_read_b128 v[108:111], v213 offset:2048
    v_mfma_f32_16x16x32_bf16 v[76:79], v[228:231], v[236:239], v[76:79]
    s_waitcnt vmcnt(0)
    s_waitcnt vmcnt(10)
    v_readfirstlane_b32 s67, v14
    s_nop 1
    s_cmp_eq_u32 s67, 0
    s_cbranch_scc1 Ltslow_21
Ltok_22:
    s_waitcnt lgkmcnt(0)
    s_barrier
    s_cmp_lg_u32 s64, 0
    s_cbranch_scc1 Lw0_24
    v_lshrrev_b32 v12, 3, v1
    s_lshr_b32 s72, s89, 1
    v_cmp_ne_u32 vcc, s72, v12
    s_cmp_lg_u32 s90, 0
    s_nop 0
    s_cselect_b64 vcc, 0, vcc
    v_lshlrev_b32 v12, 13, v12
    v_and_b32 v13, 7, v1
    v_lshl_add_u32 v12, v13, 8, v12
    v_mov_b32 v13, 1073741824
    v_cndmask_b32 v12, v12, v13, vcc
    v_mov_b32 v13, s67
    buffer_store_dword v13, v12, s[52:55], s80 offen sc1
Lw0_24:
    s_lshl_b32 s72, s2, 8
    s_add_u32 s72, s72, 15085568
    v_min_u32 v15, 33, v1
    v_lshl_add_u32 v15, v15, 2, s72
    v_mfma_f32_16x16x32_bf16 v[168:171], v[88:91], v[104:107], v[168:171]
    ds_read_b128 v[216:219], v198 offset:40960
    v_mfma_f32_16x16x32_bf16 v[172:175], v[92:95], v[104:107], v[172:175]
    ds_read_b128 v[232:235], v212 offset:40960
    v_mfma_f32_16x16x32_bf16 v[64:67], v[96:99], v[104:107], v[64:67]
    ds_read_b128 v[220:223], v198 offset:43008
    v_mfma_f32_16x16x32_bf16 v[68:71], v[100:103], v[104:107], v[68:71]
    v_mfma_f32_16x16x32_bf16 v[176:179], v[88:91], v[108:111], v[176:179]
    ds_read_b128 v[224:227], v198 offset:45056
    v_mfma_f32_16x16x32_bf16 v[180:183], v[92:95], v[108:111], v[180:183]
    ds_read_b128 v[228:231], v198 offset:47104
    v_mfma_f32_16x16x32_bf16 v[72:75], v[96:99], v[108:111], v[72:75]
    ds_read_b128 v[236:239], v212 offset:43008
    v_mfma_f32_16x16x32_bf16 v[76:79], v[100:103], v[108:111], v[76:79]
    s_waitcnt lgkmcnt(4)
    v_mfma_f32_16x16x32_bf16 v[168:171], v[216:219], v[232:235], v[168:171]
    ds_read_b128 v[88:91], v199 offset:40960
    s_waitcnt lgkmcnt(4)
    v_mfma_f32_16x16x32_bf16 v[172:175], v[220:223], v[232:235], v[172:175]
    ds_read_b128 v[104:107], v213 offset:40960
    s_waitcnt lgkmcnt(4)
    v_mfma_f32_16x16x32_bf16 v[64:67], v[224:227], v[232:235], v[64:67]
    ds_read_b128 v[92:95], v199 offset:43008
    s_waitcnt lgkmcnt(4)
    v_mfma_f32_16x16x32_bf16 v[68:71], v[228:231], v[232:235], v[68:71]
    s_waitcnt lgkmcnt(3)
    v_mfma_f32_16x16x32_bf16 v[176:179], v[216:219], v[236:239], v[176:179]
    ds_read_b128 v[96:99], v199 offset:45056
    v_mfma_f32_16x16x32_bf16 v[180:183], v[220:223], v[236:239], v[180:183]
    ds_read_b128 v[100:103], v199 offset:47104
    v_mfma_f32_16x16x32_bf16 v[72:75], v[224:227], v[236:239], v[72:75]
    ds_read_b128 v[108:111], v213 offset:43008
    v_mfma_f32_16x16x32_bf16 v[76:79], v[228:231], v[236:239], v[76:79]
    s_waitcnt lgkmcnt(0)
    s_barrier
    v_mfma_f32_16x16x32_bf16 v[168:171], v[88:91], v[104:107], v[168:171]
    ds_read_b128 v[216:219], v196 offset:0
    v_mfma_f32_16x16x32_bf16 v[172:175], v[92:95], v[104:107], v[172:175]
    ds_read_b128 v[232:235], v210 offset:0
    v_mfma_f32_16x16x32_bf16 v[64:67], v[96:99], v[104:107], v[64:67]
    ds_read_b128 v[220:223], v196 offset:2048
    v_mfma_f32_16x16x32_bf16 v[68:71], v[100:103], v[104:107], v[68:71]
    v_mfma_f32_16x16x32_bf16 v[176:179], v[88:91], v[108:111], v[176:179]
    ds_read_b128 v[224:227], v196 offset:4096
    v_mfma_f32_16x16x32_bf16 v[180:183], v[92:95], v[108:111], v[180:183]
    ds_read_b128 v[228:231], v196 offset:6144
    v_mfma_f32_16x16x32_bf16 v[72:75], v[96:99], v[108:111], v[72:75]
    ds_read_b128 v[236:239], v210 offset:2048
    v_mfma_f32_16x16x32_bf16 v[76:79], v[100:103], v[108:111], v[76:79]
    s_waitcnt lgkmcnt(4)
    v_mfma_f32_16x16x32_bf16 v[168:171], v[216:219], v[232:235], v[168:171]
    ds_read_b128 v[88:91], v197 offset:0
    s_waitcnt lgkmcnt(4)
    v_mfma_f32_16x16x32_bf16 v[172:175], v[220:223], v[232:235], v[172:175]
    ds_read_b128 v[104:107], v211 offset:0
    s_waitcnt lgkmcnt(4)
    v_mfma_f32_16x16x32_bf16 v[64:67], v[224:227], v[232:235], v[64:67]
    ds_read_b128 v[92:95], v197 offset:2048
    s_waitcnt lgkmcnt(4)
    v_mfma_f32_16x16x32_bf16 v[68:71], v[228:231], v[232:235], v[68:71]
    s_waitcnt lgkmcnt(3)
    v_mfma_f32_16x16x32_bf16 v[176:179], v[216:219], v[236:239], v[176:179]
    ds_read_b128 v[96:99], v197 offset:4096
    v_mfma_f32_16x16x32_bf16 v[180:183], v[220:223], v[236:239], v[180:183]
    ds_read_b128 v[100:103], v197 offset:6144
    v_mfma_f32_16x16x32_bf16 v[72:75], v[224:227], v[236:239], v[72:75]
    ds_read_b128 v[108:111], v211 offset:2048
    v_mfma_f32_16x16x32_bf16 v[76:79], v[228:231], v[236:239], v[76:79]
    s_waitcnt lgkmcnt(0)
    s_barrier
    v_mfma_f32_16x16x32_bf16 v[168:171], v[88:91], v[104:107], v[168:171]
    ds_read_b128 v[216:219], v196 offset:40960
    v_mfma_f32_16x16x32_bf16 v[172:175], v[92:95], v[104:107], v[172:175]
    ds_read_b128 v[232:235], v210 offset:40960
    v_mfma_f32_16x16x32_bf16 v[64:67], v[96:99], v[104:107], v[64:67]
    ds_read_b128 v[220:223], v196 offset:43008
    v_mfma_f32_16x16x32_bf16 v[68:71], v[100:103], v[104:107], v[68:71]
    v_mfma_f32_16x16x32_bf16 v[176:179], v[88:91], v[108:111], v[176:179]
    ds_read_b128 v[224:227], v196 offset:45056
    v_mfma_f32_16x16x32_bf16 v[180:183], v[92:95], v[108:111], v[180:183]
    ds_read_b128 v[228:231], v196 offset:47104
    v_mfma_f32_16x16x32_bf16 v[72:75], v[96:99], v[108:111], v[72:75]
    ds_read_b128 v[236:239], v210 offset:43008
    v_mfma_f32_16x16x32_bf16 v[76:79], v[100:103], v[108:111], v[76:79]
    s_waitcnt lgkmcnt(4)
    v_mfma_f32_16x16x32_bf16 v[168:171], v[216:219], v[232:235], v[168:171]
    ds_read_b128 v[88:91], v197 offset:40960
    s_waitcnt lgkmcnt(4)
    v_mfma_f32_16x16x32_bf16 v[172:175], v[220:223], v[232:235], v[172:175]
    ds_read_b128 v[104:107], v211 offset:40960
    s_waitcnt lgkmcnt(4)
    v_mfma_f32_16x16x32_bf16 v[64:67], v[224:227], v[232:235], v[64:67]
    ds_read_b128 v[92:95], v197 offset:43008
    s_waitcnt lgkmcnt(4)
    v_mfma_f32_16x16x32_bf16 v[68:71], v[228:231], v[232:235], v[68:71]
    s_waitcnt lgkmcnt(3)
    v_mfma_f32_16x16x32_bf16 v[176:179], v[216:219], v[236:239], v[176:179]
    ds_read_b128 v[96:99], v197 offset:45056
    v_mfma_f32_16x16x32_bf16 v[180:183], v[220:223], v[236:239], v[180:183]
    ds_read_b128 v[100:103], v197 offset:47104
    v_mfma_f32_16x16x32_bf16 v[72:75], v[224:227], v[236:239], v[72:75]
    ds_read_b128 v[108:111], v211 offset:43008
    v_mfma_f32_16x16x32_bf16 v[76:79], v[228:231], v[236:239], v[76:79]
    s_waitcnt lgkmcnt(0)
    s_barrier
    ds_read_b64 v[244:245], v33 offset:0
    ds_read_b64 v[246:247], v33 offset:128
    v_mov_b32 v40, 0
    v_mov_b32 v41, 0
    v_mov_b32 v42, 0
    v_mov_b32 v43, 0
    v_mfma_f32_16x16x32_bf16 v[168:171], v[88:91], v[104:107], v[168:171]
    ds_read_b128 v[216:219], v198 offset:0
    v_mfma_f32_16x16x32_bf16 v[172:175], v[92:95], v[104:107], v[172:175]
    ds_read_b128 v[232:235], v212 offset:0
    v_mfma_f32_16x16x32_bf16 v[64:67], v[96:99], v[104:107], v[64:67]
    ds_read_b128 v[220:223], v198 offset:2048
    v_mfma_f32_16x16x32_bf16 v[68:71], v[100:103], v[104:107], v[68:71]
    v_mfma_f32_16x16x32_bf16 v[176:179], v[88:91], v[108:111], v[176:179]
    ds_read_b128 v[224:227], v198 offset:4096
    v_mfma_f32_16x16x32_bf16 v[180:183], v[92:95], v[108:111], v[180:183]
    ds_read_b128 v[228:231], v198 offset:6144
    v_mfma_f32_16x16x32_bf16 v[72:75], v[96:99], v[108:111], v[72:75]
    ds_read_b128 v[236:239], v212 offset:2048
    v_mfma_f32_16x16x32_bf16 v[76:79], v[100:103], v[108:111], v[76:79]
    s_waitcnt lgkmcnt(4)
    v_mfma_f32_16x16x32_bf16 v[168:171], v[216:219], v[232:235], v[168:171]
    ds_read_b128 v[88:91], v199 offset:0
    s_waitcnt lgkmcnt(4)
    v_mfma_f32_16x16x32_bf16 v[172:175], v[220:223], v[232:235], v[172:175]
    ds_read_b128 v[104:107], v213 offset:0
    s_waitcnt lgkmcnt(4)
    v_mfma_f32_16x16x32_bf16 v[64:67], v[224:227], v[232:235], v[64:67]
    ds_read_b128 v[92:95], v199 offset:2048
    s_waitcnt lgkmcnt(4)
    v_mfma_f32_16x16x32_bf16 v[68:71], v[228:231], v[232:235], v[68:71]
    s_waitcnt lgkmcnt(3)
    v_mfma_f32_16x16x32_bf16 v[176:179], v[216:219], v[236:239], v[176:179]
    ds_read_b128 v[96:99], v199 offset:4096
    v_mfma_f32_16x16x32_bf16 v[180:183], v[220:223], v[236:239], v[180:183]
    ds_read_b128 v[100:103], v199 offset:6144
    v_mfma_f32_16x16x32_bf16 v[72:75], v[224:227], v[236:239], v[72:75]
    ds_read_b128 v[108:111], v213 offset:2048
    v_mfma_f32_16x16x32_bf16 v[76:79], v[228:231], v[236:239], v[76:79]
    s_waitcnt lgkmcnt(0)
    s_barrier
    v_mfma_f32_16x16x32_bf16 v[168:171], v[88:91], v[104:107], v[168:171]
    ds_read_b128 v[216:219], v198 offset:40960
    v_mfma_f32_16x16x32_bf16 v[172:175], v[92:95], v[104:107], v[172:175]
    ds_read_b128 v[232:235], v212 offset:40960
    v_mfma_f32_16x16x32_bf16 v[64:67], v[96:99], v[104:107], v[64:67]
    ds_read_b128 v[220:223], v198 offset:43008
    v_mfma_f32_16x16x32_bf16 v[68:71], v[100:103], v[104:107], v[68:71]
    v_mfma_f32_16x16x32_bf16 v[176:179], v[88:91], v[108:111], v[176:179]
    ds_read_b128 v[224:227], v198 offset:45056
    v_mfma_f32_16x16x32_bf16 v[180:183], v[92:95], v[108:111], v[180:183]
    ds_read_b128 v[228:231], v198 offset:47104
    v_mfma_f32_16x16x32_bf16 v[72:75], v[96:99], v[108:111], v[72:75]
    ds_read_b128 v[236:239], v212 offset:43008
    v_mfma_f32_16x16x32_bf16 v[76:79], v[100:103], v[108:111], v[76:79]
    s_waitcnt lgkmcnt(4)
    v_mfma_f32_16x16x32_bf16 v[168:171], v[216:219], v[232:235], v[168:171]
    ds_read_b128 v[88:91], v199 offset:40960
    s_waitcnt lgkmcnt(4)
    v_mfma_f32_16x16x32_bf16 v[172:175], v[220:223], v[232:235], v[172:175]
    ds_read_b128 v[104:107], v213 offset:40960
    s_waitcnt lgkmcnt(4)
    v_mfma_f32_16x16x32_bf16 v[64:67], v[224:227], v[232:235], v[64:67]
    ds_read_b128 v[92:95], v199 offset:43008
    s_waitcnt lgkmcnt(4)
    v_mfma_f32_16x16x32_bf16 v[68:71], v[228:231], v[232:235], v[68:71]
    s_waitcnt lgkmcnt(3)
    v_mfma_f32_16x16x32_bf16 v[176:179], v[216:219], v[236:239], v[176:179]
    ds_read_b128 v[96:99], v199 offset:45056
    v_mfma_f32_16x16x32_bf16 v[180:183], v[220:223], v[236:239], v[180:183]
    ds_read_b128 v[100:103], v199 offset:47104
    v_mfma_f32_16x16x32_bf16 v[72:75], v[224:227], v[236:239], v[72:75]
    ds_read_b128 v[108:111], v213 offset:43008
    v_mfma_f32_16x16x32_bf16 v[76:79], v[228:231], v[236:239], v[76:79]
    s_waitcnt lgkmcnt(0)
    s_barrier
    v_mfma_f32_16x16x32_bf16 v[168:171], v[88:91], v[104:107], v[168:171]
    ds_read_b128 v[216:219], v196 offset:0
    v_mfma_f32_16x16x32_bf16 v[172:175], v[92:95], v[104:107], v[172:175]
    ds_read_b128 v[232:235], v210 offset:0
    v_mfma_f32_16x16x32_bf16 v[64:67], v[96:99], v[104:107], v[64:67]
    ds_read_b128 v[220:223], v196 offset:2048
    v_mfma_f32_16x16x32_bf16 v[68:71], v[100:103], v[104:107], v[68:71]
    v_mfma_f32_16x16x32_bf16 v[176:179], v[88:91], v[108:111], v[176:179]
    ds_read_b128 v[224:227], v196 offset:4096
    v_mfma_f32_16x16x32_bf16 v[180:183], v[92:95], v[108:111], v[180:183]
    ds_read_b128 v[228:231], v196 offset:6144
    v_mfma_f32_16x16x32_bf16 v[72:75], v[96:99], v[108:111], v[72:75]
    ds_read_b128 v[236:239], v210 offset:2048
    v_mfma_f32_16x16x32_bf16 v[76:79], v[100:103], v[108:111], v[76:79]
    s_waitcnt lgkmcnt(4)
    v_mfma_f32_16x16x32_bf16 v[168:171], v[216:219], v[232:235], v[168:171]
    ds_read_b128 v[88:91], v197 offset:0
    s_waitcnt lgkmcnt(4)
    v_mfma_f32_16x16x32_bf16 v[172:175], v[220:223], v[232:235], v[172:175]
    ds_read_b128 v[104:107], v211 offset:0
    s_waitcnt lgkmcnt(4)
    v_mfma_f32_16x16x32_bf16 v[64:67], v[224:227], v[232:235], v[64:67]
    ds_read_b128 v[92:95], v197 offset:2048
    s_waitcnt lgkmcnt(4)
    v_mfma_f32_16x16x32_bf16 v[68:71], v[228:231], v[232:235], v[68:71]
    s_waitcnt lgkmcnt(3)
    v_mfma_f32_16x16x32_bf16 v[176:179], v[216:219], v[236:239], v[176:179]
    ds_read_b128 v[96:99], v197 offset:4096
    v_mfma_f32_16x16x32_bf16 v[180:183], v[220:223], v[236:239], v[180:183]
    ds_read_b128 v[100:103], v197 offset:6144
    v_mfma_f32_16x16x32_bf16 v[72:75], v[224:227], v[236:239], v[72:75]
    ds_read_b128 v[108:111], v211 offset:2048
    v_mfma_f32_16x16x32_bf16 v[76:79], v[228:231], v[236:239], v[76:79]
    s_waitcnt lgkmcnt(0)
    s_barrier
    v_mfma_f32_16x16x32_bf16 v[168:171], v[88:91], v[104:107], v[168:171]
    ds_read_b128 v[216:219], v196 offset:40960
    v_mfma_f32_16x16x32_bf16 v[172:175], v[92:95], v[104:107], v[172:175]
    ds_read_b128 v[232:235], v210 offset:40960
    v_mfma_f32_16x16x32_bf16 v[64:67], v[96:99], v[104:107], v[64:67]
    ds_read_b128 v[220:223], v196 offset:43008
    v_mfma_f32_16x16x32_bf16 v[68:71], v[100:103], v[104:107], v[68:71]
    v_mfma_f32_16x16x32_bf16 v[176:179], v[88:91], v[108:111], v[176:179]
    ds_read_b128 v[224:227], v196 offset:45056
    v_mfma_f32_16x16x32_bf16 v[180:183], v[92:95], v[108:111], v[180:183]
    ds_read_b128 v[228:231], v196 offset:47104
    v_mfma_f32_16x16x32_bf16 v[72:75], v[96:99], v[108:111], v[72:75]
    ds_read_b128 v[236:239], v210 offset:43008
    v_mfma_f32_16x16x32_bf16 v[76:79], v[100:103], v[108:111], v[76:79]
    s_waitcnt lgkmcnt(4)
    v_mfma_f32_16x16x32_bf16 v[168:171], v[216:219], v[232:235], v[168:171]
    ds_read_b128 v[88:91], v197 offset:40960
    s_waitcnt lgkmcnt(4)
    v_mfma_f32_16x16x32_bf16 v[172:175], v[220:223], v[232:235], v[172:175]
    ds_read_b128 v[104:107], v211 offset:40960
    s_waitcnt lgkmcnt(4)
    v_mfma_f32_16x16x32_bf16 v[64:67], v[224:227], v[232:235], v[64:67]
    ds_read_b128 v[92:95], v197 offset:43008
    s_waitcnt lgkmcnt(4)
    v_mfma_f32_16x16x32_bf16 v[68:71], v[228:231], v[232:235], v[68:71]
    s_waitcnt lgkmcnt(3)
    v_mfma_f32_16x16x32_bf16 v[176:179], v[216:219], v[236:239], v[176:179]
    ds_read_b128 v[96:99], v197 offset:45056
    v_mfma_f32_16x16x32_bf16 v[180:183], v[220:223], v[236:239], v[180:183]
    ds_read_b128 v[100:103], v197 offset:47104
    v_mfma_f32_16x16x32_bf16 v[72:75], v[224:227], v[236:239], v[72:75]
    ds_read_b128 v[108:111], v211 offset:43008
    v_mfma_f32_16x16x32_bf16 v[76:79], v[228:231], v[236:239], v[76:79]
    s_waitcnt lgkmcnt(0)
    s_barrier
    buffer_load_dword v14, v15, s[52:55], 0 offen sc1
    v_mfma_f32_16x16x32_bf16 v[168:171], v[88:91], v[104:107], v[168:171]
    ds_read_b128 v[196:199], v32 offset:0
    v_mfma_f32_16x16x32_bf16 v[172:175], v[92:95], v[104:107], v[172:175]
    ds_read_b128 v[212:215], v32 offset:1024
    v_mfma_f32_16x16x32_bf16 v[64:67], v[96:99], v[104:107], v[64:67]
    ds_read_b128 v[200:203], v32 offset:256
    v_mfma_f32_16x16x32_bf16 v[68:71], v[100:103], v[104:107], v[68:71]
    ds_read_b128 v[216:219], v32 offset:1280
    v_mfma_f32_16x16x32_bf16 v[176:179], v[88:91], v[108:111], v[176:179]
    ds_read_b128 v[204:207], v32 offset:512
    v_mfma_f32_16x16x32_bf16 v[180:183], v[92:95], v[108:111], v[180:183]
    ds_read_b128 v[220:223], v32 offset:1536
    v_mfma_f32_16x16x32_bf16 v[72:75], v[96:99], v[108:111], v[72:75]
    ds_read_b128 v[208:211], v32 offset:768
    v_mfma_f32_16x16x32_bf16 v[76:79], v[100:103], v[108:111], v[76:79]
    ds_read_b128 v[224:227], v32 offset:1792
    s_waitcnt lgkmcnt(6)
    v_fma_f32 v88, v196, v168, v169
    v_fma_f32 v89, v212, v176, v177
    v_fma_f32 v90, v196, v64, v65
    s_nop 0
    v_fma_f32 v91, v212, v72, v73
    v_fmac_f32_dpp v88, v168, v197 row_ror:8 row_mask:0xf bank_mask:0xf
    v_fmac_f32_dpp v89, v176, v213 row_ror:8 row_mask:0xf bank_mask:0xf
    v_fmac_f32_dpp v90, v64, v197 row_ror:8 row_mask:0xf bank_mask:0xf
    v_fmac_f32_dpp v91, v72, v213 row_ror:8 row_mask:0xf bank_mask:0xf
    ds_write_b128 v34, v[64:67] offset:48640
    v_fma_f32 v96, v196, v88, v170
    v_fma_f32 v97, v212, v89, v178
    v_fma_f32 v98, v196, v90, v66
    v_fma_f32 v99, v212, v91, v74
    v_fmac_f32_dpp v96, v88, v197 row_ror:8 row_mask:0xf bank_mask:0xf
    v_fmac_f32_dpp v97, v89, v213 row_ror:8 row_mask:0xf bank_mask:0xf
    v_fmac_f32_dpp v98, v90, v197 row_ror:8 row_mask:0xf bank_mask:0xf
    v_fmac_f32_dpp v99, v91, v213 row_ror:8 row_mask:0xf bank_mask:0xf
    ds_write_b128 v34, v[68:71] offset:49664
    v_fma_f32 v88, v196, v96, v171
    v_fma_f32 v89, v212, v97, v179
    v_fma_f32 v90, v196, v98, v67
    v_fma_f32 v91, v212, v99, v75
    v_fmac_f32_dpp v88, v96, v197 row_ror:8 row_mask:0xf bank_mask:0xf
    v_fmac_f32_dpp v89, v97, v213 row_ror:8 row_mask:0xf bank_mask:0xf
    v_fmac_f32_dpp v90, v98, v197 row_ror:8 row_mask:0xf bank_mask:0xf
    v_fmac_f32_dpp v91, v99, v213 row_ror:8 row_mask:0xf bank_mask:0xf
    ds_write_b128 v34, v[72:75] offset:50688
    v_fma_f32 v96, v196, v88, v172
    v_fma_f32 v97, v212, v89, v180
    v_fma_f32 v98, v196, v90, v68
    v_fma_f32 v99, v212, v91, v76
    v_fmac_f32_dpp v96, v88, v197 row_ror:8 row_mask:0xf bank_mask:0xf
    v_fmac_f32_dpp v97, v89, v213 row_ror:8 row_mask:0xf bank_mask:0xf
    v_fmac_f32_dpp v98, v90, v197 row_ror:8 row_mask:0xf bank_mask:0xf
    v_fmac_f32_dpp v99, v91, v213 row_ror:8 row_mask:0xf bank_mask:0xf
    ds_write_b128 v34, v[76:79] offset:51712
    v_fma_f32 v88, v196, v96, v173
    v_fma_f32 v89, v212, v97, v181
    v_fma_f32 v90, v196, v98, v69
    v_fma_f32 v91, v212, v99, v77
    v_fmac_f32_dpp v88, v96, v197 row_ror:8 row_mask:0xf bank_mask:0xf
    v_fmac_f32_dpp v89, v97, v213 row_ror:8 row_mask:0xf bank_mask:0xf
    v_fmac_f32_dpp v90, v98, v197 row_ror:8 row_mask:0xf bank_mask:0xf
    v_fmac_f32_dpp v91, v99, v213 row_ror:8 row_mask:0xf bank_mask:0xf
    v_fma_f32 v96, v196, v88, v174
    v_fma_f32 v97, v212, v89, v182
    v_fma_f32 v98, v196, v90, v70
    v_fma_f32 v99, v212, v91, v78
    v_fmac_f32_dpp v96, v88, v197 row_ror:8 row_mask:0xf bank_mask:0xf
    v_fmac_f32_dpp v97, v89, v213 row_ror:8 row_mask:0xf bank_mask:0xf
    v_fmac_f32_dpp v98, v90, v197 row_ror:8 row_mask:0xf bank_mask:0xf
    v_fmac_f32_dpp v99, v91, v213 row_ror:8 row_mask:0xf bank_mask:0xf
    v_fma_f32 v88, v196, v96, v175
    v_fma_f32 v89, v212, v97, v183
    v_fma_f32 v90, v196, v98, v71
    v_fma_f32 v91, v212, v99, v79
    v_fmac_f32_dpp v88, v96, v197 row_ror:8 row_mask:0xf bank_mask:0xf
    v_fmac_f32_dpp v89, v97, v213 row_ror:8 row_mask:0xf bank_mask:0xf
    v_fmac_f32_dpp v90, v98, v197 row_ror:8 row_mask:0xf bank_mask:0xf
    v_fmac_f32_dpp v91, v99, v213 row_ror:8 row_mask:0xf bank_mask:0xf
    s_mov_b64 exec, 0xffff
    ds_write_b128 v35, v[40:43] offset:40960
    ds_write_b128 v35, v[40:43] offset:42240
    s_mov_b64 exec, -1
    ds_write_b32 v36, v88 offset:40976
    ds_write_b32 v36, v89 offset:42256
    ds_write_b32 v36, v90 offset:40992
    ds_write_b32 v36, v91 offset:42272
    s_waitcnt vmcnt(0)
    v_cmp_ne_u32 vcc, s67, v14
    s_nop 4
    s_cbranch_vccnz Lslow_25
Lok_26:
    buffer_load_dwordx4 v[144:147], v19, s[52:55], s7 offen sc1
    buffer_load_dwordx4 v[148:151], v19, s[52:55], s7 offen offset:1280 sc1
    buffer_load_dword v152, v21, s[52:55], s7 offen sc1
    s_waitcnt vmcnt(0)
    s_mov_b32 s72, 0x3eae1a93
    s_mov_b32 s73, s72
    v_lshlrev_b32 v104, 16, v144
    v_and_b32 v105, 0xffff0000, v144
    v_lshlrev_b32 v106, 16, v145
    v_and_b32 v107, 0xffff0000, v145
    v_lshlrev_b32 v108, 16, v146
    v_and_b32 v109, 0xffff0000, v146
    v_lshlrev_b32 v110, 16, v147
    v_and_b32 v111, 0xffff0000, v147
    v_lshlrev_b32 v112, 16, v148
    v_and_b32 v113, 0xffff0000, v148
    v_lshlrev_b32 v114, 16, v149
    v_and_b32 v115, 0xffff0000, v149
    v_lshlrev_b32 v116, 16, v150
    v_and_b32 v117, 0xffff0000, v150
    v_lshlrev_b32 v118, 16, v151
    v_and_b32 v119, 0xffff0000, v151
    v_lshlrev_b32 v120, 16, v152
    v_and_b32 v121, 0xffff0000, v152
    v_pk_mul_f32 v[104:105], v[104:105], s[72:73]
    v_pk_mul_f32 v[106:107], v[106:107], s[72:73]
    v_pk_mul_f32 v[108:109], v[108:109], s[72:73]
    v_pk_mul_f32 v[110:111], v[110:111], s[72:73]
    v_pk_mul_f32 v[112:113], v[112:113], s[72:73]
    v_pk_mul_f32 v[114:115], v[114:115], s[72:73]
    v_pk_mul_f32 v[116:117], v[116:117], s[72:73]
    v_pk_mul_f32 v[118:119], v[118:119], s[72:73]
    v_pk_mul_f32 v[120:121], v[120:121], s[72:73]
    v_cvt_pk_bf16_f32 v144, v104, v105
    v_cvt_pk_bf16_f32 v145, v106, v107
    v_cvt_pk_bf16_f32 v146, v108, v109
    v_cvt_pk_bf16_f32 v147, v110, v111
    v_cvt_pk_bf16_f32 v148, v112, v113
    v_cvt_pk_bf16_f32 v149, v114, v115
    v_cvt_pk_bf16_f32 v150, v116, v117
    v_cvt_pk_bf16_f32 v151, v118, v119
    v_cvt_pk_bf16_f32 v152, v120, v121
    s_branch L_front_done
L_nofront:
    s_waitcnt lgkmcnt(0)
    s_mov_b32 s67, 0
    s_mov_b32 s68, 0
    s_and_b32 s72, s64, 1
    s_lshl_b32 s72, s72, 1
    s_add_u32 s71, s72, s70
    s_bfe_u32 s3, s64, 0x10001
    s_and_b32 s72, s65, 3
    s_lshl_b32 s72, s72, 2
    s_and_b32 s73, s66, 3
    s_add_u32 s38, s72, s73
    s_lshl_b32 s73, s73, 3
    s_add_u32 s4, s73, s65
    s_lshr_b32 s5, s66, 2
    s_mul_i32 s6, s4, 163968
    s_mul_i32 s7, s4, 82048
    s_lshl_b32 s72, s5, 3
    s_lshl_b32 s73, s69, 1
    s_add_u32 s72, s72, s73
    s_mul_i32 s72, s72, 1280
    s_add_u32 s7, s7, s72
    s_add_u32 s7, s7, 5246976
    s_lshr_b32 s72, s65, 2
    s_lshl_b32 s72, s72, 1
    s_add_u32 s72, s72, s5
    s_add_u32 s39, s72, 6
    s_mul_i32 s97, s72, 48
    s_add_u32 s97, s97, 96
    s_mov_b32 s52, s36
    s_mov_b32 s53, s37
    s_mov_b32 s54, 268435456
    s_mov_b32 s55, 0x20000
    s_mov_b32 s60, s34
    s_mov_b32 s61, s35
    s_mov_b32 s62, 256
    s_mov_b32 s63, 0x20000
    s_cmp_lt_u32 s64, 4
    s_cbranch_scc1 L_pc0
    s_mul_i32 s73, s3, 24
    s_add_u32 s72, s97, s73
    v_and_b32 v4, 7, v2
    v_lshl_add_u32 v4, v3, 3, v4
    v_add_lshl_u32 v4, s72, v4, 1
    s_mov_b32 s60, s16
    s_mov_b32 s61, s17
    s_mov_b32 s62, 1152
    s_mov_b32 s63, 0x20000
    buffer_load_ushort v64, v4, s[60:63], 0 offen offset:0
    s_mov_b32 s60, s18
    s_mov_b32 s61, s19
    s_mov_b32 s62, 1152
    s_mov_b32 s63, 0x20000
    buffer_load_ushort v65, v4, s[60:63], 0 offen offset:0
    s_mov_b32 s60, s28
    s_mov_b32 s61, s29
    s_mov_b32 s62, 1152
    s_mov_b32 s63, 0x20000
    buffer_load_ushort v66, v4, s[60:63], 0 offen offset:0
    s_mov_b32 s60, s34
    s_mov_b32 s61, s35
    s_mov_b32 s62, 256
    s_mov_b32 s63, 0x20000
    s_lshl_b32 s72, s38, 7
    s_lshl_b32 s73, s69, 5
    s_add_u32 s72, s72, s73
    v_bfe_u32 v4, v1, 3, 2
    v_lshrrev_b32 v5, 5, v1
    v_lshl_add_u32 v4, v5, 3, v4
    v_add_u32 v4, s72, v4
    v_mul_u32_u24 v4, 1152, v4
    v_and_b32 v5, 7, v1
    v_xor_b32 v5, v5, v3
    v_lshl_add_u32 v48, v5, 4, v4
    v_xor_b32 v49, 64, v48
    v_add_u32 v49, 18432, v49
    s_lshr_b32 s73, s69, 1
    s_lshl_b32 s73, s73, 3
    s_add_u32 s72, s97, s73
    v_lshrrev_b32 v4, 3, v1
    v_add_u32 v4, s72, v4
    v_mul_u32_u24 v4, 1152, v4
    s_and_b32 s73, s64, 1
    s_lshl_b32 s72, s73, 2
    v_xor_b32 v5, s72, v5
    v_lshl_add_u32 v50, v5, 4, v4
    s_cmp_eq_u32 s73, 0
    s_cselect_b32 s48, s20, s22
    s_cselect_b32 s49, s21, s23
    s_mov_b32 s50, 663552
    s_mov_b32 s51, 0x20000
    s_lshl_b32 s80, s69, 12
    s_lshl_b32 s83, s69, 10
    s_add_u32 s83, s83, 16384
    s_and_b32 s72, s66, 3
    s_lshl_b32 s72, s72, 1
    s_add_u32 s72, s72, s5
    s_add_u32 s82, s72, s65
    s_mul_i32 s73, s82, 57
    s_lshr_b32 s73, s73, 9
    s_mul_i32 s73, s73, 9
    s_sub_u32 s82, s82, s73
    s_lshl_b32 s82, s82, 7
    s_mov_b32 s56, s14
    s_mov_b32 s57, s15
    s_mov_b32 s58, 2359296
    s_mov_b32 s59, 0x20000
    s_mul_i32 s72, s70, 20480
    s_add_u32 s72, s72, 81920
    v_lshlrev_b32 v19, 4, v1
    v_add_u32 v16, s72, v19
    v_and_b32 v4, 31, v1
    v_and_b32 v7, 7, v1
    v_bfe_u32 v5, v1, 3, 1
    v_lshl_add_u32 v7, v5, 4, v7
    v_bfe_u32 v5, v1, 4, 1
    v_lshl_add_u32 v7, v5, 3, v7
    v_lshlrev_b32 v7, 3, v7
    v_add_u32 v7, 1024, v7
    v_add_u32 v17, s72, v7
    v_lshrrev_b32 v5, 5, v1
    v_mul_u32_u24 v6, 1280, v5
    v_add_u32 v21, v7, v6
    v_min_u32 v4, 19, v4
    v_lshlrev_b32 v4, 4, v4
    v_cmp_gt_u32 vcc, 0x100, v4
    v_lshl_add_u32 v6, v5, 8, v4
    v_lshl_add_u32 v4, v5, 6, v4
    v_add_u32 v4, 768, v4
    v_cndmask_b32 v4, v4, v6, vcc
    s_add_u32 s72, s72, 1280
    v_add_u32 v18, s72, v4
    v_mov_b32 v4, 128
    v_mov_b32 v5, 512
    v_cndmask_b32 v4, v4, v5, vcc
    v_add_u32 v20, v18, v4
    s_lshl_b32 s94, s69, 10
    s_and_b32 s72, s65, 3
    s_lshl_b32 s72, s72, 2
    s_and_b32 s73, s66, 3
    s_add_u32 s74, s72, s73
    s_lshr_b32 s72, s65, 2
    s_lshl_b32 s72, s72, 2
    s_bfe_u32 s73, s66, 0x20002
    s_add_u32 s75, s72, s73
    s_lshl_b32 s72, s5, 1
    s_lshr_b32 s73, s69, 1
    s_add_u32 s72, s72, s73
    s_and_b32 s73, s72, 3
    s_lshl_b32 s73, s73, 3
    s_lshr_b32 s72, s72, 2
    s_add_u32 s72, s72, s73
    s_lshl_b32 s79, s72, 1
    s_and_b32 s73, s69, 1
    s_add_u32 s79, s79, s73
    s_lshl_b32 s79, s79, 5
    s_add_u32 s79, s79, s4
    s_lshl_b32 s79, s79, 1
    s_add_u32 s79, s79, s70
    s_lshl_b32 s79, s79, 2
    s_add_u32 s79, s79, 15380480
    v_mov_b32 v22, 0
    v_mov_b32 v23, 0
    v_mov_b32 v24, 0
    v_mov_b32 v25, 0
    v_mov_b32 v26, 0
    v_mov_b32 v27, 0
    v_mov_b32 v28, 0
    v_mov_b32 v29, 0
    v_mov_b32 v30, 0
    v_mov_b32 v31, 0
    s_cmp_ge_u32 s66, 16
    s_cbranch_scc1 Lta_28
    v_and_b32 v4, 7, v1
    v_lshrrev_b32 v6, 3, v1
    s_lshl_b32 s72, s69, 4
    v_add_u32 v7, s72, v6
    s_mul_i32 s72, s69, 36864
    v_lshl_add_u32 v22, v1, 4, s72
    v_xor_b32 v4, v4, v3
    s_mul_i32 s73, s75, 72
    v_add_u32 v23, s73, v7
    v_mul_u32_u24 v23, 1152, v23
    v_lshl_add_u32 v23, v4, 4, v23
    s_add_u32 s73, s73, 64
    v_add_u32 v24, s73, v6
    v_mul_u32_u24 v24, 1152, v24
    v_lshl_add_u32 v24, v4, 4, v24
    s_branch Lta_29
Lta_28:
    s_cmp_lt_u32 s64, 4
    s_cbranch_scc1 Lta_29
    v_lshrrev_b32 v4, 5, v1
    v_and_b32 v5, 31, v1
    v_lshlrev_b32 v5, 4, v5
    s_lshl_b32 s72, s69, 16
    s_lshl_b32 s73, s74, 12
    s_add_u32 s73, s72, s73
    v_lshl_add_u32 v6, v4, 10, v5
    v_add_u32 v25, s73, v6
    s_lshl_b32 s73, s74, 9
    s_add_u32 s72, s72, s73
    s_add_u32 s72, s72, 14692352
    v_lshl_add_u32 v4, v4, 13, v5
    v_add_u32 v26, s72, v4
    s_lshl_b32 s72, s69, 7
    s_add_u32 s72, s72, 0
    v_add_u32 v4, s72, v1
    v_mul_u32_u24 v5, 7282, v4
    v_lshrrev_b32 v5, 16, v5
    v_mul_u32_u24 v6, 9, v5
    v_sub_u32 v4, v4, v6
    s_mul_i32 s73, s75, 144
    v_lshl_add_u32 v4, v4, 4, s73
    v_and_b32 v6, 1, v5
    v_bfe_u32 v7, v5, 1, 2
    v_lshl_add_u32 v7, v6, 3, v7
    v_bfe_u32 v8, v5, 3, 1
    v_lshl_add_u32 v7, v8, 2, v7
    v_lshrrev_b32 v8, 4, v5
    v_mul_u32_u24 v8, 18, v8
    v_add_u32 v7, v7, v8
    v_mul_u32_u24 v7, 1152, v7
    v_add_u32 v27, v7, v4
    v_lshrrev_b32 v7, 3, v5
    v_lshlrev_b32 v7, 2, v7
    v_lshl_add_u32 v7, v6, 1, v7
    v_bfe_u32 v6, v5, 2, 1
    v_add_u32 v7, v7, v6
    v_mul_u32_u24 v7, 18, v7
    v_bfe_u32 v6, v5, 1, 1
    v_add3_u32 v7, v7, v6, 16
    v_mul_u32_u24 v7, 1152, v7
    v_add_u32 v30, v7, v4
    s_lshl_b32 s72, s69, 7
    s_add_u32 s72, s72, 64
    v_add_u32 v4, s72, v1
    v_mul_u32_u24 v5, 7282, v4
    v_lshrrev_b32 v5, 16, v5
    v_mul_u32_u24 v6, 9, v5
    v_sub_u32 v4, v4, v6
    s_mul_i32 s73, s75, 144
    v_lshl_add_u32 v4, v4, 4, s73
    v_and_b32 v6, 1, v5
    v_bfe_u32 v7, v5, 1, 2
    v_lshl_add_u32 v7, v6, 3, v7
    v_bfe_u32 v8, v5, 3, 1
    v_lshl_add_u32 v7, v8, 2, v7
    v_lshrrev_b32 v8, 4, v5
    v_mul_u32_u24 v8, 18, v8
    v_add_u32 v7, v7, v8
    v_mul_u32_u24 v7, 1152, v7
    v_add_u32 v28, v7, v4
    v_lshrrev_b32 v7, 3, v5
    v_lshlrev_b32 v7, 2, v7
    v_lshl_add_u32 v7, v6, 1, v7
    v_bfe_u32 v6, v5, 2, 1
    v_add_u32 v7, v7, v6
    v_mul_u32_u24 v7, 18, v7
    v_bfe_u32 v6, v5, 1, 1
    v_add3_u32 v7, v7, v6, 16
    v_mul_u32_u24 v7, 1152, v7
    v_add_u32 v31, v7, v4
    v_add_u32 v4, 512, v1
    v_mul_u32_u24 v5, 7282, v4
    v_lshrrev_b32 v5, 16, v5
    v_mul_u32_u24 v6, 9, v5
    v_sub_u32 v4, v4, v6
    s_mul_i32 s73, s75, 144
    v_lshl_add_u32 v4, v4, 4, s73
    v_and_b32 v6, 1, v5
    v_bfe_u32 v7, v5, 1, 2
    v_lshl_add_u32 v7, v6, 3, v7
    v_bfe_u32 v8, v5, 3, 1
    v_lshl_add_u32 v7, v8, 2, v7
    v_lshrrev_b32 v8, 4, v5
    v_mul_u32_u24 v8, 18, v8
    v_add_u32 v7, v7, v8
    v_mul_u32_u24 v7, 1152, v7
    v_add_u32 v29, v7, v4
    v_lshrrev_b32 v7, 3, v5
    v_lshlrev_b32 v7, 2, v7
    v_lshl_add_u32 v7, v6, 1, v7
    v_bfe_u32 v6, v5, 2, 1
    v_add_u32 v7, v7, v6
    v_mul_u32_u24 v7, 18, v7
    v_bfe_u32 v6, v5, 1, 1
    v_add3_u32 v7, v7, v6, 16
    v_mul_u32_u24 v7, 1152, v7
    v_add_u32 v0, v7, v4
Lta_29:
    s_lshl_b32 s72, s2, 8
    s_add_u32 s72, s72, 15085568
    v_min_u32 v15, 33, v1
    v_lshl_add_u32 v15, v15, 2, s72
    s_mul_i32 s72, s3, 3072
    s_add_u32 s72, s72, 75776
    v_lshl_add_u32 v52, v2, 4, s72
    s_lshl_b32 s72, s3, 2
    s_add_u32 s72, s72, s71
    s_mul_i32 s72, s72, 1536
    s_add_u32 s72, s72, 151552
    v_mul_u32_u24 v53, 384, v3
    v_lshl_add_u32 v53, v2, 3, v53
    v_add_u32 v53, s72, v53
    s_waitcnt vmcnt(0)
    v_cmp_gt_u32 vcc, 8, v2
    v_mov_b32 v67, 1.0
    v_mov_b32 v70, -1.0
    v_cndmask_b32 v67, v67, v70, vcc
    v_lshlrev_b32 v66, 16, v66
    v_mul_f32 v66, 0x3fb8aa3b, v66
    v_exp_f32 v66, v66
    v_lshlrev_b32 v64, 16, v64
    v_lshlrev_b32 v65, 16, v65
    v_cvt_pk_bf16_f32 v66, v66, v66
    v_lshlrev_b32 v66, 16, v66
    v_mul_f32 v68, v66, v64
    v_mul_f32 v69, v66, v65
    v_mul_f32 v68, 0x3fb8aa3b, v68
    v_mul_f32 v69, 0x3e22f983, v69
    s_bitcmp1_b32 s64, 0
    s_cbranch_scc1 Lp_30
    v_mul_f32 v70, 0x3f800000, v68
    v_mul_f32 v71, 0x3f800000, v69
    v_exp_f32 v70, v70
    v_rndne_f32 v72, v71
    v_sub_f32 v71, v71, v72
    v_cos_f32 v72, v71
    v_sin_f32 v71, v71
    v_mul_f32 v76, v70, v72
    v_mul_f32 v70, v70, v67
    v_mul_f32 v77, v70, v71
    v_mul_f32 v70, 0x43000000, v68
    v_mul_f32 v71, 0x43000000, v69
    v_exp_f32 v70, v70
    v_rndne_f32 v72, v71
    v_sub_f32 v71, v71, v72
    v_cos_f32 v72, v71
    v_sin_f32 v71, v71
    v_mul_f32 v80, v70, v72
    v_mul_f32 v70, v70, v67
    v_mul_f32 v81, v70, v71
    v_mul_f32 v70, 0x44000000, v68
    v_mul_f32 v71, 0x44000000, v69
    v_exp_f32 v70, v70
    v_rndne_f32 v72, v71
    v_sub_f32 v71, v71, v72
    v_cos_f32 v72, v71
    v_sin_f32 v71, v71
    v_mul_f32 v82, v70, v72
    v_mul_f32 v70, v70, v67
    v_mul_f32 v83, v70, v71
    v_mul_f32 v70, 0x44800000, v68
    v_mul_f32 v71, 0x44800000, v69
    v_exp_f32 v70, v70
    v_rndne_f32 v72, v71
    v_sub_f32 v71, v71, v72
    v_cos_f32 v72, v71
    v_sin_f32 v71, v71
    v_mul_f32 v84, v70, v72
    v_mul_f32 v70, v70, v67
    v_mul_f32 v85, v70, v71
    v_mul_f32 v70, 0x41000000, v68
    v_mul_f32 v71, 0x41000000, v69
    v_exp_f32 v70, v70
    v_rndne_f32 v72, v71
    v_sub_f32 v71, v71, v72
    v_cos_f32 v72, v71
    v_sin_f32 v71, v71
    v_mul_f32 v86, v70, v72
    v_mul_f32 v70, v70, v67
    v_mul_f32 v87, v70, v71
    v_mul_f32 v70, 0x42000000, v68
    v_mul_f32 v71, 0x42000000, v69
    v_exp_f32 v70, v70
    v_rndne_f32 v72, v71
    v_sub_f32 v71, v71, v72
    v_cos_f32 v72, v71
    v_sin_f32 v71, v71
    v_mul_f32 v88, v70, v72
    v_mul_f32 v70, v70, v67
    v_mul_f32 v89, v70, v71
    v_mul_f32 v70, 0x42800000, v68
    v_mul_f32 v71, 0x42800000, v69
    v_exp_f32 v70, v70
    v_rndne_f32 v72, v71
    v_sub_f32 v71, v71, v72
    v_cos_f32 v72, v71
    v_sin_f32 v71, v71
    v_mul_f32 v90, v70, v72
    v_mul_f32 v70, v70, v67
    v_mul_f32 v91, v70, v71
    v_max_f32 v70, |v64|, |v65|
    v_rcp_f32 v70, v70
    v_add_f32 v68, -1.0, v76
    v_mul_f32 v64, v64, v70
    v_mul_f32 v65, v65, v70
    v_mul_f32 v71, v64, v64
    v_fmac_f32 v71, v65, v65
    v_rcp_f32 v71, v71
    v_mul_f32 v72, v77, v67
    v_mul_f32 v70, v70, v71
    v_mul_f32 v70, -2.0, v70
    v_mul_f32 v66, v68, v64
    v_fmac_f32 v66, v72, v65
    v_mul_f32 v66, v66, v70
    v_mul_f32 v78, v66, v67
    v_mul_f32 v66, v72, v64
    v_fma_f32 v66, -v68, v65, v66
    v_mul_f32 v79, v66, v70
    s_branch Lp_31
Lp_30:
    v_mul_f32 v70, 0x41000000, v68
    v_mul_f32 v71, 0x41000000, v69
    v_exp_f32 v70, v70
    v_rndne_f32 v72, v71
    v_sub_f32 v71, v71, v72
    v_cos_f32 v72, v71
    v_sin_f32 v71, v71
    v_mul_f32 v78, v70, v72
    v_mul_f32 v70, v70, v67
    v_mul_f32 v79, v70, v71
    v_mov_b32 v76, 1.0
    v_mov_b32 v77, 0
    v_mul_f32 v80, v78, v78
    v_mul_f32 v81, v78, v79
    v_fma_f32 v80, -v79, v79, v80
    v_fmac_f32 v81, v79, v78
    v_mul_f32 v82, v80, v78
    v_mul_f32 v83, v80, v79
    v_fma_f32 v82, -v81, v79, v82
    v_fmac_f32 v83, v81, v78
    v_mul_f32 v84, v82, v78
    v_mul_f32 v85, v82, v79
    v_fma_f32 v84, -v83, v79, v84
    v_fmac_f32 v85, v83, v78
    v_mul_f32 v86, v84, v78
    v_mul_f32 v87, v84, v79
    v_fma_f32 v86, -v85, v79, v86
    v_fmac_f32 v87, v85, v78
    v_mul_f32 v88, v86, v78
    v_mul_f32 v89, v86, v79
    v_fma_f32 v88, -v87, v79, v88
    v_fmac_f32 v89, v87, v78
    v_mul_f32 v90, v88, v78
    v_mul_f32 v91, v88, v79
    v_fma_f32 v90, -v89, v79, v90
    v_fmac_f32 v91, v89, v78
    v_mul_f32 v92, v90, v78
    v_mul_f32 v93, v90, v79
    v_fma_f32 v92, -v91, v79, v92
    v_fmac_f32 v93, v91, v78
    v_mul_f32 v94, v92, v78
    v_mul_f32 v95, v92, v79
    v_fma_f32 v94, -v93, v79, v94
    v_fmac_f32 v95, v93, v78
    v_mul_f32 v96, v94, v78
    v_mul_f32 v97, v94, v79
    v_fma_f32 v96, -v95, v79, v96
    v_fmac_f32 v97, v95, v78
    v_mul_f32 v98, v96, v78
    v_mul_f32 v99, v96, v79
    v_fma_f32 v98, -v97, v79, v98
    v_fmac_f32 v99, v97, v78
    v_mul_f32 v100, v98, v78
    v_mul_f32 v101, v98, v79
    v_fma_f32 v100, -v99, v79, v100
    v_fmac_f32 v101, v99, v78
    v_mul_f32 v102, v100, v78
    v_mul_f32 v103, v100, v79
    v_fma_f32 v102, -v101, v79, v102
    v_fmac_f32 v103, v101, v78
    v_mul_f32 v104, v102, v78
    v_mul_f32 v105, v102, v79
    v_fma_f32 v104, -v103, v79, v104
    v_fmac_f32 v105, v103, v78
    v_mul_f32 v106, v104, v78
    v_mul_f32 v107, v104, v79
    v_fma_f32 v106, -v105, v79, v106
    v_fmac_f32 v107, v105, v78
Lp_31:
    s_add_u32 s92, s82, 4608
    s_add_u32 m0, s80, 40960
    s_nop 0
    buffer_load_dwordx4 v48, s[56:59], s82 offen lds
    s_add_u32 m0, s80, 41984
    s_nop 0
    buffer_load_dwordx4 v49, s[56:59], s82 offen lds
    s_add_u32 m0, s80, 43008
    s_nop 0
    buffer_load_dwordx4 v48, s[56:59], s92 offen lds
    s_add_u32 m0, s80, 44032
    s_waitcnt vmcnt(2)
    buffer_load_dwordx4 v49, s[56:59], s92 offen lds
    s_add_u32 m0, s83, 40960
    s_waitcnt vmcnt(2)
    buffer_load_dwordx4 v50, s[48:51], s82 offen lds
    s_add_u32 s92, s82, 18432
    s_add_u32 m0, s83, 45056
    s_waitcnt vmcnt(2)
    buffer_load_dwordx4 v50, s[48:51], s92 offen lds
    s_add_u32 s92, s82, 36864
    s_add_u32 m0, s83, 49152
    s_waitcnt vmcnt(2)
    buffer_load_dwordx4 v50, s[48:51], s92 offen lds
    s_add_u32 s82, s82, 128
    s_cmp_eq_u32 s82, 1152
    s_cselect_b32 s82, 0, s82
    s_add_u32 s92, s82, 4608
    s_add_u32 m0, s80, 81920
    s_waitcnt vmcnt(2)
    buffer_load_dwordx4 v48, s[56:59], s82 offen lds
    s_add_u32 m0, s80, 82944
    s_waitcnt vmcnt(2)
    buffer_load_dwordx4 v49, s[56:59], s82 offen lds
    s_add_u32 m0, s80, 83968
    s_waitcnt vmcnt(2)
    buffer_load_dwordx4 v48, s[56:59], s92 offen lds
    s_add_u32 m0, s80, 84992
    s_waitcnt vmcnt(2)
    buffer_load_dwordx4 v49, s[56:59], s92 offen lds
    s_add_u32 m0, s83, 81920
    s_waitcnt vmcnt(2)
    buffer_load_dwordx4 v50, s[48:51], s82 offen lds
    s_add_u32 s92, s82, 18432
    s_add_u32 m0, s83, 86016
    s_waitcnt vmcnt(2)
    buffer_load_dwordx4 v50, s[48:51], s92 offen lds
    s_add_u32 s92, s82, 36864
    s_add_u32 m0, s83, 90112
    s_waitcnt vmcnt(2)
    buffer_load_dwordx4 v50, s[48:51], s92 offen lds
    s_add_u32 s82, s82, 128
    s_cmp_eq_u32 s82, 1152
    s_cselect_b32 s82, 0, s82
    s_add_u32 s92, s82, 4608
    s_add_u32 m0, s80, 122880
    s_waitcnt vmcnt(2)
    buffer_load_dwordx4 v48, s[56:59], s82 offen lds
    s_add_u32 m0, s80, 123904
    s_waitcnt vmcnt(2)
    buffer_load_dwordx4 v49, s[56:59], s82 offen lds
    s_add_u32 m0, s80, 124928
    s_waitcnt vmcnt(2)
    buffer_load_dwordx4 v48, s[56:59], s92 offen lds
    s_add_u32 m0, s80, 125952
    s_waitcnt vmcnt(2)
    buffer_load_dwordx4 v49, s[56:59], s92 offen lds
    s_add_u32 m0, s83, 122880
    s_waitcnt vmcnt(2)
    buffer_load_dwordx4 v50, s[48:51], s82 offen lds
    s_add_u32 s92, s82, 18432
    s_add_u32 m0, s83, 126976
    s_waitcnt vmcnt(2)
    buffer_load_dwordx4 v50, s[48:51], s92 offen lds
    s_add_u32 s92, s82, 36864
    s_add_u32 m0, s83, 131072
    s_waitcnt vmcnt(2)
    buffer_load_dwordx4 v50, s[48:51], s92 offen lds
    s_add_u32 s82, s82, 128
    s_cmp_eq_u32 s82, 1152
    s_cselect_b32 s82, 0, s82
    s_barrier
    s_add_u32 s92, s82, 4608
    s_add_u32 m0, s80, 0
    s_waitcnt vmcnt(2)
    buffer_load_dwordx4 v48, s[56:59], s82 offen lds
    s_add_u32 m0, s80, 1024
    s_waitcnt vmcnt(2)
    buffer_load_dwordx4 v49, s[56:59], s82 offen lds
    s_add_u32 m0, s80, 2048
    s_waitcnt vmcnt(2)
    buffer_load_dwordx4 v48, s[56:59], s92 offen lds
    s_add_u32 m0, s80, 3072
    s_waitcnt vmcnt(2)
    buffer_load_dwordx4 v49, s[56:59], s92 offen lds
    s_add_u32 m0, s83, 0
    s_waitcnt vmcnt(2)
    buffer_load_dwordx4 v50, s[48:51], s82 offen lds
    s_add_u32 s92, s82, 18432
    s_add_u32 m0, s83, 4096
    s_waitcnt vmcnt(2)
    buffer_load_dwordx4 v50, s[48:51], s92 offen lds
    s_add_u32 s92, s82, 36864
    s_add_u32 m0, s83, 8192
    s_waitcnt vmcnt(2)
    buffer_load_dwordx4 v50, s[48:51], s92 offen lds
    s_add_u32 s82, s82, 128
    s_cmp_eq_u32 s82, 1152
    s_cselect_b32 s82, 0, s82
    s_barrier
    s_add_u32 s92, s82, 4608
    s_add_u32 m0, s80, 40960
    s_waitcnt vmcnt(2)
    buffer_load_dwordx4 v48, s[56:59], s82 offen lds
    s_add_u32 m0, s80, 41984
    s_waitcnt vmcnt(2)
    buffer_load_dwordx4 v49, s[56:59], s82 offen lds
    s_add_u32 m0, s80, 43008
    s_waitcnt vmcnt(2)
    buffer_load_dwordx4 v48, s[56:59], s92 offen lds
    s_add_u32 m0, s80, 44032
    s_waitcnt vmcnt(2)
    buffer_load_dwordx4 v49, s[56:59], s92 offen lds
    s_add_u32 m0, s83, 40960
    s_waitcnt vmcnt(2)
    buffer_load_dwordx4 v50, s[48:51], s82 offen lds
    s_add_u32 s92, s82, 18432
    s_add_u32 m0, s83, 45056
    s_waitcnt vmcnt(2)
    buffer_load_dwordx4 v50, s[48:51], s92 offen lds
    s_add_u32 s92, s82, 36864
    s_add_u32 m0, s83, 49152
    s_waitcnt vmcnt(2)
    buffer_load_dwordx4 v50, s[48:51], s92 offen lds
    s_add_u32 s82, s82, 128
    s_cmp_eq_u32 s82, 1152
    s_cselect_b32 s82, 0, s82
    s_mov_b32 exec_lo, -1
    s_mov_b32 exec_hi, 0xffff
    s_bitcmp1_b32 s64, 0
    s_cbranch_scc1 Lp_32
    s_mul_i32 s72, s3, 3072
    s_add_u32 s72, s72, 75776
    v_lshlrev_b32 v4, 10, v3
    v_lshl_add_u32 v4, v2, 4, v4
    v_add_u32 v4, s72, v4
    ds_write_b128 v4, v[76:79] offset:0
    ds_write_b128 v4, v[80:83] offset:256
    ds_write_b128 v4, v[84:87] offset:512
    ds_write_b128 v4, v[88:91] offset:768
    s_branch Lp_33
Lp_32:
    s_mul_i32 s72, s3, 6144
    s_add_u32 s72, s72, 151552
    v_lshl_add_u32 v4, v1, 3, s72
    ds_write_b64 v4, v[76:77] offset:0
    ds_write_b64 v4, v[78:79] offset:384
    ds_write_b64 v4, v[80:81] offset:768
    ds_write_b64 v4, v[82:83] offset:1152
    ds_write_b64 v4, v[84:85] offset:1536
    ds_write_b64 v4, v[86:87] offset:1920
    ds_write_b64 v4, v[88:89] offset:2304
    ds_write_b64 v4, v[90:91] offset:2688
    ds_write_b64 v4, v[92:93] offset:3072
    ds_write_b64 v4, v[94:95] offset:3456
    ds_write_b64 v4, v[96:97] offset:3840
    ds_write_b64 v4, v[98:99] offset:4224
    ds_write_b64 v4, v[100:101] offset:4608
    ds_write_b64 v4, v[102:103] offset:4992
    ds_write_b64 v4, v[104:105] offset:5376
    ds_write_b64 v4, v[106:107] offset:5760
Lp_33:
    s_mov_b64 exec, -1
    s_waitcnt lgkmcnt(0)
    s_barrier
    s_add_u32 s92, s82, 4608
    s_add_u32 m0, s80, 81920
    s_waitcnt vmcnt(2)
    buffer_load_dwordx4 v48, s[56:59], s82 offen lds
    s_add_u32 m0, s80, 82944
    s_waitcnt vmcnt(2)
    buffer_load_dwordx4 v49, s[56:59], s82 offen lds
    s_add_u32 m0, s80, 83968
    s_waitcnt vmcnt(2)
    buffer_load_dwordx4 v48, s[56:59], s92 offen lds
    s_add_u32 m0, s80, 84992
    s_waitcnt vmcnt(2)
    buffer_load_dwordx4 v49, s[56:59], s92 offen lds
    s_add_u32 m0, s83, 81920
    s_waitcnt vmcnt(2)
    buffer_load_dwordx4 v50, s[48:51], s82 offen lds
    s_add_u32 s92, s82, 18432
    s_add_u32 m0, s83, 86016
    s_waitcnt vmcnt(2)
    buffer_load_dwordx4 v50, s[48:51], s92 offen lds
    s_add_u32 s92, s82, 36864
    s_add_u32 m0, s83, 90112
    s_waitcnt vmcnt(2)
    buffer_load_dwordx4 v50, s[48:51], s92 offen lds
    s_add_u32 s82, s82, 128
    s_cmp_eq_u32 s82, 1152
    s_cselect_b32 s82, 0, s82
    v_mov_b32 v253, 0
    buffer_load_dword v14, v253, s[60:63], 0 offen sc1
    s_barrier
    s_add_u32 s92, s82, 4608
    s_add_u32 m0, s80, 122880
    s_waitcnt vmcnt(2)
    buffer_load_dwordx4 v48, s[56:59], s82 offen lds
    s_add_u32 m0, s80, 123904
    s_waitcnt vmcnt(2)
    buffer_load_dwordx4 v49, s[56:59], s82 offen lds
    s_add_u32 m0, s80, 124928
    s_waitcnt vmcnt(2)
    buffer_load_dwordx4 v48, s[56:59], s92 offen lds
    s_add_u32 m0, s80, 125952
    s_waitcnt vmcnt(2)
    buffer_load_dwordx4 v49, s[56:59], s92 offen lds
    s_add_u32 m0, s83, 122880
    s_waitcnt vmcnt(2)
    buffer_load_dwordx4 v50, s[48:51], s82 offen lds
    s_add_u32 s92, s82, 18432
    s_add_u32 m0, s83, 126976
    s_waitcnt vmcnt(2)
    buffer_load_dwordx4 v50, s[48:51], s92 offen lds
    s_add_u32 s92, s82, 36864
    s_add_u32 m0, s83, 131072
    s_waitcnt vmcnt(2)
    buffer_load_dwordx4 v50, s[48:51], s92 offen lds
    s_add_u32 s82, s82, 128
    s_cmp_eq_u32 s82, 1152
    s_cselect_b32 s82, 0, s82
    ds_read_b128 v[196:199], v52 offset:0
    ds_read_b128 v[212:215], v52 offset:1024
    ds_read_b128 v[228:231], v52 offset:2048
    ds_read_b128 v[200:203], v52 offset:256
    ds_read_b128 v[216:219], v52 offset:1280
    ds_read_b128 v[232:235], v52 offset:2304
    ds_read_b128 v[204:207], v52 offset:512
    ds_read_b128 v[220:223], v52 offset:1536
    ds_read_b128 v[236:239], v52 offset:2560
    ds_read_b128 v[208:211], v52 offset:768
    ds_read_b128 v[224:227], v52 offset:1792
    ds_read_b128 v[240:243], v52 offset:2816
    ds_read_b64 v[244:245], v53 offset:0
    ds_read_b64 v[246:247], v53 offset:128
    ds_read_b64 v[248:249], v53 offset:256
    s_waitcnt lgkmcnt(0)
    s_barrier
    s_add_u32 s92, s82, 4608
    s_add_u32 m0, s80, 0
    s_waitcnt vmcnt(2)
    buffer_load_dwordx4 v48, s[56:59], s82 offen lds
    s_add_u32 m0, s80, 1024
    s_waitcnt vmcnt(2)
    buffer_load_dwordx4 v49, s[56:59], s82 offen lds
    s_add_u32 m0, s80, 2048
    s_waitcnt vmcnt(2)
    buffer_load_dwordx4 v48, s[56:59], s92 offen lds
    s_add_u32 m0, s80, 3072
    s_waitcnt vmcnt(2)
    buffer_load_dwordx4 v49, s[56:59], s92 offen lds
    s_add_u32 m0, s83, 0
    s_waitcnt vmcnt(2)
    buffer_load_dwordx4 v50, s[48:51], s82 offen lds
    s_add_u32 s92, s82, 18432
    s_add_u32 m0, s83, 4096
    s_waitcnt vmcnt(2)
    buffer_load_dwordx4 v50, s[48:51], s92 offen lds
    s_add_u32 s92, s82, 36864
    s_add_u32 m0, s83, 8192
    s_waitcnt vmcnt(2)
    buffer_load_dwordx4 v50, s[48:51], s92 offen lds
    s_add_u32 s82, s82, 128
    s_cmp_eq_u32 s82, 1152
    s_cselect_b32 s82, 0, s82
    s_barrier
    s_add_u32 s92, s82, 4608
    s_add_u32 m0, s80, 40960
    s_waitcnt vmcnt(2)
    buffer_load_dwordx4 v48, s[56:59], s82 offen lds
    s_add_u32 m0, s80, 41984
    s_waitcnt vmcnt(2)
    buffer_load_dwordx4 v49, s[56:59], s82 offen lds
    s_add_u32 m0, s80, 43008
    s_waitcnt vmcnt(2)
    buffer_load_dwordx4 v48, s[56:59], s92 offen lds
    s_add_u32 m0, s80, 44032
    s_waitcnt vmcnt(2)
    buffer_load_dwordx4 v49, s[56:59], s92 offen lds
    s_add_u32 m0, s83, 40960
    s_waitcnt vmcnt(2)
    buffer_load_dwordx4 v50, s[48:51], s82 offen lds
    s_add_u32 s92, s82, 18432
    s_add_u32 m0, s83, 45056
    s_waitcnt vmcnt(2)
    buffer_load_dwordx4 v50, s[48:51], s92 offen lds
    s_add_u32 s92, s82, 36864
    s_add_u32 m0, s83, 49152
    s_waitcnt vmcnt(2)
    buffer_load_dwordx4 v50, s[48:51], s92 offen lds
    s_add_u32 s82, s82, 128
    s_cmp_eq_u32 s82, 1152
    s_cselect_b32 s82, 0, s82
    s_waitcnt vmcnt(21)
    v_readfirstlane_b32 s67, v14
    s_nop 1
    s_cmp_eq_u32 s67, 0
    s_cbranch_scc1 Ltslow_34
Ltok_35:
    s_barrier
    s_barrier
    s_waitcnt vmcnt(0)
    s_barrier
    buffer_load_dword v14, v15, s[52:55], 0 offen sc1
    s_barrier
    s_waitcnt vmcnt(0)
    v_cmp_ne_u32 vcc, s67, v14
    s_nop 4
    s_cbranch_vccnz Lslow_37
Lok_38:
    buffer_load_dwordx4 v[144:147], v19, s[52:55], s7 offen sc1
    buffer_load_dwordx4 v[148:151], v19, s[52:55], s7 offen offset:1280 sc1
    buffer_load_dword v152, v21, s[52:55], s7 offen sc1
    s_add_u32 s73, s6, s94
    s_add_u32 s73, s73, 0
    s_add_u32 m0, s94, 81920
    s_waitcnt vmcnt(2)
    buffer_load_dwordx4 v19, s[52:55], s73 offen sc1 lds
    s_add_u32 s73, s73, 4096
    s_add_u32 m0, s94, 86016
    s_waitcnt vmcnt(2)
    buffer_load_dwordx4 v19, s[52:55], s73 offen sc1 lds
    s_add_u32 s73, s73, 4096
    s_add_u32 m0, s94, 90112
    s_waitcnt vmcnt(2)
    buffer_load_dwordx4 v19, s[52:55], s73 offen sc1 lds
    s_add_u32 s73, s73, 4096
    s_add_u32 m0, s94, 94208
    s_waitcnt vmcnt(2)
    buffer_load_dwordx4 v19, s[52:55], s73 offen sc1 lds
    s_add_u32 s73, s73, 4096
    s_add_u32 m0, s94, 98304
    s_waitcnt vmcnt(2)
    buffer_load_dwordx4 v19, s[52:55], s73 offen sc1 lds
    s_add_u32 s73, s73, 4096
    s_add_u32 m0, s94, 102400
    s_waitcnt vmcnt(2)
    buffer_load_dwordx4 v19, s[52:55], s73 offen sc1 lds
    s_add_u32 s73, s73, 4096
    s_add_u32 m0, s94, 106496
    s_waitcnt vmcnt(2)
    buffer_load_dwordx4 v19, s[52:55], s73 offen sc1 lds
    s_add_u32 s73, s73, 4096
    s_add_u32 m0, s94, 110592
    s_waitcnt vmcnt(2)
    buffer_load_dwordx4 v19, s[52:55], s73 offen sc1 lds
    s_add_u32 s73, s73, 4096
    s_add_u32 m0, s94, 114688
    s_waitcnt vmcnt(2)
    buffer_load_dwordx4 v19, s[52:55], s73 offen sc1 lds
    s_add_u32 s73, s73, 4096
    s_add_u32 m0, s94, 118784
    s_waitcnt vmcnt(2)
    buffer_load_dwordx4 v19, s[52:55], s73 offen sc1 lds
    s_mov_b32 s72, 0x3eae1a93
    s_mov_b32 s73, s72
    v_lshlrev_b32 v104, 16, v144
    v_and_b32 v105, 0xffff0000, v144
    v_lshlrev_b32 v106, 16, v145
    v_and_b32 v107, 0xffff0000, v145
    v_lshlrev_b32 v108, 16, v146
    v_and_b32 v109, 0xffff0000, v146
    v_lshlrev_b32 v110, 16, v147
    v_and_b32 v111, 0xffff0000, v147
    v_lshlrev_b32 v112, 16, v148
    v_and_b32 v113, 0xffff0000, v148
    v_lshlrev_b32 v114, 16, v149
    v_and_b32 v115, 0xffff0000, v149
    v_lshlrev_b32 v116, 16, v150
    v_and_b32 v117, 0xffff0000, v150
    v_lshlrev_b32 v118, 16, v151
    v_and_b32 v119, 0xffff0000, v151
    v_lshlrev_b32 v120, 16, v152
    v_and_b32 v121, 0xffff0000, v152
    v_pk_mul_f32 v[104:105], v[104:105], s[72:73]
    v_pk_mul_f32 v[106:107], v[106:107], s[72:73]
    v_pk_mul_f32 v[108:109], v[108:109], s[72:73]
    v_pk_mul_f32 v[110:111], v[110:111], s[72:73]
    v_pk_mul_f32 v[112:113], v[112:113], s[72:73]
    v_pk_mul_f32 v[114:115], v[114:115], s[72:73]
    v_pk_mul_f32 v[116:117], v[116:117], s[72:73]
    v_pk_mul_f32 v[118:119], v[118:119], s[72:73]
    v_pk_mul_f32 v[120:121], v[120:121], s[72:73]
    v_cvt_pk_bf16_f32 v144, v104, v105
    v_cvt_pk_bf16_f32 v145, v106, v107
    v_cvt_pk_bf16_f32 v146, v108, v109
    v_cvt_pk_bf16_f32 v147, v110, v111
    v_cvt_pk_bf16_f32 v148, v112, v113
    v_cvt_pk_bf16_f32 v149, v114, v115
    v_cvt_pk_bf16_f32 v150, v116, v117
    v_cvt_pk_bf16_f32 v151, v118, v119
    v_cvt_pk_bf16_f32 v152, v120, v121
    s_waitcnt vmcnt(0)
    s_branch L_front_done
L_pc0:
    s_xor_b32 s72, s2, 255
    s_or_b32 s72, s72, s64
    s_cmp_lg_u32 s72, 0
    s_cbranch_scc1 L_notag
    s_mov_b64 exec, 1
    v_mov_b32 v4, 15446016
    buffer_load_dword v5, v4, s[52:55], 0 offen sc1
    s_mov_b32 s72, 0x9E3779B1
    s_waitcnt vmcnt(0)
    v_mul_lo_u32 v5, v5, s72
    v_add_u32 v5, 0x7F4A7C15, v5
    v_mov_b32 v6, 0x5bd1e995
    v_cmp_eq_u32 vcc, 0, v5
    s_nop 1
    v_cndmask_b32 v5, v5, v6, vcc
    v_mov_b32 v6, 0
    buffer_store_dword v5, v6, s[60:63], 0 offen sc1
    buffer_store_dword v5, v4, s[52:55], 0 offen sc1
    s_mov_b64 exec, -1
L_notag:
    s_sub_u32 s74, s66, 24
    s_lshl_b32 s74, s74, 2
    s_add_u32 s74, s74, s64
    v_lshlrev_b32 v4, 7, v1
    s_getpc_b64 s[76:77]
L_pc:
    s_add_u32 s76, s76, concat_heads__mha_block__ssm_conv_s5__prompt_kernel-L_pc
    s_addc_u32 s77, s77, -1
    s_mov_b32 s78, L_code_end-concat_heads__mha_block__ssm_conv_s5__prompt_kernel
    s_mov_b32 s79, 0x20000
    s_lshl_b32 s72, s74, 13
    buffer_load_dword v253, v4, s[76:79], s72 offen
    v_lshrrev_b32 v4, 1, v2
    v_xor_b32 v4, v4, v3
    v_lshlrev_b32 v4, 4, v4
    v_lshl_add_u32 v4, v2, 7, v4
    s_and_b32 s72, s64, 1
    s_lshl_b32 s72, s72, 13
    v_add_u32 v196, s72, v4
    v_xor_b32 v197, 64, v196
    v_add_u32 v198, 81920, v196
    v_add_u32 v199, 81920, v197
    s_mul_i32 s72, s3, 6144
    s_add_u32 s72, s72, 16384
    v_add_u32 v210, s72, v4
    v_xor_b32 v211, 64, v210
    v_add_u32 v212, 81920, v210
    v_add_u32 v213, 81920, v211
    s_mul_i32 s72, s70, 20480
    s_add_u32 s72, s72, 81920
    v_lshlrev_b32 v19, 4, v1
    v_add_u32 v16, s72, v19
    v_and_b32 v4, 31, v1
    v_and_b32 v7, 7, v1
    v_bfe_u32 v5, v1, 3, 1
    v_lshl_add_u32 v7, v5, 4, v7
    v_bfe_u32 v5, v1, 4, 1
    v_lshl_add_u32 v7, v5, 3, v7
    v_lshlrev_b32 v7, 3, v7
    v_add_u32 v7, 1024, v7
    v_add_u32 v17, s72, v7
    v_lshrrev_b32 v5, 5, v1
    v_mul_u32_u24 v6, 1280, v5
    v_add_u32 v21, v7, v6
    v_min_u32 v4, 19, v4
    v_lshlrev_b32 v4, 4, v4
    v_cmp_gt_u32 vcc, 0x100, v4
    v_lshl_add_u32 v6, v5, 8, v4
    v_lshl_add_u32 v4, v5, 6, v4
    v_add_u32 v4, 768, v4
    v_cndmask_b32 v4, v4, v6, vcc
    s_add_u32 s72, s72, 1280
    v_add_u32 v18, s72, v4
    v_mov_b32 v4, 128
    v_mov_b32 v5, 512
    v_cndmask_b32 v4, v4, v5, vcc
    v_add_u32 v20, v18, v4
    s_and_b32 s72, s65, 3
    s_lshl_b32 s72, s72, 2
    s_and_b32 s73, s66, 3
    s_add_u32 s74, s72, s73
    s_lshr_b32 s72, s65, 2
    s_lshl_b32 s72, s72, 2
    s_bfe_u32 s73, s66, 0x20002
    s_add_u32 s75, s72, s73
    s_lshl_b32 s72, s5, 1
    s_lshr_b32 s73, s69, 1
    s_add_u32 s72, s72, s73
    s_and_b32 s73, s72, 3
    s_lshl_b32 s73, s73, 3
    s_lshr_b32 s72, s72, 2
    s_add_u32 s72, s72, s73
    s_lshl_b32 s79, s72, 1
    s_and_b32 s73, s69, 1
    s_add_u32 s79, s79, s73
    s_lshl_b32 s79, s79, 5
    s_add_u32 s79, s79, s4
    s_lshl_b32 s79, s79, 1
    s_add_u32 s79, s79, s70
    s_lshl_b32 s79, s79, 2
    s_add_u32 s79, s79, 15380480
    v_mov_b32 v22, 0
    v_mov_b32 v23, 0
    v_mov_b32 v24, 0
    v_mov_b32 v25, 0
    v_mov_b32 v26, 0
    v_mov_b32 v27, 0
    v_mov_b32 v28, 0
    v_mov_b32 v29, 0
    v_mov_b32 v30, 0
    v_mov_b32 v31, 0
    s_cmp_ge_u32 s66, 16
    s_cbranch_scc1 Lta_40
    v_and_b32 v4, 7, v1
    v_lshrrev_b32 v6, 3, v1
    s_lshl_b32 s72, s69, 4
    v_add_u32 v7, s72, v6
    s_mul_i32 s72, s69, 36864
    v_lshl_add_u32 v22, v1, 4, s72
    v_xor_b32 v4, v4, v3
    s_mul_i32 s73, s75, 72
    v_add_u32 v23, s73, v7
    v_mul_u32_u24 v23, 1152, v23
    v_lshl_add_u32 v23, v4, 4, v23
    s_add_u32 s73, s73, 64
    v_add_u32 v24, s73, v6
    v_mul_u32_u24 v24, 1152, v24
    v_lshl_add_u32 v24, v4, 4, v24
    s_branch Lta_41
Lta_40:
    s_cmp_lt_u32 s64, 4
    s_cbranch_scc1 Lta_41
    v_lshrrev_b32 v4, 5, v1
    v_and_b32 v5, 31, v1
    v_lshlrev_b32 v5, 4, v5
    s_lshl_b32 s72, s69, 16
    s_lshl_b32 s73, s74, 12
    s_add_u32 s73, s72, s73
    v_lshl_add_u32 v6, v4, 10, v5
    v_add_u32 v25, s73, v6
    s_lshl_b32 s73, s74, 9
    s_add_u32 s72, s72, s73
    s_add_u32 s72, s72, 14692352
    v_lshl_add_u32 v4, v4, 13, v5
    v_add_u32 v26, s72, v4
    s_lshl_b32 s72, s69, 7
    s_add_u32 s72, s72, 0
    v_add_u32 v4, s72, v1
    v_mul_u32_u24 v5, 7282, v4
    v_lshrrev_b32 v5, 16, v5
    v_mul_u32_u24 v6, 9, v5
    v_sub_u32 v4, v4, v6
    s_mul_i32 s73, s75, 144
    v_lshl_add_u32 v4, v4, 4, s73
    v_and_b32 v6, 1, v5
    v_bfe_u32 v7, v5, 1, 2
    v_lshl_add_u32 v7, v6, 3, v7
    v_bfe_u32 v8, v5, 3, 1
    v_lshl_add_u32 v7, v8, 2, v7
    v_lshrrev_b32 v8, 4, v5
    v_mul_u32_u24 v8, 18, v8
    v_add_u32 v7, v7, v8
    v_mul_u32_u24 v7, 1152, v7
    v_add_u32 v27, v7, v4
    v_lshrrev_b32 v7, 3, v5
    v_lshlrev_b32 v7, 2, v7
    v_lshl_add_u32 v7, v6, 1, v7
    v_bfe_u32 v6, v5, 2, 1
    v_add_u32 v7, v7, v6
    v_mul_u32_u24 v7, 18, v7
    v_bfe_u32 v6, v5, 1, 1
    v_add3_u32 v7, v7, v6, 16
    v_mul_u32_u24 v7, 1152, v7
    v_add_u32 v30, v7, v4
    s_lshl_b32 s72, s69, 7
    s_add_u32 s72, s72, 64
    v_add_u32 v4, s72, v1
    v_mul_u32_u24 v5, 7282, v4
    v_lshrrev_b32 v5, 16, v5
    v_mul_u32_u24 v6, 9, v5
    v_sub_u32 v4, v4, v6
    s_mul_i32 s73, s75, 144
    v_lshl_add_u32 v4, v4, 4, s73
    v_and_b32 v6, 1, v5
    v_bfe_u32 v7, v5, 1, 2
    v_lshl_add_u32 v7, v6, 3, v7
    v_bfe_u32 v8, v5, 3, 1
    v_lshl_add_u32 v7, v8, 2, v7
    v_lshrrev_b32 v8, 4, v5
    v_mul_u32_u24 v8, 18, v8
    v_add_u32 v7, v7, v8
    v_mul_u32_u24 v7, 1152, v7
    v_add_u32 v28, v7, v4
    v_lshrrev_b32 v7, 3, v5
    v_lshlrev_b32 v7, 2, v7
    v_lshl_add_u32 v7, v6, 1, v7
    v_bfe_u32 v6, v5, 2, 1
    v_add_u32 v7, v7, v6
    v_mul_u32_u24 v7, 18, v7
    v_bfe_u32 v6, v5, 1, 1
    v_add3_u32 v7, v7, v6, 16
    v_mul_u32_u24 v7, 1152, v7
    v_add_u32 v31, v7, v4
    v_add_u32 v4, 512, v1
    v_mul_u32_u24 v5, 7282, v4
    v_lshrrev_b32 v5, 16, v5
    v_mul_u32_u24 v6, 9, v5
    v_sub_u32 v4, v4, v6
    s_mul_i32 s73, s75, 144
    v_lshl_add_u32 v4, v4, 4, s73
    v_and_b32 v6, 1, v5
    v_bfe_u32 v7, v5, 1, 2
    v_lshl_add_u32 v7, v6, 3, v7
    v_bfe_u32 v8, v5, 3, 1
    v_lshl_add_u32 v7, v8, 2, v7
    v_lshrrev_b32 v8, 4, v5
    v_mul_u32_u24 v8, 18, v8
    v_add_u32 v7, v7, v8
    v_mul_u32_u24 v7, 1152, v7
    v_add_u32 v29, v7, v4
    v_lshrrev_b32 v7, 3, v5
    v_lshlrev_b32 v7, 2, v7
    v_lshl_add_u32 v7, v6, 1, v7
    v_bfe_u32 v6, v5, 2, 1
    v_add_u32 v7, v7, v6
    v_mul_u32_u24 v7, 18, v7
    v_bfe_u32 v6, v5, 1, 1
    v_add3_u32 v7, v7, v6, 16
    v_mul_u32_u24 v7, 1152, v7
    v_add_u32 v0, v7, v4
Lta_41:
    v_bfe_u32 v4, v1, 2, 2
    v_lshl_add_u32 v5, v3, 3, v4
    v_lshlrev_b32 v5, 4, v5
    v_bfe_u32 v6, v1, 1, 1
    v_mul_u32_u24 v6, 1088, v6
    v_and_b32 v7, 1, v1
    v_lshl_add_u32 v6, v7, 3, v6
    s_lshl_b32 s72, s69, 12
    v_add3_u32 v254, v5, v6, s72
    v_lshlrev_b32 v4, 1, v4
    v_lshl_add_u32 v4, v3, 3, v4
    v_mul_u32_u24 v4, 144, v4
    v_and_b32 v5, 3, v1
    v_lshl_add_u32 v251, v5, 3, v4
    s_lshl_b32 s72, s69, 7
    v_lshlrev_b32 v4, 11, v3
    v_lshl_add_u32 v4, v2, 2, v4
    v_add_u32 v252, s72, v4
    v_lshrrev_b32 v250, 1, v2
    v_xor_b32 v250, v250, v3
    v_lshlrev_b32 v250, 4, v250
    v_lshl_add_u32 v250, v2, 7, v250
    s_cmp_lg_u32 s64, 1
    s_cbranch_scc1 L_tf1
    s_lshl_b32 s72, s2, 9
    v_and_b32 v4, 3, v1
    v_lshlrev_b32 v4, 7, v4
    v_add_u32 v5, s72, v4
    v_add_u32 v4, 15183872, v5
    buffer_load_dword v253, v4, s[52:55], 0 offen sc1
    v_add_u32 v4, 15314944, v5
    buffer_load_dword v249, v4, s[52:55], 0 offen sc1
    s_lshl_b32 s72, s2, 8
    s_add_u32 s72, s72, 15085568
    v_and_b32 v4, 1, v1
    v_lshlrev_b32 v4, 7, v4
    buffer_load_dword v248, v4, s[52:55], s72 offen sc1
    s_lshl_b32 s72, s2, 7
    s_add_u32 s72, s72, 15151104
    v_mov_b32 v4, 0
    buffer_load_dword v247, v4, s[52:55], s72 offen sc1
L_tf1:
    s_mul_i32 s72, s3, 3072
    s_add_u32 s72, s72, 75776
    v_lshl_add_u32 v32, v2, 4, s72
    s_lshl_b32 s72, s3, 2
    s_add_u32 s72, s72, s71
    s_mul_i32 s72, s72, 1536
    s_add_u32 s72, s72, 151552
    v_mul_u32_u24 v33, 384, v3
    v_lshl_add_u32 v33, v2, 3, v33
    v_add_u32 v33, s72, v33
    s_mul_i32 s72, s3, 3840
    v_mul_u32_u24 v35, 80, v2
    v_add_u32 v35, s72, v35
    s_lshl_b32 s73, s71, 4
    v_lshl_add_u32 v36, v3, 2, v35
    v_add_u32 v36, s73, v36
    s_mul_i32 s72, s69, 6144
    v_add_u32 v34, s72, v19
    s_mov_b32 s44, s20
    s_mov_b32 s45, s21
    s_mov_b32 s46, 663552
    s_mov_b32 s47, 0x20000
    s_mov_b32 s48, s22
    s_mov_b32 s49, s23
    s_mov_b32 s50, 663552
    s_mov_b32 s51, 0x20000
    s_lshr_b32 s72, s65, 2
    s_mul_i32 s72, s72, 221184
    s_sub_u32 s73, s66, 24
    s_lshl_b32 s73, s73, 2
    s_add_u32 s73, s73, s64
    s_min_u32 s73, s73, 26
    s_lshl_b32 s73, s73, 13
    s_add_u32 s72, s72, s73
    v_lshlrev_b32 v4, 7, v1
    buffer_load_dword v5, v4, s[44:47], s72 offen
    buffer_load_dword v6, v4, s[48:51], s72 offen
    s_waitcnt lgkmcnt(0)
    s_barrier
    ds_read_b128 v[216:219], v196 offset:40960
    ds_read_b128 v[232:235], v210 offset:40960
    ds_read_b128 v[220:223], v196 offset:43008
    ds_read_b128 v[224:227], v196 offset:45056
    ds_read_b128 v[228:231], v196 offset:47104
    ds_read_b128 v[236:239], v210 offset:43008
    ds_read_b128 v[240:243], v210 offset:45056
    s_waitcnt lgkmcnt(5)
    v_mfma_f32_16x16x32_bf16 v[168:171], v[216:219], v[232:235], 0
    ds_read_b128 v[88:91], v197 offset:40960
    s_waitcnt lgkmcnt(5)
    v_mfma_f32_16x16x32_bf16 v[172:175], v[220:223], v[232:235], 0
    ds_read_b128 v[104:107], v211 offset:40960
    s_waitcnt lgkmcnt(5)
    v_mfma_f32_16x16x32_bf16 v[64:67], v[224:227], v[232:235], 0
    s_waitcnt lgkmcnt(4)
    v_mfma_f32_16x16x32_bf16 v[68:71], v[228:231], v[232:235], 0
    ds_read_b128 v[92:95], v197 offset:43008
    s_waitcnt lgkmcnt(4)
    v_mfma_f32_16x16x32_bf16 v[176:179], v[216:219], v[236:239], 0
    v_mfma_f32_16x16x32_bf16 v[180:183], v[220:223], v[236:239], 0
    ds_read_b128 v[96:99], v197 offset:45056
    v_mfma_f32_16x16x32_bf16 v[72:75], v[224:227], v[236:239], 0
    ds_read_b128 v[100:103], v197 offset:47104
    v_mfma_f32_16x16x32_bf16 v[76:79], v[228:231], v[236:239], 0
    s_waitcnt lgkmcnt(5)
    v_mfma_f32_16x16x32_bf16 v[184:187], v[216:219], v[240:243], 0
    ds_read_b128 v[108:111], v211 offset:43008
    v_mfma_f32_16x16x32_bf16 v[188:191], v[220:223], v[240:243], 0
    v_mfma_f32_16x16x32_bf16 v[80:83], v[224:227], v[240:243], 0
    ds_read_b128 v[112:115], v211 offset:45056
    v_mfma_f32_16x16x32_bf16 v[84:87], v[228:231], v[240:243], 0
    s_waitcnt lgkmcnt(0)
    s_barrier
    v_mov_b32 v15, 0
    buffer_load_dword v14, v15, s[60:63], 0 offen sc1
    v_mfma_f32_16x16x32_bf16 v[168:171], v[88:91], v[104:107], v[168:171]
    ds_read_b128 v[216:219], v198 offset:0
    v_mfma_f32_16x16x32_bf16 v[172:175], v[92:95], v[104:107], v[172:175]
    ds_read_b128 v[232:235], v212 offset:0
    v_mfma_f32_16x16x32_bf16 v[64:67], v[96:99], v[104:107], v[64:67]
    v_mfma_f32_16x16x32_bf16 v[68:71], v[100:103], v[104:107], v[68:71]
    ds_read_b128 v[220:223], v198 offset:2048
    v_mfma_f32_16x16x32_bf16 v[176:179], v[88:91], v[108:111], v[176:179]
    v_mfma_f32_16x16x32_bf16 v[180:183], v[92:95], v[108:111], v[180:183]
    ds_read_b128 v[224:227], v198 offset:4096
    v_mfma_f32_16x16x32_bf16 v[72:75], v[96:99], v[108:111], v[72:75]
    ds_read_b128 v[228:231], v198 offset:6144
    v_mfma_f32_16x16x32_bf16 v[76:79], v[100:103], v[108:111], v[76:79]
    v_mfma_f32_16x16x32_bf16 v[184:187], v[88:91], v[112:115], v[184:187]
    ds_read_b128 v[236:239], v212 offset:2048
    v_mfma_f32_16x16x32_bf16 v[188:191], v[92:95], v[112:115], v[188:191]
    v_mfma_f32_16x16x32_bf16 v[80:83], v[96:99], v[112:115], v[80:83]
    ds_read_b128 v[240:243], v212 offset:4096
    v_mfma_f32_16x16x32_bf16 v[84:87], v[100:103], v[112:115], v[84:87]
    s_waitcnt lgkmcnt(5)
    v_mfma_f32_16x16x32_bf16 v[168:171], v[216:219], v[232:235], v[168:171]
    ds_read_b128 v[88:91], v199 offset:0
    s_waitcnt lgkmcnt(5)
    v_mfma_f32_16x16x32_bf16 v[172:175], v[220:223], v[232:235], v[172:175]
    ds_read_b128 v[104:107], v213 offset:0
    s_waitcnt lgkmcnt(5)
    v_mfma_f32_16x16x32_bf16 v[64:67], v[224:227], v[232:235], v[64:67]
    s_waitcnt lgkmcnt(4)
    v_mfma_f32_16x16x32_bf16 v[68:71], v[228:231], v[232:235], v[68:71]
    ds_read_b128 v[92:95], v199 offset:2048
    s_waitcnt lgkmcnt(4)
    v_mfma_f32_16x16x32_bf16 v[176:179], v[216:219], v[236:239], v[176:179]
    v_mfma_f32_16x16x32_bf16 v[180:183], v[220:223], v[236:239], v[180:183]
    ds_read_b128 v[96:99], v199 offset:4096
    v_mfma_f32_16x16x32_bf16 v[72:75], v[224:227], v[236:239], v[72:75]
    ds_read_b128 v[100:103], v199 offset:6144
    v_mfma_f32_16x16x32_bf16 v[76:79], v[228:231], v[236:239], v[76:79]
    s_waitcnt lgkmcnt(5)
    v_mfma_f32_16x16x32_bf16 v[184:187], v[216:219], v[240:243], v[184:187]
    ds_read_b128 v[108:111], v213 offset:2048
    v_mfma_f32_16x16x32_bf16 v[188:191], v[220:223], v[240:243], v[188:191]
    v_mfma_f32_16x16x32_bf16 v[80:83], v[224:227], v[240:243], v[80:83]
    ds_read_b128 v[112:115], v213 offset:4096
    v_mfma_f32_16x16x32_bf16 v[84:87], v[228:231], v[240:243], v[84:87]
    s_waitcnt lgkmcnt(0)
    s_barrier
    v_mfma_f32_16x16x32_bf16 v[168:171], v[88:91], v[104:107], v[168:171]
    ds_read_b128 v[216:219], v198 offset:40960
    v_mfma_f32_16x16x32_bf16 v[172:175], v[92:95], v[104:107], v[172:175]
    ds_read_b128 v[232:235], v212 offset:40960
    v_mfma_f32_16x16x32_bf16 v[64:67], v[96:99], v[104:107], v[64:67]
    v_mfma_f32_16x16x32_bf16 v[68:71], v[100:103], v[104:107], v[68:71]
    ds_read_b128 v[220:223], v198 offset:43008
    v_mfma_f32_16x16x32_bf16 v[176:179], v[88:91], v[108:111], v[176:179]
    v_mfma_f32_16x16x32_bf16 v[180:183], v[92:95], v[108:111], v[180:183]
    ds_read_b128 v[224:227], v198 offset:45056
    v_mfma_f32_16x16x32_bf16 v[72:75], v[96:99], v[108:111], v[72:75]
    ds_read_b128 v[228:231], v198 offset:47104
    v_mfma_f32_16x16x32_bf16 v[76:79], v[100:103], v[108:111], v[76:79]
    v_mfma_f32_16x16x32_bf16 v[184:187], v[88:91], v[112:115], v[184:187]
    ds_read_b128 v[236:239], v212 offset:43008
    v_mfma_f32_16x16x32_bf16 v[188:191], v[92:95], v[112:115], v[188:191]
    v_mfma_f32_16x16x32_bf16 v[80:83], v[96:99], v[112:115], v[80:83]
    ds_read_b128 v[240:243], v212 offset:45056
    v_mfma_f32_16x16x32_bf16 v[84:87], v[100:103], v[112:115], v[84:87]
    s_waitcnt lgkmcnt(5)
    v_mfma_f32_16x16x32_bf16 v[168:171], v[216:219], v[232:235], v[168:171]
    ds_read_b128 v[88:91], v199 offset:40960
    s_waitcnt lgkmcnt(5)
    v_mfma_f32_16x16x32_bf16 v[172:175], v[220:223], v[232:235], v[172:175]
    ds_read_b128 v[104:107], v213 offset:40960
    s_waitcnt lgkmcnt(5)
    v_mfma_f32_16x16x32_bf16 v[64:67], v[224:227], v[232:235], v[64:67]
    s_waitcnt lgkmcnt(4)
    v_mfma_f32_16x16x32_bf16 v[68:71], v[228:231], v[232:235], v[68:71]
    ds_read_b128 v[92:95], v199 offset:43008
    s_waitcnt lgkmcnt(4)
    v_mfma_f32_16x16x32_bf16 v[176:179], v[216:219], v[236:239], v[176:179]
    v_mfma_f32_16x16x32_bf16 v[180:183], v[220:223], v[236:239], v[180:183]
    ds_read_b128 v[96:99], v199 offset:45056
    v_mfma_f32_16x16x32_bf16 v[72:75], v[224:227], v[236:239], v[72:75]
    ds_read_b128 v[100:103], v199 offset:47104
    v_mfma_f32_16x16x32_bf16 v[76:79], v[228:231], v[236:239], v[76:79]
    s_waitcnt lgkmcnt(5)
    v_mfma_f32_16x16x32_bf16 v[184:187], v[216:219], v[240:243], v[184:187]
    ds_read_b128 v[108:111], v213 offset:43008
    v_mfma_f32_16x16x32_bf16 v[188:191], v[220:223], v[240:243], v[188:191]
    v_mfma_f32_16x16x32_bf16 v[80:83], v[224:227], v[240:243], v[80:83]
    ds_read_b128 v[112:115], v213 offset:45056
    v_mfma_f32_16x16x32_bf16 v[84:87], v[228:231], v[240:243], v[84:87]
    s_waitcnt lgkmcnt(0)
    s_barrier
    s_waitcnt vmcnt(0)
    v_readfirstlane_b32 s67, v14
    s_nop 1
    s_cmp_eq_u32 s67, 0
    s_cbranch_scc1 Ltslow_42
Ltok_43:
    s_lshl_b32 s72, s2, 8
    s_add_u32 s72, s72, 15085568
    v_min_u32 v15, 33, v1
    v_lshl_add_u32 v15, v15, 2, s72
    v_mfma_f32_16x16x32_bf16 v[168:171], v[88:91], v[104:107], v[168:171]
    ds_read_b128 v[216:219], v196 offset:0
    v_mfma_f32_16x16x32_bf16 v[172:175], v[92:95], v[104:107], v[172:175]
    ds_read_b128 v[232:235], v210 offset:0
    v_mfma_f32_16x16x32_bf16 v[64:67], v[96:99], v[104:107], v[64:67]
    v_mfma_f32_16x16x32_bf16 v[68:71], v[100:103], v[104:107], v[68:71]
    ds_read_b128 v[220:223], v196 offset:2048
    v_mfma_f32_16x16x32_bf16 v[176:179], v[88:91], v[108:111], v[176:179]
    v_mfma_f32_16x16x32_bf16 v[180:183], v[92:95], v[108:111], v[180:183]
    ds_read_b128 v[224:227], v196 offset:4096
    v_mfma_f32_16x16x32_bf16 v[72:75], v[96:99], v[108:111], v[72:75]
    ds_read_b128 v[228:231], v196 offset:6144
    v_mfma_f32_16x16x32_bf16 v[76:79], v[100:103], v[108:111], v[76:79]
    v_mfma_f32_16x16x32_bf16 v[184:187], v[88:91], v[112:115], v[184:187]
    ds_read_b128 v[236:239], v210 offset:2048
    v_mfma_f32_16x16x32_bf16 v[188:191], v[92:95], v[112:115], v[188:191]
    v_mfma_f32_16x16x32_bf16 v[80:83], v[96:99], v[112:115], v[80:83]
    ds_read_b128 v[240:243], v210 offset:4096
    v_mfma_f32_16x16x32_bf16 v[84:87], v[100:103], v[112:115], v[84:87]
    s_waitcnt lgkmcnt(5)
    v_mfma_f32_16x16x32_bf16 v[168:171], v[216:219], v[232:235], v[168:171]
    ds_read_b128 v[88:91], v197 offset:0
    s_waitcnt lgkmcnt(5)
    v_mfma_f32_16x16x32_bf16 v[172:175], v[220:223], v[232:235], v[172:175]
    ds_read_b128 v[104:107], v211 offset:0
    s_waitcnt lgkmcnt(5)
    v_mfma_f32_16x16x32_bf16 v[64:67], v[224:227], v[232:235], v[64:67]
    s_waitcnt lgkmcnt(4)
    v_mfma_f32_16x16x32_bf16 v[68:71], v[228:231], v[232:235], v[68:71]
    ds_read_b128 v[92:95], v197 offset:2048
    s_waitcnt lgkmcnt(4)
    v_mfma_f32_16x16x32_bf16 v[176:179], v[216:219], v[236:239], v[176:179]
    v_mfma_f32_16x16x32_bf16 v[180:183], v[220:223], v[236:239], v[180:183]
    ds_read_b128 v[96:99], v197 offset:4096
    v_mfma_f32_16x16x32_bf16 v[72:75], v[224:227], v[236:239], v[72:75]
    ds_read_b128 v[100:103], v197 offset:6144
    v_mfma_f32_16x16x32_bf16 v[76:79], v[228:231], v[236:239], v[76:79]
    s_waitcnt lgkmcnt(5)
    v_mfma_f32_16x16x32_bf16 v[184:187], v[216:219], v[240:243], v[184:187]
    ds_read_b128 v[108:111], v211 offset:2048
    v_mfma_f32_16x16x32_bf16 v[188:191], v[220:223], v[240:243], v[188:191]
    v_mfma_f32_16x16x32_bf16 v[80:83], v[224:227], v[240:243], v[80:83]
    ds_read_b128 v[112:115], v211 offset:4096
    v_mfma_f32_16x16x32_bf16 v[84:87], v[228:231], v[240:243], v[84:87]
    s_waitcnt lgkmcnt(0)
    s_barrier
    v_mfma_f32_16x16x32_bf16 v[168:171], v[88:91], v[104:107], v[168:171]
    ds_read_b128 v[216:219], v196 offset:40960
    v_mfma_f32_16x16x32_bf16 v[172:175], v[92:95], v[104:107], v[172:175]
    ds_read_b128 v[232:235], v210 offset:40960
    v_mfma_f32_16x16x32_bf16 v[64:67], v[96:99], v[104:107], v[64:67]
    v_mfma_f32_16x16x32_bf16 v[68:71], v[100:103], v[104:107], v[68:71]
    ds_read_b128 v[220:223], v196 offset:43008
    v_mfma_f32_16x16x32_bf16 v[176:179], v[88:91], v[108:111], v[176:179]
    v_mfma_f32_16x16x32_bf16 v[180:183], v[92:95], v[108:111], v[180:183]
    ds_read_b128 v[224:227], v196 offset:45056
    v_mfma_f32_16x16x32_bf16 v[72:75], v[96:99], v[108:111], v[72:75]
    ds_read_b128 v[228:231], v196 offset:47104
    v_mfma_f32_16x16x32_bf16 v[76:79], v[100:103], v[108:111], v[76:79]
    v_mfma_f32_16x16x32_bf16 v[184:187], v[88:91], v[112:115], v[184:187]
    ds_read_b128 v[236:239], v210 offset:43008
    v_mfma_f32_16x16x32_bf16 v[188:191], v[92:95], v[112:115], v[188:191]
    v_mfma_f32_16x16x32_bf16 v[80:83], v[96:99], v[112:115], v[80:83]
    ds_read_b128 v[240:243], v210 offset:45056
    v_mfma_f32_16x16x32_bf16 v[84:87], v[100:103], v[112:115], v[84:87]
    s_waitcnt lgkmcnt(5)
    v_mfma_f32_16x16x32_bf16 v[168:171], v[216:219], v[232:235], v[168:171]
    ds_read_b128 v[88:91], v197 offset:40960
    s_waitcnt lgkmcnt(5)
    v_mfma_f32_16x16x32_bf16 v[172:175], v[220:223], v[232:235], v[172:175]
    ds_read_b128 v[104:107], v211 offset:40960
    s_waitcnt lgkmcnt(5)
    v_mfma_f32_16x16x32_bf16 v[64:67], v[224:227], v[232:235], v[64:67]
    s_waitcnt lgkmcnt(4)
    v_mfma_f32_16x16x32_bf16 v[68:71], v[228:231], v[232:235], v[68:71]
    ds_read_b128 v[92:95], v197 offset:43008
    s_waitcnt lgkmcnt(4)
    v_mfma_f32_16x16x32_bf16 v[176:179], v[216:219], v[236:239], v[176:179]
    v_mfma_f32_16x16x32_bf16 v[180:183], v[220:223], v[236:239], v[180:183]
    ds_read_b128 v[96:99], v197 offset:45056
    v_mfma_f32_16x16x32_bf16 v[72:75], v[224:227], v[236:239], v[72:75]
    ds_read_b128 v[100:103], v197 offset:47104
    v_mfma_f32_16x16x32_bf16 v[76:79], v[228:231], v[236:239], v[76:79]
    s_waitcnt lgkmcnt(5)
    v_mfma_f32_16x16x32_bf16 v[184:187], v[216:219], v[240:243], v[184:187]
    ds_read_b128 v[108:111], v211 offset:43008
    v_mfma_f32_16x16x32_bf16 v[188:191], v[220:223], v[240:243], v[188:191]
    v_mfma_f32_16x16x32_bf16 v[80:83], v[224:227], v[240:243], v[80:83]
    ds_read_b128 v[112:115], v211 offset:45056
    v_mfma_f32_16x16x32_bf16 v[84:87], v[228:231], v[240:243], v[84:87]
    s_waitcnt lgkmcnt(0)
    s_barrier
    ds_read_b64 v[244:245], v33 offset:0
    ds_read_b64 v[246:247], v33 offset:128
    ds_read_b64 v[248:249], v33 offset:256
    v_mov_b32 v40, 0
    v_mov_b32 v41, 0
    v_mov_b32 v42, 0
    v_mov_b32 v43, 0
    v_mfma_f32_16x16x32_bf16 v[168:171], v[88:91], v[104:107], v[168:171]
    ds_read_b128 v[216:219], v198 offset:0
    v_mfma_f32_16x16x32_bf16 v[172:175], v[92:95], v[104:107], v[172:175]
    ds_read_b128 v[232:235], v212 offset:0
    v_mfma_f32_16x16x32_bf16 v[64:67], v[96:99], v[104:107], v[64:67]
    v_mfma_f32_16x16x32_bf16 v[68:71], v[100:103], v[104:107], v[68:71]
    ds_read_b128 v[220:223], v198 offset:2048
    v_mfma_f32_16x16x32_bf16 v[176:179], v[88:91], v[108:111], v[176:179]
    v_mfma_f32_16x16x32_bf16 v[180:183], v[92:95], v[108:111], v[180:183]
    ds_read_b128 v[224:227], v198 offset:4096
    v_mfma_f32_16x16x32_bf16 v[72:75], v[96:99], v[108:111], v[72:75]
    ds_read_b128 v[228:231], v198 offset:6144
    v_mfma_f32_16x16x32_bf16 v[76:79], v[100:103], v[108:111], v[76:79]
    v_mfma_f32_16x16x32_bf16 v[184:187], v[88:91], v[112:115], v[184:187]
    ds_read_b128 v[236:239], v212 offset:2048
    v_mfma_f32_16x16x32_bf16 v[188:191], v[92:95], v[112:115], v[188:191]
    v_mfma_f32_16x16x32_bf16 v[80:83], v[96:99], v[112:115], v[80:83]
    ds_read_b128 v[240:243], v212 offset:4096
    v_mfma_f32_16x16x32_bf16 v[84:87], v[100:103], v[112:115], v[84:87]
    s_waitcnt lgkmcnt(5)
    v_mfma_f32_16x16x32_bf16 v[168:171], v[216:219], v[232:235], v[168:171]
    ds_read_b128 v[88:91], v199 offset:0
    s_waitcnt lgkmcnt(5)
    v_mfma_f32_16x16x32_bf16 v[172:175], v[220:223], v[232:235], v[172:175]
    ds_read_b128 v[104:107], v213 offset:0
    s_waitcnt lgkmcnt(5)
    v_mfma_f32_16x16x32_bf16 v[64:67], v[224:227], v[232:235], v[64:67]
    s_waitcnt lgkmcnt(4)
    v_mfma_f32_16x16x32_bf16 v[68:71], v[228:231], v[232:235], v[68:71]
    ds_read_b128 v[92:95], v199 offset:2048
    s_waitcnt lgkmcnt(4)
    v_mfma_f32_16x16x32_bf16 v[176:179], v[216:219], v[236:239], v[176:179]
    v_mfma_f32_16x16x32_bf16 v[180:183], v[220:223], v[236:239], v[180:183]
    ds_read_b128 v[96:99], v199 offset:4096
    v_mfma_f32_16x16x32_bf16 v[72:75], v[224:227], v[236:239], v[72:75]
    ds_read_b128 v[100:103], v199 offset:6144
    v_mfma_f32_16x16x32_bf16 v[76:79], v[228:231], v[236:239], v[76:79]
    s_waitcnt lgkmcnt(5)
    v_mfma_f32_16x16x32_bf16 v[184:187], v[216:219], v[240:243], v[184:187]
    ds_read_b128 v[108:111], v213 offset:2048
    v_mfma_f32_16x16x32_bf16 v[188:191], v[220:223], v[240:243], v[188:191]
    v_mfma_f32_16x16x32_bf16 v[80:83], v[224:227], v[240:243], v[80:83]
    ds_read_b128 v[112:115], v213 offset:4096
    v_mfma_f32_16x16x32_bf16 v[84:87], v[228:231], v[240:243], v[84:87]
    s_waitcnt lgkmcnt(0)
    s_barrier
    v_mfma_f32_16x16x32_bf16 v[168:171], v[88:91], v[104:107], v[168:171]
    ds_read_b128 v[216:219], v198 offset:40960
    v_mfma_f32_16x16x32_bf16 v[172:175], v[92:95], v[104:107], v[172:175]
    ds_read_b128 v[232:235], v212 offset:40960
    v_mfma_f32_16x16x32_bf16 v[64:67], v[96:99], v[104:107], v[64:67]
    v_mfma_f32_16x16x32_bf16 v[68:71], v[100:103], v[104:107], v[68:71]
    ds_read_b128 v[220:223], v198 offset:43008
    v_mfma_f32_16x16x32_bf16 v[176:179], v[88:91], v[108:111], v[176:179]
    v_mfma_f32_16x16x32_bf16 v[180:183], v[92:95], v[108:111], v[180:183]
    ds_read_b128 v[224:227], v198 offset:45056
    v_mfma_f32_16x16x32_bf16 v[72:75], v[96:99], v[108:111], v[72:75]
    ds_read_b128 v[228:231], v198 offset:47104
    v_mfma_f32_16x16x32_bf16 v[76:79], v[100:103], v[108:111], v[76:79]
    v_mfma_f32_16x16x32_bf16 v[184:187], v[88:91], v[112:115], v[184:187]
    ds_read_b128 v[236:239], v212 offset:43008
    v_mfma_f32_16x16x32_bf16 v[188:191], v[92:95], v[112:115], v[188:191]
    v_mfma_f32_16x16x32_bf16 v[80:83], v[96:99], v[112:115], v[80:83]
    ds_read_b128 v[240:243], v212 offset:45056
    v_mfma_f32_16x16x32_bf16 v[84:87], v[100:103], v[112:115], v[84:87]
    s_waitcnt lgkmcnt(5)
    v_mfma_f32_16x16x32_bf16 v[168:171], v[216:219], v[232:235], v[168:171]
    ds_read_b128 v[88:91], v199 offset:40960
    s_waitcnt lgkmcnt(5)
    v_mfma_f32_16x16x32_bf16 v[172:175], v[220:223], v[232:235], v[172:175]
    ds_read_b128 v[104:107], v213 offset:40960
    s_waitcnt lgkmcnt(5)
    v_mfma_f32_16x16x32_bf16 v[64:67], v[224:227], v[232:235], v[64:67]
    s_waitcnt lgkmcnt(4)
    v_mfma_f32_16x16x32_bf16 v[68:71], v[228:231], v[232:235], v[68:71]
    ds_read_b128 v[92:95], v199 offset:43008
    s_waitcnt lgkmcnt(4)
    v_mfma_f32_16x16x32_bf16 v[176:179], v[216:219], v[236:239], v[176:179]
    v_mfma_f32_16x16x32_bf16 v[180:183], v[220:223], v[236:239], v[180:183]
    ds_read_b128 v[96:99], v199 offset:45056
    v_mfma_f32_16x16x32_bf16 v[72:75], v[224:227], v[236:239], v[72:75]
    ds_read_b128 v[100:103], v199 offset:47104
    v_mfma_f32_16x16x32_bf16 v[76:79], v[228:231], v[236:239], v[76:79]
    s_waitcnt lgkmcnt(5)
    v_mfma_f32_16x16x32_bf16 v[184:187], v[216:219], v[240:243], v[184:187]
    ds_read_b128 v[108:111], v213 offset:43008
    v_mfma_f32_16x16x32_bf16 v[188:191], v[220:223], v[240:243], v[188:191]
    v_mfma_f32_16x16x32_bf16 v[80:83], v[224:227], v[240:243], v[80:83]
    ds_read_b128 v[112:115], v213 offset:45056
    v_mfma_f32_16x16x32_bf16 v[84:87], v[228:231], v[240:243], v[84:87]
    s_waitcnt lgkmcnt(0)
    s_barrier
    v_mfma_f32_16x16x32_bf16 v[168:171], v[88:91], v[104:107], v[168:171]
    ds_read_b128 v[216:219], v196 offset:0
    v_mfma_f32_16x16x32_bf16 v[172:175], v[92:95], v[104:107], v[172:175]
    ds_read_b128 v[232:235], v210 offset:0
    v_mfma_f32_16x16x32_bf16 v[64:67], v[96:99], v[104:107], v[64:67]
    v_mfma_f32_16x16x32_bf16 v[68:71], v[100:103], v[104:107], v[68:71]
    ds_read_b128 v[220:223], v196 offset:2048
    v_mfma_f32_16x16x32_bf16 v[176:179], v[88:91], v[108:111], v[176:179]
    v_mfma_f32_16x16x32_bf16 v[180:183], v[92:95], v[108:111], v[180:183]
    ds_read_b128 v[224:227], v196 offset:4096
    v_mfma_f32_16x16x32_bf16 v[72:75], v[96:99], v[108:111], v[72:75]
    ds_read_b128 v[228:231], v196 offset:6144
    v_mfma_f32_16x16x32_bf16 v[76:79], v[100:103], v[108:111], v[76:79]
    v_mfma_f32_16x16x32_bf16 v[184:187], v[88:91], v[112:115], v[184:187]
    ds_read_b128 v[236:239], v210 offset:2048
    v_mfma_f32_16x16x32_bf16 v[188:191], v[92:95], v[112:115], v[188:191]
    v_mfma_f32_16x16x32_bf16 v[80:83], v[96:99], v[112:115], v[80:83]
    ds_read_b128 v[240:243], v210 offset:4096
    v_mfma_f32_16x16x32_bf16 v[84:87], v[100:103], v[112:115], v[84:87]
    s_waitcnt lgkmcnt(5)
    v_mfma_f32_16x16x32_bf16 v[168:171], v[216:219], v[232:235], v[168:171]
    ds_read_b128 v[88:91], v197 offset:0
    s_waitcnt lgkmcnt(5)
    v_mfma_f32_16x16x32_bf16 v[172:175], v[220:223], v[232:235], v[172:175]
    ds_read_b128 v[104:107], v211 offset:0
    s_waitcnt lgkmcnt(5)
    v_mfma_f32_16x16x32_bf16 v[64:67], v[224:227], v[232:235], v[64:67]
    s_waitcnt lgkmcnt(4)
    v_mfma_f32_16x16x32_bf16 v[68:71], v[228:231], v[232:235], v[68:71]
    ds_read_b128 v[92:95], v197 offset:2048
    s_waitcnt lgkmcnt(4)
    v_mfma_f32_16x16x32_bf16 v[176:179], v[216:219], v[236:239], v[176:179]
    v_mfma_f32_16x16x32_bf16 v[180:183], v[220:223], v[236:239], v[180:183]
    ds_read_b128 v[96:99], v197 offset:4096
    v_mfma_f32_16x16x32_bf16 v[72:75], v[224:227], v[236:239], v[72:75]
    ds_read_b128 v[100:103], v197 offset:6144
    v_mfma_f32_16x16x32_bf16 v[76:79], v[228:231], v[236:239], v[76:79]
    s_waitcnt lgkmcnt(5)
    v_mfma_f32_16x16x32_bf16 v[184:187], v[216:219], v[240:243], v[184:187]
    ds_read_b128 v[108:111], v211 offset:2048
    v_mfma_f32_16x16x32_bf16 v[188:191], v[220:223], v[240:243], v[188:191]
    v_mfma_f32_16x16x32_bf16 v[80:83], v[224:227], v[240:243], v[80:83]
    ds_read_b128 v[112:115], v211 offset:4096
    v_mfma_f32_16x16x32_bf16 v[84:87], v[228:231], v[240:243], v[84:87]
    s_waitcnt lgkmcnt(0)
    s_barrier
    v_mfma_f32_16x16x32_bf16 v[168:171], v[88:91], v[104:107], v[168:171]
    ds_read_b128 v[216:219], v196 offset:40960
    v_mfma_f32_16x16x32_bf16 v[172:175], v[92:95], v[104:107], v[172:175]
    ds_read_b128 v[232:235], v210 offset:40960
    v_mfma_f32_16x16x32_bf16 v[64:67], v[96:99], v[104:107], v[64:67]
    v_mfma_f32_16x16x32_bf16 v[68:71], v[100:103], v[104:107], v[68:71]
    ds_read_b128 v[220:223], v196 offset:43008
    v_mfma_f32_16x16x32_bf16 v[176:179], v[88:91], v[108:111], v[176:179]
    v_mfma_f32_16x16x32_bf16 v[180:183], v[92:95], v[108:111], v[180:183]
    ds_read_b128 v[224:227], v196 offset:45056
    v_mfma_f32_16x16x32_bf16 v[72:75], v[96:99], v[108:111], v[72:75]
    ds_read_b128 v[228:231], v196 offset:47104
    v_mfma_f32_16x16x32_bf16 v[76:79], v[100:103], v[108:111], v[76:79]
    v_mfma_f32_16x16x32_bf16 v[184:187], v[88:91], v[112:115], v[184:187]
    ds_read_b128 v[236:239], v210 offset:43008
    v_mfma_f32_16x16x32_bf16 v[188:191], v[92:95], v[112:115], v[188:191]
    v_mfma_f32_16x16x32_bf16 v[80:83], v[96:99], v[112:115], v[80:83]
    ds_read_b128 v[240:243], v210 offset:45056
    v_mfma_f32_16x16x32_bf16 v[84:87], v[100:103], v[112:115], v[84:87]
    s_waitcnt lgkmcnt(5)
    v_mfma_f32_16x16x32_bf16 v[168:171], v[216:219], v[232:235], v[168:171]
    ds_read_b128 v[88:91], v197 offset:40960
    s_waitcnt lgkmcnt(5)
    v_mfma_f32_16x16x32_bf16 v[172:175], v[220:223], v[232:235], v[172:175]
    ds_read_b128 v[104:107], v211 offset:40960
    s_waitcnt lgkmcnt(5)
    v_mfma_f32_16x16x32_bf16 v[64:67], v[224:227], v[232:235], v[64:67]
    s_waitcnt lgkmcnt(4)
    v_mfma_f32_16x16x32_bf16 v[68:71], v[228:231], v[232:235], v[68:71]
    ds_read_b128 v[92:95], v197 offset:43008
    s_waitcnt lgkmcnt(4)
    v_mfma_f32_16x16x32_bf16 v[176:179], v[216:219], v[236:239], v[176:179]
    v_mfma_f32_16x16x32_bf16 v[180:183], v[220:223], v[236:239], v[180:183]
    ds_read_b128 v[96:99], v197 offset:45056
    v_mfma_f32_16x16x32_bf16 v[72:75], v[224:227], v[236:239], v[72:75]
    ds_read_b128 v[100:103], v197 offset:47104
    v_mfma_f32_16x16x32_bf16 v[76:79], v[228:231], v[236:239], v[76:79]
    s_waitcnt lgkmcnt(5)
    v_mfma_f32_16x16x32_bf16 v[184:187], v[216:219], v[240:243], v[184:187]
    ds_read_b128 v[108:111], v211 offset:43008
    v_mfma_f32_16x16x32_bf16 v[188:191], v[220:223], v[240:243], v[188:191]
    v_mfma_f32_16x16x32_bf16 v[80:83], v[224:227], v[240:243], v[80:83]
    ds_read_b128 v[112:115], v211 offset:45056
    v_mfma_f32_16x16x32_bf16 v[84:87], v[228:231], v[240:243], v[84:87]
    s_waitcnt lgkmcnt(0)
    s_barrier
    buffer_load_dword v14, v15, s[52:55], 0 offen sc1
    v_mfma_f32_16x16x32_bf16 v[168:171], v[88:91], v[104:107], v[168:171]
    ds_read_b128 v[196:199], v32 offset:0
    v_mfma_f32_16x16x32_bf16 v[172:175], v[92:95], v[104:107], v[172:175]
    ds_read_b128 v[212:215], v32 offset:1024
    v_mfma_f32_16x16x32_bf16 v[64:67], v[96:99], v[104:107], v[64:67]
    ds_read_b128 v[228:231], v32 offset:2048
    v_mfma_f32_16x16x32_bf16 v[68:71], v[100:103], v[104:107], v[68:71]
    ds_read_b128 v[200:203], v32 offset:256
    v_mfma_f32_16x16x32_bf16 v[176:179], v[88:91], v[108:111], v[176:179]
    ds_read_b128 v[216:219], v32 offset:1280
    v_mfma_f32_16x16x32_bf16 v[180:183], v[92:95], v[108:111], v[180:183]
    ds_read_b128 v[232:235], v32 offset:2304
    v_mfma_f32_16x16x32_bf16 v[72:75], v[96:99], v[108:111], v[72:75]
    ds_read_b128 v[204:207], v32 offset:512
    v_mfma_f32_16x16x32_bf16 v[76:79], v[100:103], v[108:111], v[76:79]
    ds_read_b128 v[220:223], v32 offset:1536
    v_mfma_f32_16x16x32_bf16 v[184:187], v[88:91], v[112:115], v[184:187]
    ds_read_b128 v[236:239], v32 offset:2560
    v_mfma_f32_16x16x32_bf16 v[188:191], v[92:95], v[112:115], v[188:191]
    ds_read_b128 v[208:211], v32 offset:768
    v_mfma_f32_16x16x32_bf16 v[80:83], v[96:99], v[112:115], v[80:83]
    ds_read_b128 v[224:227], v32 offset:1792
    v_mfma_f32_16x16x32_bf16 v[84:87], v[100:103], v[112:115], v[84:87]
    ds_read_b128 v[240:243], v32 offset:2816
    s_waitcnt lgkmcnt(9)
    v_fma_f32 v88, v196, v168, v169
    v_fma_f32 v89, v212, v176, v177
    v_fma_f32 v90, v228, v184, v185
    v_fma_f32 v91, v196, v64, v65
    v_fma_f32 v92, v212, v72, v73
    v_fma_f32 v93, v228, v80, v81
    v_fmac_f32_dpp v88, v168, v197 row_ror:8 row_mask:0xf bank_mask:0xf
    v_fmac_f32_dpp v89, v176, v213 row_ror:8 row_mask:0xf bank_mask:0xf
    v_fmac_f32_dpp v90, v184, v229 row_ror:8 row_mask:0xf bank_mask:0xf
    v_fmac_f32_dpp v91, v64, v197 row_ror:8 row_mask:0xf bank_mask:0xf
    v_fmac_f32_dpp v92, v72, v213 row_ror:8 row_mask:0xf bank_mask:0xf
    v_fmac_f32_dpp v93, v80, v229 row_ror:8 row_mask:0xf bank_mask:0xf
    ds_write_b128 v34, v[64:67] offset:48640
    v_fma_f32 v96, v196, v88, v170
    v_fma_f32 v97, v212, v89, v178
    v_fma_f32 v98, v228, v90, v186
    v_fma_f32 v99, v196, v91, v66
    v_fma_f32 v100, v212, v92, v74
    v_fma_f32 v101, v228, v93, v82
    v_fmac_f32_dpp v96, v88, v197 row_ror:8 row_mask:0xf bank_mask:0xf
    v_fmac_f32_dpp v97, v89, v213 row_ror:8 row_mask:0xf bank_mask:0xf
    v_fmac_f32_dpp v98, v90, v229 row_ror:8 row_mask:0xf bank_mask:0xf
    v_fmac_f32_dpp v99, v91, v197 row_ror:8 row_mask:0xf bank_mask:0xf
    v_fmac_f32_dpp v100, v92, v213 row_ror:8 row_mask:0xf bank_mask:0xf
    v_fmac_f32_dpp v101, v93, v229 row_ror:8 row_mask:0xf bank_mask:0xf
    ds_write_b128 v34, v[68:71] offset:49664
    v_fma_f32 v88, v196, v96, v171
    v_fma_f32 v89, v212, v97, v179
    v_fma_f32 v90, v228, v98, v187
    v_fma_f32 v91, v196, v99, v67
    v_fma_f32 v92, v212, v100, v75
    v_fma_f32 v93, v228, v101, v83
    v_fmac_f32_dpp v88, v96, v197 row_ror:8 row_mask:0xf bank_mask:0xf
    v_fmac_f32_dpp v89, v97, v213 row_ror:8 row_mask:0xf bank_mask:0xf
    v_fmac_f32_dpp v90, v98, v229 row_ror:8 row_mask:0xf bank_mask:0xf
    v_fmac_f32_dpp v91, v99, v197 row_ror:8 row_mask:0xf bank_mask:0xf
    v_fmac_f32_dpp v92, v100, v213 row_ror:8 row_mask:0xf bank_mask:0xf
    v_fmac_f32_dpp v93, v101, v229 row_ror:8 row_mask:0xf bank_mask:0xf
    ds_write_b128 v34, v[72:75] offset:50688
    v_fma_f32 v96, v196, v88, v172
    v_fma_f32 v97, v212, v89, v180
    v_fma_f32 v98, v228, v90, v188
    v_fma_f32 v99, v196, v91, v68
    v_fma_f32 v100, v212, v92, v76
    v_fma_f32 v101, v228, v93, v84
    v_fmac_f32_dpp v96, v88, v197 row_ror:8 row_mask:0xf bank_mask:0xf
    v_fmac_f32_dpp v97, v89, v213 row_ror:8 row_mask:0xf bank_mask:0xf
    v_fmac_f32_dpp v98, v90, v229 row_ror:8 row_mask:0xf bank_mask:0xf
    v_fmac_f32_dpp v99, v91, v197 row_ror:8 row_mask:0xf bank_mask:0xf
    v_fmac_f32_dpp v100, v92, v213 row_ror:8 row_mask:0xf bank_mask:0xf
    v_fmac_f32_dpp v101, v93, v229 row_ror:8 row_mask:0xf bank_mask:0xf
    ds_write_b128 v34, v[76:79] offset:51712
    v_fma_f32 v88, v196, v96, v173
    v_fma_f32 v89, v212, v97, v181
    v_fma_f32 v90, v228, v98, v189
    v_fma_f32 v91, v196, v99, v69
    v_fma_f32 v92, v212, v100, v77
    v_fma_f32 v93, v228, v101, v85
    v_fmac_f32_dpp v88, v96, v197 row_ror:8 row_mask:0xf bank_mask:0xf
    v_fmac_f32_dpp v89, v97, v213 row_ror:8 row_mask:0xf bank_mask:0xf
    v_fmac_f32_dpp v90, v98, v229 row_ror:8 row_mask:0xf bank_mask:0xf
    v_fmac_f32_dpp v91, v99, v197 row_ror:8 row_mask:0xf bank_mask:0xf
    v_fmac_f32_dpp v92, v100, v213 row_ror:8 row_mask:0xf bank_mask:0xf
    v_fmac_f32_dpp v93, v101, v229 row_ror:8 row_mask:0xf bank_mask:0xf
    ds_write_b128 v34, v[80:83] offset:52736
    v_fma_f32 v96, v196, v88, v174
    v_fma_f32 v97, v212, v89, v182
    v_fma_f32 v98, v228, v90, v190
    v_fma_f32 v99, v196, v91, v70
    v_fma_f32 v100, v212, v92, v78
    v_fma_f32 v101, v228, v93, v86
    v_fmac_f32_dpp v96, v88, v197 row_ror:8 row_mask:0xf bank_mask:0xf
    v_fmac_f32_dpp v97, v89, v213 row_ror:8 row_mask:0xf bank_mask:0xf
    v_fmac_f32_dpp v98, v90, v229 row_ror:8 row_mask:0xf bank_mask:0xf
    v_fmac_f32_dpp v99, v91, v197 row_ror:8 row_mask:0xf bank_mask:0xf
    v_fmac_f32_dpp v100, v92, v213 row_ror:8 row_mask:0xf bank_mask:0xf
    v_fmac_f32_dpp v101, v93, v229 row_ror:8 row_mask:0xf bank_mask:0xf
    ds_write_b128 v34, v[84:87] offset:53760
    v_fma_f32 v88, v196, v96, v175
    v_fma_f32 v89, v212, v97, v183
    v_fma_f32 v90, v228, v98, v191
    v_fma_f32 v91, v196, v99, v71
    v_fma_f32 v92, v212, v100, v79
    v_fma_f32 v93, v228, v101, v87
    v_fmac_f32_dpp v88, v96, v197 row_ror:8 row_mask:0xf bank_mask:0xf
    v_fmac_f32_dpp v89, v97, v213 row_ror:8 row_mask:0xf bank_mask:0xf
    v_fmac_f32_dpp v90, v98, v229 row_ror:8 row_mask:0xf bank_mask:0xf
    v_fmac_f32_dpp v91, v99, v197 row_ror:8 row_mask:0xf bank_mask:0xf
    v_fmac_f32_dpp v92, v100, v213 row_ror:8 row_mask:0xf bank_mask:0xf
    v_fmac_f32_dpp v93, v101, v229 row_ror:8 row_mask:0xf bank_mask:0xf
    s_mov_b64 exec, 0xffff
    ds_write_b128 v35, v[40:43] offset:40960
    ds_write_b128 v35, v[40:43] offset:42240
    ds_write_b128 v35, v[40:43] offset:43520
    s_mov_b64 exec, -1
    ds_write_b32 v36, v88 offset:40976
    ds_write_b32 v36, v89 offset:42256
    ds_write_b32 v36, v90 offset:43536
    ds_write_b32 v36, v91 offset:40992
    ds_write_b32 v36, v92 offset:42272
    ds_write_b32 v36, v93 offset:43552
    s_waitcnt vmcnt(0)
    v_cmp_ne_u32 vcc, s67, v14
    s_nop 4
    s_cbranch_vccnz Lslow_45
Lok_46:
    buffer_load_dwordx4 v[144:147], v19, s[52:55], s7 offen sc1
    buffer_load_dwordx4 v[148:151], v19, s[52:55], s7 offen offset:1280 sc1
    buffer_load_dword v152, v21, s[52:55], s7 offen sc1
    s_waitcnt vmcnt(0)
    s_mov_b32 s72, 0x3eae1a93
    s_mov_b32 s73, s72
    v_lshlrev_b32 v104, 16, v144
    v_and_b32 v105, 0xffff0000, v144
    v_lshlrev_b32 v106, 16, v145
    v_and_b32 v107, 0xffff0000, v145
    v_lshlrev_b32 v108, 16, v146
    v_and_b32 v109, 0xffff0000, v146
    v_lshlrev_b32 v110, 16, v147
    v_and_b32 v111, 0xffff0000, v147
    v_lshlrev_b32 v112, 16, v148
    v_and_b32 v113, 0xffff0000, v148
    v_lshlrev_b32 v114, 16, v149
    v_and_b32 v115, 0xffff0000, v149
    v_lshlrev_b32 v116, 16, v150
    v_and_b32 v117, 0xffff0000, v150
    v_lshlrev_b32 v118, 16, v151
    v_and_b32 v119, 0xffff0000, v151
    v_lshlrev_b32 v120, 16, v152
    v_and_b32 v121, 0xffff0000, v152
    v_pk_mul_f32 v[104:105], v[104:105], s[72:73]
    v_pk_mul_f32 v[106:107], v[106:107], s[72:73]
    v_pk_mul_f32 v[108:109], v[108:109], s[72:73]
    v_pk_mul_f32 v[110:111], v[110:111], s[72:73]
    v_pk_mul_f32 v[112:113], v[112:113], s[72:73]
    v_pk_mul_f32 v[114:115], v[114:115], s[72:73]
    v_pk_mul_f32 v[116:117], v[116:117], s[72:73]
    v_pk_mul_f32 v[118:119], v[118:119], s[72:73]
    v_pk_mul_f32 v[120:121], v[120:121], s[72:73]
    v_cvt_pk_bf16_f32 v144, v104, v105
    v_cvt_pk_bf16_f32 v145, v106, v107
    v_cvt_pk_bf16_f32 v146, v108, v109
    v_cvt_pk_bf16_f32 v147, v110, v111
    v_cvt_pk_bf16_f32 v148, v112, v113
    v_cvt_pk_bf16_f32 v149, v114, v115
    v_cvt_pk_bf16_f32 v150, v116, v117
    v_cvt_pk_bf16_f32 v151, v118, v119
    v_cvt_pk_bf16_f32 v152, v120, v121
L_front_done:
    v_mov_b32 v153, 0
    v_add_u32 v6, 81920, v19
    s_mul_i32 s72, s70, 20480
    v_subrev_u32 v7, s72, v17
    s_lshl_b32 s94, s64, 10
    s_waitcnt lgkmcnt(0)
    s_barrier
    ds_read_b64 v[158:159], v7
    ds_read_b128 v[154:157], v6
    s_cmp_lt_u32 s64, 4
    s_cbranch_scc1 L_nou
    s_cmp_lg_u32 s68, 0
    s_cbranch_scc1 L_nou
    s_cmp_ge_u32 s2, 192
    s_cbranch_scc1 L_nouP
    s_mul_i32 s72, s69, 4096
    v_add_u32 v4, s72, v19
    ds_read_b128 v[168:171], v4 offset:48640
    ds_read_b128 v[172:175], v4 offset:49664
    ds_read_b128 v[176:179], v4 offset:50688
    ds_read_b128 v[180:183], v4 offset:51712
    s_branch L_nou
L_nouP:
    s_mul_i32 s72, s69, 6144
    v_add_u32 v4, s72, v19
    ds_read_b128 v[168:171], v4 offset:48640
    ds_read_b128 v[172:175], v4 offset:49664
    ds_read_b128 v[176:179], v4 offset:50688
    ds_read_b128 v[180:183], v4 offset:51712
    ds_read_b128 v[184:187], v4 offset:52736
    ds_read_b128 v[188:191], v4 offset:53760
L_nou:
    s_waitcnt lgkmcnt(0)
    v_mfma_f32_32x32x4_2b_bf16 v[64:95], v[158:159], v[152:153], 0
    s_nop 15
    s_nop 3
    v_mfma_f32_32x32x16_bf16 v[64:79], v[154:157], v[144:147], v[64:79]
    v_mfma_f32_32x32x16_bf16 v[80:95], v[154:157], v[148:151], v[80:95]
    ds_read_b64 v[158:159], v17
    ds_read_b128 v[154:157], v16
    s_nop 8
    v_max3_f32 v4, v64, v65, v66
    v_max3_f32 v4, v4, v67, v68
    v_max3_f32 v4, v4, v69, v70
    v_max3_f32 v4, v4, v71, v72
    v_max3_f32 v4, v4, v73, v74
    v_max3_f32 v4, v4, v75, v76
    v_max3_f32 v4, v4, v77, v78
    v_max_f32 v4, v4, v79
    v_max3_f32 v5, v80, v81, v82
    v_max3_f32 v5, v5, v83, v84
    v_max3_f32 v5, v5, v85, v86
    v_max3_f32 v5, v5, v87, v88
    v_max3_f32 v5, v5, v89, v90
    v_max3_f32 v5, v5, v91, v92
    v_max3_f32 v5, v5, v93, v94
    v_max_f32 v5, v5, v95
    s_nop 1
    v_permlane32_swap_b32 v4, v5
    v_max_f32 v4, v4, v5
L_have_max:
    s_nop 1
    v_and_b32 v5, 0xffff0000, v4
    v_sub_f32 v6, v4, v5
    v_cvt_pk_bf16_f32 v153, -v5, -v6
    s_waitcnt lgkmcnt(0)
    s_nop 0
    v_mfma_f32_32x32x4_2b_bf16 v[32:63], v[158:159], v[152:153], 0
    s_nop 15
    s_nop 3
    v_mfma_f32_32x32x16_bf16 v[32:47], v[154:157], v[144:147], v[32:47]
    v_mfma_f32_32x32x16_bf16 v[48:63], v[154:157], v[148:151], v[48:63]
    ds_read_b64 v[158:159], v17 offset:2560
    ds_read_b128 v[154:157], v16 offset:2560
    s_setprio 3
    s_waitcnt lgkmcnt(0)
    v_mfma_f32_32x32x4_2b_bf16 v[64:95], v[158:159], v[152:153], 0
    s_nop 5
    v_exp_f32 v32, v32
    v_exp_f32 v33, v33
    s_add_u32 s95, s6, s94
    s_add_u32 s95, s95, 40960
    s_add_u32 m0, s94, 122880
    s_nop 0
    buffer_load_dwordx4 v19, s[52:55], s95 offen sc1 lds
    v_exp_f32 v34, v34
    v_exp_f32 v35, v35
    v_cvt_pk_bf16_f32 v128, v32, v33
    v_exp_f32 v36, v36
    v_exp_f32 v37, v37
    v_cvt_pk_bf16_f32 v129, v34, v35
    v_exp_f32 v38, v38
    v_exp_f32 v39, v39
    ds_read_b128 v[160:163], v18 offset:0
    v_cvt_pk_bf16_f32 v130, v36, v37
    v_exp_f32 v40, v40
    v_exp_f32 v41, v41
    v_cvt_pk_bf16_f32 v131, v38, v39
    v_exp_f32 v42, v42
    ds_read_b128 v[164:167], v20 offset:0
    v_exp_f32 v43, v43
    s_add_u32 s95, s95, 8192
    s_add_u32 m0, s94, 131072
    s_nop 0
    buffer_load_dwordx4 v19, s[52:55], s95 offen sc1 lds
    v_cvt_pk_bf16_f32 v132, v40, v41
    v_exp_f32 v44, v44
    v_exp_f32 v45, v45
    v_mfma_f32_32x32x16_bf16 v[64:79], v[154:157], v[144:147], v[64:79]
    v_cvt_pk_bf16_f32 v133, v42, v43
    v_exp_f32 v46, v46
    v_exp_f32 v47, v47
    v_cvt_pk_bf16_f32 v134, v44, v45
    v_cvt_pk_bf16_f32 v135, v46, v47
    s_setprio 2
    v_mfma_f32_32x32x16_bf16 v[80:95], v[154:157], v[148:151], v[80:95]
    v_exp_f32 v48, v48
    ds_read_b64 v[158:159], v17 offset:5120
    v_exp_f32 v49, v49
    ds_read_b128 v[154:157], v16 offset:5120
    v_exp_f32 v50, v50
    v_exp_f32 v51, v51
    v_cvt_pk_bf16_f32 v136, v48, v49
    v_exp_f32 v52, v52
    s_add_u32 s95, s95, 8192
    s_add_u32 m0, s94, 139264
    s_nop 0
    buffer_load_dwordx4 v19, s[52:55], s95 offen sc1 lds
    s_waitcnt lgkmcnt(2)
    v_mfma_f32_32x32x16_bf16 v[96:111], v[160:163], v[128:131], 0
    v_exp_f32 v53, v53
    v_cvt_pk_bf16_f32 v137, v50, v51
    v_exp_f32 v54, v54
    v_exp_f32 v55, v55
    v_cvt_pk_bf16_f32 v138, v52, v53
    v_exp_f32 v56, v56
    v_exp_f32 v57, v57
    v_cvt_pk_bf16_f32 v139, v54, v55
    v_mfma_f32_32x32x16_bf16 v[96:111], v[164:167], v[132:135], v[96:111]
    v_exp_f32 v58, v58
    v_exp_f32 v59, v59
    v_cvt_pk_bf16_f32 v140, v56, v57
    v_exp_f32 v60, v60
    v_exp_f32 v61, v61
    v_cvt_pk_bf16_f32 v141, v58, v59
    v_exp_f32 v62, v62
    v_exp_f32 v63, v63
    v_cvt_pk_bf16_f32 v142, v60, v61
    v_cvt_pk_bf16_f32 v143, v62, v63
    s_setprio 3
    s_cmp_lg_u32 s68, 0
    s_cbranch_scc1 L_c0
    s_cmp_ge_u32 s2, 192
    s_cbranch_scc1 L_c0P
    s_mul_i32 s72, s3, 2560
    v_mul_u32_u24 v15, 80, v2
    v_add_u32 v15, s72, v15
    s_sub_u32 s73, s71, 3
    v_add_u32 v14, s73, v3
    v_max_i32 v14, 0, v14
    v_lshl_add_u32 v14, v14, 4, v15
    s_lshl_b32 s73, s71, 4
    v_add_u32 v15, s73, v15
    ds_read_b128 v[112:115], v14 offset:40960
    ds_read_b128 v[116:119], v14 offset:42240
    ds_read_b128 v[124:127], v15 offset:40976
    ds_read_b128 v[4:7], v15 offset:42256
    s_waitcnt lgkmcnt(2)
    v_fmac_f32 v113, v206, v112
    v_fmac_f32 v117, v222, v116
    s_nop 0
    v_fmac_f32_dpp v113, v112, v207 row_ror:8 row_mask:0xf bank_mask:0xf
    v_fmac_f32_dpp v117, v116, v223 row_ror:8 row_mask:0xf bank_mask:0xf
    v_fmac_f32 v114, v206, v113
    v_fmac_f32 v118, v222, v117
    s_nop 0
    v_fmac_f32_dpp v114, v113, v207 row_ror:8 row_mask:0xf bank_mask:0xf
    v_fmac_f32_dpp v118, v117, v223 row_ror:8 row_mask:0xf bank_mask:0xf
    v_fmac_f32 v115, v206, v114
    v_fmac_f32 v119, v222, v118
    s_nop 0
    v_fmac_f32_dpp v115, v114, v207 row_ror:8 row_mask:0xf bank_mask:0xf
    v_fmac_f32_dpp v119, v118, v223 row_ror:8 row_mask:0xf bank_mask:0xf
    v_mov_b32 v112, v115
    v_mov_b32 v116, v119
    s_nop 0
    v_permlane16_swap_b32 v112, v115
    v_permlane16_swap_b32 v116, v119
    v_fmac_f32 v115, v208, v112
    v_fmac_f32 v119, v224, v116
    s_nop 0
    v_fmac_f32_dpp v115, v112, v209 row_ror:8 row_mask:0xf bank_mask:0xf
    v_fmac_f32_dpp v119, v116, v225 row_ror:8 row_mask:0xf bank_mask:0xf
    v_mov_b32 v112, v115
    v_mov_b32 v116, v119
    s_nop 0
    v_permlane32_swap_b32 v112, v115
    v_permlane32_swap_b32 v116, v119
    v_fmac_f32 v115, v210, v112
    v_fmac_f32 v119, v226, v116
    s_nop 0
    v_fmac_f32_dpp v115, v112, v211 row_ror:8 row_mask:0xf bank_mask:0xf
    v_fmac_f32_dpp v119, v116, v227 row_ror:8 row_mask:0xf bank_mask:0xf
    s_waitcnt lgkmcnt(0)
    v_fmac_f32 v124, v206, v115
    v_fmac_f32 v4, v222, v119
    s_nop 0
    v_fmac_f32_dpp v124, v115, v207 row_ror:8 row_mask:0xf bank_mask:0xf
    v_fmac_f32_dpp v4, v119, v223 row_ror:8 row_mask:0xf bank_mask:0xf
    v_mov_b32 v192, v115
    v_mov_b32 v193, v119
    v_fmac_f32 v125, v206, v124
    v_fmac_f32 v5, v222, v4
    s_nop 0
    v_fmac_f32_dpp v125, v124, v207 row_ror:8 row_mask:0xf bank_mask:0xf
    v_fmac_f32_dpp v5, v4, v223 row_ror:8 row_mask:0xf bank_mask:0xf
    v_fmac_f32 v126, v206, v125
    v_fmac_f32 v6, v222, v5
    s_nop 0
    v_fmac_f32_dpp v126, v125, v207 row_ror:8 row_mask:0xf bank_mask:0xf
    v_fmac_f32_dpp v6, v5, v223 row_ror:8 row_mask:0xf bank_mask:0xf
    v_fmac_f32 v127, v206, v126
    v_fmac_f32 v7, v222, v6
    s_nop 0
    v_fmac_f32_dpp v127, v126, v207 row_ror:8 row_mask:0xf bank_mask:0xf
    v_fmac_f32_dpp v7, v6, v223 row_ror:8 row_mask:0xf bank_mask:0xf
    s_mov_b32 exec_lo, 0xffff0000
    s_mov_b32 exec_hi, -1
    v_mov_b32 v192, v124
    v_mov_b32 v193, v4
    s_mov_b32 exec_lo, 0
    s_mov_b32 exec_hi, -1
    v_mov_b32 v192, v125
    v_mov_b32 v193, v5
    s_mov_b32 exec_lo, 0
    s_mov_b32 exec_hi, 0xffff0000
    v_mov_b32 v192, v126
    v_mov_b32 v193, v6
    s_cmp_lg_u32 s71, 3
    s_cbranch_scc1 L_noER
    s_lshl_b32 s72, s39, 1
    s_add_u32 s72, s72, s3
    s_lshl_b32 s72, s72, 12
    s_add_u32 s72, s72, 14954496
    s_mul_i32 s73, s38, 256
    s_add_u32 s72, s72, s73
    v_mul_u32_u24 v15, 16, v2
    v_mov_b32 v112, v127
    v_mov_b32 v113, v7
    buffer_store_dwordx4 v[112:115], v15, s[52:55], s72 offen sc1
L_noER:
    s_mov_b64 exec, -1
    s_branch L_c0
L_c0P:
    s_mul_i32 s72, s3, 3840
    v_mul_u32_u24 v15, 80, v2
    v_add_u32 v15, s72, v15
    s_sub_u32 s73, s71, 3
    v_add_u32 v14, s73, v3
    v_max_i32 v14, 0, v14
    v_lshl_add_u32 v14, v14, 4, v15
    s_lshl_b32 s73, s71, 4
    v_add_u32 v15, s73, v15
    ds_read_b128 v[112:115], v14 offset:40960
    ds_read_b128 v[116:119], v14 offset:42240
    ds_read_b128 v[120:123], v14 offset:43520
    ds_read_b128 v[124:127], v15 offset:40976
    ds_read_b128 v[4:7], v15 offset:42256
    ds_read_b128 v[8:11], v15 offset:43536
    s_waitcnt lgkmcnt(3)
    v_fmac_f32 v113, v206, v112
    v_fmac_f32 v117, v222, v116
    v_fmac_f32 v121, v238, v120
    v_fmac_f32_dpp v113, v112, v207 row_ror:8 row_mask:0xf bank_mask:0xf
    v_fmac_f32_dpp v117, v116, v223 row_ror:8 row_mask:0xf bank_mask:0xf
    v_fmac_f32_dpp v121, v120, v239 row_ror:8 row_mask:0xf bank_mask:0xf
    v_fmac_f32 v114, v206, v113
    v_fmac_f32 v118, v222, v117
    v_fmac_f32 v122, v238, v121
    v_fmac_f32_dpp v114, v113, v207 row_ror:8 row_mask:0xf bank_mask:0xf
    v_fmac_f32_dpp v118, v117, v223 row_ror:8 row_mask:0xf bank_mask:0xf
    v_fmac_f32_dpp v122, v121, v239 row_ror:8 row_mask:0xf bank_mask:0xf
    v_fmac_f32 v115, v206, v114
    v_fmac_f32 v119, v222, v118
    v_fmac_f32 v123, v238, v122
    v_fmac_f32_dpp v115, v114, v207 row_ror:8 row_mask:0xf bank_mask:0xf
    v_fmac_f32_dpp v119, v118, v223 row_ror:8 row_mask:0xf bank_mask:0xf
    v_fmac_f32_dpp v123, v122, v239 row_ror:8 row_mask:0xf bank_mask:0xf
    v_mov_b32 v112, v115
    v_mov_b32 v116, v119
    v_mov_b32 v120, v123
    v_permlane16_swap_b32 v112, v115
    v_permlane16_swap_b32 v116, v119
    v_permlane16_swap_b32 v120, v123
    v_fmac_f32 v115, v208, v112
    v_fmac_f32 v119, v224, v116
    v_fmac_f32 v123, v240, v120
    v_fmac_f32_dpp v115, v112, v209 row_ror:8 row_mask:0xf bank_mask:0xf
    v_fmac_f32_dpp v119, v116, v225 row_ror:8 row_mask:0xf bank_mask:0xf
    v_fmac_f32_dpp v123, v120, v241 row_ror:8 row_mask:0xf bank_mask:0xf
    v_mov_b32 v112, v115
    v_mov_b32 v116, v119
    v_mov_b32 v120, v123
    v_permlane32_swap_b32 v112, v115
    v_permlane32_swap_b32 v116, v119
    v_permlane32_swap_b32 v120, v123
    v_fmac_f32 v115, v210, v112
    v_fmac_f32 v119, v226, v116
    v_fmac_f32 v123, v242, v120
    v_fmac_f32_dpp v115, v112, v211 row_ror:8 row_mask:0xf bank_mask:0xf
    v_fmac_f32_dpp v119, v116, v227 row_ror:8 row_mask:0xf bank_mask:0xf
    v_fmac_f32_dpp v123, v120, v243 row_ror:8 row_mask:0xf bank_mask:0xf
    s_waitcnt lgkmcnt(0)
    v_fmac_f32 v124, v206, v115
    v_fmac_f32 v4, v222, v119
    v_fmac_f32 v8, v238, v123
    v_fmac_f32_dpp v124, v115, v207 row_ror:8 row_mask:0xf bank_mask:0xf
    v_fmac_f32_dpp v4, v119, v223 row_ror:8 row_mask:0xf bank_mask:0xf
    v_fmac_f32_dpp v8, v123, v239 row_ror:8 row_mask:0xf bank_mask:0xf
    v_mov_b32 v192, v115
    v_mov_b32 v193, v119
    v_mov_b32 v194, v123
    v_fmac_f32 v125, v206, v124
    v_fmac_f32 v5, v222, v4
    v_fmac_f32 v9, v238, v8
    v_fmac_f32_dpp v125, v124, v207 row_ror:8 row_mask:0xf bank_mask:0xf
    v_fmac_f32_dpp v5, v4, v223 row_ror:8 row_mask:0xf bank_mask:0xf
    v_fmac_f32_dpp v9, v8, v239 row_ror:8 row_mask:0xf bank_mask:0xf
    v_fmac_f32 v126, v206, v125
    v_fmac_f32 v6, v222, v5
    v_fmac_f32 v10, v238, v9
    v_fmac_f32_dpp v126, v125, v207 row_ror:8 row_mask:0xf bank_mask:0xf
    v_fmac_f32_dpp v6, v5, v223 row_ror:8 row_mask:0xf bank_mask:0xf
    v_fmac_f32_dpp v10, v9, v239 row_ror:8 row_mask:0xf bank_mask:0xf
    v_fmac_f32 v127, v206, v126
    v_fmac_f32 v7, v222, v6
    v_fmac_f32 v11, v238, v10
    v_fmac_f32_dpp v127, v126, v207 row_ror:8 row_mask:0xf bank_mask:0xf
    v_fmac_f32_dpp v7, v6, v223 row_ror:8 row_mask:0xf bank_mask:0xf
    v_fmac_f32_dpp v11, v10, v239 row_ror:8 row_mask:0xf bank_mask:0xf
    s_mov_b32 exec_lo, 0xffff0000
    s_mov_b32 exec_hi, -1
    v_mov_b32 v192, v124
    v_mov_b32 v193, v4
    v_mov_b32 v194, v8
    s_mov_b32 exec_lo, 0
    s_mov_b32 exec_hi, -1
    v_mov_b32 v192, v125
    v_mov_b32 v193, v5
    v_mov_b32 v194, v9
    s_mov_b32 exec_lo, 0
    s_mov_b32 exec_hi, 0xffff0000
    v_mov_b32 v192, v126
    v_mov_b32 v193, v6
    v_mov_b32 v194, v10
    s_cmp_lg_u32 s71, 3
    s_cbranch_scc1 L_noEP
    s_lshl_b32 s72, s39, 1
    s_add_u32 s72, s72, s3
    s_lshl_b32 s72, s72, 12
    s_add_u32 s72, s72, 14954496
    s_mul_i32 s73, s38, 256
    s_add_u32 s72, s72, s73
    v_mul_u32_u24 v15, 16, v2
    v_mov_b32 v112, v127
    v_mov_b32 v113, v7
    v_mov_b32 v114, v11
    buffer_store_dwordx4 v[112:115], v15, s[52:55], s72 offen sc1
L_noEP:
    s_mov_b64 exec, -1
L_c0:
    s_setprio 1
    s_waitcnt lgkmcnt(0)
    v_mfma_f32_32x32x4_2b_bf16 v[32:63], v[158:159], v[152:153], 0
    v_exp_f32 v64, v64
    v_exp_f32 v65, v65
    s_add_u32 s95, s95, 8192
    s_add_u32 m0, s94, 147456
    s_nop 0
    buffer_load_dwordx4 v19, s[52:55], s95 offen sc1 lds
    v_exp_f32 v66, v66
    v_exp_f32 v67, v67
    v_cvt_pk_bf16_f32 v128, v64, v65
    v_exp_f32 v68, v68
    v_exp_f32 v69, v69
    v_cvt_pk_bf16_f32 v129, v66, v67
    v_exp_f32 v70, v70
    v_mfma_f32_32x32x16_bf16 v[112:127], v[160:163], v[136:139], 0
    v_exp_f32 v71, v71
    ds_read_b128 v[160:163], v18 offset:2560
    v_cvt_pk_bf16_f32 v130, v68, v69
    v_exp_f32 v72, v72
    v_exp_f32 v73, v73
    v_cvt_pk_bf16_f32 v131, v70, v71
    v_mfma_f32_32x32x16_bf16 v[112:127], v[164:167], v[140:143], v[112:127]
    v_exp_f32 v74, v74
    ds_read_b128 v[164:167], v20 offset:2560
    v_exp_f32 v75, v75
    s_add_u32 s95, s95, 8192
    s_add_u32 m0, s94, 155648
    s_nop 0
    buffer_load_dwordx4 v19, s[52:55], s95 offen sc1 lds
    v_cvt_pk_bf16_f32 v132, v72, v73
    v_exp_f32 v76, v76
    v_exp_f32 v77, v77
    v_mfma_f32_32x32x16_bf16 v[32:47], v[154:157], v[144:147], v[32:47]
    v_cvt_pk_bf16_f32 v133, v74, v75
    v_exp_f32 v78, v78
    v_exp_f32 v79, v79
    v_cvt_pk_bf16_f32 v134, v76, v77
    v_cvt_pk_bf16_f32 v135, v78, v79
    s_setprio 0
    v_mfma_f32_32x32x16_bf16 v[48:63], v[154:157], v[148:151], v[48:63]
    v_exp_f32 v80, v80
    ds_read_b64 v[158:159], v17 offset:7680
    v_exp_f32 v81, v81
    ds_read_b128 v[154:157], v16 offset:7680
    v_exp_f32 v82, v82
    v_exp_f32 v83, v83
    v_cvt_pk_bf16_f32 v136, v80, v81
    v_exp_f32 v84, v84
    s_add_u32 s95, s6, s94
    s_add_u32 s95, s95, 81920
    s_add_u32 m0, s94, 0
    s_nop 0
    buffer_load_dwordx4 v19, s[52:55], s95 offen sc1 lds
    s_waitcnt lgkmcnt(2)
    v_mfma_f32_32x32x16_bf16 v[96:111], v[160:163], v[128:131], v[96:111]
    v_exp_f32 v85, v85
    v_cvt_pk_bf16_f32 v137, v82, v83
    v_exp_f32 v86, v86
    v_exp_f32 v87, v87
    v_cvt_pk_bf16_f32 v138, v84, v85
    v_exp_f32 v88, v88
    v_exp_f32 v89, v89
    v_cvt_pk_bf16_f32 v139, v86, v87
    v_mfma_f32_32x32x16_bf16 v[96:111], v[164:167], v[132:135], v[96:111]
    v_exp_f32 v90, v90
    v_exp_f32 v91, v91
    v_cvt_pk_bf16_f32 v140, v88, v89
    v_exp_f32 v92, v92
    v_exp_f32 v93, v93
    v_cvt_pk_bf16_f32 v141, v90, v91
    v_exp_f32 v94, v94
    v_exp_f32 v95, v95
    v_cvt_pk_bf16_f32 v142, v92, v93
    v_cvt_pk_bf16_f32 v143, v94, v95
    s_setprio 3
    s_waitcnt lgkmcnt(0)
    v_mfma_f32_32x32x4_2b_bf16 v[64:95], v[158:159], v[152:153], 0
    v_exp_f32 v32, v32
    v_exp_f32 v33, v33
    s_add_u32 s95, s95, 8192
    s_add_u32 m0, s94, 8192
    s_nop 0
    buffer_load_dwordx4 v19, s[52:55], s95 offen sc1 lds
    v_exp_f32 v34, v34
    v_exp_f32 v35, v35
    v_cvt_pk_bf16_f32 v128, v32, v33
    v_exp_f32 v36, v36
    v_exp_f32 v37, v37
    v_cvt_pk_bf16_f32 v129, v34, v35
    v_exp_f32 v38, v38
    v_mfma_f32_32x32x16_bf16 v[112:127], v[160:163], v[136:139], v[112:127]
    v_exp_f32 v39, v39
    ds_read_b128 v[160:163], v18 offset:5120
    v_cvt_pk_bf16_f32 v130, v36, v37
    v_exp_f32 v40, v40
    v_exp_f32 v41, v41
    v_cvt_pk_bf16_f32 v131, v38, v39
    v_mfma_f32_32x32x16_bf16 v[112:127], v[164:167], v[140:143], v[112:127]
    v_exp_f32 v42, v42
    ds_read_b128 v[164:167], v20 offset:5120
    v_exp_f32 v43, v43
    s_add_u32 s95, s95, 8192
    s_add_u32 m0, s94, 16384
    s_nop 0
    buffer_load_dwordx4 v19, s[52:55], s95 offen sc1 lds
    v_cvt_pk_bf16_f32 v132, v40, v41
    v_exp_f32 v44, v44
    v_exp_f32 v45, v45
    v_mfma_f32_32x32x16_bf16 v[64:79], v[154:157], v[144:147], v[64:79]
    v_cvt_pk_bf16_f32 v133, v42, v43
    v_exp_f32 v46, v46
    v_exp_f32 v47, v47
    v_cvt_pk_bf16_f32 v134, v44, v45
    v_cvt_pk_bf16_f32 v135, v46, v47
    s_setprio 2
    v_mfma_f32_32x32x16_bf16 v[80:95], v[154:157], v[148:151], v[80:95]
    v_exp_f32 v48, v48
    ds_read_b64 v[158:159], v17 offset:10240
    v_exp_f32 v49, v49
    ds_read_b128 v[154:157], v16 offset:10240
    v_exp_f32 v50, v50
    v_exp_f32 v51, v51
    v_cvt_pk_bf16_f32 v136, v48, v49
    v_exp_f32 v52, v52
    s_add_u32 s95, s95, 8192
    s_add_u32 m0, s94, 24576
    s_nop 0
    buffer_load_dwordx4 v19, s[52:55], s95 offen sc1 lds
    s_waitcnt lgkmcnt(2)
    v_mfma_f32_32x32x16_bf16 v[96:111], v[160:163], v[128:131], v[96:111]
    v_exp_f32 v53, v53
    v_cvt_pk_bf16_f32 v137, v50, v51
    v_exp_f32 v54, v54
    v_exp_f32 v55, v55
    v_cvt_pk_bf16_f32 v138, v52, v53
    v_exp_f32 v56, v56
    v_exp_f32 v57, v57
    v_cvt_pk_bf16_f32 v139, v54, v55
    v_mfma_f32_32x32x16_bf16 v[96:111], v[164:167], v[132:135], v[96:111]
    v_exp_f32 v58, v58
    v_exp_f32 v59, v59
    v_cvt_pk_bf16_f32 v140, v56, v57
    v_exp_f32 v60, v60
    v_exp_f32 v61, v61
    v_cvt_pk_bf16_f32 v141, v58, v59
    v_exp_f32 v62, v62
    v_exp_f32 v63, v63
    v_cvt_pk_bf16_f32 v142, v60, v61
    v_cvt_pk_bf16_f32 v143, v62, v63
    s_setprio 1
    s_waitcnt lgkmcnt(0)
    v_mfma_f32_32x32x4_2b_bf16 v[32:63], v[158:159], v[152:153], 0
    v_exp_f32 v64, v64
    v_exp_f32 v65, v65
    s_add_u32 s95, s95, 8192
    s_add_u32 m0, s94, 32768
    s_nop 0
    buffer_load_dwordx4 v19, s[52:55], s95 offen sc1 lds
    v_exp_f32 v66, v66
    v_exp_f32 v67, v67
    v_cvt_pk_bf16_f32 v128, v64, v65
    v_exp_f32 v68, v68
    v_exp_f32 v69, v69
    v_cvt_pk_bf16_f32 v129, v66, v67
    v_exp_f32 v70, v70
    v_mfma_f32_32x32x16_bf16 v[112:127], v[160:163], v[136:139], v[112:127]
    v_exp_f32 v71, v71
    ds_read_b128 v[160:163], v18 offset:7680
    v_cvt_pk_bf16_f32 v130, v68, v69
    v_exp_f32 v72, v72
    v_exp_f32 v73, v73
    v_cvt_pk_bf16_f32 v131, v70, v71
    v_mfma_f32_32x32x16_bf16 v[112:127], v[164:167], v[140:143], v[112:127]
    v_exp_f32 v74, v74
    ds_read_b128 v[164:167], v20 offset:7680
    v_exp_f32 v75, v75
    v_cvt_pk_bf16_f32 v132, v72, v73
    v_exp_f32 v76, v76
    v_exp_f32 v77, v77
    v_mfma_f32_32x32x16_bf16 v[32:47], v[154:157], v[144:147], v[32:47]
    v_cvt_pk_bf16_f32 v133, v74, v75
    v_exp_f32 v78, v78
    v_exp_f32 v79, v79
    v_cvt_pk_bf16_f32 v134, v76, v77
    v_cvt_pk_bf16_f32 v135, v78, v79
    s_setprio 0
    v_mfma_f32_32x32x16_bf16 v[48:63], v[154:157], v[148:151], v[48:63]
    v_exp_f32 v80, v80
    s_cmp_lg_u32 s68, 0
    s_cbranch_scc1 L_h1
    s_lshl_b32 s72, s2, 1
    s_add_u32 s72, s72, s3
    s_lshl_b32 s72, s72, 6
    s_add_u32 s72, s72, 15151104
    v_lshl_add_u32 v15, v2, 2, s72
    s_cmp_lg_u32 s71, 3
    s_cbranch_scc1 L_h1
    s_and_b32 s72, s2, 0xe4
    s_lshl_b32 s72, s72, 1
    s_add_u32 s72, s72, s3
    s_lshl_b32 s72, s72, 4
    s_add_u32 s72, s72, s38
    s_lshl_b32 s72, s72, 2
    s_add_u32 s72, s72, 15151104
    v_and_b32 v12, 3, v1
    v_lshlrev_b32 v12, 10, v12
    v_bfe_u32 v13, v1, 2, 2
    v_lshl_add_u32 v12, v13, 7, v12
    s_waitcnt vmcnt(7)
    v_mov_b32 v13, s67
    s_mov_b64 exec, 65535
    buffer_store_dword v13, v12, s[52:55], s72 offen sc1
    s_mov_b64 exec, -1
L_h1:
    ds_read_b64 v[158:159], v17 offset:12800
    v_exp_f32 v81, v81
    ds_read_b128 v[154:157], v16 offset:12800
    v_exp_f32 v82, v82
    v_exp_f32 v83, v83
    v_cvt_pk_bf16_f32 v136, v80, v81
    v_exp_f32 v84, v84
    s_waitcnt lgkmcnt(2)
    v_mfma_f32_32x32x16_bf16 v[96:111], v[160:163], v[128:131], v[96:111]
    v_exp_f32 v85, v85
    v_cvt_pk_bf16_f32 v137, v82, v83
    v_exp_f32 v86, v86
    v_exp_f32 v87, v87
    v_cvt_pk_bf16_f32 v138, v84, v85
    v_exp_f32 v88, v88
    v_exp_f32 v89, v89
    v_cvt_pk_bf16_f32 v139, v86, v87
    v_mfma_f32_32x32x16_bf16 v[96:111], v[164:167], v[132:135], v[96:111]
    v_exp_f32 v90, v90
    v_exp_f32 v91, v91
    v_cvt_pk_bf16_f32 v140, v88, v89
    v_exp_f32 v92, v92
    v_exp_f32 v93, v93
    v_cvt_pk_bf16_f32 v141, v90, v91
    v_exp_f32 v94, v94
    v_exp_f32 v95, v95
    v_cvt_pk_bf16_f32 v142, v92, v93
    v_cvt_pk_bf16_f32 v143, v94, v95
    s_setprio 3
    s_waitcnt lgkmcnt(0)
    v_mfma_f32_32x32x4_2b_bf16 v[64:95], v[158:159], v[152:153], 0
    v_exp_f32 v32, v32
    v_exp_f32 v33, v33
    v_exp_f32 v34, v34
    v_exp_f32 v35, v35
    v_cvt_pk_bf16_f32 v128, v32, v33
    v_exp_f32 v36, v36
    v_exp_f32 v37, v37
    v_cvt_pk_bf16_f32 v129, v34, v35
    v_exp_f32 v38, v38
    v_mfma_f32_32x32x16_bf16 v[112:127], v[160:163], v[136:139], v[112:127]
    v_exp_f32 v39, v39
    ds_read_b128 v[160:163], v18 offset:10240
    v_cvt_pk_bf16_f32 v130, v36, v37
    v_exp_f32 v40, v40
    v_exp_f32 v41, v41
    v_cvt_pk_bf16_f32 v131, v38, v39
    v_mfma_f32_32x32x16_bf16 v[112:127], v[164:167], v[140:143], v[112:127]
    v_exp_f32 v42, v42
    ds_read_b128 v[164:167], v20 offset:10240
    v_exp_f32 v43, v43
    v_cvt_pk_bf16_f32 v132, v40, v41
    v_exp_f32 v44, v44
    v_exp_f32 v45, v45
    v_mfma_f32_32x32x16_bf16 v[64:79], v[154:157], v[144:147], v[64:79]
    v_cvt_pk_bf16_f32 v133, v42, v43
    v_exp_f32 v46, v46
    v_exp_f32 v47, v47
    v_cvt_pk_bf16_f32 v134, v44, v45
    v_cvt_pk_bf16_f32 v135, v46, v47
    s_setprio 2
    v_mfma_f32_32x32x16_bf16 v[80:95], v[154:157], v[148:151], v[80:95]
    v_exp_f32 v48, v48
    ds_read_b64 v[158:159], v17 offset:15360
    v_exp_f32 v49, v49
    ds_read_b128 v[154:157], v16 offset:15360
    v_exp_f32 v50, v50
    v_exp_f32 v51, v51
    v_cvt_pk_bf16_f32 v136, v48, v49
    v_exp_f32 v52, v52
    s_waitcnt lgkmcnt(2)
    v_mfma_f32_32x32x16_bf16 v[96:111], v[160:163], v[128:131], v[96:111]
    v_exp_f32 v53, v53
    v_cvt_pk_bf16_f32 v137, v50, v51
    v_exp_f32 v54, v54
    v_exp_f32 v55, v55
    v_cvt_pk_bf16_f32 v138, v52, v53
    v_exp_f32 v56, v56
    v_exp_f32 v57, v57
    v_cvt_pk_bf16_f32 v139, v54, v55
    v_mfma_f32_32x32x16_bf16 v[96:111], v[164:167], v[132:135], v[96:111]
    v_exp_f32 v58, v58
    v_exp_f32 v59, v59
    v_cvt_pk_bf16_f32 v140, v56, v57
    v_exp_f32 v60, v60
    v_exp_f32 v61, v61
    v_cvt_pk_bf16_f32 v141, v58, v59
    v_exp_f32 v62, v62
    v_exp_f32 v63, v63
    v_cvt_pk_bf16_f32 v142, v60, v61
    v_cvt_pk_bf16_f32 v143, v62, v63
    s_setprio 1
    s_waitcnt lgkmcnt(0)
    v_mfma_f32_32x32x4_2b_bf16 v[32:63], v[158:159], v[152:153], 0
    v_exp_f32 v64, v64
    v_exp_f32 v65, v65
    v_exp_f32 v66, v66
    v_exp_f32 v67, v67
    v_cvt_pk_bf16_f32 v128, v64, v65
    v_exp_f32 v68, v68
    v_exp_f32 v69, v69
    v_cvt_pk_bf16_f32 v129, v66, v67
    v_exp_f32 v70, v70
    v_mfma_f32_32x32x16_bf16 v[112:127], v[160:163], v[136:139], v[112:127]
    v_exp_f32 v71, v71
    ds_read_b128 v[160:163], v18 offset:12800
    v_cvt_pk_bf16_f32 v130, v68, v69
    v_exp_f32 v72, v72
    v_exp_f32 v73, v73
    v_cvt_pk_bf16_f32 v131, v70, v71
    v_mfma_f32_32x32x16_bf16 v[112:127], v[164:167], v[140:143], v[112:127]
    v_exp_f32 v74, v74
    ds_read_b128 v[164:167], v20 offset:12800
    v_exp_f32 v75, v75
    v_cvt_pk_bf16_f32 v132, v72, v73
    v_exp_f32 v76, v76
    v_exp_f32 v77, v77
    v_mfma_f32_32x32x16_bf16 v[32:47], v[154:157], v[144:147], v[32:47]
    v_cvt_pk_bf16_f32 v133, v74, v75
    v_exp_f32 v78, v78
    v_exp_f32 v79, v79
    v_cvt_pk_bf16_f32 v134, v76, v77
    v_cvt_pk_bf16_f32 v135, v78, v79
    s_setprio 0
    v_mfma_f32_32x32x16_bf16 v[48:63], v[154:157], v[148:151], v[48:63]
    v_exp_f32 v80, v80
    ds_read_b64 v[158:159], v17 offset:17920
    v_exp_f32 v81, v81
    ds_read_b128 v[154:157], v16 offset:17920
    v_exp_f32 v82, v82
    v_exp_f32 v83, v83
    v_cvt_pk_bf16_f32 v136, v80, v81
    v_exp_f32 v84, v84
    s_waitcnt lgkmcnt(2)
    v_mfma_f32_32x32x16_bf16 v[96:111], v[160:163], v[128:131], v[96:111]
    v_exp_f32 v85, v85
    v_cvt_pk_bf16_f32 v137, v82, v83
    v_exp_f32 v86, v86
    v_exp_f32 v87, v87
    v_cvt_pk_bf16_f32 v138, v84, v85
    v_exp_f32 v88, v88
    v_exp_f32 v89, v89
    v_cvt_pk_bf16_f32 v139, v86, v87
    v_mfma_f32_32x32x16_bf16 v[96:111], v[164:167], v[132:135], v[96:111]
    v_exp_f32 v90, v90
    v_exp_f32 v91, v91
    v_cvt_pk_bf16_f32 v140, v88, v89
    v_exp_f32 v92, v92
    v_exp_f32 v93, v93
    v_cvt_pk_bf16_f32 v141, v90, v91
    v_exp_f32 v94, v94
    v_exp_f32 v95, v95
    v_cvt_pk_bf16_f32 v142, v92, v93
    v_cvt_pk_bf16_f32 v143, v94, v95
    s_setprio 3
    s_waitcnt lgkmcnt(0)
    v_mfma_f32_32x32x4_2b_bf16 v[64:95], v[158:159], v[152:153], 0
    v_exp_f32 v32, v32
    v_exp_f32 v33, v33
    v_exp_f32 v34, v34
    v_exp_f32 v35, v35
    v_cvt_pk_bf16_f32 v128, v32, v33
    v_exp_f32 v36, v36
    v_exp_f32 v37, v37
    v_cvt_pk_bf16_f32 v129, v34, v35
    v_exp_f32 v38, v38
    v_mfma_f32_32x32x16_bf16 v[112:127], v[160:163], v[136:139], v[112:127]
    v_exp_f32 v39, v39
    ds_read_b128 v[160:163], v18 offset:15360
    v_cvt_pk_bf16_f32 v130, v36, v37
    v_exp_f32 v40, v40
    v_exp_f32 v41, v41
    v_cvt_pk_bf16_f32 v131, v38, v39
    v_mfma_f32_32x32x16_bf16 v[112:127], v[164:167], v[140:143], v[112:127]
    v_exp_f32 v42, v42
    ds_read_b128 v[164:167], v20 offset:15360
    v_exp_f32 v43, v43
    v_cvt_pk_bf16_f32 v132, v40, v41
    v_exp_f32 v44, v44
    v_exp_f32 v45, v45
    v_mfma_f32_32x32x16_bf16 v[64:79], v[154:157], v[144:147], v[64:79]
    v_cvt_pk_bf16_f32 v133, v42, v43
    v_exp_f32 v46, v46
    v_exp_f32 v47, v47
    v_cvt_pk_bf16_f32 v134, v44, v45
    v_cvt_pk_bf16_f32 v135, v46, v47
    s_setprio 2
    v_mfma_f32_32x32x16_bf16 v[80:95], v[154:157], v[148:151], v[80:95]
    v_exp_f32 v48, v48
    s_waitcnt vmcnt(5)
    s_barrier
    ds_read_b64 v[158:159], v17 offset:40960
    v_exp_f32 v49, v49
    ds_read_b128 v[154:157], v16 offset:40960
    v_exp_f32 v50, v50
    v_exp_f32 v51, v51
    v_cvt_pk_bf16_f32 v136, v48, v49
    v_exp_f32 v52, v52
    s_waitcnt lgkmcnt(2)
    v_mfma_f32_32x32x16_bf16 v[96:111], v[160:163], v[128:131], v[96:111]
    v_exp_f32 v53, v53
    v_cvt_pk_bf16_f32 v137, v50, v51
    v_exp_f32 v54, v54
    v_exp_f32 v55, v55
    v_cvt_pk_bf16_f32 v138, v52, v53
    v_exp_f32 v56, v56
    v_exp_f32 v57, v57
    v_cvt_pk_bf16_f32 v139, v54, v55
    v_mfma_f32_32x32x16_bf16 v[96:111], v[164:167], v[132:135], v[96:111]
    v_exp_f32 v58, v58
    v_exp_f32 v59, v59
    v_cvt_pk_bf16_f32 v140, v56, v57
    v_exp_f32 v60, v60
    v_exp_f32 v61, v61
    v_cvt_pk_bf16_f32 v141, v58, v59
    v_exp_f32 v62, v62
    v_exp_f32 v63, v63
    v_cvt_pk_bf16_f32 v142, v60, v61
    v_cvt_pk_bf16_f32 v143, v62, v63
    s_setprio 1
    s_waitcnt lgkmcnt(0)
    v_mfma_f32_32x32x4_2b_bf16 v[32:63], v[158:159], v[152:153], 0
    v_exp_f32 v64, v64
    v_exp_f32 v65, v65
    s_add_u32 s95, s6, s94
    s_add_u32 s95, s95, 122880
    s_add_u32 m0, s94, 40960
    s_nop 0
    buffer_load_dwordx4 v19, s[52:55], s95 offen sc1 lds
    v_exp_f32 v66, v66
    v_exp_f32 v67, v67
    v_cvt_pk_bf16_f32 v128, v64, v65
    v_exp_f32 v68, v68
    v_exp_f32 v69, v69
    v_cvt_pk_bf16_f32 v129, v66, v67
    v_exp_f32 v70, v70
    v_mfma_f32_32x32x16_bf16 v[112:127], v[160:163], v[136:139], v[112:127]
    v_exp_f32 v71, v71
    ds_read_b128 v[160:163], v18 offset:17920
    v_cvt_pk_bf16_f32 v130, v68, v69
    v_exp_f32 v72, v72
    v_exp_f32 v73, v73
    v_cvt_pk_bf16_f32 v131, v70, v71
    v_mfma_f32_32x32x16_bf16 v[112:127], v[164:167], v[140:143], v[112:127]
    v_exp_f32 v74, v74
    ds_read_b128 v[164:167], v20 offset:17920
    v_exp_f32 v75, v75
    s_add_u32 s95, s95, 8192
    s_add_u32 m0, s94, 49152
    s_nop 0
    buffer_load_dwordx4 v19, s[52:55], s95 offen sc1 lds
    v_cvt_pk_bf16_f32 v132, v72, v73
    v_exp_f32 v76, v76
    v_exp_f32 v77, v77
    v_mfma_f32_32x32x16_bf16 v[32:47], v[154:157], v[144:147], v[32:47]
    v_cvt_pk_bf16_f32 v133, v74, v75
    v_exp_f32 v78, v78
    v_exp_f32 v79, v79
    v_cvt_pk_bf16_f32 v134, v76, v77
    v_cvt_pk_bf16_f32 v135, v78, v79
    s_setprio 0
    v_mfma_f32_32x32x16_bf16 v[48:63], v[154:157], v[148:151], v[48:63]
    v_exp_f32 v80, v80
    s_cmp_lg_u32 s68, 0
    s_cbranch_scc1 L_h5
    buffer_load_dword v14, v15, s[52:55], 0 offen sc1
L_h5:
    ds_read_b64 v[158:159], v17 offset:43520
    v_exp_f32 v81, v81
    ds_read_b128 v[154:157], v16 offset:43520
    v_exp_f32 v82, v82
    v_exp_f32 v83, v83
    v_cvt_pk_bf16_f32 v136, v80, v81
    v_exp_f32 v84, v84
    s_add_u32 s95, s95, 8192
    s_add_u32 m0, s94, 57344
    s_nop 0
    buffer_load_dwordx4 v19, s[52:55], s95 offen sc1 lds
    s_waitcnt lgkmcnt(2)
    v_mfma_f32_32x32x16_bf16 v[96:111], v[160:163], v[128:131], v[96:111]
    v_exp_f32 v85, v85
    v_cvt_pk_bf16_f32 v137, v82, v83
    v_exp_f32 v86, v86
    v_exp_f32 v87, v87
    v_cvt_pk_bf16_f32 v138, v84, v85
    v_exp_f32 v88, v88
    v_exp_f32 v89, v89
    v_cvt_pk_bf16_f32 v139, v86, v87
    v_mfma_f32_32x32x16_bf16 v[96:111], v[164:167], v[132:135], v[96:111]
    v_exp_f32 v90, v90
    v_exp_f32 v91, v91
    v_cvt_pk_bf16_f32 v140, v88, v89
    v_exp_f32 v92, v92
    v_exp_f32 v93, v93
    v_cvt_pk_bf16_f32 v141, v90, v91
    v_exp_f32 v94, v94
    v_exp_f32 v95, v95
    v_cvt_pk_bf16_f32 v142, v92, v93
    v_cvt_pk_bf16_f32 v143, v94, v95
    s_setprio 3
    s_waitcnt lgkmcnt(0)
    v_mfma_f32_32x32x4_2b_bf16 v[64:95], v[158:159], v[152:153], 0
    v_exp_f32 v32, v32
    v_exp_f32 v33, v33
    s_add_u32 s95, s95, 8192
    s_add_u32 m0, s94, 65536
    s_nop 0
    buffer_load_dwordx4 v19, s[52:55], s95 offen sc1 lds
    v_exp_f32 v34, v34
    v_exp_f32 v35, v35
    v_cvt_pk_bf16_f32 v128, v32, v33
    v_exp_f32 v36, v36
    v_exp_f32 v37, v37
    v_cvt_pk_bf16_f32 v129, v34, v35
    v_exp_f32 v38, v38
    v_mfma_f32_32x32x16_bf16 v[112:127], v[160:163], v[136:139], v[112:127]
    v_exp_f32 v39, v39
    ds_read_b128 v[160:163], v18 offset:40960
    v_cvt_pk_bf16_f32 v130, v36, v37
    v_exp_f32 v40, v40
    v_exp_f32 v41, v41
    v_cvt_pk_bf16_f32 v131, v38, v39
    v_mfma_f32_32x32x16_bf16 v[112:127], v[164:167], v[140:143], v[112:127]
    v_exp_f32 v42, v42
    ds_read_b128 v[164:167], v20 offset:40960
    v_exp_f32 v43, v43
    s_add_u32 s95, s95, 8192
    s_add_u32 m0, s94, 73728
    s_nop 0
    buffer_load_dwordx4 v19, s[52:55], s95 offen sc1 lds
    v_cvt_pk_bf16_f32 v132, v40, v41
    v_exp_f32 v44, v44
    v_exp_f32 v45, v45
    v_mfma_f32_32x32x16_bf16 v[64:79], v[154:157], v[144:147], v[64:79]
    v_cvt_pk_bf16_f32 v133, v42, v43
    v_exp_f32 v46, v46
    v_exp_f32 v47, v47
    v_cvt_pk_bf16_f32 v134, v44, v45
    v_cvt_pk_bf16_f32 v135, v46, v47
    s_setprio 2
    v_mfma_f32_32x32x16_bf16 v[80:95], v[154:157], v[148:151], v[80:95]
    v_exp_f32 v48, v48
    ds_read_b64 v[158:159], v17 offset:46080
    v_exp_f32 v49, v49
    ds_read_b128 v[154:157], v16 offset:46080
    v_exp_f32 v50, v50
    v_exp_f32 v51, v51
    v_cvt_pk_bf16_f32 v136, v48, v49
    v_exp_f32 v52, v52
    s_waitcnt lgkmcnt(2)
    v_mfma_f32_32x32x16_bf16 v[96:111], v[160:163], v[128:131], v[96:111]
    v_exp_f32 v53, v53
    v_cvt_pk_bf16_f32 v137, v50, v51
    v_exp_f32 v54, v54
    v_exp_f32 v55, v55
    v_cvt_pk_bf16_f32 v138, v52, v53
    v_exp_f32 v56, v56
    v_exp_f32 v57, v57
    v_cvt_pk_bf16_f32 v139, v54, v55
    v_mfma_f32_32x32x16_bf16 v[96:111], v[164:167], v[132:135], v[96:111]
    v_exp_f32 v58, v58
    v_exp_f32 v59, v59
    v_cvt_pk_bf16_f32 v140, v56, v57
    v_exp_f32 v60, v60
    v_exp_f32 v61, v61
    v_cvt_pk_bf16_f32 v141, v58, v59
    v_exp_f32 v62, v62
    v_exp_f32 v63, v63
    v_cvt_pk_bf16_f32 v142, v60, v61
    v_cvt_pk_bf16_f32 v143, v62, v63
    s_cmp_lg_u32 s68, 0
    s_cbranch_scc1 L_b2b
    s_waitcnt vmcnt(3)
    v_cmp_ne_u32 vcc, s67, v14
    s_nop 4
    s_cbranch_vccnz Lslow_48
Lok_49:
    s_lshl_b32 s72, s39, 1
    s_add_u32 s72, s72, s3
    s_lshl_b32 s72, s72, 12
    s_add_u32 s72, s72, 14954496
    s_add_u32 s56, s36, s72
    s_addc_u32 s57, s37, 0
    s_mov_b32 s58, 4096
    s_mov_b32 s59, 0x20000
    s_sub_u32 s72, s38, 16
    s_mul_i32 s72, s72, 256
    v_lshl_add_u32 v4, v3, 6, v2
    v_mul_u32_u24 v4, 16, v4
    v_add_u32 v4, s72, v4
    buffer_load_dwordx4 v[208:211], v4, s[56:59], 0 offen sc1
    v_add_u32 v4, 256, v4
    buffer_load_dwordx4 v[224:227], v4, s[56:59], 0 offen sc1
    v_add_u32 v4, 256, v4
    buffer_load_dwordx4 v[240:243], v4, s[56:59], 0 offen sc1
    v_add_u32 v4, 256, v4
    buffer_load_dwordx4 v[8:11], v4, s[56:59], 0 offen sc1
L_b2b:
    s_setprio 1
    s_waitcnt lgkmcnt(0)
    v_mfma_f32_32x32x4_2b_bf16 v[32:63], v[158:159], v[152:153], 0
    v_exp_f32 v64, v64
    v_exp_f32 v65, v65
    v_exp_f32 v66, v66
    v_exp_f32 v67, v67
    v_cvt_pk_bf16_f32 v128, v64, v65
    v_exp_f32 v68, v68
    v_exp_f32 v69, v69
    v_cvt_pk_bf16_f32 v129, v66, v67
    v_exp_f32 v70, v70
    v_mfma_f32_32x32x16_bf16 v[112:127], v[160:163], v[136:139], v[112:127]
    v_exp_f32 v71, v71
    ds_read_b128 v[160:163], v18 offset:43520
    v_cvt_pk_bf16_f32 v130, v68, v69
    v_exp_f32 v72, v72
    v_exp_f32 v73, v73
    v_cvt_pk_bf16_f32 v131, v70, v71
    v_mfma_f32_32x32x16_bf16 v[112:127], v[164:167], v[140:143], v[112:127]
    v_exp_f32 v74, v74
    ds_read_b128 v[164:167], v20 offset:43520
    v_exp_f32 v75, v75
    v_cvt_pk_bf16_f32 v132, v72, v73
    v_exp_f32 v76, v76
    v_exp_f32 v77, v77
    v_mfma_f32_32x32x16_bf16 v[32:47], v[154:157], v[144:147], v[32:47]
    v_cvt_pk_bf16_f32 v133, v74, v75
    v_exp_f32 v78, v78
    v_exp_f32 v79, v79
    v_cvt_pk_bf16_f32 v134, v76, v77
    v_cvt_pk_bf16_f32 v135, v78, v79
    s_setprio 0
    v_mfma_f32_32x32x16_bf16 v[48:63], v[154:157], v[148:151], v[48:63]
    v_exp_f32 v80, v80
    ds_read_b64 v[158:159], v17 offset:48640
    v_exp_f32 v81, v81
    ds_read_b128 v[154:157], v16 offset:48640
    v_exp_f32 v82, v82
    v_exp_f32 v83, v83
    v_cvt_pk_bf16_f32 v136, v80, v81
    v_exp_f32 v84, v84
    s_waitcnt lgkmcnt(2)
    v_mfma_f32_32x32x16_bf16 v[96:111], v[160:163], v[128:131], v[96:111]
    v_exp_f32 v85, v85
    v_cvt_pk_bf16_f32 v137, v82, v83
    v_exp_f32 v86, v86
    v_exp_f32 v87, v87
    v_cvt_pk_bf16_f32 v138, v84, v85
    v_exp_f32 v88, v88
    v_exp_f32 v89, v89
    v_cvt_pk_bf16_f32 v139, v86, v87
    v_mfma_f32_32x32x16_bf16 v[96:111], v[164:167], v[132:135], v[96:111]
    v_exp_f32 v90, v90
    v_exp_f32 v91, v91
    v_cvt_pk_bf16_f32 v140, v88, v89
    v_exp_f32 v92, v92
    v_exp_f32 v93, v93
    v_cvt_pk_bf16_f32 v141, v90, v91
    v_exp_f32 v94, v94
    v_exp_f32 v95, v95
    v_cvt_pk_bf16_f32 v142, v92, v93
    v_cvt_pk_bf16_f32 v143, v94, v95
    s_setprio 3
    s_waitcnt lgkmcnt(0)
    v_mfma_f32_32x32x4_2b_bf16 v[64:95], v[158:159], v[152:153], 0
    v_exp_f32 v32, v32
    v_exp_f32 v33, v33
    v_exp_f32 v34, v34
    v_exp_f32 v35, v35
    v_cvt_pk_bf16_f32 v128, v32, v33
    v_exp_f32 v36, v36
    v_exp_f32 v37, v37
    v_cvt_pk_bf16_f32 v129, v34, v35
    v_exp_f32 v38, v38
    v_mfma_f32_32x32x16_bf16 v[112:127], v[160:163], v[136:139], v[112:127]
    v_exp_f32 v39, v39
    ds_read_b128 v[160:163], v18 offset:46080
    v_cvt_pk_bf16_f32 v130, v36, v37
    v_exp_f32 v40, v40
    v_exp_f32 v41, v41
    v_cvt_pk_bf16_f32 v131, v38, v39
    v_mfma_f32_32x32x16_bf16 v[112:127], v[164:167], v[140:143], v[112:127]
    v_exp_f32 v42, v42
    ds_read_b128 v[164:167], v20 offset:46080
    v_exp_f32 v43, v43
    v_cvt_pk_bf16_f32 v132, v40, v41
    v_exp_f32 v44, v44
    v_exp_f32 v45, v45
    v_mfma_f32_32x32x16_bf16 v[64:79], v[154:157], v[144:147], v[64:79]
    v_cvt_pk_bf16_f32 v133, v42, v43
    v_exp_f32 v46, v46
    v_exp_f32 v47, v47
    v_cvt_pk_bf16_f32 v134, v44, v45
    v_cvt_pk_bf16_f32 v135, v46, v47
    s_setprio 2
    v_mfma_f32_32x32x16_bf16 v[80:95], v[154:157], v[148:151], v[80:95]
    v_exp_f32 v48, v48
    ds_read_b64 v[158:159], v17 offset:51200
    v_exp_f32 v49, v49
    ds_read_b128 v[154:157], v16 offset:51200
    v_exp_f32 v50, v50
    v_exp_f32 v51, v51
    v_cvt_pk_bf16_f32 v136, v48, v49
    v_exp_f32 v52, v52
    s_waitcnt lgkmcnt(2)
    v_mfma_f32_32x32x16_bf16 v[96:111], v[160:163], v[128:131], v[96:111]
    v_exp_f32 v53, v53
    v_cvt_pk_bf16_f32 v137, v50, v51
    v_exp_f32 v54, v54
    v_exp_f32 v55, v55
    v_cvt_pk_bf16_f32 v138, v52, v53
    v_exp_f32 v56, v56
    v_exp_f32 v57, v57
    v_cvt_pk_bf16_f32 v139, v54, v55
    v_mfma_f32_32x32x16_bf16 v[96:111], v[164:167], v[132:135], v[96:111]
    v_exp_f32 v58, v58
    v_exp_f32 v59, v59
    v_cvt_pk_bf16_f32 v140, v56, v57
    v_exp_f32 v60, v60
    v_exp_f32 v61, v61
    v_cvt_pk_bf16_f32 v141, v58, v59
    v_exp_f32 v62, v62
    v_exp_f32 v63, v63
    v_cvt_pk_bf16_f32 v142, v60, v61
    v_cvt_pk_bf16_f32 v143, v62, v63
    s_setprio 3
    s_cmp_lg_u32 s68, 0
    s_cbranch_scc1 L_b2c
    s_cmp_ge_u32 s2, 192
    s_cbranch_scc1 L_b2cP
    s_waitcnt vmcnt(0)
    v_fmac_f32 v224, v200, v208
    v_fmac_f32 v225, v216, v209
    s_nop 0
    v_fmac_f32_dpp v224, v208, v201 row_ror:8 row_mask:0xf bank_mask:0xf
    v_fmac_f32_dpp v225, v209, v217 row_ror:8 row_mask:0xf bank_mask:0xf
    v_fmac_f32 v240, v200, v224
    v_fmac_f32 v241, v216, v225
    s_nop 0
    v_fmac_f32_dpp v240, v224, v201 row_ror:8 row_mask:0xf bank_mask:0xf
    v_fmac_f32_dpp v241, v225, v217 row_ror:8 row_mask:0xf bank_mask:0xf
    v_fmac_f32 v8, v200, v240
    v_fmac_f32 v9, v216, v241
    s_nop 0
    v_fmac_f32_dpp v8, v240, v201 row_ror:8 row_mask:0xf bank_mask:0xf
    v_fmac_f32_dpp v9, v241, v217 row_ror:8 row_mask:0xf bank_mask:0xf
    v_mov_b32 v208, v8
    v_mov_b32 v209, v9
    s_nop 0
    v_permlane16_swap_b32 v208, v8
    v_permlane16_swap_b32 v209, v9
    v_fmac_f32 v8, v202, v208
    v_fmac_f32 v9, v218, v209
    s_nop 0
    v_fmac_f32_dpp v8, v208, v203 row_ror:8 row_mask:0xf bank_mask:0xf
    v_fmac_f32_dpp v9, v209, v219 row_ror:8 row_mask:0xf bank_mask:0xf
    v_mov_b32 v208, v8
    v_mov_b32 v209, v9
    s_nop 0
    v_permlane32_swap_b32 v208, v8
    v_permlane32_swap_b32 v209, v9
    v_fmac_f32 v8, v204, v208
    v_fmac_f32 v9, v220, v209
    s_nop 0
    v_fmac_f32_dpp v8, v208, v205 row_ror:8 row_mask:0xf bank_mask:0xf
    v_fmac_f32_dpp v9, v209, v221 row_ror:8 row_mask:0xf bank_mask:0xf
    v_fmac_f32 v192, v244, v8
    v_fmac_f32 v193, v246, v9
    s_nop 0
    v_fmac_f32_dpp v192, v8, v245 row_ror:8 row_mask:0xf bank_mask:0xf
    v_fmac_f32_dpp v193, v9, v247 row_ror:8 row_mask:0xf bank_mask:0xf
    s_lshl_b32 s72, s38, 1
    s_lshr_b32 s73, s71, 1
    s_add_u32 s72, s72, s73
    s_mul_i32 s72, s72, 147584
    s_mul_i32 s73, s3, 16
    s_add_u32 s73, s73, s97
    s_lshl_b32 s73, s73, 4
    s_add_u32 s72, s72, s73
    s_mul_i32 s73, s70, 73728
    s_add_u32 s72, s72, s73
    s_add_u32 s72, s72, 7872512
    v_lshrrev_b32 v4, 3, v1
    v_mul_u32_u24 v4, 9216, v4
    v_and_b32 v5, 7, v2
    v_lshl_add_u32 v4, v5, 4, v4
    v_fmac_f32 v168, v196, v192
    v_fmac_f32 v176, v212, v193
    s_nop 0
    v_fmac_f32_dpp v168, v192, v197 row_ror:8 row_mask:0xf bank_mask:0xf
    v_fmac_f32_dpp v176, v193, v213 row_ror:8 row_mask:0xf bank_mask:0xf
    v_fmac_f32 v169, v196, v168
    v_fmac_f32 v177, v212, v176
    s_nop 0
    v_fmac_f32_dpp v169, v168, v197 row_ror:8 row_mask:0xf bank_mask:0xf
    v_fmac_f32_dpp v177, v176, v213 row_ror:8 row_mask:0xf bank_mask:0xf
    v_fmac_f32 v170, v196, v169
    v_fmac_f32 v178, v212, v177
    s_nop 0
    v_fmac_f32_dpp v170, v169, v197 row_ror:8 row_mask:0xf bank_mask:0xf
    v_fmac_f32_dpp v178, v177, v213 row_ror:8 row_mask:0xf bank_mask:0xf
    v_fmac_f32 v171, v196, v170
    v_fmac_f32 v179, v212, v178
    s_nop 0
    v_fmac_f32_dpp v171, v170, v197 row_ror:8 row_mask:0xf bank_mask:0xf
    v_fmac_f32_dpp v179, v178, v213 row_ror:8 row_mask:0xf bank_mask:0xf
    v_fmac_f32 v172, v196, v171
    v_fmac_f32 v180, v212, v179
    s_nop 0
    v_fmac_f32_dpp v172, v171, v197 row_ror:8 row_mask:0xf bank_mask:0xf
    v_fmac_f32_dpp v180, v179, v213 row_ror:8 row_mask:0xf bank_mask:0xf
    v_fmac_f32 v173, v196, v172
    v_fmac_f32 v181, v212, v180
    s_nop 0
    v_fmac_f32_dpp v173, v172, v197 row_ror:8 row_mask:0xf bank_mask:0xf
    v_fmac_f32_dpp v181, v180, v213 row_ror:8 row_mask:0xf bank_mask:0xf
    v_fmac_f32 v174, v196, v173
    v_fmac_f32 v182, v212, v181
    s_nop 0
    v_fmac_f32_dpp v174, v173, v197 row_ror:8 row_mask:0xf bank_mask:0xf
    v_fmac_f32_dpp v182, v181, v213 row_ror:8 row_mask:0xf bank_mask:0xf
    v_fmac_f32 v175, v196, v174
    v_fmac_f32 v183, v212, v182
    s_nop 0
    v_fmac_f32_dpp v175, v174, v197 row_ror:8 row_mask:0xf bank_mask:0xf
    v_fmac_f32_dpp v183, v182, v213 row_ror:8 row_mask:0xf bank_mask:0xf
    v_mul_f32 v208, v198, v168
    v_mul_f32 v209, v198, v169
    v_mul_f32 v210, v198, v170
    v_mul_f32 v211, v198, v171
    v_mul_f32 v224, v198, v172
    v_mul_f32 v225, v198, v173
    v_mul_f32 v226, v198, v174
    v_mul_f32 v227, v198, v175
    v_fmac_f32_dpp v208, v168, v199 row_ror:8 row_mask:0xf bank_mask:0xf
    v_fmac_f32_dpp v209, v169, v199 row_ror:8 row_mask:0xf bank_mask:0xf
    v_fmac_f32_dpp v210, v170, v199 row_ror:8 row_mask:0xf bank_mask:0xf
    v_fmac_f32_dpp v211, v171, v199 row_ror:8 row_mask:0xf bank_mask:0xf
    v_fmac_f32_dpp v224, v172, v199 row_ror:8 row_mask:0xf bank_mask:0xf
    v_fmac_f32_dpp v225, v173, v199 row_ror:8 row_mask:0xf bank_mask:0xf
    v_fmac_f32_dpp v226, v174, v199 row_ror:8 row_mask:0xf bank_mask:0xf
    v_fmac_f32_dpp v227, v175, v199 row_ror:8 row_mask:0xf bank_mask:0xf
    v_cvt_pk_bf16_f32 v168, v208, v209
    v_cvt_pk_bf16_f32 v169, v210, v211
    v_cvt_pk_bf16_f32 v170, v224, v225
    v_cvt_pk_bf16_f32 v171, v226, v227
    buffer_store_dwordx4 v[168:171], v4, s[52:55], s72 offen offset:0 sc1
    v_mul_f32 v240, v214, v176
    v_mul_f32 v241, v214, v177
    v_mul_f32 v242, v214, v178
    v_mul_f32 v243, v214, v179
    v_mul_f32 v8, v214, v180
    v_mul_f32 v9, v214, v181
    v_mul_f32 v10, v214, v182
    v_mul_f32 v11, v214, v183
    v_fmac_f32_dpp v240, v176, v215 row_ror:8 row_mask:0xf bank_mask:0xf
    v_fmac_f32_dpp v241, v177, v215 row_ror:8 row_mask:0xf bank_mask:0xf
    v_fmac_f32_dpp v242, v178, v215 row_ror:8 row_mask:0xf bank_mask:0xf
    v_fmac_f32_dpp v243, v179, v215 row_ror:8 row_mask:0xf bank_mask:0xf
    v_fmac_f32_dpp v8, v180, v215 row_ror:8 row_mask:0xf bank_mask:0xf
    v_fmac_f32_dpp v9, v181, v215 row_ror:8 row_mask:0xf bank_mask:0xf
    v_fmac_f32_dpp v10, v182, v215 row_ror:8 row_mask:0xf bank_mask:0xf
    v_fmac_f32_dpp v11, v183, v215 row_ror:8 row_mask:0xf bank_mask:0xf
    v_cvt_pk_bf16_f32 v176, v240, v241
    v_cvt_pk_bf16_f32 v177, v242, v243
    v_cvt_pk_bf16_f32 v178, v8, v9
    v_cvt_pk_bf16_f32 v179, v10, v11
    buffer_store_dwordx4 v[176:179], v4, s[52:55], s72 offen offset:128 sc1
    s_branch L_b2c
L_b2cP:
    s_waitcnt vmcnt(0)
    v_fmac_f32 v224, v200, v208
    v_fmac_f32 v225, v216, v209
    v_fmac_f32 v226, v232, v210
    v_fmac_f32_dpp v224, v208, v201 row_ror:8 row_mask:0xf bank_mask:0xf
    v_fmac_f32_dpp v225, v209, v217 row_ror:8 row_mask:0xf bank_mask:0xf
    v_fmac_f32_dpp v226, v210, v233 row_ror:8 row_mask:0xf bank_mask:0xf
    v_fmac_f32 v240, v200, v224
    v_fmac_f32 v241, v216, v225
    v_fmac_f32 v242, v232, v226
    v_fmac_f32_dpp v240, v224, v201 row_ror:8 row_mask:0xf bank_mask:0xf
    v_fmac_f32_dpp v241, v225, v217 row_ror:8 row_mask:0xf bank_mask:0xf
    v_fmac_f32_dpp v242, v226, v233 row_ror:8 row_mask:0xf bank_mask:0xf
    v_fmac_f32 v8, v200, v240
    v_fmac_f32 v9, v216, v241
    v_fmac_f32 v10, v232, v242
    v_fmac_f32_dpp v8, v240, v201 row_ror:8 row_mask:0xf bank_mask:0xf
    v_fmac_f32_dpp v9, v241, v217 row_ror:8 row_mask:0xf bank_mask:0xf
    v_fmac_f32_dpp v10, v242, v233 row_ror:8 row_mask:0xf bank_mask:0xf
    v_mov_b32 v208, v8
    v_mov_b32 v209, v9
    v_mov_b32 v210, v10
    v_permlane16_swap_b32 v208, v8
    v_permlane16_swap_b32 v209, v9
    v_permlane16_swap_b32 v210, v10
    v_fmac_f32 v8, v202, v208
    v_fmac_f32 v9, v218, v209
    v_fmac_f32 v10, v234, v210
    v_fmac_f32_dpp v8, v208, v203 row_ror:8 row_mask:0xf bank_mask:0xf
    v_fmac_f32_dpp v9, v209, v219 row_ror:8 row_mask:0xf bank_mask:0xf
    v_fmac_f32_dpp v10, v210, v235 row_ror:8 row_mask:0xf bank_mask:0xf
    v_mov_b32 v208, v8
    v_mov_b32 v209, v9
    v_mov_b32 v210, v10
    v_permlane32_swap_b32 v208, v8
    v_permlane32_swap_b32 v209, v9
    v_permlane32_swap_b32 v210, v10
    v_fmac_f32 v8, v204, v208
    v_fmac_f32 v9, v220, v209
    v_fmac_f32 v10, v236, v210
    v_fmac_f32_dpp v8, v208, v205 row_ror:8 row_mask:0xf bank_mask:0xf
    v_fmac_f32_dpp v9, v209, v221 row_ror:8 row_mask:0xf bank_mask:0xf
    v_fmac_f32_dpp v10, v210, v237 row_ror:8 row_mask:0xf bank_mask:0xf
    v_fmac_f32 v192, v244, v8
    v_fmac_f32 v193, v246, v9
    v_fmac_f32 v194, v248, v10
    v_fmac_f32_dpp v192, v8, v245 row_ror:8 row_mask:0xf bank_mask:0xf
    v_fmac_f32_dpp v193, v9, v247 row_ror:8 row_mask:0xf bank_mask:0xf
    v_fmac_f32_dpp v194, v10, v249 row_ror:8 row_mask:0xf bank_mask:0xf
    s_lshl_b32 s72, s38, 1
    s_lshr_b32 s73, s71, 1
    s_add_u32 s72, s72, s73
    s_mul_i32 s72, s72, 147584
    s_mul_i32 s73, s3, 24
    s_add_u32 s73, s73, s97
    s_lshl_b32 s73, s73, 4
    s_add_u32 s72, s72, s73
    s_mul_i32 s73, s70, 73728
    s_add_u32 s72, s72, s73
    s_add_u32 s72, s72, 7872512
    v_lshrrev_b32 v4, 3, v1
    v_mul_u32_u24 v4, 9216, v4
    v_and_b32 v5, 7, v2
    v_lshl_add_u32 v4, v5, 4, v4
    v_fmac_f32 v168, v196, v192
    v_fmac_f32 v176, v212, v193
    v_fmac_f32 v184, v228, v194
    v_fmac_f32_dpp v168, v192, v197 row_ror:8 row_mask:0xf bank_mask:0xf
    v_fmac_f32_dpp v176, v193, v213 row_ror:8 row_mask:0xf bank_mask:0xf
    v_fmac_f32_dpp v184, v194, v229 row_ror:8 row_mask:0xf bank_mask:0xf
    v_fmac_f32 v169, v196, v168
    v_fmac_f32 v177, v212, v176
    v_fmac_f32 v185, v228, v184
    v_fmac_f32_dpp v169, v168, v197 row_ror:8 row_mask:0xf bank_mask:0xf
    v_fmac_f32_dpp v177, v176, v213 row_ror:8 row_mask:0xf bank_mask:0xf
    v_fmac_f32_dpp v185, v184, v229 row_ror:8 row_mask:0xf bank_mask:0xf
    v_fmac_f32 v170, v196, v169
    v_fmac_f32 v178, v212, v177
    v_fmac_f32 v186, v228, v185
    v_fmac_f32_dpp v170, v169, v197 row_ror:8 row_mask:0xf bank_mask:0xf
    v_fmac_f32_dpp v178, v177, v213 row_ror:8 row_mask:0xf bank_mask:0xf
    v_fmac_f32_dpp v186, v185, v229 row_ror:8 row_mask:0xf bank_mask:0xf
    v_fmac_f32 v171, v196, v170
    v_fmac_f32 v179, v212, v178
    v_fmac_f32 v187, v228, v186
    v_fmac_f32_dpp v171, v170, v197 row_ror:8 row_mask:0xf bank_mask:0xf
    v_fmac_f32_dpp v179, v178, v213 row_ror:8 row_mask:0xf bank_mask:0xf
    v_fmac_f32_dpp v187, v186, v229 row_ror:8 row_mask:0xf bank_mask:0xf
    v_fmac_f32 v172, v196, v171
    v_fmac_f32 v180, v212, v179
    v_fmac_f32 v188, v228, v187
    v_fmac_f32_dpp v172, v171, v197 row_ror:8 row_mask:0xf bank_mask:0xf
    v_fmac_f32_dpp v180, v179, v213 row_ror:8 row_mask:0xf bank_mask:0xf
    v_fmac_f32_dpp v188, v187, v229 row_ror:8 row_mask:0xf bank_mask:0xf
    v_fmac_f32 v173, v196, v172
    v_fmac_f32 v181, v212, v180
    v_fmac_f32 v189, v228, v188
    v_fmac_f32_dpp v173, v172, v197 row_ror:8 row_mask:0xf bank_mask:0xf
    v_fmac_f32_dpp v181, v180, v213 row_ror:8 row_mask:0xf bank_mask:0xf
    v_fmac_f32_dpp v189, v188, v229 row_ror:8 row_mask:0xf bank_mask:0xf
    v_fmac_f32 v174, v196, v173
    v_fmac_f32 v182, v212, v181
    v_fmac_f32 v190, v228, v189
    v_fmac_f32_dpp v174, v173, v197 row_ror:8 row_mask:0xf bank_mask:0xf
    v_fmac_f32_dpp v182, v181, v213 row_ror:8 row_mask:0xf bank_mask:0xf
    v_fmac_f32_dpp v190, v189, v229 row_ror:8 row_mask:0xf bank_mask:0xf
    v_fmac_f32 v175, v196, v174
    v_fmac_f32 v183, v212, v182
    v_fmac_f32 v191, v228, v190
    v_fmac_f32_dpp v175, v174, v197 row_ror:8 row_mask:0xf bank_mask:0xf
    v_fmac_f32_dpp v183, v182, v213 row_ror:8 row_mask:0xf bank_mask:0xf
    v_fmac_f32_dpp v191, v190, v229 row_ror:8 row_mask:0xf bank_mask:0xf
    v_mul_f32 v208, v198, v168
    v_mul_f32 v209, v198, v169
    v_mul_f32 v210, v198, v170
    v_mul_f32 v211, v198, v171
    v_mul_f32 v224, v198, v172
    v_mul_f32 v225, v198, v173
    v_mul_f32 v226, v198, v174
    v_mul_f32 v227, v198, v175
    v_fmac_f32_dpp v208, v168, v199 row_ror:8 row_mask:0xf bank_mask:0xf
    v_fmac_f32_dpp v209, v169, v199 row_ror:8 row_mask:0xf bank_mask:0xf
    v_fmac_f32_dpp v210, v170, v199 row_ror:8 row_mask:0xf bank_mask:0xf
    v_fmac_f32_dpp v211, v171, v199 row_ror:8 row_mask:0xf bank_mask:0xf
    v_fmac_f32_dpp v224, v172, v199 row_ror:8 row_mask:0xf bank_mask:0xf
    v_fmac_f32_dpp v225, v173, v199 row_ror:8 row_mask:0xf bank_mask:0xf
    v_fmac_f32_dpp v226, v174, v199 row_ror:8 row_mask:0xf bank_mask:0xf
    v_fmac_f32_dpp v227, v175, v199 row_ror:8 row_mask:0xf bank_mask:0xf
    v_cvt_pk_bf16_f32 v168, v208, v209
    v_cvt_pk_bf16_f32 v169, v210, v211
    v_cvt_pk_bf16_f32 v170, v224, v225
    v_cvt_pk_bf16_f32 v171, v226, v227
    buffer_store_dwordx4 v[168:171], v4, s[52:55], s72 offen offset:0 sc1
    v_mul_f32 v240, v214, v176
    v_mul_f32 v241, v214, v177
    v_mul_f32 v242, v214, v178
    v_mul_f32 v243, v214, v179
    v_mul_f32 v8, v214, v180
    v_mul_f32 v9, v214, v181
    v_mul_f32 v10, v214, v182
    v_mul_f32 v11, v214, v183
    v_fmac_f32_dpp v240, v176, v215 row_ror:8 row_mask:0xf bank_mask:0xf
    v_fmac_f32_dpp v241, v177, v215 row_ror:8 row_mask:0xf bank_mask:0xf
    v_fmac_f32_dpp v242, v178, v215 row_ror:8 row_mask:0xf bank_mask:0xf
    v_fmac_f32_dpp v243, v179, v215 row_ror:8 row_mask:0xf bank_mask:0xf
    v_fmac_f32_dpp v8, v180, v215 row_ror:8 row_mask:0xf bank_mask:0xf
    v_fmac_f32_dpp v9, v181, v215 row_ror:8 row_mask:0xf bank_mask:0xf
    v_fmac_f32_dpp v10, v182, v215 row_ror:8 row_mask:0xf bank_mask:0xf
    v_fmac_f32_dpp v11, v183, v215 row_ror:8 row_mask:0xf bank_mask:0xf
    v_cvt_pk_bf16_f32 v176, v240, v241
    v_cvt_pk_bf16_f32 v177, v242, v243
    v_cvt_pk_bf16_f32 v178, v8, v9
    v_cvt_pk_bf16_f32 v179, v10, v11
    buffer_store_dwordx4 v[176:179], v4, s[52:55], s72 offen offset:128 sc1
    v_mul_f32 v208, v230, v184
    v_mul_f32 v209, v230, v185
    v_mul_f32 v210, v230, v186
    v_mul_f32 v211, v230, v187
    v_mul_f32 v224, v230, v188
    v_mul_f32 v225, v230, v189
    v_mul_f32 v226, v230, v190
    v_mul_f32 v227, v230, v191
    v_fmac_f32_dpp v208, v184, v231 row_ror:8 row_mask:0xf bank_mask:0xf
    v_fmac_f32_dpp v209, v185, v231 row_ror:8 row_mask:0xf bank_mask:0xf
    v_fmac_f32_dpp v210, v186, v231 row_ror:8 row_mask:0xf bank_mask:0xf
    v_fmac_f32_dpp v211, v187, v231 row_ror:8 row_mask:0xf bank_mask:0xf
    v_fmac_f32_dpp v224, v188, v231 row_ror:8 row_mask:0xf bank_mask:0xf
    v_fmac_f32_dpp v225, v189, v231 row_ror:8 row_mask:0xf bank_mask:0xf
    v_fmac_f32_dpp v226, v190, v231 row_ror:8 row_mask:0xf bank_mask:0xf
    v_fmac_f32_dpp v227, v191, v231 row_ror:8 row_mask:0xf bank_mask:0xf
    v_cvt_pk_bf16_f32 v184, v208, v209
    v_cvt_pk_bf16_f32 v185, v210, v211
    v_cvt_pk_bf16_f32 v186, v224, v225
    v_cvt_pk_bf16_f32 v187, v226, v227
    buffer_store_dwordx4 v[184:187], v4, s[52:55], s72 offen offset:256 sc1
L_b2c:
    s_setprio 1
    s_waitcnt lgkmcnt(0)
    v_mfma_f32_32x32x4_2b_bf16 v[32:63], v[158:159], v[152:153], 0
    v_exp_f32 v64, v64
    v_exp_f32 v65, v65
    v_exp_f32 v66, v66
    v_exp_f32 v67, v67
    v_cvt_pk_bf16_f32 v128, v64, v65
    v_exp_f32 v68, v68
    v_exp_f32 v69, v69
    v_cvt_pk_bf16_f32 v129, v66, v67
    v_exp_f32 v70, v70
    v_mfma_f32_32x32x16_bf16 v[112:127], v[160:163], v[136:139], v[112:127]
    v_exp_f32 v71, v71
    ds_read_b128 v[160:163], v18 offset:48640
    v_cvt_pk_bf16_f32 v130, v68, v69
    v_exp_f32 v72, v72
    v_exp_f32 v73, v73
    v_cvt_pk_bf16_f32 v131, v70, v71
    v_mfma_f32_32x32x16_bf16 v[112:127], v[164:167], v[140:143], v[112:127]
    v_exp_f32 v74, v74
    ds_read_b128 v[164:167], v20 offset:48640
    v_exp_f32 v75, v75
    v_cvt_pk_bf16_f32 v132, v72, v73
    v_exp_f32 v76, v76
    v_exp_f32 v77, v77
    v_mfma_f32_32x32x16_bf16 v[32:47], v[154:157], v[144:147], v[32:47]
    v_cvt_pk_bf16_f32 v133, v74, v75
    v_exp_f32 v78, v78
    v_exp_f32 v79, v79
    v_cvt_pk_bf16_f32 v134, v76, v77
    v_cvt_pk_bf16_f32 v135, v78, v79
    s_setprio 0
    v_mfma_f32_32x32x16_bf16 v[48:63], v[154:157], v[148:151], v[48:63]
    v_exp_f32 v80, v80
    ds_read_b64 v[158:159], v17 offset:53760
    v_exp_f32 v81, v81
    ds_read_b128 v[154:157], v16 offset:53760
    v_exp_f32 v82, v82
    v_exp_f32 v83, v83
    v_cvt_pk_bf16_f32 v136, v80, v81
    v_exp_f32 v84, v84
    s_waitcnt lgkmcnt(2)
    v_mfma_f32_32x32x16_bf16 v[96:111], v[160:163], v[128:131], v[96:111]
    v_exp_f32 v85, v85
    v_cvt_pk_bf16_f32 v137, v82, v83
    v_exp_f32 v86, v86
    v_exp_f32 v87, v87
    v_cvt_pk_bf16_f32 v138, v84, v85
    v_exp_f32 v88, v88
    v_exp_f32 v89, v89
    v_cvt_pk_bf16_f32 v139, v86, v87
    v_mfma_f32_32x32x16_bf16 v[96:111], v[164:167], v[132:135], v[96:111]
    v_exp_f32 v90, v90
    v_exp_f32 v91, v91
    v_cvt_pk_bf16_f32 v140, v88, v89
    v_exp_f32 v92, v92
    v_exp_f32 v93, v93
    v_cvt_pk_bf16_f32 v141, v90, v91
    v_exp_f32 v94, v94
    v_exp_f32 v95, v95
    v_cvt_pk_bf16_f32 v142, v92, v93
    v_cvt_pk_bf16_f32 v143, v94, v95
    s_setprio 3
    s_waitcnt lgkmcnt(0)
    v_mfma_f32_32x32x4_2b_bf16 v[64:95], v[158:159], v[152:153], 0
    v_exp_f32 v32, v32
    v_exp_f32 v33, v33
    v_exp_f32 v34, v34
    v_exp_f32 v35, v35
    v_cvt_pk_bf16_f32 v128, v32, v33
    v_exp_f32 v36, v36
    v_exp_f32 v37, v37
    v_cvt_pk_bf16_f32 v129, v34, v35
    v_exp_f32 v38, v38
    v_mfma_f32_32x32x16_bf16 v[112:127], v[160:163], v[136:139], v[112:127]
    v_exp_f32 v39, v39
    ds_read_b128 v[160:163], v18 offset:51200
    v_cvt_pk_bf16_f32 v130, v36, v37
    v_exp_f32 v40, v40
    v_exp_f32 v41, v41
    v_cvt_pk_bf16_f32 v131, v38, v39
    v_mfma_f32_32x32x16_bf16 v[112:127], v[164:167], v[140:143], v[112:127]
    v_exp_f32 v42, v42
    ds_read_b128 v[164:167], v20 offset:51200
    v_exp_f32 v43, v43
    v_cvt_pk_bf16_f32 v132, v40, v41
    v_exp_f32 v44, v44
    v_exp_f32 v45, v45
    v_mfma_f32_32x32x16_bf16 v[64:79], v[154:157], v[144:147], v[64:79]
    v_cvt_pk_bf16_f32 v133, v42, v43
    v_exp_f32 v46, v46
    v_exp_f32 v47, v47
    v_cvt_pk_bf16_f32 v134, v44, v45
    v_cvt_pk_bf16_f32 v135, v46, v47
    s_setprio 2
    v_mfma_f32_32x32x16_bf16 v[80:95], v[154:157], v[148:151], v[80:95]
    v_exp_f32 v48, v48
    ds_read_b64 v[158:159], v17 offset:56320
    v_exp_f32 v49, v49
    ds_read_b128 v[154:157], v16 offset:56320
    v_exp_f32 v50, v50
    v_exp_f32 v51, v51
    v_cvt_pk_bf16_f32 v136, v48, v49
    v_exp_f32 v52, v52
    s_waitcnt lgkmcnt(2)
    v_mfma_f32_32x32x16_bf16 v[96:111], v[160:163], v[128:131], v[96:111]
    v_exp_f32 v53, v53
    v_cvt_pk_bf16_f32 v137, v50, v51
    v_exp_f32 v54, v54
    v_exp_f32 v55, v55
    v_cvt_pk_bf16_f32 v138, v52, v53
    v_exp_f32 v56, v56
    v_exp_f32 v57, v57
    v_cvt_pk_bf16_f32 v139, v54, v55
    v_mfma_f32_32x32x16_bf16 v[96:111], v[164:167], v[132:135], v[96:111]
    v_exp_f32 v58, v58
    v_exp_f32 v59, v59
    v_cvt_pk_bf16_f32 v140, v56, v57
    v_exp_f32 v60, v60
    v_exp_f32 v61, v61
    v_cvt_pk_bf16_f32 v141, v58, v59
    v_exp_f32 v62, v62
    v_exp_f32 v63, v63
    v_cvt_pk_bf16_f32 v142, v60, v61
    v_cvt_pk_bf16_f32 v143, v62, v63
    s_setprio 1
    s_waitcnt lgkmcnt(0)
    v_mfma_f32_32x32x4_2b_bf16 v[32:63], v[158:159], v[152:153], 0
    v_exp_f32 v64, v64
    v_exp_f32 v65, v65
    v_exp_f32 v66, v66
    v_exp_f32 v67, v67
    v_cvt_pk_bf16_f32 v128, v64, v65
    v_exp_f32 v68, v68
    v_exp_f32 v69, v69
    v_cvt_pk_bf16_f32 v129, v66, v67
    v_exp_f32 v70, v70
    v_mfma_f32_32x32x16_bf16 v[112:127], v[160:163], v[136:139], v[112:127]
    v_exp_f32 v71, v71
    ds_read_b128 v[160:163], v18 offset:53760
    v_cvt_pk_bf16_f32 v130, v68, v69
    v_exp_f32 v72, v72
    v_exp_f32 v73, v73
    v_cvt_pk_bf16_f32 v131, v70, v71
    v_mfma_f32_32x32x16_bf16 v[112:127], v[164:167], v[140:143], v[112:127]
    v_exp_f32 v74, v74
    ds_read_b128 v[164:167], v20 offset:53760
    v_exp_f32 v75, v75
    v_cvt_pk_bf16_f32 v132, v72, v73
    v_exp_f32 v76, v76
    v_exp_f32 v77, v77
    v_mfma_f32_32x32x16_bf16 v[32:47], v[154:157], v[144:147], v[32:47]
    v_cvt_pk_bf16_f32 v133, v74, v75
    v_exp_f32 v78, v78
    v_exp_f32 v79, v79
    v_cvt_pk_bf16_f32 v134, v76, v77
    v_cvt_pk_bf16_f32 v135, v78, v79
    s_setprio 0
    v_mfma_f32_32x32x16_bf16 v[48:63], v[154:157], v[148:151], v[48:63]
    v_exp_f32 v80, v80
    s_waitcnt vmcnt(0)
    s_cmp_lg_u32 s68, 0
    s_cbranch_scc1 L_h13
    s_and_b32 s72, s38, 3
    s_lshl_b32 s72, s72, 3
    s_lshr_b32 s73, s38, 2
    s_add_u32 s72, s72, s73
    s_add_u32 s72, s72, 0
    s_lshl_b32 s72, s72, 1
    s_lshr_b32 s73, s71, 1
    s_add_u32 s72, s72, s73
    s_lshl_b32 s72, s72, 4
    s_add_u32 s72, s72, s39
    s_lshl_b32 s72, s72, 1
    s_add_u32 s72, s72, s3
    s_lshl_b32 s72, s72, 1
    s_add_u32 s72, s72, s70
    s_lshl_b32 s72, s72, 2
    s_add_u32 s72, s72, 15183872
    v_and_b32 v12, 3, v1
    v_lshlrev_b32 v12, 14, v12
    v_bfe_u32 v13, v1, 2, 1
    v_lshl_add_u32 v12, v13, 11, v12
    v_bfe_u32 v13, v1, 3, 1
    v_lshl_add_u32 v12, v13, 16, v12
    v_mov_b32 v13, s67
    s_mov_b64 exec, 65535
    buffer_store_dword v13, v12, s[52:55], s72 offen sc1
    s_mov_b64 exec, -1
L_h13:
    s_barrier
    ds_read_b64 v[158:159], v17 offset:58880
    v_exp_f32 v81, v81
    ds_read_b128 v[154:157], v16 offset:58880
    v_exp_f32 v82, v82
    v_exp_f32 v83, v83
    v_cvt_pk_bf16_f32 v136, v80, v81
    v_exp_f32 v84, v84
    s_waitcnt lgkmcnt(2)
    v_mfma_f32_32x32x16_bf16 v[96:111], v[160:163], v[128:131], v[96:111]
    v_exp_f32 v85, v85
    v_cvt_pk_bf16_f32 v137, v82, v83
    v_exp_f32 v86, v86
    v_exp_f32 v87, v87
    v_cvt_pk_bf16_f32 v138, v84, v85
    v_exp_f32 v88, v88
    v_exp_f32 v89, v89
    v_cvt_pk_bf16_f32 v139, v86, v87
    v_mfma_f32_32x32x16_bf16 v[96:111], v[164:167], v[132:135], v[96:111]
    v_exp_f32 v90, v90
    v_exp_f32 v91, v91
    v_cvt_pk_bf16_f32 v140, v88, v89
    v_exp_f32 v92, v92
    v_exp_f32 v93, v93
    v_cvt_pk_bf16_f32 v141, v90, v91
    v_exp_f32 v94, v94
    v_exp_f32 v95, v95
    v_cvt_pk_bf16_f32 v142, v92, v93
    v_cvt_pk_bf16_f32 v143, v94, v95
    s_setprio 3
    s_waitcnt lgkmcnt(0)
    v_mfma_f32_32x32x4_2b_bf16 v[64:95], v[158:159], v[152:153], 0
    v_exp_f32 v32, v32
    v_exp_f32 v33, v33
    v_exp_f32 v34, v34
    v_exp_f32 v35, v35
    v_cvt_pk_bf16_f32 v128, v32, v33
    v_exp_f32 v36, v36
    v_exp_f32 v37, v37
    v_cvt_pk_bf16_f32 v129, v34, v35
    v_exp_f32 v38, v38
    v_mfma_f32_32x32x16_bf16 v[112:127], v[160:163], v[136:139], v[112:127]
    v_exp_f32 v39, v39
    ds_read_b128 v[160:163], v18 offset:56320
    v_cvt_pk_bf16_f32 v130, v36, v37
    v_exp_f32 v40, v40
    v_exp_f32 v41, v41
    v_cvt_pk_bf16_f32 v131, v38, v39
    v_mfma_f32_32x32x16_bf16 v[112:127], v[164:167], v[140:143], v[112:127]
    v_exp_f32 v42, v42
    ds_read_b128 v[164:167], v20 offset:56320
    v_exp_f32 v43, v43
    v_cvt_pk_bf16_f32 v132, v40, v41
    v_exp_f32 v44, v44
    v_exp_f32 v45, v45
    v_mfma_f32_32x32x16_bf16 v[64:79], v[154:157], v[144:147], v[64:79]
    v_cvt_pk_bf16_f32 v133, v42, v43
    v_exp_f32 v46, v46
    v_exp_f32 v47, v47
    v_cvt_pk_bf16_f32 v134, v44, v45
    v_cvt_pk_bf16_f32 v135, v46, v47
    s_setprio 2
    v_mfma_f32_32x32x16_bf16 v[80:95], v[154:157], v[148:151], v[80:95]
    v_exp_f32 v48, v48
    v_add_u32 v16, -81920, v16
    v_add_u32 v17, -81920, v17
    ds_read_b64 v[158:159], v17 offset:0
    v_exp_f32 v49, v49
    ds_read_b128 v[154:157], v16 offset:0
    v_exp_f32 v50, v50
    v_exp_f32 v51, v51
    v_cvt_pk_bf16_f32 v136, v48, v49
    v_exp_f32 v52, v52
    s_waitcnt lgkmcnt(2)
    v_mfma_f32_32x32x16_bf16 v[96:111], v[160:163], v[128:131], v[96:111]
    v_exp_f32 v53, v53
    v_cvt_pk_bf16_f32 v137, v50, v51
    v_exp_f32 v54, v54
    v_exp_f32 v55, v55
    v_cvt_pk_bf16_f32 v138, v52, v53
    v_exp_f32 v56, v56
    v_exp_f32 v57, v57
    v_cvt_pk_bf16_f32 v139, v54, v55
    v_mfma_f32_32x32x16_bf16 v[96:111], v[164:167], v[132:135], v[96:111]
    v_exp_f32 v58, v58
    v_exp_f32 v59, v59
    v_cvt_pk_bf16_f32 v140, v56, v57
    v_exp_f32 v60, v60
    v_exp_f32 v61, v61
    v_cvt_pk_bf16_f32 v141, v58, v59
    v_exp_f32 v62, v62
    v_exp_f32 v63, v63
    v_cvt_pk_bf16_f32 v142, v60, v61
    v_cvt_pk_bf16_f32 v143, v62, v63
    s_setprio 1
    s_waitcnt lgkmcnt(0)
    v_mfma_f32_32x32x4_2b_bf16 v[32:63], v[158:159], v[152:153], 0
    v_exp_f32 v64, v64
    v_exp_f32 v65, v65
    v_exp_f32 v66, v66
    v_exp_f32 v67, v67
    v_cvt_pk_bf16_f32 v128, v64, v65
    v_exp_f32 v68, v68
    v_exp_f32 v69, v69
    v_cvt_pk_bf16_f32 v129, v66, v67
    v_exp_f32 v70, v70
    v_mfma_f32_32x32x16_bf16 v[112:127], v[160:163], v[136:139], v[112:127]
    v_exp_f32 v71, v71
    ds_read_b128 v[160:163], v18 offset:58880
    v_cvt_pk_bf16_f32 v130, v68, v69
    v_exp_f32 v72, v72
    v_exp_f32 v73, v73
    v_cvt_pk_bf16_f32 v131, v70, v71
    v_mfma_f32_32x32x16_bf16 v[112:127], v[164:167], v[140:143], v[112:127]
    v_exp_f32 v74, v74
    ds_read_b128 v[164:167], v20 offset:58880
    v_exp_f32 v75, v75
    v_cvt_pk_bf16_f32 v132, v72, v73
    v_exp_f32 v76, v76
    v_exp_f32 v77, v77
    v_mfma_f32_32x32x16_bf16 v[32:47], v[154:157], v[144:147], v[32:47]
    v_cvt_pk_bf16_f32 v133, v74, v75
    v_exp_f32 v78, v78
    v_exp_f32 v79, v79
    v_cvt_pk_bf16_f32 v134, v76, v77
    v_cvt_pk_bf16_f32 v135, v78, v79
    s_setprio 0
    v_mfma_f32_32x32x16_bf16 v[48:63], v[154:157], v[148:151], v[48:63]
    v_exp_f32 v80, v80
    ds_read_b64 v[158:159], v17 offset:2560
    v_exp_f32 v81, v81
    ds_read_b128 v[154:157], v16 offset:2560
    v_exp_f32 v82, v82
    v_exp_f32 v83, v83
    v_cvt_pk_bf16_f32 v136, v80, v81
    v_exp_f32 v84, v84
    s_waitcnt lgkmcnt(2)
    v_mfma_f32_32x32x16_bf16 v[96:111], v[160:163], v[128:131], v[96:111]
    v_exp_f32 v85, v85
    v_cvt_pk_bf16_f32 v137, v82, v83
    v_exp_f32 v86, v86
    v_exp_f32 v87, v87
    v_cvt_pk_bf16_f32 v138, v84, v85
    v_exp_f32 v88, v88
    v_exp_f32 v89, v89
    v_cvt_pk_bf16_f32 v139, v86, v87
    v_mfma_f32_32x32x16_bf16 v[96:111], v[164:167], v[132:135], v[96:111]
    v_exp_f32 v90, v90
    v_exp_f32 v91, v91
    v_cvt_pk_bf16_f32 v140, v88, v89
    v_exp_f32 v92, v92
    v_exp_f32 v93, v93
    v_cvt_pk_bf16_f32 v141, v90, v91
    v_exp_f32 v94, v94
    v_exp_f32 v95, v95
    v_cvt_pk_bf16_f32 v142, v92, v93
    v_cvt_pk_bf16_f32 v143, v94, v95
    s_setprio 3
    s_waitcnt lgkmcnt(0)
    v_mfma_f32_32x32x4_2b_bf16 v[64:95], v[158:159], v[152:153], 0
    v_exp_f32 v32, v32
    v_exp_f32 v33, v33
    v_exp_f32 v34, v34
    v_exp_f32 v35, v35
    v_cvt_pk_bf16_f32 v128, v32, v33
    v_exp_f32 v36, v36
    v_exp_f32 v37, v37
    v_cvt_pk_bf16_f32 v129, v34, v35
    v_exp_f32 v38, v38
    v_mfma_f32_32x32x16_bf16 v[112:127], v[160:163], v[136:139], v[112:127]
    v_exp_f32 v39, v39
    v_add_u32 v18, -81920, v18
    v_add_u32 v20, -81920, v20
    ds_read_b128 v[160:163], v18 offset:0
    v_cvt_pk_bf16_f32 v130, v36, v37
    v_exp_f32 v40, v40
    v_exp_f32 v41, v41
    v_cvt_pk_bf16_f32 v131, v38, v39
    v_mfma_f32_32x32x16_bf16 v[112:127], v[164:167], v[140:143], v[112:127]
    v_exp_f32 v42, v42
    ds_read_b128 v[164:167], v20 offset:0
    v_exp_f32 v43, v43
    v_cvt_pk_bf16_f32 v132, v40, v41
    v_exp_f32 v44, v44
    v_exp_f32 v45, v45
    v_mfma_f32_32x32x16_bf16 v[64:79], v[154:157], v[144:147], v[64:79]
    v_cvt_pk_bf16_f32 v133, v42, v43
    v_exp_f32 v46, v46
    v_exp_f32 v47, v47
    v_cvt_pk_bf16_f32 v134, v44, v45
    v_cvt_pk_bf16_f32 v135, v46, v47
    s_setprio 2
    v_mfma_f32_32x32x16_bf16 v[80:95], v[154:157], v[148:151], v[80:95]
    v_exp_f32 v48, v48
    ds_read_b64 v[158:159], v17 offset:5120
    v_exp_f32 v49, v49
    ds_read_b128 v[154:157], v16 offset:5120
    v_exp_f32 v50, v50
    v_exp_f32 v51, v51
    v_cvt_pk_bf16_f32 v136, v48, v49
    v_exp_f32 v52, v52
    s_waitcnt lgkmcnt(2)
    v_mfma_f32_32x32x16_bf16 v[96:111], v[160:163], v[128:131], v[96:111]
    v_exp_f32 v53, v53
    v_cvt_pk_bf16_f32 v137, v50, v51
    v_exp_f32 v54, v54
    v_exp_f32 v55, v55
    v_cvt_pk_bf16_f32 v138, v52, v53
    v_exp_f32 v56, v56
    v_exp_f32 v57, v57
    v_cvt_pk_bf16_f32 v139, v54, v55
    v_mfma_f32_32x32x16_bf16 v[96:111], v[164:167], v[132:135], v[96:111]
    v_exp_f32 v58, v58
    v_exp_f32 v59, v59
    v_cvt_pk_bf16_f32 v140, v56, v57
    v_exp_f32 v60, v60
    v_exp_f32 v61, v61
    v_cvt_pk_bf16_f32 v141, v58, v59
    v_exp_f32 v62, v62
    v_exp_f32 v63, v63
    v_cvt_pk_bf16_f32 v142, v60, v61
    v_cvt_pk_bf16_f32 v143, v62, v63
    s_setprio 1
    s_waitcnt lgkmcnt(0)
    v_mfma_f32_32x32x4_2b_bf16 v[32:63], v[158:159], v[152:153], 0
    v_exp_f32 v64, v64
    v_exp_f32 v65, v65
    v_exp_f32 v66, v66
    v_exp_f32 v67, v67
    v_cvt_pk_bf16_f32 v128, v64, v65
    v_exp_f32 v68, v68
    v_exp_f32 v69, v69
    v_cvt_pk_bf16_f32 v129, v66, v67
    v_exp_f32 v70, v70
    v_mfma_f32_32x32x16_bf16 v[112:127], v[160:163], v[136:139], v[112:127]
    v_exp_f32 v71, v71
    ds_read_b128 v[160:163], v18 offset:2560
    v_cvt_pk_bf16_f32 v130, v68, v69
    v_exp_f32 v72, v72
    v_exp_f32 v73, v73
    v_cvt_pk_bf16_f32 v131, v70, v71
    v_mfma_f32_32x32x16_bf16 v[112:127], v[164:167], v[140:143], v[112:127]
    v_exp_f32 v74, v74
    ds_read_b128 v[164:167], v20 offset:2560
    v_exp_f32 v75, v75
    v_cvt_pk_bf16_f32 v132, v72, v73
    v_exp_f32 v76, v76
    v_exp_f32 v77, v77
    v_mfma_f32_32x32x16_bf16 v[32:47], v[154:157], v[144:147], v[32:47]
    v_cvt_pk_bf16_f32 v133, v74, v75
    v_exp_f32 v78, v78
    v_exp_f32 v79, v79
    v_cvt_pk_bf16_f32 v134, v76, v77
    v_cvt_pk_bf16_f32 v135, v78, v79
    s_setprio 0
    v_mfma_f32_32x32x16_bf16 v[48:63], v[154:157], v[148:151], v[48:63]
    v_exp_f32 v80, v80
    ds_read_b64 v[158:159], v17 offset:7680
    v_exp_f32 v81, v81
    ds_read_b128 v[154:157], v16 offset:7680
    v_exp_f32 v82, v82
    v_exp_f32 v83, v83
    v_cvt_pk_bf16_f32 v136, v80, v81
    v_exp_f32 v84, v84
    s_waitcnt lgkmcnt(2)
    v_mfma_f32_32x32x16_bf16 v[96:111], v[160:163], v[128:131], v[96:111]
    v_exp_f32 v85, v85
    v_cvt_pk_bf16_f32 v137, v82, v83
    v_exp_f32 v86, v86
    v_exp_f32 v87, v87
    v_cvt_pk_bf16_f32 v138, v84, v85
    v_exp_f32 v88, v88
    v_exp_f32 v89, v89
    v_cvt_pk_bf16_f32 v139, v86, v87
    v_mfma_f32_32x32x16_bf16 v[96:111], v[164:167], v[132:135], v[96:111]
    v_exp_f32 v90, v90
    v_exp_f32 v91, v91
    v_cvt_pk_bf16_f32 v140, v88, v89
    v_exp_f32 v92, v92
    v_exp_f32 v93, v93
    v_cvt_pk_bf16_f32 v141, v90, v91
    v_exp_f32 v94, v94
    v_exp_f32 v95, v95
    v_cvt_pk_bf16_f32 v142, v92, v93
    v_cvt_pk_bf16_f32 v143, v94, v95
    s_setprio 3
    s_waitcnt lgkmcnt(0)
    v_mfma_f32_32x32x4_2b_bf16 v[64:95], v[158:159], v[152:153], 0
    v_exp_f32 v32, v32
    v_exp_f32 v33, v33
    v_exp_f32 v34, v34
    v_exp_f32 v35, v35
    v_cvt_pk_bf16_f32 v128, v32, v33
    v_exp_f32 v36, v36
    v_exp_f32 v37, v37
    v_cvt_pk_bf16_f32 v129, v34, v35
    v_exp_f32 v38, v38
    v_mfma_f32_32x32x16_bf16 v[112:127], v[160:163], v[136:139], v[112:127]
    v_exp_f32 v39, v39
    ds_read_b128 v[160:163], v18 offset:5120
    v_cvt_pk_bf16_f32 v130, v36, v37
    v_exp_f32 v40, v40
    v_exp_f32 v41, v41
    v_cvt_pk_bf16_f32 v131, v38, v39
    v_mfma_f32_32x32x16_bf16 v[112:127], v[164:167], v[140:143], v[112:127]
    v_exp_f32 v42, v42
    ds_read_b128 v[164:167], v20 offset:5120
    v_exp_f32 v43, v43
    v_cvt_pk_bf16_f32 v132, v40, v41
    v_exp_f32 v44, v44
    v_exp_f32 v45, v45
    v_mfma_f32_32x32x16_bf16 v[64:79], v[154:157], v[144:147], v[64:79]
    v_cvt_pk_bf16_f32 v133, v42, v43
    v_exp_f32 v46, v46
    v_exp_f32 v47, v47
    v_cvt_pk_bf16_f32 v134, v44, v45
    v_cvt_pk_bf16_f32 v135, v46, v47
    s_setprio 2
    v_mfma_f32_32x32x16_bf16 v[80:95], v[154:157], v[148:151], v[80:95]
    v_exp_f32 v48, v48
    s_mov_b32 s40, s24
    s_mov_b32 s41, s25
    s_mov_b32 s42, 663552
    s_mov_b32 s43, 0x20000
    s_mov_b32 s44, s26
    s_mov_b32 s45, s27
    s_mov_b32 s46, 663552
    s_mov_b32 s47, 0x20000
    s_mov_b32 s48, s12
    s_mov_b32 s49, s13
    s_mov_b32 s50, 663552
    s_mov_b32 s51, 0x20000
    s_lshl_b32 s72, s66, 3
    s_add_u32 s72, s72, s64
    s_lshr_b32 s73, s65, 2
    v_lshlrev_b32 v4, 7, v1
    s_cmp_ge_u32 s72, 82
    s_cbranch_scc1 L_l2b
    s_mul_i32 s73, s73, 331776
    s_cmp_ge_u32 s72, 41
    s_cselect_b32 s40, s44, s40
    s_cselect_b32 s41, s45, s41
    s_cselect_b32 s95, 41, 0
    s_sub_u32 s72, s72, s95
    s_lshl_b32 s72, s72, 13
    s_add_u32 s72, s72, s73
    buffer_load_dword v253, v4, s[40:43], s72 offen
    s_branch L_l2c
L_l2b:
    s_cmp_ge_u32 s72, 127
    s_cbranch_scc1 L_l2c
    s_sub_u32 s72, s72, 82
    s_lshl_b32 s72, s72, 6
    v_add_u32 v4, s72, v1
    v_mul_u32_u24 v5, 13108, v4
    v_lshrrev_b32 v5, 16, v5
    v_mul_u32_u24 v6, 5, v5
    v_sub_u32 v4, v4, v6
    v_mul_u32_u24 v5, 1152, v5
    v_lshl_add_u32 v4, v4, 7, v5
    s_lshl_b32 s73, s73, 9
    buffer_load_dword v253, v4, s[48:51], s73 offen
L_l2c:
    ds_read_b64 v[158:159], v17 offset:10240
    v_exp_f32 v49, v49
    ds_read_b128 v[154:157], v16 offset:10240
    v_exp_f32 v50, v50
    v_exp_f32 v51, v51
    v_cvt_pk_bf16_f32 v136, v48, v49
    v_exp_f32 v52, v52
    s_waitcnt lgkmcnt(2)
    v_mfma_f32_32x32x16_bf16 v[96:111], v[160:163], v[128:131], v[96:111]
    v_exp_f32 v53, v53
    v_cvt_pk_bf16_f32 v137, v50, v51
    v_exp_f32 v54, v54
    v_exp_f32 v55, v55
    v_cvt_pk_bf16_f32 v138, v52, v53
    v_exp_f32 v56, v56
    v_exp_f32 v57, v57
    v_cvt_pk_bf16_f32 v139, v54, v55
    v_mfma_f32_32x32x16_bf16 v[96:111], v[164:167], v[132:135], v[96:111]
    v_exp_f32 v58, v58
    v_exp_f32 v59, v59
    v_cvt_pk_bf16_f32 v140, v56, v57
    v_exp_f32 v60, v60
    v_exp_f32 v61, v61
    v_cvt_pk_bf16_f32 v141, v58, v59
    v_exp_f32 v62, v62
    v_exp_f32 v63, v63
    v_cvt_pk_bf16_f32 v142, v60, v61
    v_cvt_pk_bf16_f32 v143, v62, v63
    s_setprio 1
    s_waitcnt lgkmcnt(0)
    v_mfma_f32_32x32x4_2b_bf16 v[32:63], v[158:159], v[152:153], 0
    v_exp_f32 v64, v64
    v_exp_f32 v65, v65
    v_exp_f32 v66, v66
    v_exp_f32 v67, v67
    v_cvt_pk_bf16_f32 v128, v64, v65
    v_exp_f32 v68, v68
    v_exp_f32 v69, v69
    v_cvt_pk_bf16_f32 v129, v66, v67
    v_exp_f32 v70, v70
    v_mfma_f32_32x32x16_bf16 v[112:127], v[160:163], v[136:139], v[112:127]
    v_exp_f32 v71, v71
    ds_read_b128 v[160:163], v18 offset:7680
    v_cvt_pk_bf16_f32 v130, v68, v69
    v_exp_f32 v72, v72
    v_exp_f32 v73, v73
    v_cvt_pk_bf16_f32 v131, v70, v71
    v_mfma_f32_32x32x16_bf16 v[112:127], v[164:167], v[140:143], v[112:127]
    v_exp_f32 v74, v74
    ds_read_b128 v[164:167], v20 offset:7680
    v_exp_f32 v75, v75
    v_cvt_pk_bf16_f32 v132, v72, v73
    v_exp_f32 v76, v76
    v_exp_f32 v77, v77
    v_mfma_f32_32x32x16_bf16 v[32:47], v[154:157], v[144:147], v[32:47]
    v_cvt_pk_bf16_f32 v133, v74, v75
    v_exp_f32 v78, v78
    v_exp_f32 v79, v79
    v_cvt_pk_bf16_f32 v134, v76, v77
    v_cvt_pk_bf16_f32 v135, v78, v79
    s_setprio 0
    v_mfma_f32_32x32x16_bf16 v[48:63], v[154:157], v[148:151], v[48:63]
    v_exp_f32 v80, v80
    ds_read_b64 v[158:159], v17 offset:12800
    v_exp_f32 v81, v81
    ds_read_b128 v[154:157], v16 offset:12800
    v_exp_f32 v82, v82
    v_exp_f32 v83, v83
    v_cvt_pk_bf16_f32 v136, v80, v81
    v_exp_f32 v84, v84
    s_waitcnt lgkmcnt(2)
    v_mfma_f32_32x32x16_bf16 v[96:111], v[160:163], v[128:131], v[96:111]
    v_exp_f32 v85, v85
    v_cvt_pk_bf16_f32 v137, v82, v83
    v_exp_f32 v86, v86
    v_exp_f32 v87, v87
    v_cvt_pk_bf16_f32 v138, v84, v85
    v_exp_f32 v88, v88
    v_exp_f32 v89, v89
    v_cvt_pk_bf16_f32 v139, v86, v87
    v_mfma_f32_32x32x16_bf16 v[96:111], v[164:167], v[132:135], v[96:111]
    v_exp_f32 v90, v90
    v_exp_f32 v91, v91
    v_cvt_pk_bf16_f32 v140, v88, v89
    v_exp_f32 v92, v92
    v_exp_f32 v93, v93
    v_cvt_pk_bf16_f32 v141, v90, v91
    v_exp_f32 v94, v94
    v_exp_f32 v95, v95
    v_cvt_pk_bf16_f32 v142, v92, v93
    v_cvt_pk_bf16_f32 v143, v94, v95
    s_setprio 3
    s_waitcnt lgkmcnt(0)
    v_mfma_f32_32x32x4_2b_bf16 v[64:95], v[158:159], v[152:153], 0
    v_exp_f32 v32, v32
    v_exp_f32 v33, v33
    v_exp_f32 v34, v34
    v_exp_f32 v35, v35
    v_cvt_pk_bf16_f32 v128, v32, v33
    v_exp_f32 v36, v36
    v_exp_f32 v37, v37
    v_cvt_pk_bf16_f32 v129, v34, v35
    v_exp_f32 v38, v38
    v_mfma_f32_32x32x16_bf16 v[112:127], v[160:163], v[136:139], v[112:127]
    v_exp_f32 v39, v39
    ds_read_b128 v[160:163], v18 offset:10240
    v_cvt_pk_bf16_f32 v130, v36, v37
    v_exp_f32 v40, v40
    v_exp_f32 v41, v41
    v_cvt_pk_bf16_f32 v131, v38, v39
    v_mfma_f32_32x32x16_bf16 v[112:127], v[164:167], v[140:143], v[112:127]
    v_exp_f32 v42, v42
    ds_read_b128 v[164:167], v20 offset:10240
    v_exp_f32 v43, v43
    v_cvt_pk_bf16_f32 v132, v40, v41
    v_exp_f32 v44, v44
    v_exp_f32 v45, v45
    v_mfma_f32_32x32x16_bf16 v[64:79], v[154:157], v[144:147], v[64:79]
    v_cvt_pk_bf16_f32 v133, v42, v43
    v_exp_f32 v46, v46
    v_exp_f32 v47, v47
    v_cvt_pk_bf16_f32 v134, v44, v45
    v_cvt_pk_bf16_f32 v135, v46, v47
    s_setprio 2
    v_mfma_f32_32x32x16_bf16 v[80:95], v[154:157], v[148:151], v[80:95]
    v_exp_f32 v48, v48
    ds_read_b64 v[158:159], v17 offset:15360
    v_exp_f32 v49, v49
    ds_read_b128 v[154:157], v16 offset:15360
    v_exp_f32 v50, v50
    v_exp_f32 v51, v51
    v_cvt_pk_bf16_f32 v136, v48, v49
    v_exp_f32 v52, v52
    s_waitcnt lgkmcnt(2)
    v_mfma_f32_32x32x16_bf16 v[96:111], v[160:163], v[128:131], v[96:111]
    v_exp_f32 v53, v53
    v_cvt_pk_bf16_f32 v137, v50, v51
    v_exp_f32 v54, v54
    v_exp_f32 v55, v55
    v_cvt_pk_bf16_f32 v138, v52, v53
    v_exp_f32 v56, v56
    v_exp_f32 v57, v57
    v_cvt_pk_bf16_f32 v139, v54, v55
    v_mfma_f32_32x32x16_bf16 v[96:111], v[164:167], v[132:135], v[96:111]
    v_exp_f32 v58, v58
    v_exp_f32 v59, v59
    v_cvt_pk_bf16_f32 v140, v56, v57
    v_exp_f32 v60, v60
    v_exp_f32 v61, v61
    v_cvt_pk_bf16_f32 v141, v58, v59
    v_exp_f32 v62, v62
    v_exp_f32 v63, v63
    v_cvt_pk_bf16_f32 v142, v60, v61
    v_cvt_pk_bf16_f32 v143, v62, v63
    s_setprio 1
    s_waitcnt lgkmcnt(0)
    v_mfma_f32_32x32x4_2b_bf16 v[32:63], v[158:159], v[152:153], 0
    v_exp_f32 v64, v64
    v_exp_f32 v65, v65
    v_exp_f32 v66, v66
    v_exp_f32 v67, v67
    v_cvt_pk_bf16_f32 v128, v64, v65
    v_exp_f32 v68, v68
    v_exp_f32 v69, v69
    v_cvt_pk_bf16_f32 v129, v66, v67
    v_exp_f32 v70, v70
    v_mfma_f32_32x32x16_bf16 v[112:127], v[160:163], v[136:139], v[112:127]
    v_exp_f32 v71, v71
    ds_read_b128 v[160:163], v18 offset:12800
    v_cvt_pk_bf16_f32 v130, v68, v69
    v_exp_f32 v72, v72
    v_exp_f32 v73, v73
    v_cvt_pk_bf16_f32 v131, v70, v71
    v_mfma_f32_32x32x16_bf16 v[112:127], v[164:167], v[140:143], v[112:127]
    v_exp_f32 v74, v74
    ds_read_b128 v[164:167], v20 offset:12800
    v_exp_f32 v75, v75
    v_cvt_pk_bf16_f32 v132, v72, v73
    v_exp_f32 v76, v76
    v_exp_f32 v77, v77
    v_mfma_f32_32x32x16_bf16 v[32:47], v[154:157], v[144:147], v[32:47]
    v_cvt_pk_bf16_f32 v133, v74, v75
    v_exp_f32 v78, v78
    v_exp_f32 v79, v79
    v_cvt_pk_bf16_f32 v134, v76, v77
    v_cvt_pk_bf16_f32 v135, v78, v79
    s_setprio 0
    v_mfma_f32_32x32x16_bf16 v[48:63], v[154:157], v[148:151], v[48:63]
    v_exp_f32 v80, v80
    ds_read_b64 v[158:159], v17 offset:17920
    v_exp_f32 v81, v81
    ds_read_b128 v[154:157], v16 offset:17920
    v_exp_f32 v82, v82
    v_exp_f32 v83, v83
    v_cvt_pk_bf16_f32 v136, v80, v81
    v_exp_f32 v84, v84
    s_waitcnt lgkmcnt(2)
    v_mfma_f32_32x32x16_bf16 v[96:111], v[160:163], v[128:131], v[96:111]
    v_exp_f32 v85, v85
    v_cvt_pk_bf16_f32 v137, v82, v83
    v_exp_f32 v86, v86
    v_exp_f32 v87, v87
    v_cvt_pk_bf16_f32 v138, v84, v85
    v_exp_f32 v88, v88
    v_exp_f32 v89, v89
    v_cvt_pk_bf16_f32 v139, v86, v87
    v_mfma_f32_32x32x16_bf16 v[96:111], v[164:167], v[132:135], v[96:111]
    v_exp_f32 v90, v90
    v_exp_f32 v91, v91
    v_cvt_pk_bf16_f32 v140, v88, v89
    v_exp_f32 v92, v92
    v_exp_f32 v93, v93
    v_cvt_pk_bf16_f32 v141, v90, v91
    v_exp_f32 v94, v94
    v_exp_f32 v95, v95
    v_cvt_pk_bf16_f32 v142, v92, v93
    v_cvt_pk_bf16_f32 v143, v94, v95
    s_setprio 3
    s_waitcnt lgkmcnt(0)
    v_mfma_f32_32x32x4_2b_bf16 v[64:95], v[158:159], v[152:153], 0
    v_exp_f32 v32, v32
    v_exp_f32 v33, v33
    v_exp_f32 v34, v34
    v_exp_f32 v35, v35
    v_cvt_pk_bf16_f32 v128, v32, v33
    v_exp_f32 v36, v36
    v_exp_f32 v37, v37
    v_cvt_pk_bf16_f32 v129, v34, v35
    v_exp_f32 v38, v38
    v_mfma_f32_32x32x16_bf16 v[112:127], v[160:163], v[136:139], v[112:127]
    v_exp_f32 v39, v39
    ds_read_b128 v[160:163], v18 offset:15360
    v_cvt_pk_bf16_f32 v130, v36, v37
    v_exp_f32 v40, v40
    v_exp_f32 v41, v41
    v_cvt_pk_bf16_f32 v131, v38, v39
    v_mfma_f32_32x32x16_bf16 v[112:127], v[164:167], v[140:143], v[112:127]
    v_exp_f32 v42, v42
    ds_read_b128 v[164:167], v20 offset:15360
    v_exp_f32 v43, v43
    v_cvt_pk_bf16_f32 v132, v40, v41
    v_exp_f32 v44, v44
    v_exp_f32 v45, v45
    v_mfma_f32_32x32x16_bf16 v[64:79], v[154:157], v[144:147], v[64:79]
    v_cvt_pk_bf16_f32 v133, v42, v43
    v_exp_f32 v46, v46
    v_exp_f32 v47, v47
    v_cvt_pk_bf16_f32 v134, v44, v45
    v_cvt_pk_bf16_f32 v135, v46, v47
    s_setprio 2
    v_mfma_f32_32x32x16_bf16 v[80:95], v[154:157], v[148:151], v[80:95]
    v_exp_f32 v48, v48
    ds_read_b64 v[158:159], v17 offset:40960
    v_exp_f32 v49, v49
    ds_read_b128 v[154:157], v16 offset:40960
    v_exp_f32 v50, v50
    v_exp_f32 v51, v51
    v_cvt_pk_bf16_f32 v136, v48, v49
    v_exp_f32 v52, v52
    s_waitcnt lgkmcnt(2)
    v_mfma_f32_32x32x16_bf16 v[96:111], v[160:163], v[128:131], v[96:111]
    v_exp_f32 v53, v53
    v_cvt_pk_bf16_f32 v137, v50, v51
    v_exp_f32 v54, v54
    v_exp_f32 v55, v55
    v_cvt_pk_bf16_f32 v138, v52, v53
    v_exp_f32 v56, v56
    v_exp_f32 v57, v57
    v_cvt_pk_bf16_f32 v139, v54, v55
    v_mfma_f32_32x32x16_bf16 v[96:111], v[164:167], v[132:135], v[96:111]
    v_exp_f32 v58, v58
    v_exp_f32 v59, v59
    v_cvt_pk_bf16_f32 v140, v56, v57
    v_exp_f32 v60, v60
    v_exp_f32 v61, v61
    v_cvt_pk_bf16_f32 v141, v58, v59
    v_exp_f32 v62, v62
    v_exp_f32 v63, v63
    v_cvt_pk_bf16_f32 v142, v60, v61
    v_cvt_pk_bf16_f32 v143, v62, v63
    s_setprio 1
    s_waitcnt lgkmcnt(0)
    v_mfma_f32_32x32x4_2b_bf16 v[32:63], v[158:159], v[152:153], 0
    v_exp_f32 v64, v64
    v_exp_f32 v65, v65
    v_exp_f32 v66, v66
    v_exp_f32 v67, v67
    v_cvt_pk_bf16_f32 v128, v64, v65
    v_exp_f32 v68, v68
    v_exp_f32 v69, v69
    v_cvt_pk_bf16_f32 v129, v66, v67
    v_exp_f32 v70, v70
    v_mfma_f32_32x32x16_bf16 v[112:127], v[160:163], v[136:139], v[112:127]
    v_exp_f32 v71, v71
    ds_read_b128 v[160:163], v18 offset:17920
    v_cvt_pk_bf16_f32 v130, v68, v69
    v_exp_f32 v72, v72
    v_exp_f32 v73, v73
    v_cvt_pk_bf16_f32 v131, v70, v71
    v_mfma_f32_32x32x16_bf16 v[112:127], v[164:167], v[140:143], v[112:127]
    v_exp_f32 v74, v74
    ds_read_b128 v[164:167], v20 offset:17920
    v_exp_f32 v75, v75
    v_cvt_pk_bf16_f32 v132, v72, v73
    v_exp_f32 v76, v76
    v_exp_f32 v77, v77
    v_mfma_f32_32x32x16_bf16 v[32:47], v[154:157], v[144:147], v[32:47]
    v_cvt_pk_bf16_f32 v133, v74, v75
    v_exp_f32 v78, v78
    v_exp_f32 v79, v79
    v_cvt_pk_bf16_f32 v134, v76, v77
    v_cvt_pk_bf16_f32 v135, v78, v79
    s_setprio 0
    v_mfma_f32_32x32x16_bf16 v[48:63], v[154:157], v[148:151], v[48:63]
    v_exp_f32 v80, v80
    s_mov_b32 s40, s24
    s_mov_b32 s41, s25
    s_mov_b32 s42, 663552
    s_mov_b32 s43, 0x20000
    s_mov_b32 s44, s26
    s_mov_b32 s45, s27
    s_mov_b32 s46, 663552
    s_mov_b32 s47, 0x20000
    s_mov_b32 s48, s12
    s_mov_b32 s49, s13
    s_mov_b32 s50, 663552
    s_mov_b32 s51, 0x20000
    s_lshl_b32 s78, s69, 11
    v_xor_b32 v168, 64, v22
    v_add_u32 v168, 18432, v168
    v_xor_b32 v169, 64, v23
    v_add_u32 v169, 9216, v169
    s_mul_i32 s82, s74, 295168
    s_add_u32 s82, s82, 7872512
    s_and_b32 s81, s66, 15
    s_lshl_b32 s72, s2, 9
    s_add_u32 s72, s72, 15183872
    v_lshl_add_u32 v15, v1, 2, s72
    s_waitcnt vmcnt(0)
    s_cmp_lt_u32 s64, 4
    s_cbranch_scc1 L_pfa
    buffer_load_dword v14, v15, s[52:55], 0 offen sc1
    buffer_load_dword v253, v15, s[52:55], 0 offen offset:256 sc1
L_pfa:
    ds_read_b64 v[158:159], v17 offset:43520
    v_exp_f32 v81, v81
    ds_read_b128 v[154:157], v16 offset:43520
    v_exp_f32 v82, v82
    v_exp_f32 v83, v83
    v_cvt_pk_bf16_f32 v136, v80, v81
    v_exp_f32 v84, v84
    s_waitcnt lgkmcnt(2)
    v_mfma_f32_32x32x16_bf16 v[96:111], v[160:163], v[128:131], v[96:111]
    v_exp_f32 v85, v85
    v_cvt_pk_bf16_f32 v137, v82, v83
    v_exp_f32 v86, v86
    v_exp_f32 v87, v87
    v_cvt_pk_bf16_f32 v138, v84, v85
    v_exp_f32 v88, v88
    v_exp_f32 v89, v89
    v_cvt_pk_bf16_f32 v139, v86, v87
    v_mfma_f32_32x32x16_bf16 v[96:111], v[164:167], v[132:135], v[96:111]
    v_exp_f32 v90, v90
    v_exp_f32 v91, v91
    v_cvt_pk_bf16_f32 v140, v88, v89
    v_exp_f32 v92, v92
    v_exp_f32 v93, v93
    v_cvt_pk_bf16_f32 v141, v90, v91
    v_exp_f32 v94, v94
    v_exp_f32 v95, v95
    v_cvt_pk_bf16_f32 v142, v92, v93
    v_cvt_pk_bf16_f32 v143, v94, v95
    s_setprio 3
    s_waitcnt lgkmcnt(0)
    v_mfma_f32_32x32x4_2b_bf16 v[64:95], v[158:159], v[152:153], 0
    v_exp_f32 v32, v32
    v_exp_f32 v33, v33
    v_exp_f32 v34, v34
    v_exp_f32 v35, v35
    v_cvt_pk_bf16_f32 v128, v32, v33
    v_exp_f32 v36, v36
    v_exp_f32 v37, v37
    v_cvt_pk_bf16_f32 v129, v34, v35
    v_exp_f32 v38, v38
    v_mfma_f32_32x32x16_bf16 v[112:127], v[160:163], v[136:139], v[112:127]
    v_exp_f32 v39, v39
    ds_read_b128 v[160:163], v18 offset:40960
    v_cvt_pk_bf16_f32 v130, v36, v37
    v_exp_f32 v40, v40
    v_exp_f32 v41, v41
    v_cvt_pk_bf16_f32 v131, v38, v39
    v_mfma_f32_32x32x16_bf16 v[112:127], v[164:167], v[140:143], v[112:127]
    v_exp_f32 v42, v42
    ds_read_b128 v[164:167], v20 offset:40960
    v_exp_f32 v43, v43
    v_cvt_pk_bf16_f32 v132, v40, v41
    v_exp_f32 v44, v44
    v_exp_f32 v45, v45
    v_mfma_f32_32x32x16_bf16 v[64:79], v[154:157], v[144:147], v[64:79]
    v_cvt_pk_bf16_f32 v133, v42, v43
    v_exp_f32 v46, v46
    v_exp_f32 v47, v47
    v_cvt_pk_bf16_f32 v134, v44, v45
    v_cvt_pk_bf16_f32 v135, v46, v47
    s_setprio 2
    v_mfma_f32_32x32x16_bf16 v[80:95], v[154:157], v[148:151], v[80:95]
    v_exp_f32 v48, v48
    s_barrier
    s_cmp_ge_u32 s66, 16
    s_cbranch_scc1 Lpf_53
    s_cmp_ge_u32 s81, 9
    s_cselect_b32 s40, s26, s24
    s_cselect_b32 s41, s27, s25
    s_cselect_b32 s77, 1152, 0
    s_lshl_b32 s72, s81, 7
    s_sub_u32 s77, s72, s77
    s_lshl_b32 s72, s81, 10
    s_add_u32 s76, s82, s72
    s_add_u32 s81, s81, 1
    s_cmp_eq_u32 s81, 18
    s_cselect_b32 s81, 0, s81
    s_add_u32 s72, s76, 147584
    s_cmp_lt_u32 s64, 4
    s_cbranch_scc1 Lpf_51
    s_waitcnt vmcnt(0)
    v_xor_b32 v253, v253, v14
    v_xor_b32 v14, s67, v14
    v_or_b32 v14, v14, v253
    v_cmp_ne_u32 vcc, 0, v14
    s_nop 4
    s_cbranch_vccnz Lslow_54
Lok_55:
    s_add_u32 m0, s78, 81920
    s_nop 0
    buffer_load_dwordx4 v22, s[52:55], s76 offen sc1 lds
    s_add_u32 m0, s78, 82944
    s_nop 0
    buffer_load_dwordx4 v168, s[52:55], s76 offen sc1 lds
    s_add_u32 m0, s78, 90112
    s_nop 0
    buffer_load_dwordx4 v22, s[52:55], s72 offen sc1 lds
    s_add_u32 m0, s78, 91136
    s_nop 0
    buffer_load_dwordx4 v168, s[52:55], s72 offen sc1 lds
    s_branch Lpf_52
Lpf_51:
    s_add_u32 m0, s78, 98304
    s_nop 0
    buffer_load_dwordx4 v23, s[40:43], s77 offen lds
    s_add_u32 m0, s78, 99328
    s_nop 0
    buffer_load_dwordx4 v169, s[40:43], s77 offen lds
    s_cmp_lg_u32 s64, 0
    s_cbranch_scc1 Ld_57
    s_mov_b32 m0, 106496
    s_nop 0
    buffer_load_dwordx4 v24, s[40:43], s77 offen lds
Ld_57:
    s_branch Lpf_52
Lpf_53:
    s_cmp_lt_u32 s64, 4
    s_cbranch_scc1 Lpf_52
Lpf_52:
    ds_read_b64 v[158:159], v17 offset:46080
    v_exp_f32 v49, v49
    ds_read_b128 v[154:157], v16 offset:46080
    v_exp_f32 v50, v50
    v_exp_f32 v51, v51
    v_cvt_pk_bf16_f32 v136, v48, v49
    v_exp_f32 v52, v52
    s_waitcnt lgkmcnt(2)
    v_mfma_f32_32x32x16_bf16 v[96:111], v[160:163], v[128:131], v[96:111]
    v_exp_f32 v53, v53
    v_cvt_pk_bf16_f32 v137, v50, v51
    v_exp_f32 v54, v54
    v_exp_f32 v55, v55
    v_cvt_pk_bf16_f32 v138, v52, v53
    v_exp_f32 v56, v56
    v_exp_f32 v57, v57
    v_cvt_pk_bf16_f32 v139, v54, v55
    v_mfma_f32_32x32x16_bf16 v[96:111], v[164:167], v[132:135], v[96:111]
    v_exp_f32 v58, v58
    v_exp_f32 v59, v59
    v_cvt_pk_bf16_f32 v140, v56, v57
    v_exp_f32 v60, v60
    v_exp_f32 v61, v61
    v_cvt_pk_bf16_f32 v141, v58, v59
    v_exp_f32 v62, v62
    v_exp_f32 v63, v63
    v_cvt_pk_bf16_f32 v142, v60, v61
    v_cvt_pk_bf16_f32 v143, v62, v63
    s_setprio 1
    s_waitcnt lgkmcnt(0)
    v_mfma_f32_32x32x4_2b_bf16 v[32:63], v[158:159], v[152:153], 0
    v_exp_f32 v64, v64
    v_exp_f32 v65, v65
    v_exp_f32 v66, v66
    v_exp_f32 v67, v67
    v_cvt_pk_bf16_f32 v128, v64, v65
    v_exp_f32 v68, v68
    v_exp_f32 v69, v69
    v_cvt_pk_bf16_f32 v129, v66, v67
    v_exp_f32 v70, v70
    v_mfma_f32_32x32x16_bf16 v[112:127], v[160:163], v[136:139], v[112:127]
    v_exp_f32 v71, v71
    ds_read_b128 v[160:163], v18 offset:43520
    v_cvt_pk_bf16_f32 v130, v68, v69
    v_exp_f32 v72, v72
    v_exp_f32 v73, v73
    v_cvt_pk_bf16_f32 v131, v70, v71
    v_mfma_f32_32x32x16_bf16 v[112:127], v[164:167], v[140:143], v[112:127]
    v_exp_f32 v74, v74
    ds_read_b128 v[164:167], v20 offset:43520
    v_exp_f32 v75, v75
    v_cvt_pk_bf16_f32 v132, v72, v73
    v_exp_f32 v76, v76
    v_exp_f32 v77, v77
    v_mfma_f32_32x32x16_bf16 v[32:47], v[154:157], v[144:147], v[32:47]
    v_cvt_pk_bf16_f32 v133, v74, v75
    v_exp_f32 v78, v78
    v_exp_f32 v79, v79
    v_cvt_pk_bf16_f32 v134, v76, v77
    v_cvt_pk_bf16_f32 v135, v78, v79
    s_setprio 0
    v_mfma_f32_32x32x16_bf16 v[48:63], v[154:157], v[148:151], v[48:63]
    v_exp_f32 v80, v80
    s_cmp_ge_u32 s66, 16
    s_cbranch_scc1 Lpf_60
    s_cmp_ge_u32 s81, 9
    s_cselect_b32 s40, s26, s24
    s_cselect_b32 s41, s27, s25
    s_cselect_b32 s77, 1152, 0
    s_lshl_b32 s72, s81, 7
    s_sub_u32 s77, s72, s77
    s_lshl_b32 s72, s81, 10
    s_add_u32 s76, s82, s72
    s_add_u32 s81, s81, 1
    s_cmp_eq_u32 s81, 18
    s_cselect_b32 s81, 0, s81
    s_add_u32 s72, s76, 147584
    s_cmp_lt_u32 s64, 4
    s_cbranch_scc1 Lpf_58
    s_add_u32 m0, s78, 107520
    s_nop 0
    buffer_load_dwordx4 v22, s[52:55], s76 offen sc1 lds
    s_add_u32 m0, s78, 108544
    s_nop 0
    buffer_load_dwordx4 v168, s[52:55], s76 offen sc1 lds
    s_add_u32 m0, s78, 115712
    s_nop 0
    buffer_load_dwordx4 v22, s[52:55], s72 offen sc1 lds
    s_add_u32 m0, s78, 116736
    s_nop 0
    buffer_load_dwordx4 v168, s[52:55], s72 offen sc1 lds
    s_branch Lpf_59
Lpf_58:
    s_add_u32 m0, s78, 123904
    s_nop 0
    buffer_load_dwordx4 v23, s[40:43], s77 offen lds
    s_add_u32 m0, s78, 124928
    s_nop 0
    buffer_load_dwordx4 v169, s[40:43], s77 offen lds
    s_cmp_lg_u32 s64, 0
    s_cbranch_scc1 Ld_61
    s_mov_b32 m0, 132096
    s_nop 0
    buffer_load_dwordx4 v24, s[40:43], s77 offen lds
Ld_61:
    s_branch Lpf_59
Lpf_60:
    s_cmp_lt_u32 s64, 4
    s_cbranch_scc1 Lpf_59
Lpf_59:
    ds_read_b64 v[158:159], v17 offset:48640
    v_exp_f32 v81, v81
    ds_read_b128 v[154:157], v16 offset:48640
    v_exp_f32 v82, v82
    v_exp_f32 v83, v83
    v_cvt_pk_bf16_f32 v136, v80, v81
    v_exp_f32 v84, v84
    s_waitcnt lgkmcnt(2)
    v_mfma_f32_32x32x16_bf16 v[96:111], v[160:163], v[128:131], v[96:111]
    v_exp_f32 v85, v85
    v_cvt_pk_bf16_f32 v137, v82, v83
    v_exp_f32 v86, v86
    v_exp_f32 v87, v87
    v_cvt_pk_bf16_f32 v138, v84, v85
    v_exp_f32 v88, v88
    v_exp_f32 v89, v89
    v_cvt_pk_bf16_f32 v139, v86, v87
    v_mfma_f32_32x32x16_bf16 v[96:111], v[164:167], v[132:135], v[96:111]
    v_exp_f32 v90, v90
    v_exp_f32 v91, v91
    v_cvt_pk_bf16_f32 v140, v88, v89
    v_exp_f32 v92, v92
    v_exp_f32 v93, v93
    v_cvt_pk_bf16_f32 v141, v90, v91
    v_exp_f32 v94, v94
    v_exp_f32 v95, v95
    v_cvt_pk_bf16_f32 v142, v92, v93
    v_cvt_pk_bf16_f32 v143, v94, v95
    s_setprio 3
    s_waitcnt lgkmcnt(0)
    v_mfma_f32_32x32x4_2b_bf16 v[64:95], v[158:159], v[152:153], 0
    v_exp_f32 v32, v32
    v_exp_f32 v33, v33
    v_exp_f32 v34, v34
    v_exp_f32 v35, v35
    v_cvt_pk_bf16_f32 v128, v32, v33
    v_exp_f32 v36, v36
    v_exp_f32 v37, v37
    v_cvt_pk_bf16_f32 v129, v34, v35
    v_exp_f32 v38, v38
    v_mfma_f32_32x32x16_bf16 v[112:127], v[160:163], v[136:139], v[112:127]
    v_exp_f32 v39, v39
    ds_read_b128 v[160:163], v18 offset:46080
    v_cvt_pk_bf16_f32 v130, v36, v37
    v_exp_f32 v40, v40
    v_exp_f32 v41, v41
    v_cvt_pk_bf16_f32 v131, v38, v39
    v_mfma_f32_32x32x16_bf16 v[112:127], v[164:167], v[140:143], v[112:127]
    v_exp_f32 v42, v42
    ds_read_b128 v[164:167], v20 offset:46080
    v_exp_f32 v43, v43
    v_cvt_pk_bf16_f32 v132, v40, v41
    v_exp_f32 v44, v44
    v_exp_f32 v45, v45
    v_mfma_f32_32x32x16_bf16 v[64:79], v[154:157], v[144:147], v[64:79]
    v_cvt_pk_bf16_f32 v133, v42, v43
    v_exp_f32 v46, v46
    v_exp_f32 v47, v47
    v_cvt_pk_bf16_f32 v134, v44, v45
    v_cvt_pk_bf16_f32 v135, v46, v47
    s_setprio 2
    v_mfma_f32_32x32x16_bf16 v[80:95], v[154:157], v[148:151], v[80:95]
    v_exp_f32 v48, v48
    s_cmp_ge_u32 s66, 16
    s_cbranch_scc1 Lpf_64
    s_cmp_ge_u32 s81, 9
    s_cselect_b32 s40, s26, s24
    s_cselect_b32 s41, s27, s25
    s_cselect_b32 s77, 1152, 0
    s_lshl_b32 s72, s81, 7
    s_sub_u32 s77, s72, s77
    s_lshl_b32 s72, s81, 10
    s_add_u32 s76, s82, s72
    s_add_u32 s81, s81, 1
    s_cmp_eq_u32 s81, 18
    s_cselect_b32 s81, 0, s81
    s_add_u32 s72, s76, 147584
    s_cmp_lt_u32 s64, 4
    s_cbranch_scc1 Lpf_62
    s_add_u32 m0, s78, 133120
    s_nop 0
    buffer_load_dwordx4 v22, s[52:55], s76 offen sc1 lds
    s_add_u32 m0, s78, 134144
    s_nop 0
    buffer_load_dwordx4 v168, s[52:55], s76 offen sc1 lds
    s_add_u32 m0, s78, 141312
    s_nop 0
    buffer_load_dwordx4 v22, s[52:55], s72 offen sc1 lds
    s_add_u32 m0, s78, 142336
    s_nop 0
    buffer_load_dwordx4 v168, s[52:55], s72 offen sc1 lds
    s_branch Lpf_63
Lpf_62:
    s_add_u32 m0, s78, 149504
    s_nop 0
    buffer_load_dwordx4 v23, s[40:43], s77 offen lds
    s_add_u32 m0, s78, 150528
    s_nop 0
    buffer_load_dwordx4 v169, s[40:43], s77 offen lds
    s_cmp_lg_u32 s64, 0
    s_cbranch_scc1 Ld_65
    s_mov_b32 m0, 157696
    s_nop 0
    buffer_load_dwordx4 v24, s[40:43], s77 offen lds
Ld_65:
    s_branch Lpf_63
Lpf_64:
    s_cmp_lt_u32 s64, 4
    s_cbranch_scc1 Lpf_63
Lpf_63:
    ds_read_b64 v[158:159], v17 offset:51200
    v_exp_f32 v49, v49
    ds_read_b128 v[154:157], v16 offset:51200
    v_exp_f32 v50, v50
    v_exp_f32 v51, v51
    v_cvt_pk_bf16_f32 v136, v48, v49
    v_exp_f32 v52, v52
    s_waitcnt lgkmcnt(2)
    v_mfma_f32_32x32x16_bf16 v[96:111], v[160:163], v[128:131], v[96:111]
    v_exp_f32 v53, v53
    v_cvt_pk_bf16_f32 v137, v50, v51
    v_exp_f32 v54, v54
    v_exp_f32 v55, v55
    v_cvt_pk_bf16_f32 v138, v52, v53
    v_exp_f32 v56, v56
    v_exp_f32 v57, v57
    v_cvt_pk_bf16_f32 v139, v54, v55
    v_mfma_f32_32x32x16_bf16 v[96:111], v[164:167], v[132:135], v[96:111]
    v_exp_f32 v58, v58
    v_exp_f32 v59, v59
    v_cvt_pk_bf16_f32 v140, v56, v57
    v_exp_f32 v60, v60
    v_exp_f32 v61, v61
    v_cvt_pk_bf16_f32 v141, v58, v59
    v_exp_f32 v62, v62
    v_exp_f32 v63, v63
    v_cvt_pk_bf16_f32 v142, v60, v61
    v_cvt_pk_bf16_f32 v143, v62, v63
    s_setprio 1
    s_waitcnt lgkmcnt(0)
    v_mfma_f32_32x32x4_2b_bf16 v[32:63], v[158:159], v[152:153], 0
    v_exp_f32 v64, v64
    v_exp_f32 v65, v65
    v_exp_f32 v66, v66
    v_exp_f32 v67, v67
    v_cvt_pk_bf16_f32 v128, v64, v65
    v_exp_f32 v68, v68
    v_exp_f32 v69, v69
    v_cvt_pk_bf16_f32 v129, v66, v67
    v_exp_f32 v70, v70
    v_mfma_f32_32x32x16_bf16 v[112:127], v[160:163], v[136:139], v[112:127]
    v_exp_f32 v71, v71
    ds_read_b128 v[160:163], v18 offset:48640
    v_cvt_pk_bf16_f32 v130, v68, v69
    v_exp_f32 v72, v72
    v_exp_f32 v73, v73
    v_cvt_pk_bf16_f32 v131, v70, v71
    v_mfma_f32_32x32x16_bf16 v[112:127], v[164:167], v[140:143], v[112:127]
    v_exp_f32 v74, v74
    ds_read_b128 v[164:167], v20 offset:48640
    v_exp_f32 v75, v75
    v_cvt_pk_bf16_f32 v132, v72, v73
    v_exp_f32 v76, v76
    v_exp_f32 v77, v77
    v_mfma_f32_32x32x16_bf16 v[32:47], v[154:157], v[144:147], v[32:47]
    v_cvt_pk_bf16_f32 v133, v74, v75
    v_exp_f32 v78, v78
    v_exp_f32 v79, v79
    v_cvt_pk_bf16_f32 v134, v76, v77
    v_cvt_pk_bf16_f32 v135, v78, v79
    s_setprio 0
    v_mfma_f32_32x32x16_bf16 v[48:63], v[154:157], v[148:151], v[48:63]
    v_exp_f32 v80, v80
    ds_read_b64 v[158:159], v17 offset:53760
    v_exp_f32 v81, v81
    ds_read_b128 v[154:157], v16 offset:53760
    v_exp_f32 v82, v82
    v_exp_f32 v83, v83
    v_cvt_pk_bf16_f32 v136, v80, v81
    v_exp_f32 v84, v84
    s_waitcnt lgkmcnt(2)
    v_mfma_f32_32x32x16_bf16 v[96:111], v[160:163], v[128:131], v[96:111]
    v_exp_f32 v85, v85
    v_cvt_pk_bf16_f32 v137, v82, v83
    v_exp_f32 v86, v86
    v_exp_f32 v87, v87
    v_cvt_pk_bf16_f32 v138, v84, v85
    v_exp_f32 v88, v88
    v_exp_f32 v89, v89
    v_cvt_pk_bf16_f32 v139, v86, v87
    v_mfma_f32_32x32x16_bf16 v[96:111], v[164:167], v[132:135], v[96:111]
    v_exp_f32 v90, v90
    v_exp_f32 v91, v91
    v_cvt_pk_bf16_f32 v140, v88, v89
    v_exp_f32 v92, v92
    v_exp_f32 v93, v93
    v_cvt_pk_bf16_f32 v141, v90, v91
    v_exp_f32 v94, v94
    v_exp_f32 v95, v95
    v_cvt_pk_bf16_f32 v142, v92, v93
    v_cvt_pk_bf16_f32 v143, v94, v95
    s_setprio 3
    s_waitcnt lgkmcnt(0)
    v_mfma_f32_32x32x4_2b_bf16 v[64:95], v[158:159], v[152:153], 0
    v_exp_f32 v32, v32
    v_exp_f32 v33, v33
    v_exp_f32 v34, v34
    v_exp_f32 v35, v35
    v_cvt_pk_bf16_f32 v128, v32, v33
    v_exp_f32 v36, v36
    v_exp_f32 v37, v37
    v_cvt_pk_bf16_f32 v129, v34, v35
    v_exp_f32 v38, v38
    v_mfma_f32_32x32x16_bf16 v[112:127], v[160:163], v[136:139], v[112:127]
    v_exp_f32 v39, v39
    ds_read_b128 v[160:163], v18 offset:51200
    v_cvt_pk_bf16_f32 v130, v36, v37
    v_exp_f32 v40, v40
    v_exp_f32 v41, v41
    v_cvt_pk_bf16_f32 v131, v38, v39
    v_mfma_f32_32x32x16_bf16 v[112:127], v[164:167], v[140:143], v[112:127]
    v_exp_f32 v42, v42
    ds_read_b128 v[164:167], v20 offset:51200
    v_exp_f32 v43, v43
    v_cvt_pk_bf16_f32 v132, v40, v41
    v_exp_f32 v44, v44
    v_exp_f32 v45, v45
    v_mfma_f32_32x32x16_bf16 v[64:79], v[154:157], v[144:147], v[64:79]
    v_cvt_pk_bf16_f32 v133, v42, v43
    v_exp_f32 v46, v46
    v_exp_f32 v47, v47
    v_cvt_pk_bf16_f32 v134, v44, v45
    v_cvt_pk_bf16_f32 v135, v46, v47
    s_setprio 2
    v_mfma_f32_32x32x16_bf16 v[80:95], v[154:157], v[148:151], v[80:95]
    v_exp_f32 v48, v48
    s_cmp_ge_u32 s66, 16
    s_cbranch_scc1 L_noxd
    s_cmp_ge_u32 s64, 4
    s_cbranch_scc1 L_noxd
    s_lshl_b32 s72, s74, 7
    s_lshl_b32 s73, s69, 5
    s_add_u32 s72, s72, s73
    v_add_u32 v4, s72, v2
    v_mul_u32_u24 v4, 1152, v4
    s_mul_i32 s72, s75, 144
    v_lshl_add_u32 v5, v3, 3, s72
    v_add_u32 v4, v4, v5
    s_mov_b32 s72, 18432
    s_mov_b32 s56, s14
    s_mov_b32 s57, s15
    s_mov_b32 s58, 2359296
    s_mov_b32 s59, 0x20000
    buffer_load_dwordx2 v[228:229], v4, s[56:59], 0 offen offset:0
    buffer_load_dwordx2 v[230:231], v4, s[56:59], 0 offen offset:32
    buffer_load_dwordx2 v[232:233], v4, s[56:59], 0 offen offset:64
    buffer_load_dwordx2 v[234:235], v4, s[56:59], 0 offen offset:96
    buffer_load_dwordx2 v[236:237], v4, s[56:59], 0 offen offset:128
    buffer_load_dwordx2 v[238:239], v4, s[56:59], s72 offen offset:0
    buffer_load_dwordx2 v[240:241], v4, s[56:59], s72 offen offset:32
    buffer_load_dwordx2 v[242:243], v4, s[56:59], s72 offen offset:64
    buffer_load_dwordx2 v[244:245], v4, s[56:59], s72 offen offset:96
    buffer_load_dwordx2 v[246:247], v4, s[56:59], s72 offen offset:128
    s_mov_b32 s56, s30
    s_mov_b32 s57, s31
    s_mov_b32 s58, 1152
    s_mov_b32 s59, 0x20000
    buffer_load_dwordx2 v[182:183], v5, s[56:59], 0 offen offset:0
    buffer_load_dwordx2 v[186:187], v5, s[56:59], 0 offen offset:32
    buffer_load_dwordx2 v[190:191], v5, s[56:59], 0 offen offset:64
    buffer_load_dwordx2 v[194:195], v5, s[56:59], 0 offen offset:96
    buffer_load_dwordx2 v[198:199], v5, s[56:59], 0 offen offset:128
L_noxd:
    ds_read_b64 v[158:159], v17 offset:56320
    v_exp_f32 v49, v49
    ds_read_b128 v[154:157], v16 offset:56320
    v_exp_f32 v50, v50
    v_exp_f32 v51, v51
    v_cvt_pk_bf16_f32 v136, v48, v49
    v_exp_f32 v52, v52
    s_waitcnt lgkmcnt(2)
    v_mfma_f32_32x32x16_bf16 v[96:111], v[160:163], v[128:131], v[96:111]
    v_exp_f32 v53, v53
    v_cvt_pk_bf16_f32 v137, v50, v51
    v_exp_f32 v54, v54
    v_exp_f32 v55, v55
    v_cvt_pk_bf16_f32 v138, v52, v53
    v_exp_f32 v56, v56
    v_exp_f32 v57, v57
    v_cvt_pk_bf16_f32 v139, v54, v55
    v_mfma_f32_32x32x16_bf16 v[96:111], v[164:167], v[132:135], v[96:111]
    v_exp_f32 v58, v58
    v_exp_f32 v59, v59
    v_cvt_pk_bf16_f32 v140, v56, v57
    v_exp_f32 v60, v60
    v_exp_f32 v61, v61
    v_cvt_pk_bf16_f32 v141, v58, v59
    v_exp_f32 v62, v62
    v_exp_f32 v63, v63
    v_cvt_pk_bf16_f32 v142, v60, v61
    v_cvt_pk_bf16_f32 v143, v62, v63
    s_setprio 1
    s_waitcnt lgkmcnt(0)
    v_mfma_f32_32x32x4_2b_bf16 v[32:63], v[158:159], v[152:153], 0
    v_exp_f32 v64, v64
    v_exp_f32 v65, v65
    v_exp_f32 v66, v66
    v_exp_f32 v67, v67
    v_cvt_pk_bf16_f32 v128, v64, v65
    v_exp_f32 v68, v68
    v_exp_f32 v69, v69
    v_cvt_pk_bf16_f32 v129, v66, v67
    v_exp_f32 v70, v70
    v_mfma_f32_32x32x16_bf16 v[112:127], v[160:163], v[136:139], v[112:127]
    v_exp_f32 v71, v71
    ds_read_b128 v[160:163], v18 offset:53760
    v_cvt_pk_bf16_f32 v130, v68, v69
    v_exp_f32 v72, v72
    v_exp_f32 v73, v73
    v_cvt_pk_bf16_f32 v131, v70, v71
    v_mfma_f32_32x32x16_bf16 v[112:127], v[164:167], v[140:143], v[112:127]
    v_exp_f32 v74, v74
    ds_read_b128 v[164:167], v20 offset:53760
    v_exp_f32 v75, v75
    v_cvt_pk_bf16_f32 v132, v72, v73
    v_exp_f32 v76, v76
    v_exp_f32 v77, v77
    v_mfma_f32_32x32x16_bf16 v[32:47], v[154:157], v[144:147], v[32:47]
    v_cvt_pk_bf16_f32 v133, v74, v75
    v_exp_f32 v78, v78
    v_exp_f32 v79, v79
    v_cvt_pk_bf16_f32 v134, v76, v77
    v_cvt_pk_bf16_f32 v135, v78, v79
    s_setprio 0
    v_mfma_f32_32x32x16_bf16 v[48:63], v[154:157], v[148:151], v[48:63]
    v_exp_f32 v80, v80
    ds_read_b64 v[158:159], v17 offset:58880
    v_exp_f32 v81, v81
    ds_read_b128 v[154:157], v16 offset:58880
    v_exp_f32 v82, v82
    v_exp_f32 v83, v83
    v_cvt_pk_bf16_f32 v136, v80, v81
    v_exp_f32 v84, v84
    s_waitcnt lgkmcnt(2)
    v_mfma_f32_32x32x16_bf16 v[96:111], v[160:163], v[128:131], v[96:111]
    v_exp_f32 v85, v85
    v_cvt_pk_bf16_f32 v137, v82, v83
    v_exp_f32 v86, v86
    v_exp_f32 v87, v87
    v_cvt_pk_bf16_f32 v138, v84, v85
    v_exp_f32 v88, v88
    v_exp_f32 v89, v89
    v_cvt_pk_bf16_f32 v139, v86, v87
    v_mfma_f32_32x32x16_bf16 v[96:111], v[164:167], v[132:135], v[96:111]
    v_exp_f32 v90, v90
    v_exp_f32 v91, v91
    v_cvt_pk_bf16_f32 v140, v88, v89
    v_exp_f32 v92, v92
    v_exp_f32 v93, v93
    v_cvt_pk_bf16_f32 v141, v90, v91
    v_exp_f32 v94, v94
    v_exp_f32 v95, v95
    v_cvt_pk_bf16_f32 v142, v92, v93
    v_cvt_pk_bf16_f32 v143, v94, v95
    s_setprio 3
    s_waitcnt lgkmcnt(0)
    v_mfma_f32_32x32x4_2b_bf16 v[64:95], v[158:159], v[152:153], 0
    v_exp_f32 v32, v32
    v_exp_f32 v33, v33
    v_exp_f32 v34, v34
    v_exp_f32 v35, v35
    v_cvt_pk_bf16_f32 v128, v32, v33
    v_exp_f32 v36, v36
    v_exp_f32 v37, v37
    v_cvt_pk_bf16_f32 v129, v34, v35
    v_exp_f32 v38, v38
    v_mfma_f32_32x32x16_bf16 v[112:127], v[160:163], v[136:139], v[112:127]
    v_exp_f32 v39, v39
    ds_read_b128 v[160:163], v18 offset:56320
    v_cvt_pk_bf16_f32 v130, v36, v37
    v_exp_f32 v40, v40
    v_exp_f32 v41, v41
    v_cvt_pk_bf16_f32 v131, v38, v39
    v_mfma_f32_32x32x16_bf16 v[112:127], v[164:167], v[140:143], v[112:127]
    v_exp_f32 v42, v42
    ds_read_b128 v[164:167], v20 offset:56320
    v_exp_f32 v43, v43
    v_cvt_pk_bf16_f32 v132, v40, v41
    v_exp_f32 v44, v44
    v_exp_f32 v45, v45
    v_mfma_f32_32x32x16_bf16 v[64:79], v[154:157], v[144:147], v[64:79]
    v_cvt_pk_bf16_f32 v133, v42, v43
    v_exp_f32 v46, v46
    v_exp_f32 v47, v47
    v_cvt_pk_bf16_f32 v134, v44, v45
    v_cvt_pk_bf16_f32 v135, v46, v47
    s_setprio 2
    v_mfma_f32_32x32x16_bf16 v[80:95], v[154:157], v[148:151], v[80:95]
    v_exp_f32 v48, v48
    v_exp_f32 v49, v49
    v_exp_f32 v50, v50
    v_exp_f32 v51, v51
    v_cvt_pk_bf16_f32 v136, v48, v49
    v_exp_f32 v52, v52
    s_waitcnt lgkmcnt(0)
    v_mfma_f32_32x32x16_bf16 v[96:111], v[160:163], v[128:131], v[96:111]
    v_exp_f32 v53, v53
    v_cvt_pk_bf16_f32 v137, v50, v51
    v_exp_f32 v54, v54
    v_exp_f32 v55, v55
    v_cvt_pk_bf16_f32 v138, v52, v53
    v_exp_f32 v56, v56
    v_exp_f32 v57, v57
    v_cvt_pk_bf16_f32 v139, v54, v55
    v_mfma_f32_32x32x16_bf16 v[96:111], v[164:167], v[132:135], v[96:111]
    v_exp_f32 v58, v58
    v_exp_f32 v59, v59
    v_cvt_pk_bf16_f32 v140, v56, v57
    v_exp_f32 v60, v60
    v_exp_f32 v61, v61
    v_cvt_pk_bf16_f32 v141, v58, v59
    v_exp_f32 v62, v62
    v_exp_f32 v63, v63
    v_cvt_pk_bf16_f32 v142, v60, v61
    v_cvt_pk_bf16_f32 v143, v62, v63
    s_setprio 1
    v_exp_f32 v64, v64
    v_exp_f32 v65, v65
    v_exp_f32 v66, v66
    v_exp_f32 v67, v67
    v_cvt_pk_bf16_f32 v128, v64, v65
    v_exp_f32 v68, v68
    v_exp_f32 v69, v69
    v_cvt_pk_bf16_f32 v129, v66, v67
    v_exp_f32 v70, v70
    v_mfma_f32_32x32x16_bf16 v[112:127], v[160:163], v[136:139], v[112:127]
    v_exp_f32 v71, v71
    ds_read_b128 v[160:163], v18 offset:58880
    v_cvt_pk_bf16_f32 v130, v68, v69
    v_exp_f32 v72, v72
    v_exp_f32 v73, v73
    v_cvt_pk_bf16_f32 v131, v70, v71
    v_mfma_f32_32x32x16_bf16 v[112:127], v[164:167], v[140:143], v[112:127]
    v_exp_f32 v74, v74
    ds_read_b128 v[164:167], v20 offset:58880
    v_exp_f32 v75, v75
    v_cvt_pk_bf16_f32 v132, v72, v73
    v_exp_f32 v76, v76
    v_exp_f32 v77, v77
    v_cvt_pk_bf16_f32 v133, v74, v75
    v_exp_f32 v78, v78
    v_exp_f32 v79, v79
    v_cvt_pk_bf16_f32 v134, v76, v77
    v_cvt_pk_bf16_f32 v135, v78, v79
    s_setprio 0
    v_exp_f32 v80, v80
    v_exp_f32 v81, v81
    v_exp_f32 v82, v82
    v_exp_f32 v83, v83
    v_cvt_pk_bf16_f32 v136, v80, v81
    v_exp_f32 v84, v84
    s_waitcnt lgkmcnt(0)
    v_mfma_f32_32x32x16_bf16 v[96:111], v[160:163], v[128:131], v[96:111]
    v_exp_f32 v85, v85
    v_cvt_pk_bf16_f32 v137, v82, v83
    v_exp_f32 v86, v86
    v_exp_f32 v87, v87
    v_cvt_pk_bf16_f32 v138, v84, v85
    v_exp_f32 v88, v88
    v_exp_f32 v89, v89
    v_cvt_pk_bf16_f32 v139, v86, v87
    v_mfma_f32_32x32x16_bf16 v[96:111], v[164:167], v[132:135], v[96:111]
    v_exp_f32 v90, v90
    v_exp_f32 v91, v91
    v_cvt_pk_bf16_f32 v140, v88, v89
    v_exp_f32 v92, v92
    v_exp_f32 v93, v93
    v_cvt_pk_bf16_f32 v141, v90, v91
    v_exp_f32 v94, v94
    v_exp_f32 v95, v95
    v_cvt_pk_bf16_f32 v142, v92, v93
    v_cvt_pk_bf16_f32 v143, v94, v95
    v_mfma_f32_32x32x16_bf16 v[112:127], v[160:163], v[136:139], v[112:127]
    s_nop 0
    v_mfma_f32_32x32x16_bf16 v[112:127], v[164:167], v[140:143], v[112:127]
    s_setprio 0
    s_waitcnt vmcnt(0)
    s_mul_i32 s72, s64, 2816
    s_add_u32 s72, s72, 0
    v_add_u32 v6, s72, v19
    s_xor_b32 s73, s64, 4
    s_mul_i32 s73, s73, 2816
    s_add_u32 s73, s73, 0
    v_add_u32 v7, s73, v19
    v_lshlrev_b32 v8, 3, v1
    v_add_u32 v9, s73, v8
    v_add_u32 v8, s72, v8
    v_lshlrev_b32 v12, 2, v1
    v_add_u32 v13, s73, v12
    v_add_u32 v12, s72, v12
    s_lshl_b32 s72, s64, 2
    s_add_u32 s72, s72, 22528
    v_mov_b32 v10, s72
    v_and_b32 v11, 7, v1
    v_lshlrev_b32 v11, 2, v11
    v_maximum3_f32 v4, |v96|, |v97|, |v98|
    v_maximum3_f32 v4, v4, |v99|, |v100|
    v_maximum3_f32 v4, v4, |v101|, |v102|
    v_maximum3_f32 v4, v4, |v103|, |v104|
    v_maximum3_f32 v4, v4, |v105|, |v106|
    v_maximum3_f32 v4, v4, |v112|, |v113|
    v_maximum3_f32 v4, v4, |v114|, |v115|
    v_maximum3_f32 v4, v4, |v116|, |v117|
    v_maximum3_f32 v4, v4, |v118|, |v119|
    v_maximum3_f32 v4, v4, |v120|, |v121|
    v_maximum3_f32 v4, v4, |v122|, |v122|
    v_mov_b32 v5, 0x7b800000
    v_cmp_nlt_f32 vcc, v4, v5
    s_nop 1
    s_cmp_lg_u64 vcc, 0
    s_cselect_b32 s72, 1, 0
    v_mov_b32 v5, s72
    ds_write_b32 v10, v5
    s_cmp_lg_u32 s70, 0
    s_cbranch_scc1 L_att_hi
    ds_write_b128 v6, v[112:115]
    ds_write_b128 v6, v[116:119] offset:1024
    ds_write_b64 v8, v[120:121] offset:2048
    ds_write_b32 v12, v122 offset:2560
    s_lshl_b32 s80, s5, 3
    s_lshl_b32 s73, s69, 1
    s_add_u32 s80, s80, s73
    s_add_u32 s80, s80, 0
    s_lshl_b32 s73, s4, 6
    s_add_u32 s80, s80, s73
    s_lshl_b32 s72, s80, 10
    s_add_u32 s72, s72, 12595200
    s_lshl_b32 s73, s80, 7
    s_add_u32 s73, s73, 14692352
    v_lshlrev_b32 v5, 2, v1
    s_waitcnt lgkmcnt(0)
    s_barrier
    ds_read_b32 v4, v11 offset:22528
    ds_read_b32 v42, v13 offset:2560
    ds_read_b128 v[32:35], v7
    ds_read_b128 v[36:39], v7 offset:1024
    ds_read_b64 v[40:41], v9 offset:2048
    s_waitcnt lgkmcnt(4)
    v_cmp_ne_u32 vcc, 0, v4
    s_nop 4
    s_cbranch_vccnz L_fallback0
L_att_fin0:
    s_waitcnt lgkmcnt(3)
    v_add_f32 v4, v106, v42
    v_mov_b32 v42, v4
    s_nop 1
    v_permlane32_swap_b32 v4, v42
    v_rcp_f32 v4, v4
    s_waitcnt lgkmcnt(2)
    v_pk_add_f32 v[32:33], v[32:33], v[96:97]
    v_pk_add_f32 v[34:35], v[34:35], v[98:99]
    s_waitcnt lgkmcnt(1)
    v_pk_add_f32 v[36:37], v[36:37], v[100:101]
    v_pk_add_f32 v[38:39], v[38:39], v[102:103]
    s_waitcnt lgkmcnt(0)
    v_pk_add_f32 v[40:41], v[40:41], v[104:105]
    v_pk_mul_f32 v[32:33], v[32:33], v[4:5] op_sel_hi:[1,0]
    v_pk_mul_f32 v[34:35], v[34:35], v[4:5] op_sel_hi:[1,0]
    v_pk_mul_f32 v[36:37], v[36:37], v[4:5] op_sel_hi:[1,0]
    v_pk_mul_f32 v[38:39], v[38:39], v[4:5] op_sel_hi:[1,0]
    v_pk_mul_f32 v[40:41], v[40:41], v[4:5] op_sel_hi:[1,0]
    v_cvt_pk_bf16_f32 v32, v32, v33
    v_cvt_pk_bf16_f32 v33, v34, v35
    v_cvt_pk_bf16_f32 v34, v36, v37
    v_cvt_pk_bf16_f32 v35, v38, v39
    v_cvt_pk_bf16_f32 v36, v40, v41
    buffer_store_dwordx4 v[32:35], v19, s[52:55], s72 offen sc1
    s_mov_b32 exec_hi, 0
    buffer_store_dword v36, v5, s[52:55], s73 offen sc1
    s_mov_b32 exec_hi, -1
    s_branch L_tail_c
L_att_hi:
    ds_write_b128 v6, v[96:99]
    ds_write_b128 v6, v[100:103] offset:1024
    ds_write_b64 v8, v[104:105] offset:2048
    ds_write_b32 v12, v106 offset:2560
    s_lshl_b32 s80, s5, 3
    s_lshl_b32 s73, s69, 1
    s_add_u32 s80, s80, s73
    s_add_u32 s80, s80, 1
    s_lshl_b32 s73, s4, 6
    s_add_u32 s80, s80, s73
    s_lshl_b32 s72, s80, 10
    s_add_u32 s72, s72, 12595200
    s_lshl_b32 s73, s80, 7
    s_add_u32 s73, s73, 14692352
    v_lshlrev_b32 v5, 2, v1
    s_waitcnt lgkmcnt(0)
    s_barrier
    ds_read_b32 v4, v11 offset:22528
    ds_read_b32 v42, v13 offset:2560
    ds_read_b128 v[32:35], v7
    ds_read_b128 v[36:39], v7 offset:1024
    ds_read_b64 v[40:41], v9 offset:2048
    s_mov_b32 s83, s72
    s_cmp_ge_u32 s66, 16
    s_cbranch_scc1 L_early
    s_cmp_ge_u32 s81, 9
    s_cselect_b32 s40, s26, s24
    s_cselect_b32 s41, s27, s25
    s_cselect_b32 s77, 1152, 0
    s_lshl_b32 s72, s81, 7
    s_sub_u32 s77, s72, s77
    s_lshl_b32 s72, s81, 10
    s_add_u32 s76, s82, s72
    s_add_u32 s81, s81, 1
    s_cmp_eq_u32 s81, 18
    s_cselect_b32 s81, 0, s81
    s_add_u32 s72, s76, 147584
    s_add_u32 m0, s78, 56320
    s_nop 0
    buffer_load_dwordx4 v22, s[52:55], s76 offen sc1 lds
    s_add_u32 m0, s78, 57344
    s_nop 0
    buffer_load_dwordx4 v168, s[52:55], s76 offen sc1 lds
    s_add_u32 m0, s78, 64512
    s_nop 0
    buffer_load_dwordx4 v22, s[52:55], s72 offen sc1 lds
    s_add_u32 m0, s78, 65536
    s_nop 0
    buffer_load_dwordx4 v168, s[52:55], s72 offen sc1 lds
    s_add_u32 m0, s78, 72704
    s_nop 0
    buffer_load_dwordx4 v23, s[40:43], s77 offen lds
    s_add_u32 m0, s78, 73728
    s_nop 0
    buffer_load_dwordx4 v169, s[40:43], s77 offen lds
    s_cmp_lg_u32 s64, 4
    s_cbranch_scc1 Ld_66
    s_mov_b32 m0, 80896
    s_nop 0
    buffer_load_dwordx4 v24, s[40:43], s77 offen lds
Ld_66:
L_early:
    s_mov_b32 s72, s83
    s_waitcnt lgkmcnt(4)
    v_cmp_ne_u32 vcc, 0, v4
    s_nop 4
    s_cbranch_vccnz L_fallback1
L_att_fin1:
    s_waitcnt lgkmcnt(3)
    v_add_f32 v4, v122, v42
    v_mov_b32 v42, v4
    s_nop 1
    v_permlane32_swap_b32 v4, v42
    v_rcp_f32 v4, v4
    s_waitcnt lgkmcnt(2)
    v_pk_add_f32 v[32:33], v[32:33], v[112:113]
    v_pk_add_f32 v[34:35], v[34:35], v[114:115]
    s_waitcnt lgkmcnt(1)
    v_pk_add_f32 v[36:37], v[36:37], v[116:117]
    v_pk_add_f32 v[38:39], v[38:39], v[118:119]
    s_waitcnt lgkmcnt(0)
    v_pk_add_f32 v[40:41], v[40:41], v[120:121]
    v_pk_mul_f32 v[32:33], v[32:33], v[4:5] op_sel_hi:[1,0]
    v_pk_mul_f32 v[34:35], v[34:35], v[4:5] op_sel_hi:[1,0]
    v_pk_mul_f32 v[36:37], v[36:37], v[4:5] op_sel_hi:[1,0]
    v_pk_mul_f32 v[38:39], v[38:39], v[4:5] op_sel_hi:[1,0]
    v_pk_mul_f32 v[40:41], v[40:41], v[4:5] op_sel_hi:[1,0]
    v_cvt_pk_bf16_f32 v32, v32, v33
    v_cvt_pk_bf16_f32 v33, v34, v35
    v_cvt_pk_bf16_f32 v34, v36, v37
    v_cvt_pk_bf16_f32 v35, v38, v39
    v_cvt_pk_bf16_f32 v36, v40, v41
    buffer_store_dwordx4 v[32:35], v19, s[52:55], s72 offen sc1
    s_mov_b32 exec_hi, 0
    buffer_store_dword v36, v5, s[52:55], s73 offen sc1
    s_mov_b32 exec_hi, -1
    s_cmp_ge_u32 s66, 16
    s_cbranch_scc1 L_tail_la
    s_waitcnt vmcnt(0)
    v_and_b32 v12, 3, v1
    v_lshlrev_b32 v12, 14, v12
    v_bfe_u32 v13, v1, 2, 1
    v_lshl_add_u32 v12, v13, 11, v12
    v_mov_b32 v13, s67
    s_mov_b64 exec, 255
    buffer_store_dword v13, v12, s[52:55], s79 offen sc1
    s_mov_b64 exec, -1
    s_cmp_ge_u32 s81, 9
    s_cselect_b32 s40, s26, s24
    s_cselect_b32 s41, s27, s25
    s_cselect_b32 s77, 1152, 0
    s_lshl_b32 s72, s81, 7
    s_sub_u32 s77, s72, s77
    s_lshl_b32 s72, s81, 10
    s_add_u32 s76, s82, s72
    s_add_u32 s81, s81, 1
    s_cmp_eq_u32 s81, 18
    s_cselect_b32 s81, 0, s81
    s_add_u32 s72, s76, 147584
    s_add_u32 m0, s78, 30720
    s_nop 0
    buffer_load_dwordx4 v22, s[52:55], s76 offen sc1 lds
    s_add_u32 m0, s78, 31744
    s_nop 0
    buffer_load_dwordx4 v168, s[52:55], s76 offen sc1 lds
    s_add_u32 m0, s78, 38912
    s_nop 0
    buffer_load_dwordx4 v22, s[52:55], s72 offen sc1 lds
    s_add_u32 m0, s78, 39936
    s_nop 0
    buffer_load_dwordx4 v168, s[52:55], s72 offen sc1 lds
    s_add_u32 m0, s78, 47104
    s_nop 0
    buffer_load_dwordx4 v23, s[40:43], s77 offen lds
    s_add_u32 m0, s78, 48128
    s_nop 0
    buffer_load_dwordx4 v169, s[40:43], s77 offen lds
    s_cmp_lg_u32 s64, 4
    s_cbranch_scc1 Ld_67
    s_mov_b32 m0, 55296
    s_nop 0
    buffer_load_dwordx4 v24, s[40:43], s77 offen lds
Ld_67:
    s_barrier
    s_cmp_ge_u32 s81, 9
    s_cselect_b32 s40, s26, s24
    s_cselect_b32 s41, s27, s25
    s_cselect_b32 s77, 1152, 0
    s_lshl_b32 s72, s81, 7
    s_sub_u32 s77, s72, s77
    s_lshl_b32 s72, s81, 10
    s_add_u32 s76, s82, s72
    s_add_u32 s81, s81, 1
    s_cmp_eq_u32 s81, 18
    s_cselect_b32 s81, 0, s81
    s_add_u32 s72, s76, 147584
    s_add_u32 m0, s78, 0
    s_nop 0
    buffer_load_dwordx4 v22, s[52:55], s76 offen sc1 lds
    s_add_u32 m0, s78, 1024
    s_nop 0
    buffer_load_dwordx4 v168, s[52:55], s76 offen sc1 lds
    s_add_u32 m0, s78, 8192
    s_nop 0
    buffer_load_dwordx4 v22, s[52:55], s72 offen sc1 lds
    s_add_u32 m0, s78, 9216
    s_nop 0
    buffer_load_dwordx4 v168, s[52:55], s72 offen sc1 lds
    s_add_u32 m0, s78, 16384
    s_nop 0
    buffer_load_dwordx4 v23, s[40:43], s77 offen lds
    s_add_u32 m0, s78, 17408
    s_nop 0
    buffer_load_dwordx4 v169, s[40:43], s77 offen lds
    s_cmp_lg_u32 s64, 4
    s_cbranch_scc1 Ld_68
    s_mov_b32 m0, 24576
    s_nop 0
    buffer_load_dwordx4 v24, s[40:43], s77 offen lds
Ld_68:
    s_cmp_ge_u32 s81, 9
    s_cselect_b32 s40, s26, s24
    s_cselect_b32 s41, s27, s25
    s_cselect_b32 s77, 1152, 0
    s_lshl_b32 s72, s81, 7
    s_sub_u32 s77, s72, s77
    s_lshl_b32 s72, s81, 10
    s_add_u32 s76, s82, s72
    s_add_u32 s81, s81, 1
    s_cmp_eq_u32 s81, 18
    s_cselect_b32 s81, 0, s81
    s_add_u32 s72, s76, 147584
    s_add_u32 m0, s78, 81920
    s_nop 0
    buffer_load_dwordx4 v22, s[52:55], s76 offen sc1 lds
    s_add_u32 m0, s78, 82944
    s_nop 0
    buffer_load_dwordx4 v168, s[52:55], s76 offen sc1 lds
    s_add_u32 m0, s78, 90112
    s_nop 0
    buffer_load_dwordx4 v22, s[52:55], s72 offen sc1 lds
    s_add_u32 m0, s78, 91136
    s_nop 0
    buffer_load_dwordx4 v168, s[52:55], s72 offen sc1 lds
    s_add_u32 m0, s78, 98304
    s_nop 0
    buffer_load_dwordx4 v23, s[40:43], s77 offen lds
    s_add_u32 m0, s78, 99328
    s_nop 0
    buffer_load_dwordx4 v169, s[40:43], s77 offen lds
    s_cmp_lg_u32 s64, 4
    s_cbranch_scc1 Ld_69
    s_mov_b32 m0, 106496
    s_nop 0
    buffer_load_dwordx4 v24, s[40:43], s77 offen lds
Ld_69:
    s_waitcnt vmcnt(12)
    s_barrier
    s_cmp_ge_u32 s81, 9
    s_cselect_b32 s40, s26, s24
    s_cselect_b32 s41, s27, s25
    s_cselect_b32 s77, 1152, 0
    s_lshl_b32 s72, s81, 7
    s_sub_u32 s77, s72, s77
    s_lshl_b32 s72, s81, 10
    s_add_u32 s76, s82, s72
    s_add_u32 s81, s81, 1
    s_cmp_eq_u32 s81, 18
    s_cselect_b32 s81, 0, s81
    s_add_u32 s72, s76, 147584
    s_add_u32 m0, s78, 107520
    s_nop 0
    buffer_load_dwordx4 v22, s[52:55], s76 offen sc1 lds
    s_add_u32 m0, s78, 108544
    s_nop 0
    buffer_load_dwordx4 v168, s[52:55], s76 offen sc1 lds
    s_add_u32 m0, s78, 115712
    s_nop 0
    buffer_load_dwordx4 v22, s[52:55], s72 offen sc1 lds
    s_add_u32 m0, s78, 116736
    s_nop 0
    buffer_load_dwordx4 v168, s[52:55], s72 offen sc1 lds
    s_add_u32 m0, s78, 123904
    s_nop 0
    buffer_load_dwordx4 v23, s[40:43], s77 offen lds
    s_add_u32 m0, s78, 124928
    s_nop 0
    buffer_load_dwordx4 v169, s[40:43], s77 offen lds
    s_cmp_lg_u32 s64, 4
    s_cbranch_scc1 Ld_70
    s_mov_b32 m0, 132096
    s_nop 0
    buffer_load_dwordx4 v24, s[40:43], s77 offen lds
Ld_70:
    s_cmp_ge_u32 s81, 9
    s_cselect_b32 s40, s26, s24
    s_cselect_b32 s41, s27, s25
    s_cselect_b32 s77, 1152, 0
    s_lshl_b32 s72, s81, 7
    s_sub_u32 s77, s72, s77
    s_lshl_b32 s72, s81, 10
    s_add_u32 s76, s82, s72
    s_add_u32 s81, s81, 1
    s_cmp_eq_u32 s81, 18
    s_cselect_b32 s81, 0, s81
    s_add_u32 s72, s76, 147584
    s_add_u32 m0, s78, 133120
    s_nop 0
    buffer_load_dwordx4 v22, s[52:55], s76 offen sc1 lds
    s_add_u32 m0, s78, 134144
    s_nop 0
    buffer_load_dwordx4 v168, s[52:55], s76 offen sc1 lds
    s_add_u32 m0, s78, 141312
    s_nop 0
    buffer_load_dwordx4 v22, s[52:55], s72 offen sc1 lds
    s_add_u32 m0, s78, 142336
    s_nop 0
    buffer_load_dwordx4 v168, s[52:55], s72 offen sc1 lds
    s_add_u32 m0, s78, 149504
    s_nop 0
    buffer_load_dwordx4 v23, s[40:43], s77 offen lds
    s_add_u32 m0, s78, 150528
    s_nop 0
    buffer_load_dwordx4 v169, s[40:43], s77 offen lds
    s_cmp_lg_u32 s64, 4
    s_cbranch_scc1 Ld_71
    s_mov_b32 m0, 157696
    s_nop 0
    buffer_load_dwordx4 v24, s[40:43], s77 offen lds
Ld_71:
    s_waitcnt vmcnt(18)
    s_barrier
    s_cmp_ge_u32 s81, 9
    s_cselect_b32 s40, s26, s24
    s_cselect_b32 s41, s27, s25
    s_cselect_b32 s77, 1152, 0
    s_lshl_b32 s72, s81, 7
    s_sub_u32 s77, s72, s77
    s_lshl_b32 s72, s81, 10
    s_add_u32 s76, s82, s72
    s_add_u32 s81, s81, 1
    s_cmp_eq_u32 s81, 18
    s_cselect_b32 s81, 0, s81
    s_add_u32 s72, s76, 147584
    s_add_u32 m0, s78, 56320
    s_nop 0
    buffer_load_dwordx4 v22, s[52:55], s76 offen sc1 lds
    s_add_u32 m0, s78, 57344
    s_nop 0
    buffer_load_dwordx4 v168, s[52:55], s76 offen sc1 lds
    s_add_u32 m0, s78, 64512
    s_nop 0
    buffer_load_dwordx4 v22, s[52:55], s72 offen sc1 lds
    s_add_u32 m0, s78, 65536
    s_nop 0
    buffer_load_dwordx4 v168, s[52:55], s72 offen sc1 lds
    s_add_u32 m0, s78, 72704
    s_nop 0
    buffer_load_dwordx4 v23, s[40:43], s77 offen lds
    s_add_u32 m0, s78, 73728
    s_nop 0
    buffer_load_dwordx4 v169, s[40:43], s77 offen lds
    s_cmp_lg_u32 s64, 4
    s_cbranch_scc1 Ld_72
    s_mov_b32 m0, 80896
    s_nop 0
    buffer_load_dwordx4 v24, s[40:43], s77 offen lds
Ld_72:
    s_cmp_ge_u32 s81, 9
    s_cselect_b32 s40, s26, s24
    s_cselect_b32 s41, s27, s25
    s_cselect_b32 s77, 1152, 0
    s_lshl_b32 s72, s81, 7
    s_sub_u32 s77, s72, s77
    s_lshl_b32 s72, s81, 10
    s_add_u32 s76, s82, s72
    s_add_u32 s81, s81, 1
    s_cmp_eq_u32 s81, 18
    s_cselect_b32 s81, 0, s81
    s_add_u32 s72, s76, 147584
    s_add_u32 m0, s78, 30720
    s_nop 0
    buffer_load_dwordx4 v22, s[52:55], s76 offen sc1 lds
    s_add_u32 m0, s78, 31744
    s_nop 0
    buffer_load_dwordx4 v168, s[52:55], s76 offen sc1 lds
    s_add_u32 m0, s78, 38912
    s_nop 0
    buffer_load_dwordx4 v22, s[52:55], s72 offen sc1 lds
    s_add_u32 m0, s78, 39936
    s_nop 0
    buffer_load_dwordx4 v168, s[52:55], s72 offen sc1 lds
    s_add_u32 m0, s78, 47104
    s_nop 0
    buffer_load_dwordx4 v23, s[40:43], s77 offen lds
    s_add_u32 m0, s78, 48128
    s_nop 0
    buffer_load_dwordx4 v169, s[40:43], s77 offen lds
    s_cmp_lg_u32 s64, 4
    s_cbranch_scc1 Ld_73
    s_mov_b32 m0, 55296
    s_nop 0
    buffer_load_dwordx4 v24, s[40:43], s77 offen lds
Ld_73:
    s_waitcnt vmcnt(24)
    s_barrier
    s_cmp_ge_u32 s81, 9
    s_cselect_b32 s40, s26, s24
    s_cselect_b32 s41, s27, s25
    s_cselect_b32 s77, 1152, 0
    s_lshl_b32 s72, s81, 7
    s_sub_u32 s77, s72, s77
    s_lshl_b32 s72, s81, 10
    s_add_u32 s76, s82, s72
    s_add_u32 s81, s81, 1
    s_cmp_eq_u32 s81, 18
    s_cselect_b32 s81, 0, s81
    s_add_u32 s72, s76, 147584
    s_add_u32 m0, s78, 0
    s_nop 0
    buffer_load_dwordx4 v22, s[52:55], s76 offen sc1 lds
    s_add_u32 m0, s78, 1024
    s_nop 0
    buffer_load_dwordx4 v168, s[52:55], s76 offen sc1 lds
    s_add_u32 m0, s78, 8192
    s_nop 0
    buffer_load_dwordx4 v22, s[52:55], s72 offen sc1 lds
    s_add_u32 m0, s78, 9216
    s_nop 0
    buffer_load_dwordx4 v168, s[52:55], s72 offen sc1 lds
    s_add_u32 m0, s78, 16384
    s_nop 0
    buffer_load_dwordx4 v23, s[40:43], s77 offen lds
    s_add_u32 m0, s78, 17408
    s_nop 0
    buffer_load_dwordx4 v169, s[40:43], s77 offen lds
    s_cmp_lg_u32 s64, 4
    s_cbranch_scc1 Ld_74
    s_mov_b32 m0, 24576
    s_nop 0
    buffer_load_dwordx4 v24, s[40:43], s77 offen lds
Ld_74:
    s_waitcnt vmcnt(24)
    s_barrier
    s_cmp_ge_u32 s81, 9
    s_cselect_b32 s40, s26, s24
    s_cselect_b32 s41, s27, s25
    s_cselect_b32 s77, 1152, 0
    s_lshl_b32 s72, s81, 7
    s_sub_u32 s77, s72, s77
    s_lshl_b32 s72, s81, 10
    s_add_u32 s76, s82, s72
    s_add_u32 s81, s81, 1
    s_cmp_eq_u32 s81, 18
    s_cselect_b32 s81, 0, s81
    s_add_u32 s72, s76, 147584
    s_add_u32 m0, s78, 81920
    s_nop 0
    buffer_load_dwordx4 v22, s[52:55], s76 offen sc1 lds
    s_add_u32 m0, s78, 82944
    s_nop 0
    buffer_load_dwordx4 v168, s[52:55], s76 offen sc1 lds
    s_add_u32 m0, s78, 90112
    s_nop 0
    buffer_load_dwordx4 v22, s[52:55], s72 offen sc1 lds
    s_add_u32 m0, s78, 91136
    s_nop 0
    buffer_load_dwordx4 v168, s[52:55], s72 offen sc1 lds
    s_add_u32 m0, s78, 98304
    s_nop 0
    buffer_load_dwordx4 v23, s[40:43], s77 offen lds
    s_add_u32 m0, s78, 99328
    s_nop 0
    buffer_load_dwordx4 v169, s[40:43], s77 offen lds
    s_cmp_lg_u32 s64, 4
    s_cbranch_scc1 Ld_75
    s_mov_b32 m0, 106496
    s_nop 0
    buffer_load_dwordx4 v24, s[40:43], s77 offen lds
Ld_75:
    s_waitcnt vmcnt(24)
    s_barrier
    s_cmp_ge_u32 s81, 9
    s_cselect_b32 s40, s26, s24
    s_cselect_b32 s41, s27, s25
    s_cselect_b32 s77, 1152, 0
    s_lshl_b32 s72, s81, 7
    s_sub_u32 s77, s72, s77
    s_lshl_b32 s72, s81, 10
    s_add_u32 s76, s82, s72
    s_add_u32 s81, s81, 1
    s_cmp_eq_u32 s81, 18
    s_cselect_b32 s81, 0, s81
    s_add_u32 s72, s76, 147584
    s_add_u32 m0, s78, 107520
    s_nop 0
    buffer_load_dwordx4 v22, s[52:55], s76 offen sc1 lds
    s_add_u32 m0, s78, 108544
    s_nop 0
    buffer_load_dwordx4 v168, s[52:55], s76 offen sc1 lds
    s_add_u32 m0, s78, 115712
    s_nop 0
    buffer_load_dwordx4 v22, s[52:55], s72 offen sc1 lds
    s_add_u32 m0, s78, 116736
    s_nop 0
    buffer_load_dwordx4 v168, s[52:55], s72 offen sc1 lds
    s_add_u32 m0, s78, 123904
    s_nop 0
    buffer_load_dwordx4 v23, s[40:43], s77 offen lds
    s_add_u32 m0, s78, 124928
    s_nop 0
    buffer_load_dwordx4 v169, s[40:43], s77 offen lds
    s_cmp_lg_u32 s64, 4
    s_cbranch_scc1 Ld_76
    s_mov_b32 m0, 132096
    s_nop 0
    buffer_load_dwordx4 v24, s[40:43], s77 offen lds
Ld_76:
    s_waitcnt vmcnt(24)
    s_barrier
    s_cmp_ge_u32 s81, 9
    s_cselect_b32 s40, s26, s24
    s_cselect_b32 s41, s27, s25
    s_cselect_b32 s77, 1152, 0
    s_lshl_b32 s72, s81, 7
    s_sub_u32 s77, s72, s77
    s_lshl_b32 s72, s81, 10
    s_add_u32 s76, s82, s72
    s_add_u32 s81, s81, 1
    s_cmp_eq_u32 s81, 18
    s_cselect_b32 s81, 0, s81
    s_add_u32 s72, s76, 147584
    s_add_u32 m0, s78, 133120
    s_nop 0
    buffer_load_dwordx4 v22, s[52:55], s76 offen sc1 lds
    s_add_u32 m0, s78, 134144
    s_nop 0
    buffer_load_dwordx4 v168, s[52:55], s76 offen sc1 lds
    s_add_u32 m0, s78, 141312
    s_nop 0
    buffer_load_dwordx4 v22, s[52:55], s72 offen sc1 lds
    s_add_u32 m0, s78, 142336
    s_nop 0
    buffer_load_dwordx4 v168, s[52:55], s72 offen sc1 lds
    s_add_u32 m0, s78, 149504
    s_nop 0
    buffer_load_dwordx4 v23, s[40:43], s77 offen lds
    s_add_u32 m0, s78, 150528
    s_nop 0
    buffer_load_dwordx4 v169, s[40:43], s77 offen lds
    s_cmp_lg_u32 s64, 4
    s_cbranch_scc1 Ld_77
    s_mov_b32 m0, 157696
    s_nop 0
    buffer_load_dwordx4 v24, s[40:43], s77 offen lds
Ld_77:
    s_waitcnt vmcnt(24)
    s_barrier
    s_cmp_ge_u32 s81, 9
    s_cselect_b32 s40, s26, s24
    s_cselect_b32 s41, s27, s25
    s_cselect_b32 s77, 1152, 0
    s_lshl_b32 s72, s81, 7
    s_sub_u32 s77, s72, s77
    s_lshl_b32 s72, s81, 10
    s_add_u32 s76, s82, s72
    s_add_u32 s81, s81, 1
    s_cmp_eq_u32 s81, 18
    s_cselect_b32 s81, 0, s81
    s_add_u32 s72, s76, 147584
    s_add_u32 m0, s78, 56320
    s_nop 0
    buffer_load_dwordx4 v22, s[52:55], s76 offen sc1 lds
    s_add_u32 m0, s78, 57344
    s_nop 0
    buffer_load_dwordx4 v168, s[52:55], s76 offen sc1 lds
    s_add_u32 m0, s78, 64512
    s_nop 0
    buffer_load_dwordx4 v22, s[52:55], s72 offen sc1 lds
    s_add_u32 m0, s78, 65536
    s_nop 0
    buffer_load_dwordx4 v168, s[52:55], s72 offen sc1 lds
    s_add_u32 m0, s78, 72704
    s_nop 0
    buffer_load_dwordx4 v23, s[40:43], s77 offen lds
    s_add_u32 m0, s78, 73728
    s_nop 0
    buffer_load_dwordx4 v169, s[40:43], s77 offen lds
    s_cmp_lg_u32 s64, 4
    s_cbranch_scc1 Ld_78
    s_mov_b32 m0, 80896
    s_nop 0
    buffer_load_dwordx4 v24, s[40:43], s77 offen lds
Ld_78:
    s_waitcnt vmcnt(24)
    s_barrier
    s_cmp_ge_u32 s81, 9
    s_cselect_b32 s40, s26, s24
    s_cselect_b32 s41, s27, s25
    s_cselect_b32 s77, 1152, 0
    s_lshl_b32 s72, s81, 7
    s_sub_u32 s77, s72, s77
    s_lshl_b32 s72, s81, 10
    s_add_u32 s76, s82, s72
    s_add_u32 s81, s81, 1
    s_cmp_eq_u32 s81, 18
    s_cselect_b32 s81, 0, s81
    s_add_u32 s72, s76, 147584
    s_add_u32 m0, s78, 30720
    s_nop 0
    buffer_load_dwordx4 v22, s[52:55], s76 offen sc1 lds
    s_add_u32 m0, s78, 31744
    s_nop 0
    buffer_load_dwordx4 v168, s[52:55], s76 offen sc1 lds
    s_add_u32 m0, s78, 38912
    s_nop 0
    buffer_load_dwordx4 v22, s[52:55], s72 offen sc1 lds
    s_add_u32 m0, s78, 39936
    s_nop 0
    buffer_load_dwordx4 v168, s[52:55], s72 offen sc1 lds
    s_add_u32 m0, s78, 47104
    s_nop 0
    buffer_load_dwordx4 v23, s[40:43], s77 offen lds
    s_add_u32 m0, s78, 48128
    s_nop 0
    buffer_load_dwordx4 v169, s[40:43], s77 offen lds
    s_cmp_lg_u32 s64, 4
    s_cbranch_scc1 Ld_79
    s_mov_b32 m0, 55296
    s_nop 0
    buffer_load_dwordx4 v24, s[40:43], s77 offen lds
Ld_79:
    s_waitcnt vmcnt(24)
    s_barrier
    s_cmp_ge_u32 s81, 9
    s_cselect_b32 s40, s26, s24
    s_cselect_b32 s41, s27, s25
    s_cselect_b32 s77, 1152, 0
    s_lshl_b32 s72, s81, 7
    s_sub_u32 s77, s72, s77
    s_lshl_b32 s72, s81, 10
    s_add_u32 s76, s82, s72
    s_add_u32 s81, s81, 1
    s_cmp_eq_u32 s81, 18
    s_cselect_b32 s81, 0, s81
    s_add_u32 s72, s76, 147584
    s_add_u32 m0, s78, 0
    s_nop 0
    buffer_load_dwordx4 v22, s[52:55], s76 offen sc1 lds
    s_add_u32 m0, s78, 1024
    s_nop 0
    buffer_load_dwordx4 v168, s[52:55], s76 offen sc1 lds
    s_add_u32 m0, s78, 8192
    s_nop 0
    buffer_load_dwordx4 v22, s[52:55], s72 offen sc1 lds
    s_add_u32 m0, s78, 9216
    s_nop 0
    buffer_load_dwordx4 v168, s[52:55], s72 offen sc1 lds
    s_add_u32 m0, s78, 16384
    s_nop 0
    buffer_load_dwordx4 v23, s[40:43], s77 offen lds
    s_add_u32 m0, s78, 17408
    s_nop 0
    buffer_load_dwordx4 v169, s[40:43], s77 offen lds
    s_cmp_lg_u32 s64, 4
    s_cbranch_scc1 Ld_80
    s_mov_b32 m0, 24576
    s_nop 0
    buffer_load_dwordx4 v24, s[40:43], s77 offen lds
Ld_80:
    s_waitcnt vmcnt(24)
    s_barrier
    s_waitcnt vmcnt(18)
    s_barrier
    s_waitcnt vmcnt(12)
    s_barrier
    s_waitcnt vmcnt(6)
    s_barrier
    s_waitcnt vmcnt(0)
    s_barrier
    s_branch L_tail_end
L_tail_la:
    s_lshl_b32 s72, s2, 9
    s_add_u32 s72, s72, 15314944
    v_lshl_add_u32 v15, v1, 2, s72
    s_lshl_b32 s80, s69, 12
    s_lshl_b32 s81, s75, 1
    s_waitcnt vmcnt(0)
    v_and_b32 v12, 3, v1
    v_lshlrev_b32 v12, 14, v12
    v_bfe_u32 v13, v1, 2, 1
    v_lshl_add_u32 v12, v13, 11, v12
    v_mov_b32 v13, s67
    s_mov_b64 exec, 255
    buffer_store_dword v13, v12, s[52:55], s79 offen sc1
    s_mov_b64 exec, -1
    s_add_u32 s73, s81, 0
    s_and_b32 s73, s73, 7
    s_mul_i32 s73, s73, 82944
    s_add_u32 m0, s78, 81920
    s_nop 0
    buffer_load_dwordx4 v27, s[48:51], s73 offen lds
    s_add_u32 m0, s78, 82944
    s_nop 0
    buffer_load_dwordx4 v28, s[48:51], s73 offen lds
    s_cmp_lg_u32 s64, 4
    s_cbranch_scc1 Ld_81
    s_mov_b32 m0, 90112
    s_nop 0
    buffer_load_dwordx4 v29, s[48:51], s73 offen lds
Ld_81:
    s_add_u32 s73, s81, 1
    s_and_b32 s73, s73, 7
    s_mul_i32 s73, s73, 82944
    s_add_u32 m0, s78, 91136
    s_nop 0
    buffer_load_dwordx4 v27, s[48:51], s73 offen lds
    s_add_u32 m0, s78, 92160
    s_nop 0
    buffer_load_dwordx4 v28, s[48:51], s73 offen lds
    s_cmp_lg_u32 s64, 4
    s_cbranch_scc1 Ld_82
    s_mov_b32 m0, 99328
    s_nop 0
    buffer_load_dwordx4 v29, s[48:51], s73 offen lds
Ld_82:
    s_add_u32 s73, s81, 2
    s_and_b32 s73, s73, 7
    s_mul_i32 s73, s73, 82944
    s_add_u32 m0, s78, 100352
    s_nop 0
    buffer_load_dwordx4 v27, s[48:51], s73 offen lds
    s_add_u32 m0, s78, 101376
    s_nop 0
    buffer_load_dwordx4 v28, s[48:51], s73 offen lds
    s_cmp_lg_u32 s64, 4
    s_cbranch_scc1 Ld_83
    s_mov_b32 m0, 108544
    s_nop 0
    buffer_load_dwordx4 v29, s[48:51], s73 offen lds
Ld_83:
    s_add_u32 s73, s81, 3
    s_and_b32 s73, s73, 7
    s_mul_i32 s73, s73, 82944
    s_add_u32 m0, s78, 109568
    s_nop 0
    buffer_load_dwordx4 v27, s[48:51], s73 offen lds
    s_add_u32 m0, s78, 110592
    s_nop 0
    buffer_load_dwordx4 v28, s[48:51], s73 offen lds
    s_cmp_lg_u32 s64, 4
    s_cbranch_scc1 Ld_84
    s_mov_b32 m0, 117760
    s_nop 0
    buffer_load_dwordx4 v29, s[48:51], s73 offen lds
Ld_84:
    s_add_u32 s73, s81, 4
    s_and_b32 s73, s73, 7
    s_mul_i32 s73, s73, 82944
    s_add_u32 m0, s78, 118784
    s_nop 0
    buffer_load_dwordx4 v27, s[48:51], s73 offen lds
    s_add_u32 m0, s78, 119808
    s_nop 0
    buffer_load_dwordx4 v28, s[48:51], s73 offen lds
    s_cmp_lg_u32 s64, 4
    s_cbranch_scc1 Ld_85
    s_mov_b32 m0, 126976
    s_nop 0
    buffer_load_dwordx4 v29, s[48:51], s73 offen lds
Ld_85:
    s_add_u32 s73, s81, 5
    s_and_b32 s73, s73, 7
    s_mul_i32 s73, s73, 82944
    s_add_u32 m0, s78, 128000
    s_nop 0
    buffer_load_dwordx4 v27, s[48:51], s73 offen lds
    s_add_u32 m0, s78, 129024
    s_nop 0
    buffer_load_dwordx4 v28, s[48:51], s73 offen lds
    s_cmp_lg_u32 s64, 4
    s_cbranch_scc1 Ld_86
    s_mov_b32 m0, 136192
    s_nop 0
    buffer_load_dwordx4 v29, s[48:51], s73 offen lds
Ld_86:
    s_add_u32 s73, s81, 6
    s_and_b32 s73, s73, 7
    s_mul_i32 s73, s73, 82944
    s_add_u32 m0, s78, 137216
    s_nop 0
    buffer_load_dwordx4 v27, s[48:51], s73 offen lds
    s_add_u32 m0, s78, 138240
    s_nop 0
    buffer_load_dwordx4 v28, s[48:51], s73 offen lds
    s_cmp_lg_u32 s64, 4
    s_cbranch_scc1 Ld_87
    s_mov_b32 m0, 145408
    s_nop 0
    buffer_load_dwordx4 v29, s[48:51], s73 offen lds
Ld_87:
    s_add_u32 s73, s81, 7
    s_and_b32 s73, s73, 7
    s_mul_i32 s73, s73, 82944
    s_add_u32 m0, s78, 146432
    s_nop 0
    buffer_load_dwordx4 v27, s[48:51], s73 offen lds
    s_add_u32 m0, s78, 147456
    s_nop 0
    buffer_load_dwordx4 v28, s[48:51], s73 offen lds
    s_cmp_lg_u32 s64, 4
    s_cbranch_scc1 Ld_88
    s_mov_b32 m0, 154624
    s_nop 0
    buffer_load_dwordx4 v29, s[48:51], s73 offen lds
Ld_88:
    s_mov_b32 s73, 0
    s_add_u32 m0, s78, 72704
    s_nop 0
    buffer_load_dwordx4 v30, s[48:51], s73 offen lds
    s_add_u32 m0, s78, 73728
    s_nop 0
    buffer_load_dwordx4 v31, s[48:51], s73 offen lds
    s_cmp_lg_u32 s64, 4
    s_cbranch_scc1 Ld_89
    s_mov_b32 m0, 80896
    s_nop 0
    buffer_load_dwordx4 v0, s[48:51], s73 offen lds
Ld_89:
    s_cmp_lg_u32 s64, 4
    s_cbranch_scc1 L_fo
    buffer_load_dword v14, v15, s[52:55], 0 offen sc1
    buffer_load_dword v253, v15, s[52:55], 0 offen offset:256 sc1
    s_waitcnt vmcnt(0)
    v_xor_b32 v253, v253, v14
    v_xor_b32 v14, s67, v14
    v_or_b32 v14, v14, v253
    v_cmp_ne_u32 vcc, 0, v14
    s_nop 4
    s_cbranch_vccnz Lslow_90
Lok_91:
L_fo:
    s_barrier
    s_add_u32 s73, s81, 0
    s_and_b32 s73, s73, 7
    s_lshl_b32 s73, s73, 18
    s_add_u32 s72, s73, 12595200
    s_add_u32 m0, s80, 0
    s_nop 0
    buffer_load_dwordx4 v25, s[52:55], s72 offen sc1 lds
    s_add_u32 s72, s73, 12597248
    s_add_u32 m0, s80, 1024
    s_nop 0
    buffer_load_dwordx4 v25, s[52:55], s72 offen sc1 lds
    s_add_u32 s72, s73, 12595712
    s_add_u32 m0, s80, 2048
    s_nop 0
    buffer_load_dwordx4 v25, s[52:55], s72 offen sc1 lds
    s_add_u32 s72, s73, 12597760
    s_add_u32 m0, s80, 3072
    s_nop 0
    buffer_load_dwordx4 v25, s[52:55], s72 offen sc1 lds
    s_add_u32 s73, s81, 1
    s_and_b32 s73, s73, 7
    s_lshl_b32 s73, s73, 18
    s_add_u32 s72, s73, 12595200
    s_add_u32 m0, s80, 16384
    s_nop 0
    buffer_load_dwordx4 v25, s[52:55], s72 offen sc1 lds
    s_add_u32 s72, s73, 12597248
    s_add_u32 m0, s80, 17408
    s_nop 0
    buffer_load_dwordx4 v25, s[52:55], s72 offen sc1 lds
    s_add_u32 s72, s73, 12595712
    s_add_u32 m0, s80, 18432
    s_nop 0
    buffer_load_dwordx4 v25, s[52:55], s72 offen sc1 lds
    s_add_u32 s72, s73, 12597760
    s_add_u32 m0, s80, 19456
    s_nop 0
    buffer_load_dwordx4 v25, s[52:55], s72 offen sc1 lds
    s_add_u32 s73, s81, 2
    s_and_b32 s73, s73, 7
    s_lshl_b32 s73, s73, 18
    s_add_u32 s72, s73, 12595200
    s_add_u32 m0, s80, 32768
    s_nop 0
    buffer_load_dwordx4 v25, s[52:55], s72 offen sc1 lds
    s_add_u32 s72, s73, 12597248
    s_add_u32 m0, s80, 33792
    s_nop 0
    buffer_load_dwordx4 v25, s[52:55], s72 offen sc1 lds
    s_add_u32 s72, s73, 12595712
    s_add_u32 m0, s80, 34816
    s_nop 0
    buffer_load_dwordx4 v25, s[52:55], s72 offen sc1 lds
    s_add_u32 s72, s73, 12597760
    s_add_u32 m0, s80, 35840
    s_nop 0
    buffer_load_dwordx4 v25, s[52:55], s72 offen sc1 lds
    s_add_u32 s73, s81, 3
    s_and_b32 s73, s73, 7
    s_lshl_b32 s73, s73, 18
    s_add_u32 s72, s73, 12595200
    s_add_u32 m0, s80, 49152
    s_nop 0
    buffer_load_dwordx4 v25, s[52:55], s72 offen sc1 lds
    s_add_u32 s72, s73, 12597248
    s_add_u32 m0, s80, 50176
    s_nop 0
    buffer_load_dwordx4 v25, s[52:55], s72 offen sc1 lds
    s_add_u32 s72, s73, 12595712
    s_add_u32 m0, s80, 51200
    s_nop 0
    buffer_load_dwordx4 v25, s[52:55], s72 offen sc1 lds
    s_add_u32 s72, s73, 12597760
    s_add_u32 m0, s80, 52224
    s_nop 0
    buffer_load_dwordx4 v25, s[52:55], s72 offen sc1 lds
    s_waitcnt vmcnt(12)
    s_barrier
    s_waitcnt vmcnt(8)
    s_barrier
    s_add_u32 s73, s81, 4
    s_and_b32 s73, s73, 7
    s_lshl_b32 s73, s73, 18
    s_add_u32 s72, s73, 12595200
    s_add_u32 m0, s80, 0
    s_nop 0
    buffer_load_dwordx4 v25, s[52:55], s72 offen sc1 lds
    s_add_u32 s72, s73, 12597248
    s_add_u32 m0, s80, 1024
    s_nop 0
    buffer_load_dwordx4 v25, s[52:55], s72 offen sc1 lds
    s_add_u32 s72, s73, 12595712
    s_add_u32 m0, s80, 2048
    s_nop 0
    buffer_load_dwordx4 v25, s[52:55], s72 offen sc1 lds
    s_add_u32 s72, s73, 12597760
    s_add_u32 m0, s80, 3072
    s_nop 0
    buffer_load_dwordx4 v25, s[52:55], s72 offen sc1 lds
    s_waitcnt vmcnt(8)
    s_barrier
    s_add_u32 s73, s81, 5
    s_and_b32 s73, s73, 7
    s_lshl_b32 s73, s73, 18
    s_add_u32 s72, s73, 12595200
    s_add_u32 m0, s80, 16384
    s_nop 0
    buffer_load_dwordx4 v25, s[52:55], s72 offen sc1 lds
    s_add_u32 s72, s73, 12597248
    s_add_u32 m0, s80, 17408
    s_nop 0
    buffer_load_dwordx4 v25, s[52:55], s72 offen sc1 lds
    s_add_u32 s72, s73, 12595712
    s_add_u32 m0, s80, 18432
    s_nop 0
    buffer_load_dwordx4 v25, s[52:55], s72 offen sc1 lds
    s_add_u32 s72, s73, 12597760
    s_add_u32 m0, s80, 19456
    s_nop 0
    buffer_load_dwordx4 v25, s[52:55], s72 offen sc1 lds
    s_waitcnt vmcnt(8)
    s_barrier
    s_add_u32 s73, s81, 6
    s_and_b32 s73, s73, 7
    s_lshl_b32 s73, s73, 18
    s_add_u32 s72, s73, 12595200
    s_add_u32 m0, s80, 32768
    s_nop 0
    buffer_load_dwordx4 v25, s[52:55], s72 offen sc1 lds
    s_add_u32 s72, s73, 12597248
    s_add_u32 m0, s80, 33792
    s_nop 0
    buffer_load_dwordx4 v25, s[52:55], s72 offen sc1 lds
    s_add_u32 s72, s73, 12595712
    s_add_u32 m0, s80, 34816
    s_nop 0
    buffer_load_dwordx4 v25, s[52:55], s72 offen sc1 lds
    s_add_u32 s72, s73, 12597760
    s_add_u32 m0, s80, 35840
    s_nop 0
    buffer_load_dwordx4 v25, s[52:55], s72 offen sc1 lds
    s_waitcnt vmcnt(8)
    s_barrier
    s_add_u32 s73, s81, 7
    s_and_b32 s73, s73, 7
    s_lshl_b32 s73, s73, 18
    s_add_u32 s72, s73, 12595200
    s_add_u32 m0, s80, 49152
    s_nop 0
    buffer_load_dwordx4 v25, s[52:55], s72 offen sc1 lds
    s_add_u32 s72, s73, 12597248
    s_add_u32 m0, s80, 50176
    s_nop 0
    buffer_load_dwordx4 v25, s[52:55], s72 offen sc1 lds
    s_add_u32 s72, s73, 12595712
    s_add_u32 m0, s80, 51200
    s_nop 0
    buffer_load_dwordx4 v25, s[52:55], s72 offen sc1 lds
    s_add_u32 s72, s73, 12597760
    s_add_u32 m0, s80, 52224
    s_nop 0
    buffer_load_dwordx4 v25, s[52:55], s72 offen sc1 lds
    s_waitcnt vmcnt(8)
    s_barrier
    s_mov_b32 s72, 0
    s_add_u32 m0, s80, 0
    s_nop 0
    buffer_load_dwordx4 v26, s[52:55], s72 offen sc1 lds
    s_mov_b32 s72, 16384
    s_add_u32 m0, s80, 1024
    s_nop 0
    buffer_load_dwordx4 v26, s[52:55], s72 offen sc1 lds
    s_mov_b32 s72, 32768
    s_add_u32 m0, s80, 2048
    s_nop 0
    buffer_load_dwordx4 v26, s[52:55], s72 offen sc1 lds
    s_mov_b32 s72, 49152
    s_add_u32 m0, s80, 3072
    s_nop 0
    buffer_load_dwordx4 v26, s[52:55], s72 offen sc1 lds
    s_waitcnt vmcnt(8)
    s_barrier
    s_waitcnt vmcnt(4)
    s_barrier
    s_waitcnt vmcnt(0)
    s_barrier
    s_branch L_tail_end
L_tail_c:
    s_cmp_ge_u32 s66, 16
    s_cbranch_scc1 L_tail_ca
    v_xor_b32 v35, 64, v254
    v_add_u32 v34, 56320, v254
    v_add_u32 v35, 56320, v35
    v_add_u32 v40, 72704, v250
    v_xor_b32 v41, 64, v40
    ds_read_b64_tr_b16 v[104:105], v34 offset:25600
    ds_read_b64_tr_b16 v[106:107], v35 offset:25600
    ds_read_b64_tr_b16 v[108:109], v34 offset:27648
    ds_read_b64_tr_b16 v[110:111], v35 offset:27648
    ds_read_b128 v[112:115], v40 offset:25600
    ds_read_b128 v[116:119], v40 offset:27648
    ds_read_b128 v[120:123], v40 offset:29696
    ds_read_b128 v[124:127], v40 offset:31744
    ds_read_b128 v[128:131], v40 offset:33792
    ds_read_b64_tr_b16 v[132:133], v34 offset:26112
    ds_read_b64_tr_b16 v[134:135], v35 offset:26112
    ds_read_b64_tr_b16 v[136:137], v34 offset:28160
    ds_read_b64_tr_b16 v[138:139], v35 offset:28160
    ds_read_b128 v[140:143], v41 offset:25600
    ds_read_b128 v[144:147], v41 offset:27648
    ds_read_b128 v[148:151], v41 offset:29696
    ds_read_b128 v[152:155], v41 offset:31744
    ds_read_b128 v[156:159], v41 offset:33792
    v_xor_b32 v37, 64, v254
    v_add_u32 v36, 107520, v254
    v_add_u32 v37, 107520, v37
    v_add_u32 v42, 123904, v250
    v_xor_b32 v43, 64, v42
    s_waitcnt lgkmcnt(13)
    v_mfma_f32_16x16x32_bf16 v[64:67], v[112:115], v[104:107], 0
    ds_read_b64_tr_b16 v[200:201], v36 offset:0
    ds_read_b64_tr_b16 v[202:203], v37 offset:0
    v_mfma_f32_16x16x32_bf16 v[84:87], v[112:115], v[108:111], 0
    ds_read_b64_tr_b16 v[204:205], v36 offset:2048
    ds_read_b64_tr_b16 v[206:207], v37 offset:2048
    s_waitcnt lgkmcnt(15)
    v_mfma_f32_16x16x32_bf16 v[68:71], v[116:119], v[104:107], 0
    ds_read_b128 v[208:211], v42 offset:0
    ds_read_b128 v[212:215], v42 offset:2048
    v_mfma_f32_16x16x32_bf16 v[88:91], v[116:119], v[108:111], 0
    ds_read_b128 v[216:219], v42 offset:4096
    ds_read_b128 v[220:223], v42 offset:6144
    v_mfma_f32_16x16x32_bf16 v[72:75], v[120:123], v[104:107], 0
    ds_read_b128 v[224:227], v42 offset:8192
    v_mfma_f32_16x16x32_bf16 v[92:95], v[120:123], v[108:111], 0
    v_xor_b32 v33, 64, v254
    s_waitcnt lgkmcnt(15)
    v_mfma_f32_16x16x32_bf16 v[76:79], v[124:127], v[104:107], 0
    v_add_u32 v32, 0, v254
    v_mfma_f32_16x16x32_bf16 v[96:99], v[124:127], v[108:111], 0
    v_add_u32 v33, 0, v33
    v_mfma_f32_16x16x32_bf16 v[80:83], v[128:131], v[104:107], 0
    v_mfma_f32_16x16x32_bf16 v[100:103], v[128:131], v[108:111], 0
    s_waitcnt lgkmcnt(13)
    v_mfma_f32_16x16x32_bf16 v[64:67], v[140:143], v[132:135], v[64:67]
    ds_read_b64_tr_b16 v[104:105], v36 offset:512
    ds_read_b64_tr_b16 v[106:107], v37 offset:512
    v_mfma_f32_16x16x32_bf16 v[84:87], v[140:143], v[136:139], v[84:87]
    ds_read_b64_tr_b16 v[108:109], v36 offset:2560
    ds_read_b64_tr_b16 v[110:111], v37 offset:2560
    s_waitcnt lgkmcnt(15)
    v_mfma_f32_16x16x32_bf16 v[68:71], v[144:147], v[132:135], v[68:71]
    ds_read_b128 v[112:115], v43 offset:0
    ds_read_b128 v[116:119], v43 offset:2048
    v_mfma_f32_16x16x32_bf16 v[88:91], v[144:147], v[136:139], v[88:91]
    ds_read_b128 v[120:123], v43 offset:4096
    ds_read_b128 v[124:127], v43 offset:6144
    v_mfma_f32_16x16x32_bf16 v[72:75], v[148:151], v[132:135], v[72:75]
    ds_read_b128 v[128:131], v43 offset:8192
    v_mfma_f32_16x16x32_bf16 v[92:95], v[148:151], v[136:139], v[92:95]
    v_add_u32 v38, 16384, v250
    s_waitcnt lgkmcnt(15)
    v_mfma_f32_16x16x32_bf16 v[76:79], v[152:155], v[132:135], v[76:79]
    v_xor_b32 v39, 64, v38
    v_mfma_f32_16x16x32_bf16 v[96:99], v[152:155], v[136:139], v[96:99]
    v_mfma_f32_16x16x32_bf16 v[80:83], v[156:159], v[132:135], v[80:83]
    v_mfma_f32_16x16x32_bf16 v[100:103], v[156:159], v[136:139], v[100:103]
    s_waitcnt vmcnt(0)
    v_and_b32 v12, 3, v1
    v_lshlrev_b32 v12, 14, v12
    v_bfe_u32 v13, v1, 2, 1
    v_lshl_add_u32 v12, v13, 11, v12
    v_mov_b32 v13, s67
    s_mov_b64 exec, 255
    buffer_store_dword v13, v12, s[52:55], s79 offen sc1
    s_mov_b64 exec, -1
    s_waitcnt lgkmcnt(9)
    v_mfma_f32_16x16x32_bf16 v[64:67], v[208:211], v[200:203], v[64:67]
    ds_read_b64_tr_b16 v[132:133], v36 offset:25600
    ds_read_b64_tr_b16 v[134:135], v37 offset:25600
    v_mfma_f32_16x16x32_bf16 v[84:87], v[208:211], v[204:207], v[84:87]
    ds_read_b64_tr_b16 v[136:137], v36 offset:27648
    ds_read_b64_tr_b16 v[138:139], v37 offset:27648
    v_mfma_f32_16x16x32_bf16 v[68:71], v[212:215], v[200:203], v[68:71]
    ds_read_b128 v[140:143], v42 offset:25600
    ds_read_b128 v[144:147], v42 offset:27648
    v_mfma_f32_16x16x32_bf16 v[88:91], v[212:215], v[204:207], v[88:91]
    ds_read_b128 v[148:151], v42 offset:29696
    ds_read_b128 v[152:155], v42 offset:31744
    v_mfma_f32_16x16x32_bf16 v[72:75], v[216:219], v[200:203], v[72:75]
    ds_read_b128 v[156:159], v42 offset:33792
    v_mfma_f32_16x16x32_bf16 v[92:95], v[216:219], v[204:207], v[92:95]
    v_mfma_f32_16x16x32_bf16 v[76:79], v[220:223], v[200:203], v[76:79]
    v_mfma_f32_16x16x32_bf16 v[96:99], v[220:223], v[204:207], v[96:99]
    v_mfma_f32_16x16x32_bf16 v[80:83], v[224:227], v[200:203], v[80:83]
    v_mfma_f32_16x16x32_bf16 v[100:103], v[224:227], v[204:207], v[100:103]
    s_waitcnt lgkmcnt(9)
    v_mfma_f32_16x16x32_bf16 v[64:67], v[112:115], v[104:107], v[64:67]
    ds_read_b64_tr_b16 v[200:201], v36 offset:26112
    ds_read_b64_tr_b16 v[202:203], v37 offset:26112
    v_mfma_f32_16x16x32_bf16 v[84:87], v[112:115], v[108:111], v[84:87]
    ds_read_b64_tr_b16 v[204:205], v36 offset:28160
    ds_read_b64_tr_b16 v[206:207], v37 offset:28160
    v_mfma_f32_16x16x32_bf16 v[68:71], v[116:119], v[104:107], v[68:71]
    ds_read_b128 v[208:211], v43 offset:25600
    ds_read_b128 v[212:215], v43 offset:27648
    v_mfma_f32_16x16x32_bf16 v[88:91], v[116:119], v[108:111], v[88:91]
    ds_read_b128 v[216:219], v43 offset:29696
    ds_read_b128 v[220:223], v43 offset:31744
    v_mfma_f32_16x16x32_bf16 v[72:75], v[120:123], v[104:107], v[72:75]
    ds_read_b128 v[224:227], v43 offset:33792
    v_mfma_f32_16x16x32_bf16 v[92:95], v[120:123], v[108:111], v[92:95]
    v_mfma_f32_16x16x32_bf16 v[76:79], v[124:127], v[104:107], v[76:79]
    v_mfma_f32_16x16x32_bf16 v[96:99], v[124:127], v[108:111], v[96:99]
    v_mfma_f32_16x16x32_bf16 v[80:83], v[128:131], v[104:107], v[80:83]
    v_mfma_f32_16x16x32_bf16 v[100:103], v[128:131], v[108:111], v[100:103]
    s_waitcnt lgkmcnt(0)
    s_barrier
    v_mfma_f32_16x16x32_bf16 v[64:67], v[140:143], v[132:135], v[64:67]
    ds_read_b64_tr_b16 v[104:105], v34 offset:0
    ds_read_b64_tr_b16 v[106:107], v35 offset:0
    v_mfma_f32_16x16x32_bf16 v[84:87], v[140:143], v[136:139], v[84:87]
    ds_read_b64_tr_b16 v[108:109], v34 offset:2048
    ds_read_b64_tr_b16 v[110:111], v35 offset:2048
    v_mfma_f32_16x16x32_bf16 v[68:71], v[144:147], v[132:135], v[68:71]
    ds_read_b128 v[112:115], v40 offset:0
    ds_read_b128 v[116:119], v40 offset:2048
    v_mfma_f32_16x16x32_bf16 v[88:91], v[144:147], v[136:139], v[88:91]
    ds_read_b128 v[120:123], v40 offset:4096
    ds_read_b128 v[124:127], v40 offset:6144
    v_mfma_f32_16x16x32_bf16 v[72:75], v[148:151], v[132:135], v[72:75]
    ds_read_b128 v[128:131], v40 offset:8192
    v_mfma_f32_16x16x32_bf16 v[92:95], v[148:151], v[136:139], v[92:95]
    s_mov_b32 s56, s32
    s_mov_b32 s57, s33
    v_mfma_f32_16x16x32_bf16 v[76:79], v[152:155], v[132:135], v[76:79]
    s_mov_b32 s58, 9437184
    s_mov_b32 s59, 0x20000
    v_mfma_f32_16x16x32_bf16 v[96:99], v[152:155], v[136:139], v[96:99]
    s_lshl_b32 s80, s74, 2
    s_add_u32 s80, s80, s69
    v_mfma_f32_16x16x32_bf16 v[80:83], v[156:159], v[132:135], v[80:83]
    s_mul_i32 s80, s80, 147456
    v_mfma_f32_16x16x32_bf16 v[100:103], v[156:159], v[136:139], v[100:103]
    v_mfma_f32_16x16x32_bf16 v[64:67], v[208:211], v[200:203], v[64:67]
    ds_read_b64_tr_b16 v[132:133], v34 offset:512
    ds_read_b64_tr_b16 v[134:135], v35 offset:512
    v_mfma_f32_16x16x32_bf16 v[84:87], v[208:211], v[204:207], v[84:87]
    ds_read_b64_tr_b16 v[136:137], v34 offset:2560
    ds_read_b64_tr_b16 v[138:139], v35 offset:2560
    v_mfma_f32_16x16x32_bf16 v[68:71], v[212:215], v[200:203], v[68:71]
    ds_read_b128 v[140:143], v41 offset:0
    ds_read_b128 v[144:147], v41 offset:2048
    v_mfma_f32_16x16x32_bf16 v[88:91], v[212:215], v[204:207], v[88:91]
    ds_read_b128 v[148:151], v41 offset:4096
    ds_read_b128 v[152:155], v41 offset:6144
    v_mfma_f32_16x16x32_bf16 v[72:75], v[216:219], v[200:203], v[72:75]
    ds_read_b128 v[156:159], v41 offset:8192
    v_mfma_f32_16x16x32_bf16 v[92:95], v[216:219], v[204:207], v[92:95]
    s_mul_i32 s81, s75, 288
    s_add_u32 s80, s80, s81
    v_mfma_f32_16x16x32_bf16 v[76:79], v[220:223], v[200:203], v[76:79]
    v_add_u32 v10, 0, v1
    v_mul_u32_u24 v11, 3641, v10
    v_mfma_f32_16x16x32_bf16 v[96:99], v[220:223], v[204:207], v[96:99]
    v_lshrrev_b32 v11, 16, v11
    v_mul_u32_u24 v11, 270, v11
    v_mfma_f32_16x16x32_bf16 v[80:83], v[224:227], v[200:203], v[80:83]
    v_add_lshl_u32 v44, v10, v11, 4
    v_mfma_f32_16x16x32_bf16 v[100:103], v[224:227], v[204:207], v[100:103]
    s_waitcnt lgkmcnt(0)
    s_barrier
    v_mfma_f32_16x16x32_bf16 v[64:67], v[112:115], v[104:107], v[64:67]
    ds_read_b64_tr_b16 v[200:201], v32 offset:30720
    ds_read_b64_tr_b16 v[202:203], v33 offset:30720
    v_mfma_f32_16x16x32_bf16 v[84:87], v[112:115], v[108:111], v[84:87]
    ds_read_b64_tr_b16 v[204:205], v32 offset:32768
    ds_read_b64_tr_b16 v[206:207], v33 offset:32768
    v_mfma_f32_16x16x32_bf16 v[68:71], v[116:119], v[104:107], v[68:71]
    ds_read_b128 v[208:211], v38 offset:30720
    ds_read_b128 v[212:215], v38 offset:32768
    v_mfma_f32_16x16x32_bf16 v[88:91], v[116:119], v[108:111], v[88:91]
    ds_read_b128 v[216:219], v38 offset:34816
    ds_read_b128 v[220:223], v38 offset:36864
    v_mfma_f32_16x16x32_bf16 v[72:75], v[120:123], v[104:107], v[72:75]
    ds_read_b128 v[224:227], v38 offset:38912
    v_mfma_f32_16x16x32_bf16 v[92:95], v[120:123], v[108:111], v[92:95]
    v_add_u32 v10, 64, v1
    v_mul_u32_u24 v11, 3641, v10
    v_mfma_f32_16x16x32_bf16 v[76:79], v[124:127], v[104:107], v[76:79]
    v_lshrrev_b32 v11, 16, v11
    v_mul_u32_u24 v11, 270, v11
    v_mfma_f32_16x16x32_bf16 v[96:99], v[124:127], v[108:111], v[96:99]
    v_add_lshl_u32 v45, v10, v11, 4
    v_add_u32 v10, 128, v1
    v_mfma_f32_16x16x32_bf16 v[80:83], v[128:131], v[104:107], v[80:83]
    v_mul_u32_u24 v11, 3641, v10
    v_mfma_f32_16x16x32_bf16 v[100:103], v[128:131], v[108:111], v[100:103]
    v_mfma_f32_16x16x32_bf16 v[64:67], v[140:143], v[132:135], v[64:67]
    ds_read_b64_tr_b16 v[104:105], v32 offset:31232
    ds_read_b64_tr_b16 v[106:107], v33 offset:31232
    v_mfma_f32_16x16x32_bf16 v[84:87], v[140:143], v[136:139], v[84:87]
    ds_read_b64_tr_b16 v[108:109], v32 offset:33280
    ds_read_b64_tr_b16 v[110:111], v33 offset:33280
    v_mfma_f32_16x16x32_bf16 v[68:71], v[144:147], v[132:135], v[68:71]
    ds_read_b128 v[112:115], v39 offset:30720
    ds_read_b128 v[116:119], v39 offset:32768
    v_mfma_f32_16x16x32_bf16 v[88:91], v[144:147], v[136:139], v[88:91]
    ds_read_b128 v[120:123], v39 offset:34816
    ds_read_b128 v[124:127], v39 offset:36864
    v_mfma_f32_16x16x32_bf16 v[72:75], v[148:151], v[132:135], v[72:75]
    ds_read_b128 v[128:131], v39 offset:38912
    v_mfma_f32_16x16x32_bf16 v[92:95], v[148:151], v[136:139], v[92:95]
    v_lshrrev_b32 v11, 16, v11
    v_mul_u32_u24 v11, 270, v11
    v_mfma_f32_16x16x32_bf16 v[76:79], v[152:155], v[132:135], v[76:79]
    v_add_lshl_u32 v46, v10, v11, 4
    v_add_u32 v10, 192, v1
    v_mfma_f32_16x16x32_bf16 v[96:99], v[152:155], v[136:139], v[96:99]
    v_mul_u32_u24 v11, 3641, v10
    v_lshrrev_b32 v11, 16, v11
    v_mfma_f32_16x16x32_bf16 v[80:83], v[156:159], v[132:135], v[80:83]
    v_mul_u32_u24 v11, 270, v11
    v_mfma_f32_16x16x32_bf16 v[100:103], v[156:159], v[136:139], v[100:103]
    s_waitcnt lgkmcnt(0)
    s_barrier
    v_mfma_f32_16x16x32_bf16 v[64:67], v[208:211], v[200:203], v[64:67]
    ds_read_b64_tr_b16 v[132:133], v32 offset:0
    ds_read_b64_tr_b16 v[134:135], v33 offset:0
    v_mfma_f32_16x16x32_bf16 v[84:87], v[208:211], v[204:207], v[84:87]
    ds_read_b64_tr_b16 v[136:137], v32 offset:2048
    ds_read_b64_tr_b16 v[138:139], v33 offset:2048
    v_mfma_f32_16x16x32_bf16 v[68:71], v[212:215], v[200:203], v[68:71]
    ds_read_b128 v[140:143], v38 offset:0
    ds_read_b128 v[144:147], v38 offset:2048
    v_mfma_f32_16x16x32_bf16 v[88:91], v[212:215], v[204:207], v[88:91]
    ds_read_b128 v[148:151], v38 offset:4096
    ds_read_b128 v[152:155], v38 offset:6144
    v_mfma_f32_16x16x32_bf16 v[72:75], v[216:219], v[200:203], v[72:75]
    ds_read_b128 v[156:159], v38 offset:8192
    v_mfma_f32_16x16x32_bf16 v[92:95], v[216:219], v[204:207], v[92:95]
    v_add_lshl_u32 v47, v10, v11, 4
    v_add_u32 v10, 256, v1
    v_mfma_f32_16x16x32_bf16 v[76:79], v[220:223], v[200:203], v[76:79]
    v_mul_u32_u24 v11, 3641, v10
    v_lshrrev_b32 v11, 16, v11
    v_mfma_f32_16x16x32_bf16 v[96:99], v[220:223], v[204:207], v[96:99]
    v_mul_u32_u24 v11, 270, v11
    v_add_lshl_u32 v48, v10, v11, 4
    v_mfma_f32_16x16x32_bf16 v[80:83], v[224:227], v[200:203], v[80:83]
    v_add_u32 v10, 320, v1
    v_mfma_f32_16x16x32_bf16 v[100:103], v[224:227], v[204:207], v[100:103]
    v_mfma_f32_16x16x32_bf16 v[64:67], v[112:115], v[104:107], v[64:67]
    ds_read_b64_tr_b16 v[200:201], v32 offset:512
    ds_read_b64_tr_b16 v[202:203], v33 offset:512
    v_mfma_f32_16x16x32_bf16 v[84:87], v[112:115], v[108:111], v[84:87]
    ds_read_b64_tr_b16 v[204:205], v32 offset:2560
    ds_read_b64_tr_b16 v[206:207], v33 offset:2560
    v_mfma_f32_16x16x32_bf16 v[68:71], v[116:119], v[104:107], v[68:71]
    ds_read_b128 v[208:211], v39 offset:0
    ds_read_b128 v[212:215], v39 offset:2048
    v_mfma_f32_16x16x32_bf16 v[88:91], v[116:119], v[108:111], v[88:91]
    ds_read_b128 v[216:219], v39 offset:4096
    ds_read_b128 v[220:223], v39 offset:6144
    v_mfma_f32_16x16x32_bf16 v[72:75], v[120:123], v[104:107], v[72:75]
    ds_read_b128 v[224:227], v39 offset:8192
    v_mfma_f32_16x16x32_bf16 v[92:95], v[120:123], v[108:111], v[92:95]
    v_mul_u32_u24 v11, 3641, v10
    v_lshrrev_b32 v11, 16, v11
    v_mfma_f32_16x16x32_bf16 v[76:79], v[124:127], v[104:107], v[76:79]
    v_mul_u32_u24 v11, 270, v11
    v_add_lshl_u32 v49, v10, v11, 4
    v_mfma_f32_16x16x32_bf16 v[96:99], v[124:127], v[108:111], v[96:99]
    v_add_u32 v10, 384, v1
    v_mul_u32_u24 v11, 3641, v10
    v_mfma_f32_16x16x32_bf16 v[80:83], v[128:131], v[104:107], v[80:83]
    v_lshrrev_b32 v11, 16, v11
    v_mfma_f32_16x16x32_bf16 v[100:103], v[128:131], v[108:111], v[100:103]
    s_waitcnt lgkmcnt(0)
    s_barrier
    v_mfma_f32_16x16x32_bf16 v[64:67], v[140:143], v[132:135], v[64:67]
    ds_read_b64_tr_b16 v[104:105], v34 offset:25600
    ds_read_b64_tr_b16 v[106:107], v35 offset:25600
    v_mfma_f32_16x16x32_bf16 v[84:87], v[140:143], v[136:139], v[84:87]
    ds_read_b64_tr_b16 v[108:109], v34 offset:27648
    ds_read_b64_tr_b16 v[110:111], v35 offset:27648
    v_mfma_f32_16x16x32_bf16 v[68:71], v[144:147], v[132:135], v[68:71]
    ds_read_b128 v[112:115], v40 offset:25600
    ds_read_b128 v[116:119], v40 offset:27648
    v_mfma_f32_16x16x32_bf16 v[88:91], v[144:147], v[136:139], v[88:91]
    ds_read_b128 v[120:123], v40 offset:29696
    ds_read_b128 v[124:127], v40 offset:31744
    v_mfma_f32_16x16x32_bf16 v[72:75], v[148:151], v[132:135], v[72:75]
    ds_read_b128 v[128:131], v40 offset:33792
    v_mfma_f32_16x16x32_bf16 v[92:95], v[148:151], v[136:139], v[92:95]
    v_mul_u32_u24 v11, 270, v11
    v_add_lshl_u32 v50, v10, v11, 4
    v_mfma_f32_16x16x32_bf16 v[76:79], v[152:155], v[132:135], v[76:79]
    v_add_u32 v10, 448, v1
    v_mul_u32_u24 v11, 3641, v10
    v_mfma_f32_16x16x32_bf16 v[96:99], v[152:155], v[136:139], v[96:99]
    v_lshrrev_b32 v11, 16, v11
    v_mul_u32_u24 v11, 270, v11
    v_mfma_f32_16x16x32_bf16 v[80:83], v[156:159], v[132:135], v[80:83]
    v_add_lshl_u32 v51, v10, v11, 4
    v_mfma_f32_16x16x32_bf16 v[100:103], v[156:159], v[136:139], v[100:103]
    v_mfma_f32_16x16x32_bf16 v[64:67], v[208:211], v[200:203], v[64:67]
    ds_read_b64_tr_b16 v[132:133], v34 offset:26112
    ds_read_b64_tr_b16 v[134:135], v35 offset:26112
    v_mfma_f32_16x16x32_bf16 v[84:87], v[208:211], v[204:207], v[84:87]
    ds_read_b64_tr_b16 v[136:137], v34 offset:28160
    ds_read_b64_tr_b16 v[138:139], v35 offset:28160
    v_mfma_f32_16x16x32_bf16 v[68:71], v[212:215], v[200:203], v[68:71]
    ds_read_b128 v[140:143], v41 offset:25600
    ds_read_b128 v[144:147], v41 offset:27648
    v_mfma_f32_16x16x32_bf16 v[88:91], v[212:215], v[204:207], v[88:91]
    ds_read_b128 v[148:151], v41 offset:29696
    ds_read_b128 v[152:155], v41 offset:31744
    v_mfma_f32_16x16x32_bf16 v[72:75], v[216:219], v[200:203], v[72:75]
    ds_read_b128 v[156:159], v41 offset:33792
    v_mfma_f32_16x16x32_bf16 v[92:95], v[216:219], v[204:207], v[92:95]
    v_add_u32 v10, 512, v1
    v_mul_u32_u24 v11, 3641, v10
    v_mfma_f32_16x16x32_bf16 v[76:79], v[220:223], v[200:203], v[76:79]
    v_lshrrev_b32 v11, 16, v11
    v_mul_u32_u24 v11, 270, v11
    v_mfma_f32_16x16x32_bf16 v[96:99], v[220:223], v[204:207], v[96:99]
    v_add_lshl_u32 v52, v10, v11, 4
    s_mul_i32 s81, s69, 9216
    v_mfma_f32_16x16x32_bf16 v[80:83], v[224:227], v[200:203], v[80:83]
    s_add_u32 s81, s81, 81920
    v_mfma_f32_16x16x32_bf16 v[100:103], v[224:227], v[204:207], v[100:103]
    s_waitcnt lgkmcnt(0)
    s_barrier
    v_mfma_f32_16x16x32_bf16 v[64:67], v[112:115], v[104:107], v[64:67]
    ds_read_b64_tr_b16 v[200:201], v36 offset:0
    ds_read_b64_tr_b16 v[202:203], v37 offset:0
    v_mfma_f32_16x16x32_bf16 v[84:87], v[112:115], v[108:111], v[84:87]
    ds_read_b64_tr_b16 v[204:205], v36 offset:2048
    ds_read_b64_tr_b16 v[206:207], v37 offset:2048
    v_mfma_f32_16x16x32_bf16 v[68:71], v[116:119], v[104:107], v[68:71]
    ds_read_b128 v[208:211], v42 offset:0
    ds_read_b128 v[212:215], v42 offset:2048
    v_mfma_f32_16x16x32_bf16 v[88:91], v[116:119], v[108:111], v[88:91]
    ds_read_b128 v[216:219], v42 offset:4096
    ds_read_b128 v[220:223], v42 offset:6144
    v_mfma_f32_16x16x32_bf16 v[72:75], v[120:123], v[104:107], v[72:75]
    ds_read_b128 v[224:227], v42 offset:8192
    v_mfma_f32_16x16x32_bf16 v[92:95], v[120:123], v[108:111], v[92:95]
    v_mul_u32_u24 v54, 288, v2
    v_lshl_add_u32 v54, v3, 4, v54
    v_mfma_f32_16x16x32_bf16 v[76:79], v[124:127], v[104:107], v[76:79]
    v_add_u32 v54, s81, v54
    v_add_u32 v55, s81, v19
    v_mfma_f32_16x16x32_bf16 v[96:99], v[124:127], v[108:111], v[96:99]
    v_lshlrev_b32 v10, 16, v182
    v_and_b32 v11, 0xffff0000, v182
    v_mfma_f32_16x16x32_bf16 v[80:83], v[128:131], v[104:107], v[80:83]
    v_lshlrev_b32 v8, 16, v228
    v_mfma_f32_16x16x32_bf16 v[100:103], v[128:131], v[108:111], v[100:103]
    v_mfma_f32_16x16x32_bf16 v[64:67], v[140:143], v[132:135], v[64:67]
    ds_read_b64_tr_b16 v[104:105], v36 offset:512
    ds_read_b64_tr_b16 v[106:107], v37 offset:512
    v_mfma_f32_16x16x32_bf16 v[84:87], v[140:143], v[136:139], v[84:87]
    ds_read_b64_tr_b16 v[108:109], v36 offset:2560
    ds_read_b64_tr_b16 v[110:111], v37 offset:2560
    v_mfma_f32_16x16x32_bf16 v[68:71], v[144:147], v[132:135], v[68:71]
    ds_read_b128 v[112:115], v43 offset:0
    ds_read_b128 v[116:119], v43 offset:2048
    v_mfma_f32_16x16x32_bf16 v[88:91], v[144:147], v[136:139], v[88:91]
    ds_read_b128 v[120:123], v43 offset:4096
    ds_read_b128 v[124:127], v43 offset:6144
    v_mfma_f32_16x16x32_bf16 v[72:75], v[148:151], v[132:135], v[72:75]
    ds_read_b128 v[128:131], v43 offset:8192
    v_mfma_f32_16x16x32_bf16 v[92:95], v[148:151], v[136:139], v[92:95]
    v_and_b32 v9, 0xffff0000, v228
    v_pk_mul_f32 v[8:9], v[8:9], v[10:11]
    v_mfma_f32_16x16x32_bf16 v[76:79], v[152:155], v[132:135], v[76:79]
    v_cvt_pk_bf16_f32 v160, v8, v9
    v_and_b32 v161, 0xffff0000, v160
    v_mfma_f32_16x16x32_bf16 v[96:99], v[152:155], v[136:139], v[96:99]
    v_lshlrev_b32 v160, 16, v160
    v_lshlrev_b32 v8, 16, v238
    v_mfma_f32_16x16x32_bf16 v[80:83], v[156:159], v[132:135], v[80:83]
    v_and_b32 v9, 0xffff0000, v238
    v_mfma_f32_16x16x32_bf16 v[100:103], v[156:159], v[136:139], v[100:103]
    s_waitcnt lgkmcnt(0)
    s_barrier
    v_mfma_f32_16x16x32_bf16 v[64:67], v[208:211], v[200:203], v[64:67]
    ds_read_b64_tr_b16 v[132:133], v36 offset:25600
    ds_read_b64_tr_b16 v[134:135], v37 offset:25600
    v_mfma_f32_16x16x32_bf16 v[84:87], v[208:211], v[204:207], v[84:87]
    ds_read_b64_tr_b16 v[136:137], v36 offset:27648
    ds_read_b64_tr_b16 v[138:139], v37 offset:27648
    v_mfma_f32_16x16x32_bf16 v[68:71], v[212:215], v[200:203], v[68:71]
    ds_read_b128 v[140:143], v42 offset:25600
    ds_read_b128 v[144:147], v42 offset:27648
    v_mfma_f32_16x16x32_bf16 v[88:91], v[212:215], v[204:207], v[88:91]
    ds_read_b128 v[148:151], v42 offset:29696
    ds_read_b128 v[152:155], v42 offset:31744
    v_mfma_f32_16x16x32_bf16 v[72:75], v[216:219], v[200:203], v[72:75]
    ds_read_b128 v[156:159], v42 offset:33792
    v_mfma_f32_16x16x32_bf16 v[92:95], v[216:219], v[204:207], v[92:95]
    v_pk_mul_f32 v[8:9], v[8:9], v[10:11]
    v_cvt_pk_bf16_f32 v180, v8, v9
    v_mfma_f32_16x16x32_bf16 v[76:79], v[220:223], v[200:203], v[76:79]
    v_and_b32 v181, 0xffff0000, v180
    v_lshlrev_b32 v180, 16, v180
    v_mfma_f32_16x16x32_bf16 v[96:99], v[220:223], v[204:207], v[96:99]
    v_lshlrev_b32 v10, 16, v183
    v_and_b32 v11, 0xffff0000, v183
    v_mfma_f32_16x16x32_bf16 v[80:83], v[224:227], v[200:203], v[80:83]
    v_lshlrev_b32 v8, 16, v229
    v_mfma_f32_16x16x32_bf16 v[100:103], v[224:227], v[204:207], v[100:103]
    v_mfma_f32_16x16x32_bf16 v[64:67], v[112:115], v[104:107], v[64:67]
    ds_read_b64_tr_b16 v[200:201], v36 offset:26112
    ds_read_b64_tr_b16 v[202:203], v37 offset:26112
    v_mfma_f32_16x16x32_bf16 v[84:87], v[112:115], v[108:111], v[84:87]
    ds_read_b64_tr_b16 v[204:205], v36 offset:28160
    ds_read_b64_tr_b16 v[206:207], v37 offset:28160
    v_mfma_f32_16x16x32_bf16 v[68:71], v[116:119], v[104:107], v[68:71]
    ds_read_b128 v[208:211], v43 offset:25600
    ds_read_b128 v[212:215], v43 offset:27648
    v_mfma_f32_16x16x32_bf16 v[88:91], v[116:119], v[108:111], v[88:91]
    ds_read_b128 v[216:219], v43 offset:29696
    ds_read_b128 v[220:223], v43 offset:31744
    v_mfma_f32_16x16x32_bf16 v[72:75], v[120:123], v[104:107], v[72:75]
    ds_read_b128 v[224:227], v43 offset:33792
    v_mfma_f32_16x16x32_bf16 v[92:95], v[120:123], v[108:111], v[92:95]
    v_and_b32 v9, 0xffff0000, v229
    v_pk_mul_f32 v[8:9], v[8:9], v[10:11]
    v_mfma_f32_16x16x32_bf16 v[76:79], v[124:127], v[104:107], v[76:79]
    v_cvt_pk_bf16_f32 v162, v8, v9
    v_and_b32 v163, 0xffff0000, v162
    v_mfma_f32_16x16x32_bf16 v[96:99], v[124:127], v[108:111], v[96:99]
    v_lshlrev_b32 v162, 16, v162
    v_lshlrev_b32 v8, 16, v239
    v_mfma_f32_16x16x32_bf16 v[80:83], v[128:131], v[104:107], v[80:83]
    v_and_b32 v9, 0xffff0000, v239
    v_mfma_f32_16x16x32_bf16 v[100:103], v[128:131], v[108:111], v[100:103]
    s_waitcnt lgkmcnt(0)
    s_barrier
    v_mfma_f32_16x16x32_bf16 v[64:67], v[140:143], v[132:135], v[64:67]
    ds_read_b64_tr_b16 v[104:105], v34 offset:0
    ds_read_b64_tr_b16 v[106:107], v35 offset:0
    v_mfma_f32_16x16x32_bf16 v[84:87], v[140:143], v[136:139], v[84:87]
    ds_read_b64_tr_b16 v[108:109], v34 offset:2048
    ds_read_b64_tr_b16 v[110:111], v35 offset:2048
    v_mfma_f32_16x16x32_bf16 v[68:71], v[144:147], v[132:135], v[68:71]
    ds_read_b128 v[112:115], v40 offset:0
    ds_read_b128 v[116:119], v40 offset:2048
    v_mfma_f32_16x16x32_bf16 v[88:91], v[144:147], v[136:139], v[88:91]
    ds_read_b128 v[120:123], v40 offset:4096
    ds_read_b128 v[124:127], v40 offset:6144
    v_mfma_f32_16x16x32_bf16 v[72:75], v[148:151], v[132:135], v[72:75]
    ds_read_b128 v[128:131], v40 offset:8192
    v_mfma_f32_16x16x32_bf16 v[92:95], v[148:151], v[136:139], v[92:95]
    v_pk_mul_f32 v[8:9], v[8:9], v[10:11]
    v_cvt_pk_bf16_f32 v182, v8, v9
    v_mfma_f32_16x16x32_bf16 v[76:79], v[152:155], v[132:135], v[76:79]
    v_and_b32 v183, 0xffff0000, v182
    v_lshlrev_b32 v182, 16, v182
    v_mfma_f32_16x16x32_bf16 v[96:99], v[152:155], v[136:139], v[96:99]
    v_lshlrev_b32 v10, 16, v186
    v_and_b32 v11, 0xffff0000, v186
    v_mfma_f32_16x16x32_bf16 v[80:83], v[156:159], v[132:135], v[80:83]
    v_lshlrev_b32 v8, 16, v230
    v_mfma_f32_16x16x32_bf16 v[100:103], v[156:159], v[136:139], v[100:103]
    v_mfma_f32_16x16x32_bf16 v[64:67], v[208:211], v[200:203], v[64:67]
    ds_read_b64_tr_b16 v[132:133], v34 offset:512
    ds_read_b64_tr_b16 v[134:135], v35 offset:512
    v_mfma_f32_16x16x32_bf16 v[84:87], v[208:211], v[204:207], v[84:87]
    ds_read_b64_tr_b16 v[136:137], v34 offset:2560
    ds_read_b64_tr_b16 v[138:139], v35 offset:2560
    v_mfma_f32_16x16x32_bf16 v[68:71], v[212:215], v[200:203], v[68:71]
    ds_read_b128 v[140:143], v41 offset:0
    ds_read_b128 v[144:147], v41 offset:2048
    v_mfma_f32_16x16x32_bf16 v[88:91], v[212:215], v[204:207], v[88:91]
    ds_read_b128 v[148:151], v41 offset:4096
    ds_read_b128 v[152:155], v41 offset:6144
    v_mfma_f32_16x16x32_bf16 v[72:75], v[216:219], v[200:203], v[72:75]
    ds_read_b128 v[156:159], v41 offset:8192
    v_mfma_f32_16x16x32_bf16 v[92:95], v[216:219], v[204:207], v[92:95]
    v_and_b32 v9, 0xffff0000, v230
    v_pk_mul_f32 v[8:9], v[8:9], v[10:11]
    v_mfma_f32_16x16x32_bf16 v[76:79], v[220:223], v[200:203], v[76:79]
    v_cvt_pk_bf16_f32 v164, v8, v9
    v_and_b32 v165, 0xffff0000, v164
    v_mfma_f32_16x16x32_bf16 v[96:99], v[220:223], v[204:207], v[96:99]
    v_lshlrev_b32 v164, 16, v164
    v_lshlrev_b32 v8, 16, v240
    v_mfma_f32_16x16x32_bf16 v[80:83], v[224:227], v[200:203], v[80:83]
    v_and_b32 v9, 0xffff0000, v240
    v_mfma_f32_16x16x32_bf16 v[100:103], v[224:227], v[204:207], v[100:103]
    s_waitcnt lgkmcnt(0)
    s_barrier
    v_mfma_f32_16x16x32_bf16 v[64:67], v[112:115], v[104:107], v[64:67]
    ds_read_b64_tr_b16 v[200:201], v32 offset:30720
    ds_read_b64_tr_b16 v[202:203], v33 offset:30720
    v_mfma_f32_16x16x32_bf16 v[84:87], v[112:115], v[108:111], v[84:87]
    ds_read_b64_tr_b16 v[204:205], v32 offset:32768
    ds_read_b64_tr_b16 v[206:207], v33 offset:32768
    v_mfma_f32_16x16x32_bf16 v[68:71], v[116:119], v[104:107], v[68:71]
    ds_read_b128 v[208:211], v38 offset:30720
    ds_read_b128 v[212:215], v38 offset:32768
    v_mfma_f32_16x16x32_bf16 v[88:91], v[116:119], v[108:111], v[88:91]
    ds_read_b128 v[216:219], v38 offset:34816
    ds_read_b128 v[220:223], v38 offset:36864
    v_mfma_f32_16x16x32_bf16 v[72:75], v[120:123], v[104:107], v[72:75]
    ds_read_b128 v[224:227], v38 offset:38912
    v_mfma_f32_16x16x32_bf16 v[92:95], v[120:123], v[108:111], v[92:95]
    v_pk_mul_f32 v[8:9], v[8:9], v[10:11]
    v_cvt_pk_bf16_f32 v184, v8, v9
    v_mfma_f32_16x16x32_bf16 v[76:79], v[124:127], v[104:107], v[76:79]
    v_and_b32 v185, 0xffff0000, v184
    v_lshlrev_b32 v184, 16, v184
    v_mfma_f32_16x16x32_bf16 v[96:99], v[124:127], v[108:111], v[96:99]
    v_lshlrev_b32 v10, 16, v187
    v_and_b32 v11, 0xffff0000, v187
    v_mfma_f32_16x16x32_bf16 v[80:83], v[128:131], v[104:107], v[80:83]
    v_lshlrev_b32 v8, 16, v231
    v_mfma_f32_16x16x32_bf16 v[100:103], v[128:131], v[108:111], v[100:103]
    v_mfma_f32_16x16x32_bf16 v[64:67], v[140:143], v[132:135], v[64:67]
    ds_read_b64_tr_b16 v[104:105], v32 offset:31232
    ds_read_b64_tr_b16 v[106:107], v33 offset:31232
    v_mfma_f32_16x16x32_bf16 v[84:87], v[140:143], v[136:139], v[84:87]
    ds_read_b64_tr_b16 v[108:109], v32 offset:33280
    ds_read_b64_tr_b16 v[110:111], v33 offset:33280
    v_mfma_f32_16x16x32_bf16 v[68:71], v[144:147], v[132:135], v[68:71]
    ds_read_b128 v[112:115], v39 offset:30720
    ds_read_b128 v[116:119], v39 offset:32768
    v_mfma_f32_16x16x32_bf16 v[88:91], v[144:147], v[136:139], v[88:91]
    ds_read_b128 v[120:123], v39 offset:34816
    ds_read_b128 v[124:127], v39 offset:36864
    v_mfma_f32_16x16x32_bf16 v[72:75], v[148:151], v[132:135], v[72:75]
    ds_read_b128 v[128:131], v39 offset:38912
    v_mfma_f32_16x16x32_bf16 v[92:95], v[148:151], v[136:139], v[92:95]
    v_and_b32 v9, 0xffff0000, v231
    v_pk_mul_f32 v[8:9], v[8:9], v[10:11]
    v_mfma_f32_16x16x32_bf16 v[76:79], v[152:155], v[132:135], v[76:79]
    v_cvt_pk_bf16_f32 v166, v8, v9
    v_and_b32 v167, 0xffff0000, v166
    v_mfma_f32_16x16x32_bf16 v[96:99], v[152:155], v[136:139], v[96:99]
    v_lshlrev_b32 v166, 16, v166
    v_lshlrev_b32 v8, 16, v241
    v_mfma_f32_16x16x32_bf16 v[80:83], v[156:159], v[132:135], v[80:83]
    v_and_b32 v9, 0xffff0000, v241
    v_mfma_f32_16x16x32_bf16 v[100:103], v[156:159], v[136:139], v[100:103]
    s_waitcnt lgkmcnt(0)
    s_barrier
    v_mfma_f32_16x16x32_bf16 v[64:67], v[208:211], v[200:203], v[64:67]
    ds_read_b64_tr_b16 v[132:133], v32 offset:0
    ds_read_b64_tr_b16 v[134:135], v33 offset:0
    v_mfma_f32_16x16x32_bf16 v[84:87], v[208:211], v[204:207], v[84:87]
    ds_read_b64_tr_b16 v[136:137], v32 offset:2048
    ds_read_b64_tr_b16 v[138:139], v33 offset:2048
    v_mfma_f32_16x16x32_bf16 v[68:71], v[212:215], v[200:203], v[68:71]
    ds_read_b128 v[140:143], v38 offset:0
    ds_read_b128 v[144:147], v38 offset:2048
    v_mfma_f32_16x16x32_bf16 v[88:91], v[212:215], v[204:207], v[88:91]
    ds_read_b128 v[148:151], v38 offset:4096
    ds_read_b128 v[152:155], v38 offset:6144
    v_mfma_f32_16x16x32_bf16 v[72:75], v[216:219], v[200:203], v[72:75]
    ds_read_b128 v[156:159], v38 offset:8192
    v_mfma_f32_16x16x32_bf16 v[92:95], v[216:219], v[204:207], v[92:95]
    v_pk_mul_f32 v[8:9], v[8:9], v[10:11]
    v_cvt_pk_bf16_f32 v186, v8, v9
    v_mfma_f32_16x16x32_bf16 v[76:79], v[220:223], v[200:203], v[76:79]
    v_and_b32 v187, 0xffff0000, v186
    v_lshlrev_b32 v186, 16, v186
    v_mfma_f32_16x16x32_bf16 v[96:99], v[220:223], v[204:207], v[96:99]
    v_lshlrev_b32 v10, 16, v190
    v_and_b32 v11, 0xffff0000, v190
    v_mfma_f32_16x16x32_bf16 v[80:83], v[224:227], v[200:203], v[80:83]
    v_lshlrev_b32 v8, 16, v232
    v_mfma_f32_16x16x32_bf16 v[100:103], v[224:227], v[204:207], v[100:103]
    v_mfma_f32_16x16x32_bf16 v[64:67], v[112:115], v[104:107], v[64:67]
    ds_read_b64_tr_b16 v[200:201], v32 offset:512
    ds_read_b64_tr_b16 v[202:203], v33 offset:512
    v_mfma_f32_16x16x32_bf16 v[84:87], v[112:115], v[108:111], v[84:87]
    ds_read_b64_tr_b16 v[204:205], v32 offset:2560
    ds_read_b64_tr_b16 v[206:207], v33 offset:2560
    v_mfma_f32_16x16x32_bf16 v[68:71], v[116:119], v[104:107], v[68:71]
    ds_read_b128 v[208:211], v39 offset:0
    ds_read_b128 v[212:215], v39 offset:2048
    v_mfma_f32_16x16x32_bf16 v[88:91], v[116:119], v[108:111], v[88:91]
    ds_read_b128 v[216:219], v39 offset:4096
    ds_read_b128 v[220:223], v39 offset:6144
    v_mfma_f32_16x16x32_bf16 v[72:75], v[120:123], v[104:107], v[72:75]
    ds_read_b128 v[224:227], v39 offset:8192
    v_mfma_f32_16x16x32_bf16 v[92:95], v[120:123], v[108:111], v[92:95]
    v_and_b32 v9, 0xffff0000, v232
    v_pk_mul_f32 v[8:9], v[8:9], v[10:11]
    v_mfma_f32_16x16x32_bf16 v[76:79], v[124:127], v[104:107], v[76:79]
    v_cvt_pk_bf16_f32 v168, v8, v9
    v_and_b32 v169, 0xffff0000, v168
    v_mfma_f32_16x16x32_bf16 v[96:99], v[124:127], v[108:111], v[96:99]
    v_lshlrev_b32 v168, 16, v168
    v_lshlrev_b32 v8, 16, v242
    v_mfma_f32_16x16x32_bf16 v[80:83], v[128:131], v[104:107], v[80:83]
    v_and_b32 v9, 0xffff0000, v242
    v_mfma_f32_16x16x32_bf16 v[100:103], v[128:131], v[108:111], v[100:103]
    s_waitcnt lgkmcnt(0)
    s_barrier
    v_mfma_f32_16x16x32_bf16 v[64:67], v[140:143], v[132:135], v[64:67]
    ds_read_b64_tr_b16 v[104:105], v34 offset:25600
    ds_read_b64_tr_b16 v[106:107], v35 offset:25600
    v_mfma_f32_16x16x32_bf16 v[84:87], v[140:143], v[136:139], v[84:87]
    ds_read_b64_tr_b16 v[108:109], v34 offset:27648
    ds_read_b64_tr_b16 v[110:111], v35 offset:27648
    v_mfma_f32_16x16x32_bf16 v[68:71], v[144:147], v[132:135], v[68:71]
    ds_read_b128 v[112:115], v40 offset:25600
    ds_read_b128 v[116:119], v40 offset:27648
    v_mfma_f32_16x16x32_bf16 v[88:91], v[144:147], v[136:139], v[88:91]
    ds_read_b128 v[120:123], v40 offset:29696
    ds_read_b128 v[124:127], v40 offset:31744
    v_mfma_f32_16x16x32_bf16 v[72:75], v[148:151], v[132:135], v[72:75]
    ds_read_b128 v[128:131], v40 offset:33792
    v_mfma_f32_16x16x32_bf16 v[92:95], v[148:151], v[136:139], v[92:95]
    v_pk_mul_f32 v[8:9], v[8:9], v[10:11]
    v_cvt_pk_bf16_f32 v188, v8, v9
    v_mfma_f32_16x16x32_bf16 v[76:79], v[152:155], v[132:135], v[76:79]
    v_and_b32 v189, 0xffff0000, v188
    v_lshlrev_b32 v188, 16, v188
    v_mfma_f32_16x16x32_bf16 v[96:99], v[152:155], v[136:139], v[96:99]
    v_lshlrev_b32 v10, 16, v191
    v_and_b32 v11, 0xffff0000, v191
    v_mfma_f32_16x16x32_bf16 v[80:83], v[156:159], v[132:135], v[80:83]
    v_lshlrev_b32 v8, 16, v233
    v_mfma_f32_16x16x32_bf16 v[100:103], v[156:159], v[136:139], v[100:103]
    v_mfma_f32_16x16x32_bf16 v[64:67], v[208:211], v[200:203], v[64:67]
    ds_read_b64_tr_b16 v[132:133], v34 offset:26112
    ds_read_b64_tr_b16 v[134:135], v35 offset:26112
    v_mfma_f32_16x16x32_bf16 v[84:87], v[208:211], v[204:207], v[84:87]
    ds_read_b64_tr_b16 v[136:137], v34 offset:28160
    ds_read_b64_tr_b16 v[138:139], v35 offset:28160
    v_mfma_f32_16x16x32_bf16 v[68:71], v[212:215], v[200:203], v[68:71]
    ds_read_b128 v[140:143], v41 offset:25600
    ds_read_b128 v[144:147], v41 offset:27648
    v_mfma_f32_16x16x32_bf16 v[88:91], v[212:215], v[204:207], v[88:91]
    ds_read_b128 v[148:151], v41 offset:29696
    ds_read_b128 v[152:155], v41 offset:31744
    v_mfma_f32_16x16x32_bf16 v[72:75], v[216:219], v[200:203], v[72:75]
    ds_read_b128 v[156:159], v41 offset:33792
    v_mfma_f32_16x16x32_bf16 v[92:95], v[216:219], v[204:207], v[92:95]
    v_and_b32 v9, 0xffff0000, v233
    v_pk_mul_f32 v[8:9], v[8:9], v[10:11]
    v_mfma_f32_16x16x32_bf16 v[76:79], v[220:223], v[200:203], v[76:79]
    v_cvt_pk_bf16_f32 v170, v8, v9
    v_and_b32 v171, 0xffff0000, v170
    v_mfma_f32_16x16x32_bf16 v[96:99], v[220:223], v[204:207], v[96:99]
    v_lshlrev_b32 v170, 16, v170
    v_lshlrev_b32 v8, 16, v243
    v_mfma_f32_16x16x32_bf16 v[80:83], v[224:227], v[200:203], v[80:83]
    v_and_b32 v9, 0xffff0000, v243
    v_mfma_f32_16x16x32_bf16 v[100:103], v[224:227], v[204:207], v[100:103]
    s_waitcnt lgkmcnt(0)
    s_barrier
    v_mfma_f32_16x16x32_bf16 v[64:67], v[112:115], v[104:107], v[64:67]
    ds_read_b64_tr_b16 v[200:201], v36 offset:0
    ds_read_b64_tr_b16 v[202:203], v37 offset:0
    v_mfma_f32_16x16x32_bf16 v[84:87], v[112:115], v[108:111], v[84:87]
    ds_read_b64_tr_b16 v[204:205], v36 offset:2048
    ds_read_b64_tr_b16 v[206:207], v37 offset:2048
    v_mfma_f32_16x16x32_bf16 v[68:71], v[116:119], v[104:107], v[68:71]
    ds_read_b128 v[208:211], v42 offset:0
    ds_read_b128 v[212:215], v42 offset:2048
    v_mfma_f32_16x16x32_bf16 v[88:91], v[116:119], v[108:111], v[88:91]
    ds_read_b128 v[216:219], v42 offset:4096
    ds_read_b128 v[220:223], v42 offset:6144
    v_mfma_f32_16x16x32_bf16 v[72:75], v[120:123], v[104:107], v[72:75]
    ds_read_b128 v[224:227], v42 offset:8192
    v_mfma_f32_16x16x32_bf16 v[92:95], v[120:123], v[108:111], v[92:95]
    v_pk_mul_f32 v[8:9], v[8:9], v[10:11]
    v_cvt_pk_bf16_f32 v190, v8, v9
    v_mfma_f32_16x16x32_bf16 v[76:79], v[124:127], v[104:107], v[76:79]
    v_and_b32 v191, 0xffff0000, v190
    v_lshlrev_b32 v190, 16, v190
    v_mfma_f32_16x16x32_bf16 v[96:99], v[124:127], v[108:111], v[96:99]
    v_lshlrev_b32 v10, 16, v194
    v_and_b32 v11, 0xffff0000, v194
    v_mfma_f32_16x16x32_bf16 v[80:83], v[128:131], v[104:107], v[80:83]
    v_lshlrev_b32 v8, 16, v234
    v_mfma_f32_16x16x32_bf16 v[100:103], v[128:131], v[108:111], v[100:103]
    v_mfma_f32_16x16x32_bf16 v[64:67], v[140:143], v[132:135], v[64:67]
    ds_read_b64_tr_b16 v[104:105], v36 offset:512
    ds_read_b64_tr_b16 v[106:107], v37 offset:512
    v_mfma_f32_16x16x32_bf16 v[84:87], v[140:143], v[136:139], v[84:87]
    ds_read_b64_tr_b16 v[108:109], v36 offset:2560
    ds_read_b64_tr_b16 v[110:111], v37 offset:2560
    v_mfma_f32_16x16x32_bf16 v[68:71], v[144:147], v[132:135], v[68:71]
    ds_read_b128 v[112:115], v43 offset:0
    ds_read_b128 v[116:119], v43 offset:2048
    v_mfma_f32_16x16x32_bf16 v[88:91], v[144:147], v[136:139], v[88:91]
    ds_read_b128 v[120:123], v43 offset:4096
    ds_read_b128 v[124:127], v43 offset:6144
    v_mfma_f32_16x16x32_bf16 v[72:75], v[148:151], v[132:135], v[72:75]
    ds_read_b128 v[128:131], v43 offset:8192
    v_mfma_f32_16x16x32_bf16 v[92:95], v[148:151], v[136:139], v[92:95]
    v_and_b32 v9, 0xffff0000, v234
    v_pk_mul_f32 v[8:9], v[8:9], v[10:11]
    v_mfma_f32_16x16x32_bf16 v[76:79], v[152:155], v[132:135], v[76:79]
    v_cvt_pk_bf16_f32 v172, v8, v9
    v_and_b32 v173, 0xffff0000, v172
    v_mfma_f32_16x16x32_bf16 v[96:99], v[152:155], v[136:139], v[96:99]
    v_lshlrev_b32 v172, 16, v172
    v_lshlrev_b32 v8, 16, v244
    v_mfma_f32_16x16x32_bf16 v[80:83], v[156:159], v[132:135], v[80:83]
    v_and_b32 v9, 0xffff0000, v244
    v_mfma_f32_16x16x32_bf16 v[100:103], v[156:159], v[136:139], v[100:103]
    s_waitcnt lgkmcnt(0)
    s_barrier
    v_mfma_f32_16x16x32_bf16 v[64:67], v[208:211], v[200:203], v[64:67]
    ds_read_b64_tr_b16 v[132:133], v36 offset:25600
    ds_read_b64_tr_b16 v[134:135], v37 offset:25600
    v_mfma_f32_16x16x32_bf16 v[84:87], v[208:211], v[204:207], v[84:87]
    ds_read_b64_tr_b16 v[136:137], v36 offset:27648
    ds_read_b64_tr_b16 v[138:139], v37 offset:27648
    v_mfma_f32_16x16x32_bf16 v[68:71], v[212:215], v[200:203], v[68:71]
    ds_read_b128 v[140:143], v42 offset:25600
    ds_read_b128 v[144:147], v42 offset:27648
    v_mfma_f32_16x16x32_bf16 v[88:91], v[212:215], v[204:207], v[88:91]
    ds_read_b128 v[148:151], v42 offset:29696
    ds_read_b128 v[152:155], v42 offset:31744
    v_mfma_f32_16x16x32_bf16 v[72:75], v[216:219], v[200:203], v[72:75]
    ds_read_b128 v[156:159], v42 offset:33792
    v_mfma_f32_16x16x32_bf16 v[92:95], v[216:219], v[204:207], v[92:95]
    v_pk_mul_f32 v[8:9], v[8:9], v[10:11]
    v_cvt_pk_bf16_f32 v192, v8, v9
    v_mfma_f32_16x16x32_bf16 v[76:79], v[220:223], v[200:203], v[76:79]
    v_and_b32 v193, 0xffff0000, v192
    v_lshlrev_b32 v192, 16, v192
    v_mfma_f32_16x16x32_bf16 v[96:99], v[220:223], v[204:207], v[96:99]
    v_lshlrev_b32 v10, 16, v195
    v_and_b32 v11, 0xffff0000, v195
    v_mfma_f32_16x16x32_bf16 v[80:83], v[224:227], v[200:203], v[80:83]
    v_lshlrev_b32 v8, 16, v235
    v_mfma_f32_16x16x32_bf16 v[100:103], v[224:227], v[204:207], v[100:103]
    v_mfma_f32_16x16x32_bf16 v[64:67], v[112:115], v[104:107], v[64:67]
    ds_read_b64_tr_b16 v[200:201], v36 offset:26112
    ds_read_b64_tr_b16 v[202:203], v37 offset:26112
    v_mfma_f32_16x16x32_bf16 v[84:87], v[112:115], v[108:111], v[84:87]
    ds_read_b64_tr_b16 v[204:205], v36 offset:28160
    ds_read_b64_tr_b16 v[206:207], v37 offset:28160
    v_mfma_f32_16x16x32_bf16 v[68:71], v[116:119], v[104:107], v[68:71]
    ds_read_b128 v[208:211], v43 offset:25600
    ds_read_b128 v[212:215], v43 offset:27648
    v_mfma_f32_16x16x32_bf16 v[88:91], v[116:119], v[108:111], v[88:91]
    ds_read_b128 v[216:219], v43 offset:29696
    ds_read_b128 v[220:223], v43 offset:31744
    v_mfma_f32_16x16x32_bf16 v[72:75], v[120:123], v[104:107], v[72:75]
    ds_read_b128 v[224:227], v43 offset:33792
    v_mfma_f32_16x16x32_bf16 v[92:95], v[120:123], v[108:111], v[92:95]
    v_and_b32 v9, 0xffff0000, v235
    v_pk_mul_f32 v[8:9], v[8:9], v[10:11]
    v_mfma_f32_16x16x32_bf16 v[76:79], v[124:127], v[104:107], v[76:79]
    v_cvt_pk_bf16_f32 v174, v8, v9
    v_and_b32 v175, 0xffff0000, v174
    v_mfma_f32_16x16x32_bf16 v[96:99], v[124:127], v[108:111], v[96:99]
    v_lshlrev_b32 v174, 16, v174
    v_lshlrev_b32 v8, 16, v245
    v_mfma_f32_16x16x32_bf16 v[80:83], v[128:131], v[104:107], v[80:83]
    v_and_b32 v9, 0xffff0000, v245
    v_mfma_f32_16x16x32_bf16 v[100:103], v[128:131], v[108:111], v[100:103]
    s_waitcnt lgkmcnt(0)
    s_barrier
    v_mfma_f32_16x16x32_bf16 v[64:67], v[140:143], v[132:135], v[64:67]
    ds_read_b64_tr_b16 v[104:105], v34 offset:0
    ds_read_b64_tr_b16 v[106:107], v35 offset:0
    v_mfma_f32_16x16x32_bf16 v[84:87], v[140:143], v[136:139], v[84:87]
    ds_read_b64_tr_b16 v[108:109], v34 offset:2048
    ds_read_b64_tr_b16 v[110:111], v35 offset:2048
    v_mfma_f32_16x16x32_bf16 v[68:71], v[144:147], v[132:135], v[68:71]
    ds_read_b128 v[112:115], v40 offset:0
    ds_read_b128 v[116:119], v40 offset:2048
    v_mfma_f32_16x16x32_bf16 v[88:91], v[144:147], v[136:139], v[88:91]
    ds_read_b128 v[120:123], v40 offset:4096
    ds_read_b128 v[124:127], v40 offset:6144
    v_mfma_f32_16x16x32_bf16 v[72:75], v[148:151], v[132:135], v[72:75]
    ds_read_b128 v[128:131], v40 offset:8192
    v_mfma_f32_16x16x32_bf16 v[92:95], v[148:151], v[136:139], v[92:95]
    v_pk_mul_f32 v[8:9], v[8:9], v[10:11]
    v_cvt_pk_bf16_f32 v194, v8, v9
    v_mfma_f32_16x16x32_bf16 v[76:79], v[152:155], v[132:135], v[76:79]
    v_and_b32 v195, 0xffff0000, v194
    v_lshlrev_b32 v194, 16, v194
    v_mfma_f32_16x16x32_bf16 v[96:99], v[152:155], v[136:139], v[96:99]
    v_lshlrev_b32 v10, 16, v198
    v_and_b32 v11, 0xffff0000, v198
    v_mfma_f32_16x16x32_bf16 v[80:83], v[156:159], v[132:135], v[80:83]
    v_lshlrev_b32 v8, 16, v236
    v_mfma_f32_16x16x32_bf16 v[100:103], v[156:159], v[136:139], v[100:103]
    v_mfma_f32_16x16x32_bf16 v[64:67], v[208:211], v[200:203], v[64:67]
    ds_read_b64_tr_b16 v[132:133], v34 offset:512
    ds_read_b64_tr_b16 v[134:135], v35 offset:512
    v_mfma_f32_16x16x32_bf16 v[84:87], v[208:211], v[204:207], v[84:87]
    ds_read_b64_tr_b16 v[136:137], v34 offset:2560
    ds_read_b64_tr_b16 v[138:139], v35 offset:2560
    v_mfma_f32_16x16x32_bf16 v[68:71], v[212:215], v[200:203], v[68:71]
    ds_read_b128 v[140:143], v41 offset:0
    ds_read_b128 v[144:147], v41 offset:2048
    v_mfma_f32_16x16x32_bf16 v[88:91], v[212:215], v[204:207], v[88:91]
    ds_read_b128 v[148:151], v41 offset:4096
    ds_read_b128 v[152:155], v41 offset:6144
    v_mfma_f32_16x16x32_bf16 v[72:75], v[216:219], v[200:203], v[72:75]
    ds_read_b128 v[156:159], v41 offset:8192
    v_mfma_f32_16x16x32_bf16 v[92:95], v[216:219], v[204:207], v[92:95]
    v_and_b32 v9, 0xffff0000, v236
    v_pk_mul_f32 v[8:9], v[8:9], v[10:11]
    v_mfma_f32_16x16x32_bf16 v[76:79], v[220:223], v[200:203], v[76:79]
    v_cvt_pk_bf16_f32 v176, v8, v9
    v_and_b32 v177, 0xffff0000, v176
    v_mfma_f32_16x16x32_bf16 v[96:99], v[220:223], v[204:207], v[96:99]
    v_lshlrev_b32 v176, 16, v176
    v_lshlrev_b32 v8, 16, v246
    v_mfma_f32_16x16x32_bf16 v[80:83], v[224:227], v[200:203], v[80:83]
    v_and_b32 v9, 0xffff0000, v246
    v_mfma_f32_16x16x32_bf16 v[100:103], v[224:227], v[204:207], v[100:103]
    s_waitcnt lgkmcnt(0)
    s_barrier
    v_mfma_f32_16x16x32_bf16 v[64:67], v[112:115], v[104:107], v[64:67]
    ds_read_b64_tr_b16 v[200:201], v32 offset:30720
    ds_read_b64_tr_b16 v[202:203], v33 offset:30720
    v_mfma_f32_16x16x32_bf16 v[84:87], v[112:115], v[108:111], v[84:87]
    ds_read_b64_tr_b16 v[204:205], v32 offset:32768
    ds_read_b64_tr_b16 v[206:207], v33 offset:32768
    v_mfma_f32_16x16x32_bf16 v[68:71], v[116:119], v[104:107], v[68:71]
    ds_read_b128 v[208:211], v38 offset:30720
    ds_read_b128 v[212:215], v38 offset:32768
    v_mfma_f32_16x16x32_bf16 v[88:91], v[116:119], v[108:111], v[88:91]
    ds_read_b128 v[216:219], v38 offset:34816
    ds_read_b128 v[220:223], v38 offset:36864
    v_mfma_f32_16x16x32_bf16 v[72:75], v[120:123], v[104:107], v[72:75]
    ds_read_b128 v[224:227], v38 offset:38912
    v_mfma_f32_16x16x32_bf16 v[92:95], v[120:123], v[108:111], v[92:95]
    v_pk_mul_f32 v[8:9], v[8:9], v[10:11]
    v_cvt_pk_bf16_f32 v196, v8, v9
    v_mfma_f32_16x16x32_bf16 v[76:79], v[124:127], v[104:107], v[76:79]
    v_and_b32 v197, 0xffff0000, v196
    v_lshlrev_b32 v196, 16, v196
    v_mfma_f32_16x16x32_bf16 v[96:99], v[124:127], v[108:111], v[96:99]
    v_lshlrev_b32 v10, 16, v199
    v_and_b32 v11, 0xffff0000, v199
    v_mfma_f32_16x16x32_bf16 v[80:83], v[128:131], v[104:107], v[80:83]
    v_lshlrev_b32 v8, 16, v237
    v_mfma_f32_16x16x32_bf16 v[100:103], v[128:131], v[108:111], v[100:103]
    v_mfma_f32_16x16x32_bf16 v[64:67], v[140:143], v[132:135], v[64:67]
    ds_read_b64_tr_b16 v[104:105], v32 offset:31232
    ds_read_b64_tr_b16 v[106:107], v33 offset:31232
    v_mfma_f32_16x16x32_bf16 v[84:87], v[140:143], v[136:139], v[84:87]
    ds_read_b64_tr_b16 v[108:109], v32 offset:33280
    ds_read_b64_tr_b16 v[110:111], v33 offset:33280
    v_mfma_f32_16x16x32_bf16 v[68:71], v[144:147], v[132:135], v[68:71]
    ds_read_b128 v[112:115], v39 offset:30720
    ds_read_b128 v[116:119], v39 offset:32768
    v_mfma_f32_16x16x32_bf16 v[88:91], v[144:147], v[136:139], v[88:91]
    ds_read_b128 v[120:123], v39 offset:34816
    ds_read_b128 v[124:127], v39 offset:36864
    v_mfma_f32_16x16x32_bf16 v[72:75], v[148:151], v[132:135], v[72:75]
    ds_read_b128 v[128:131], v39 offset:38912
    v_mfma_f32_16x16x32_bf16 v[92:95], v[148:151], v[136:139], v[92:95]
    v_and_b32 v9, 0xffff0000, v237
    v_pk_mul_f32 v[8:9], v[8:9], v[10:11]
    v_mfma_f32_16x16x32_bf16 v[76:79], v[152:155], v[132:135], v[76:79]
    v_cvt_pk_bf16_f32 v178, v8, v9
    v_and_b32 v179, 0xffff0000, v178
    v_mfma_f32_16x16x32_bf16 v[96:99], v[152:155], v[136:139], v[96:99]
    v_lshlrev_b32 v178, 16, v178
    v_lshlrev_b32 v8, 16, v247
    v_mfma_f32_16x16x32_bf16 v[80:83], v[156:159], v[132:135], v[80:83]
    v_and_b32 v9, 0xffff0000, v247
    v_mfma_f32_16x16x32_bf16 v[100:103], v[156:159], v[136:139], v[100:103]
    s_waitcnt lgkmcnt(0)
    s_barrier
    v_mfma_f32_16x16x32_bf16 v[64:67], v[208:211], v[200:203], v[64:67]
    ds_read_b64_tr_b16 v[132:133], v32 offset:0
    ds_read_b64_tr_b16 v[134:135], v33 offset:0
    v_mfma_f32_16x16x32_bf16 v[84:87], v[208:211], v[204:207], v[84:87]
    ds_read_b64_tr_b16 v[136:137], v32 offset:2048
    ds_read_b64_tr_b16 v[138:139], v33 offset:2048
    v_mfma_f32_16x16x32_bf16 v[68:71], v[212:215], v[200:203], v[68:71]
    ds_read_b128 v[140:143], v38 offset:0
    ds_read_b128 v[144:147], v38 offset:2048
    v_mfma_f32_16x16x32_bf16 v[88:91], v[212:215], v[204:207], v[88:91]
    ds_read_b128 v[148:151], v38 offset:4096
    ds_read_b128 v[152:155], v38 offset:6144
    v_mfma_f32_16x16x32_bf16 v[72:75], v[216:219], v[200:203], v[72:75]
    ds_read_b128 v[156:159], v38 offset:8192
    v_mfma_f32_16x16x32_bf16 v[92:95], v[216:219], v[204:207], v[92:95]
    v_pk_mul_f32 v[8:9], v[8:9], v[10:11]
    v_mfma_f32_16x16x32_bf16 v[76:79], v[220:223], v[200:203], v[76:79]
    v_cvt_pk_bf16_f32 v198, v8, v9
    v_mfma_f32_16x16x32_bf16 v[96:99], v[220:223], v[204:207], v[96:99]
    v_and_b32 v199, 0xffff0000, v198
    v_mfma_f32_16x16x32_bf16 v[80:83], v[224:227], v[200:203], v[80:83]
    v_lshlrev_b32 v198, 16, v198
    v_mfma_f32_16x16x32_bf16 v[100:103], v[224:227], v[204:207], v[100:103]
    v_mfma_f32_16x16x32_bf16 v[64:67], v[112:115], v[104:107], v[64:67]
    ds_read_b64_tr_b16 v[200:201], v32 offset:512
    ds_read_b64_tr_b16 v[202:203], v33 offset:512
    v_mfma_f32_16x16x32_bf16 v[84:87], v[112:115], v[108:111], v[84:87]
    ds_read_b64_tr_b16 v[204:205], v32 offset:2560
    ds_read_b64_tr_b16 v[206:207], v33 offset:2560
    v_mfma_f32_16x16x32_bf16 v[68:71], v[116:119], v[104:107], v[68:71]
    ds_read_b128 v[208:211], v39 offset:0
    ds_read_b128 v[212:215], v39 offset:2048
    v_mfma_f32_16x16x32_bf16 v[88:91], v[116:119], v[108:111], v[88:91]
    ds_read_b128 v[216:219], v39 offset:4096
    ds_read_b128 v[220:223], v39 offset:6144
    v_mfma_f32_16x16x32_bf16 v[72:75], v[120:123], v[104:107], v[72:75]
    ds_read_b128 v[224:227], v39 offset:8192
    v_mfma_f32_16x16x32_bf16 v[92:95], v[120:123], v[108:111], v[92:95]
    v_mfma_f32_16x16x32_bf16 v[76:79], v[124:127], v[104:107], v[76:79]
    v_mfma_f32_16x16x32_bf16 v[96:99], v[124:127], v[108:111], v[96:99]
    v_mfma_f32_16x16x32_bf16 v[80:83], v[128:131], v[104:107], v[80:83]
    v_mfma_f32_16x16x32_bf16 v[100:103], v[128:131], v[108:111], v[100:103]
    s_waitcnt lgkmcnt(9)
    v_mfma_f32_16x16x32_bf16 v[64:67], v[140:143], v[132:135], v[64:67]
    v_mfma_f32_16x16x32_bf16 v[84:87], v[140:143], v[136:139], v[84:87]
    v_mfma_f32_16x16x32_bf16 v[68:71], v[144:147], v[132:135], v[68:71]
    v_mfma_f32_16x16x32_bf16 v[88:91], v[144:147], v[136:139], v[88:91]
    v_mfma_f32_16x16x32_bf16 v[72:75], v[148:151], v[132:135], v[72:75]
    v_mfma_f32_16x16x32_bf16 v[92:95], v[148:151], v[136:139], v[92:95]
    v_mfma_f32_16x16x32_bf16 v[76:79], v[152:155], v[132:135], v[76:79]
    v_mfma_f32_16x16x32_bf16 v[96:99], v[152:155], v[136:139], v[96:99]
    v_mfma_f32_16x16x32_bf16 v[80:83], v[156:159], v[132:135], v[80:83]
    v_mfma_f32_16x16x32_bf16 v[100:103], v[156:159], v[136:139], v[100:103]
    s_waitcnt lgkmcnt(0)
    v_mfma_f32_16x16x32_bf16 v[64:67], v[208:211], v[200:203], v[64:67]
    v_mfma_f32_16x16x32_bf16 v[84:87], v[208:211], v[204:207], v[84:87]
    v_mfma_f32_16x16x32_bf16 v[68:71], v[212:215], v[200:203], v[68:71]
    v_mfma_f32_16x16x32_bf16 v[88:91], v[212:215], v[204:207], v[88:91]
    v_mfma_f32_16x16x32_bf16 v[72:75], v[216:219], v[200:203], v[72:75]
    v_mfma_f32_16x16x32_bf16 v[92:95], v[216:219], v[204:207], v[92:95]
    v_mfma_f32_16x16x32_bf16 v[76:79], v[220:223], v[200:203], v[76:79]
    v_mfma_f32_16x16x32_bf16 v[96:99], v[220:223], v[204:207], v[96:99]
    v_mfma_f32_16x16x32_bf16 v[80:83], v[224:227], v[200:203], v[80:83]
    v_mfma_f32_16x16x32_bf16 v[100:103], v[224:227], v[204:207], v[100:103]
    v_pk_add_f32 v[64:65], v[64:65], v[160:161]
    v_pk_add_f32 v[66:67], v[66:67], v[162:163]
    ds_write_b128 v54, v[64:67] offset:0
    v_pk_add_f32 v[68:69], v[68:69], v[164:165]
    v_pk_add_f32 v[70:71], v[70:71], v[166:167]
    ds_write_b128 v54, v[68:71] offset:64
    v_pk_add_f32 v[72:73], v[72:73], v[168:169]
    v_pk_add_f32 v[74:75], v[74:75], v[170:171]
    ds_write_b128 v54, v[72:75] offset:128
    v_pk_add_f32 v[76:77], v[76:77], v[172:173]
    v_pk_add_f32 v[78:79], v[78:79], v[174:175]
    ds_write_b128 v54, v[76:79] offset:192
    v_pk_add_f32 v[80:81], v[80:81], v[176:177]
    v_pk_add_f32 v[82:83], v[82:83], v[178:179]
    s_mov_b32 exec_hi, 0
    ds_write_b128 v54, v[80:83] offset:256
    s_mov_b32 exec_hi, -1
    ds_read_b128 v[104:107], v55 offset:0
    ds_read_b128 v[108:111], v55 offset:1024
    ds_read_b128 v[112:115], v55 offset:2048
    ds_read_b128 v[116:119], v55 offset:3072
    v_pk_add_f32 v[84:85], v[84:85], v[180:181]
    v_pk_add_f32 v[86:87], v[86:87], v[182:183]
    ds_write_b128 v54, v[84:87] offset:4608
    v_pk_add_f32 v[88:89], v[88:89], v[184:185]
    v_pk_add_f32 v[90:91], v[90:91], v[186:187]
    ds_write_b128 v54, v[88:91] offset:4672
    v_pk_add_f32 v[92:93], v[92:93], v[188:189]
    v_pk_add_f32 v[94:95], v[94:95], v[190:191]
    ds_write_b128 v54, v[92:95] offset:4736
    v_pk_add_f32 v[96:97], v[96:97], v[192:193]
    v_pk_add_f32 v[98:99], v[98:99], v[194:195]
    ds_write_b128 v54, v[96:99] offset:4800
    v_pk_add_f32 v[100:101], v[100:101], v[196:197]
    v_pk_add_f32 v[102:103], v[102:103], v[198:199]
    s_mov_b32 exec_hi, 0
    ds_write_b128 v54, v[100:103] offset:4864
    s_mov_b32 exec_hi, -1
    ds_read_b128 v[120:123], v55 offset:4096
    ds_read_b128 v[124:127], v55 offset:5120
    ds_read_b128 v[128:131], v55 offset:6144
    ds_read_b128 v[132:135], v55 offset:7168
    ds_read_b128 v[136:139], v55 offset:8192
    s_waitcnt lgkmcnt(13)
    buffer_store_dwordx4 v[104:107], v44, s[56:59], s80 offen offset:2304 nt
    s_waitcnt lgkmcnt(12)
    buffer_store_dwordx4 v[108:111], v45, s[56:59], s80 offen offset:2304 nt
    s_waitcnt lgkmcnt(11)
    buffer_store_dwordx4 v[112:115], v46, s[56:59], s80 offen offset:2304 nt
    s_waitcnt lgkmcnt(10)
    buffer_store_dwordx4 v[116:119], v47, s[56:59], s80 offen offset:2304 nt
    s_waitcnt lgkmcnt(4)
    buffer_store_dwordx4 v[120:123], v48, s[56:59], s80 offen offset:2304 nt
    s_waitcnt lgkmcnt(3)
    buffer_store_dwordx4 v[124:127], v49, s[56:59], s80 offen offset:2304 nt
    s_waitcnt lgkmcnt(2)
    buffer_store_dwordx4 v[128:131], v50, s[56:59], s80 offen offset:2304 nt
    s_waitcnt lgkmcnt(1)
    buffer_store_dwordx4 v[132:135], v51, s[56:59], s80 offen offset:2304 nt
    s_waitcnt lgkmcnt(0)
    buffer_store_dwordx4 v[136:139], v52, s[56:59], s80 offen offset:2304 nt
    s_branch L_tail_end
L_tail_ca:
    s_lshl_b32 s72, s69, 9
    v_lshlrev_b32 v32, 11, v3
    v_lshl_add_u32 v32, v2, 4, v32
    v_add_u32 v32, s72, v32
    v_add_u32 v36, 72704, v251
    v_add_u32 v37, 128000, v251
    v_mov_b32 v40, v252
    v_add_u32 v41, 64, v252
    s_mov_b32 s56, s32
    s_mov_b32 s57, s33
    s_mov_b32 s58, 9437184
    s_mov_b32 s59, 0x20000
    s_lshl_b32 s80, s74, 2
    s_add_u32 s80, s80, s69
    s_mul_i32 s80, s80, 147456
    s_mul_i32 s81, s75, 288
    s_add_u32 s80, s80, s81
    v_add_u32 v10, 0, v1
    v_mul_u32_u24 v11, 3641, v10
    v_lshrrev_b32 v11, 16, v11
    v_mul_u32_u24 v11, 270, v11
    v_add_lshl_u32 v44, v10, v11, 4
    v_add_u32 v10, 64, v1
    v_mul_u32_u24 v11, 3641, v10
    v_lshrrev_b32 v11, 16, v11
    v_mul_u32_u24 v11, 270, v11
    v_add_lshl_u32 v45, v10, v11, 4
    v_add_u32 v10, 128, v1
    v_mul_u32_u24 v11, 3641, v10
    v_lshrrev_b32 v11, 16, v11
    v_mul_u32_u24 v11, 270, v11
    v_add_lshl_u32 v46, v10, v11, 4
    v_add_u32 v10, 192, v1
    v_mul_u32_u24 v11, 3641, v10
    v_lshrrev_b32 v11, 16, v11
    v_mul_u32_u24 v11, 270, v11
    v_add_lshl_u32 v47, v10, v11, 4
    v_add_u32 v10, 256, v1
    v_mul_u32_u24 v11, 3641, v10
    v_lshrrev_b32 v11, 16, v11
    v_mul_u32_u24 v11, 270, v11
    v_add_lshl_u32 v48, v10, v11, 4
    v_add_u32 v10, 320, v1
    v_mul_u32_u24 v11, 3641, v10
    v_lshrrev_b32 v11, 16, v11
    v_mul_u32_u24 v11, 270, v11
    v_add_lshl_u32 v49, v10, v11, 4
    v_add_u32 v10, 384, v1
    v_mul_u32_u24 v11, 3641, v10
    v_lshrrev_b32 v11, 16, v11
    v_mul_u32_u24 v11, 270, v11
    v_add_lshl_u32 v50, v10, v11, 4
    v_add_u32 v10, 448, v1
    v_mul_u32_u24 v11, 3641, v10
    v_lshrrev_b32 v11, 16, v11
    v_mul_u32_u24 v11, 270, v11
    v_add_lshl_u32 v51, v10, v11, 4
    v_add_u32 v10, 512, v1
    v_mul_u32_u24 v11, 3641, v10
    v_lshrrev_b32 v11, 16, v11
    v_mul_u32_u24 v11, 270, v11
    v_add_lshl_u32 v52, v10, v11, 4
    s_mul_i32 s81, s69, 9216
    s_add_u32 s81, s81, 16384
    v_mul_u32_u24 v54, 288, v2
    v_lshl_add_u32 v54, v3, 4, v54
    v_add_u32 v54, s81, v54
    v_add_u32 v55, s81, v19
    v_and_b32 v10, 8, v2
    v_mul_u32_u24 v10, 288, v10
    v_add_u32 v54, v54, v10
    s_waitcnt vmcnt(0)
    v_and_b32 v12, 3, v1
    v_lshlrev_b32 v12, 14, v12
    v_bfe_u32 v13, v1, 2, 1
    v_lshl_add_u32 v12, v13, 11, v12
    v_mov_b32 v13, s67
    s_mov_b64 exec, 255
    buffer_store_dword v13, v12, s[52:55], s79 offen sc1
    s_mov_b64 exec, -1
    s_barrier
    s_waitcnt lgkmcnt(0)
    s_barrier
    ds_read_b128 v[104:107], v32 offset:0
    ds_read_b128 v[108:111], v32 offset:256
    ds_read_b64_tr_b16 v[112:113], v36 offset:9216
    ds_read_b64_tr_b16 v[114:115], v36 offset:9360
    ds_read_b64_tr_b16 v[116:117], v36 offset:9248
    ds_read_b64_tr_b16 v[118:119], v36 offset:9392
    ds_read_b64_tr_b16 v[120:121], v36 offset:9280
    ds_read_b64_tr_b16 v[122:123], v36 offset:9424
    ds_read_b64_tr_b16 v[124:125], v36 offset:9312
    ds_read_b64_tr_b16 v[126:127], v36 offset:9456
    ds_read_b64_tr_b16 v[128:129], v36 offset:9344
    ds_read_b64_tr_b16 v[130:131], v36 offset:9488
    ds_read_b128 v[132:135], v32 offset:8192
    ds_read_b128 v[136:139], v32 offset:8448
    ds_read_b64_tr_b16 v[140:141], v36 offset:13824
    ds_read_b64_tr_b16 v[142:143], v36 offset:13968
    ds_read_b64_tr_b16 v[144:145], v36 offset:13856
    ds_read_b64_tr_b16 v[146:147], v36 offset:14000
    ds_read_b64_tr_b16 v[148:149], v36 offset:13888
    ds_read_b64_tr_b16 v[150:151], v36 offset:14032
    ds_read_b64_tr_b16 v[152:153], v36 offset:13920
    ds_read_b64_tr_b16 v[154:155], v36 offset:14064
    ds_read_b64_tr_b16 v[156:157], v36 offset:13952
    ds_read_b64_tr_b16 v[158:159], v36 offset:14096
    s_waitcnt lgkmcnt(10)
    s_barrier
    v_mfma_f32_16x16x32_bf16 v[64:67], v[112:115], v[104:107], 0
    ds_read_b128 v[200:203], v32 offset:16384
    ds_read_b128 v[204:207], v32 offset:16640
    v_mfma_f32_16x16x32_bf16 v[84:87], v[112:115], v[108:111], 0
    ds_read_b64_tr_b16 v[208:209], v36 offset:18432
    ds_read_b64_tr_b16 v[210:211], v36 offset:18576
    v_mfma_f32_16x16x32_bf16 v[68:71], v[116:119], v[104:107], 0
    ds_read_b64_tr_b16 v[212:213], v36 offset:18464
    ds_read_b64_tr_b16 v[214:215], v36 offset:18608
    v_mfma_f32_16x16x32_bf16 v[88:91], v[116:119], v[108:111], 0
    ds_read_b64_tr_b16 v[216:217], v36 offset:18496
    ds_read_b64_tr_b16 v[218:219], v36 offset:18640
    v_mfma_f32_16x16x32_bf16 v[72:75], v[120:123], v[104:107], 0
    ds_read_b64_tr_b16 v[220:221], v36 offset:18528
    ds_read_b64_tr_b16 v[222:223], v36 offset:18672
    v_mfma_f32_16x16x32_bf16 v[92:95], v[120:123], v[108:111], 0
    ds_read_b64_tr_b16 v[224:225], v36 offset:18560
    ds_read_b64_tr_b16 v[226:227], v36 offset:18704
    v_mfma_f32_16x16x32_bf16 v[76:79], v[124:127], v[104:107], 0
    v_mfma_f32_16x16x32_bf16 v[96:99], v[124:127], v[108:111], 0
    v_mfma_f32_16x16x32_bf16 v[80:83], v[128:131], v[104:107], 0
    v_mfma_f32_16x16x32_bf16 v[100:103], v[128:131], v[108:111], 0
    s_waitcnt lgkmcnt(15)
    v_mfma_f32_16x16x32_bf16 v[64:67], v[140:143], v[132:135], v[64:67]
    ds_read_b128 v[104:107], v32 offset:24576
    ds_read_b128 v[108:111], v32 offset:24832
    v_mfma_f32_16x16x32_bf16 v[84:87], v[140:143], v[136:139], v[84:87]
    ds_read_b64_tr_b16 v[112:113], v36 offset:23040
    ds_read_b64_tr_b16 v[114:115], v36 offset:23184
    v_mfma_f32_16x16x32_bf16 v[68:71], v[144:147], v[132:135], v[68:71]
    ds_read_b64_tr_b16 v[116:117], v36 offset:23072
    ds_read_b64_tr_b16 v[118:119], v36 offset:23216
    v_mfma_f32_16x16x32_bf16 v[88:91], v[144:147], v[136:139], v[88:91]
    ds_read_b64_tr_b16 v[120:121], v36 offset:23104
    ds_read_b64_tr_b16 v[122:123], v36 offset:23248
    v_mfma_f32_16x16x32_bf16 v[72:75], v[148:151], v[132:135], v[72:75]
    ds_read_b64_tr_b16 v[124:125], v36 offset:23136
    ds_read_b64_tr_b16 v[126:127], v36 offset:23280
    v_mfma_f32_16x16x32_bf16 v[92:95], v[148:151], v[136:139], v[92:95]
    ds_read_b64_tr_b16 v[128:129], v36 offset:23168
    ds_read_b64_tr_b16 v[130:131], v36 offset:23312
    s_waitcnt lgkmcnt(15)
    v_mfma_f32_16x16x32_bf16 v[76:79], v[152:155], v[132:135], v[76:79]
    v_mfma_f32_16x16x32_bf16 v[96:99], v[152:155], v[136:139], v[96:99]
    v_mfma_f32_16x16x32_bf16 v[80:83], v[156:159], v[132:135], v[80:83]
    v_mfma_f32_16x16x32_bf16 v[100:103], v[156:159], v[136:139], v[100:103]
    s_waitcnt lgkmcnt(10)
    s_barrier
    v_mfma_f32_16x16x32_bf16 v[64:67], v[208:211], v[200:203], v[64:67]
    ds_read_b128 v[132:135], v32 offset:32768
    ds_read_b128 v[136:139], v32 offset:33024
    v_mfma_f32_16x16x32_bf16 v[84:87], v[208:211], v[204:207], v[84:87]
    ds_read_b64_tr_b16 v[140:141], v36 offset:27648
    ds_read_b64_tr_b16 v[142:143], v36 offset:27792
    v_mfma_f32_16x16x32_bf16 v[68:71], v[212:215], v[200:203], v[68:71]
    ds_read_b64_tr_b16 v[144:145], v36 offset:27680
    ds_read_b64_tr_b16 v[146:147], v36 offset:27824
    v_mfma_f32_16x16x32_bf16 v[88:91], v[212:215], v[204:207], v[88:91]
    ds_read_b64_tr_b16 v[148:149], v36 offset:27712
    ds_read_b64_tr_b16 v[150:151], v36 offset:27856
    v_mfma_f32_16x16x32_bf16 v[72:75], v[216:219], v[200:203], v[72:75]
    ds_read_b64_tr_b16 v[152:153], v36 offset:27744
    ds_read_b64_tr_b16 v[154:155], v36 offset:27888
    v_mfma_f32_16x16x32_bf16 v[92:95], v[216:219], v[204:207], v[92:95]
    ds_read_b64_tr_b16 v[156:157], v36 offset:27776
    ds_read_b64_tr_b16 v[158:159], v36 offset:27920
    v_mfma_f32_16x16x32_bf16 v[76:79], v[220:223], v[200:203], v[76:79]
    v_mfma_f32_16x16x32_bf16 v[96:99], v[220:223], v[204:207], v[96:99]
    v_mfma_f32_16x16x32_bf16 v[80:83], v[224:227], v[200:203], v[80:83]
    v_mfma_f32_16x16x32_bf16 v[100:103], v[224:227], v[204:207], v[100:103]
    s_waitcnt lgkmcnt(12)
    v_mfma_f32_16x16x32_bf16 v[64:67], v[112:115], v[104:107], v[64:67]
    ds_read_b128 v[200:203], v32 offset:40960
    ds_read_b128 v[204:207], v32 offset:41216
    v_mfma_f32_16x16x32_bf16 v[84:87], v[112:115], v[108:111], v[84:87]
    ds_read_b64_tr_b16 v[208:209], v36 offset:32256
    ds_read_b64_tr_b16 v[210:211], v36 offset:32400
    v_mfma_f32_16x16x32_bf16 v[68:71], v[116:119], v[104:107], v[68:71]
    ds_read_b64_tr_b16 v[212:213], v36 offset:32288
    ds_read_b64_tr_b16 v[214:215], v36 offset:32432
    v_mfma_f32_16x16x32_bf16 v[88:91], v[116:119], v[108:111], v[88:91]
    ds_read_b64_tr_b16 v[216:217], v36 offset:32320
    ds_read_b64_tr_b16 v[218:219], v36 offset:32464
    v_mfma_f32_16x16x32_bf16 v[72:75], v[120:123], v[104:107], v[72:75]
    ds_read_b64_tr_b16 v[220:221], v36 offset:32352
    ds_read_b64_tr_b16 v[222:223], v36 offset:32496
    v_mfma_f32_16x16x32_bf16 v[92:95], v[120:123], v[108:111], v[92:95]
    ds_read_b64_tr_b16 v[224:225], v36 offset:32384
    ds_read_b64_tr_b16 v[226:227], v36 offset:32528
    v_mfma_f32_16x16x32_bf16 v[76:79], v[124:127], v[104:107], v[76:79]
    v_mfma_f32_16x16x32_bf16 v[96:99], v[124:127], v[108:111], v[96:99]
    v_mfma_f32_16x16x32_bf16 v[80:83], v[128:131], v[104:107], v[80:83]
    v_mfma_f32_16x16x32_bf16 v[100:103], v[128:131], v[108:111], v[100:103]
    s_waitcnt lgkmcnt(10)
    s_barrier
    v_mfma_f32_16x16x32_bf16 v[64:67], v[140:143], v[132:135], v[64:67]
    ds_read_b128 v[104:107], v32 offset:49152
    ds_read_b128 v[108:111], v32 offset:49408
    v_mfma_f32_16x16x32_bf16 v[84:87], v[140:143], v[136:139], v[84:87]
    ds_read_b64_tr_b16 v[112:113], v36 offset:36864
    ds_read_b64_tr_b16 v[114:115], v36 offset:37008
    v_mfma_f32_16x16x32_bf16 v[68:71], v[144:147], v[132:135], v[68:71]
    ds_read_b64_tr_b16 v[116:117], v36 offset:36896
    ds_read_b64_tr_b16 v[118:119], v36 offset:37040
    v_mfma_f32_16x16x32_bf16 v[88:91], v[144:147], v[136:139], v[88:91]
    ds_read_b64_tr_b16 v[120:121], v36 offset:36928
    ds_read_b64_tr_b16 v[122:123], v36 offset:37072
    v_mfma_f32_16x16x32_bf16 v[72:75], v[148:151], v[132:135], v[72:75]
    ds_read_b64_tr_b16 v[124:125], v36 offset:36960
    ds_read_b64_tr_b16 v[126:127], v36 offset:37104
    v_mfma_f32_16x16x32_bf16 v[92:95], v[148:151], v[136:139], v[92:95]
    ds_read_b64_tr_b16 v[128:129], v36 offset:36992
    ds_read_b64_tr_b16 v[130:131], v36 offset:37136
    v_mfma_f32_16x16x32_bf16 v[76:79], v[152:155], v[132:135], v[76:79]
    v_mfma_f32_16x16x32_bf16 v[96:99], v[152:155], v[136:139], v[96:99]
    v_mfma_f32_16x16x32_bf16 v[80:83], v[156:159], v[132:135], v[80:83]
    v_mfma_f32_16x16x32_bf16 v[100:103], v[156:159], v[136:139], v[100:103]
    s_waitcnt lgkmcnt(12)
    v_mfma_f32_16x16x32_bf16 v[64:67], v[208:211], v[200:203], v[64:67]
    ds_read_b128 v[132:135], v32 offset:57344
    ds_read_b128 v[136:139], v32 offset:57600
    v_mfma_f32_16x16x32_bf16 v[84:87], v[208:211], v[204:207], v[84:87]
    ds_read_b64_tr_b16 v[140:141], v36 offset:41472
    ds_read_b64_tr_b16 v[142:143], v36 offset:41616
    v_mfma_f32_16x16x32_bf16 v[68:71], v[212:215], v[200:203], v[68:71]
    ds_read_b64_tr_b16 v[144:145], v36 offset:41504
    ds_read_b64_tr_b16 v[146:147], v36 offset:41648
    v_mfma_f32_16x16x32_bf16 v[88:91], v[212:215], v[204:207], v[88:91]
    ds_read_b64_tr_b16 v[148:149], v36 offset:41536
    ds_read_b64_tr_b16 v[150:151], v36 offset:41680
    v_mfma_f32_16x16x32_bf16 v[72:75], v[216:219], v[200:203], v[72:75]
    ds_read_b64_tr_b16 v[152:153], v36 offset:41568
    ds_read_b64_tr_b16 v[154:155], v36 offset:41712
    v_mfma_f32_16x16x32_bf16 v[92:95], v[216:219], v[204:207], v[92:95]
    ds_read_b64_tr_b16 v[156:157], v36 offset:41600
    ds_read_b64_tr_b16 v[158:159], v36 offset:41744
    v_mfma_f32_16x16x32_bf16 v[76:79], v[220:223], v[200:203], v[76:79]
    v_mfma_f32_16x16x32_bf16 v[96:99], v[220:223], v[204:207], v[96:99]
    v_mfma_f32_16x16x32_bf16 v[80:83], v[224:227], v[200:203], v[80:83]
    v_mfma_f32_16x16x32_bf16 v[100:103], v[224:227], v[204:207], v[100:103]
    s_waitcnt lgkmcnt(10)
    s_barrier
    v_mfma_f32_16x16x32_bf16 v[64:67], v[112:115], v[104:107], v[64:67]
    ds_read_b128 v[200:203], v32 offset:0
    ds_read_b128 v[204:207], v32 offset:256
    v_mfma_f32_16x16x32_bf16 v[84:87], v[112:115], v[108:111], v[84:87]
    ds_read_b64_tr_b16 v[208:209], v36 offset:46080
    ds_read_b64_tr_b16 v[210:211], v36 offset:46224
    v_mfma_f32_16x16x32_bf16 v[68:71], v[116:119], v[104:107], v[68:71]
    ds_read_b64_tr_b16 v[212:213], v36 offset:46112
    ds_read_b64_tr_b16 v[214:215], v36 offset:46256
    v_mfma_f32_16x16x32_bf16 v[88:91], v[116:119], v[108:111], v[88:91]
    ds_read_b64_tr_b16 v[216:217], v36 offset:46144
    ds_read_b64_tr_b16 v[218:219], v36 offset:46288
    v_mfma_f32_16x16x32_bf16 v[72:75], v[120:123], v[104:107], v[72:75]
    ds_read_b64_tr_b16 v[220:221], v36 offset:46176
    ds_read_b64_tr_b16 v[222:223], v36 offset:46320
    v_mfma_f32_16x16x32_bf16 v[92:95], v[120:123], v[108:111], v[92:95]
    ds_read_b64_tr_b16 v[224:225], v36 offset:46208
    ds_read_b64_tr_b16 v[226:227], v36 offset:46352
    v_mfma_f32_16x16x32_bf16 v[76:79], v[124:127], v[104:107], v[76:79]
    v_mfma_f32_16x16x32_bf16 v[96:99], v[124:127], v[108:111], v[96:99]
    v_mfma_f32_16x16x32_bf16 v[80:83], v[128:131], v[104:107], v[80:83]
    v_mfma_f32_16x16x32_bf16 v[100:103], v[128:131], v[108:111], v[100:103]
    s_waitcnt lgkmcnt(12)
    v_mfma_f32_16x16x32_bf16 v[64:67], v[140:143], v[132:135], v[64:67]
    ds_read_b128 v[104:107], v32 offset:8192
    ds_read_b128 v[108:111], v32 offset:8448
    v_mfma_f32_16x16x32_bf16 v[84:87], v[140:143], v[136:139], v[84:87]
    ds_read_b64_tr_b16 v[112:113], v36 offset:50688
    ds_read_b64_tr_b16 v[114:115], v36 offset:50832
    v_mfma_f32_16x16x32_bf16 v[68:71], v[144:147], v[132:135], v[68:71]
    ds_read_b64_tr_b16 v[116:117], v36 offset:50720
    ds_read_b64_tr_b16 v[118:119], v36 offset:50864
    v_mfma_f32_16x16x32_bf16 v[88:91], v[144:147], v[136:139], v[88:91]
    ds_read_b64_tr_b16 v[120:121], v36 offset:50752
    ds_read_b64_tr_b16 v[122:123], v36 offset:50896
    v_mfma_f32_16x16x32_bf16 v[72:75], v[148:151], v[132:135], v[72:75]
    ds_read_b64_tr_b16 v[124:125], v36 offset:50784
    ds_read_b64_tr_b16 v[126:127], v36 offset:50928
    v_mfma_f32_16x16x32_bf16 v[92:95], v[148:151], v[136:139], v[92:95]
    ds_read_b64_tr_b16 v[128:129], v36 offset:50816
    ds_read_b64_tr_b16 v[130:131], v36 offset:50960
    v_mfma_f32_16x16x32_bf16 v[76:79], v[152:155], v[132:135], v[76:79]
    v_mfma_f32_16x16x32_bf16 v[96:99], v[152:155], v[136:139], v[96:99]
    v_mfma_f32_16x16x32_bf16 v[80:83], v[156:159], v[132:135], v[80:83]
    v_mfma_f32_16x16x32_bf16 v[100:103], v[156:159], v[136:139], v[100:103]
    s_waitcnt lgkmcnt(10)
    s_barrier
    v_mfma_f32_16x16x32_bf16 v[64:67], v[208:211], v[200:203], v[64:67]
    ds_read_b128 v[132:135], v32 offset:16384
    ds_read_b128 v[136:139], v32 offset:16640
    v_mfma_f32_16x16x32_bf16 v[84:87], v[208:211], v[204:207], v[84:87]
    ds_read_b64_tr_b16 v[140:141], v37 offset:0
    ds_read_b64_tr_b16 v[142:143], v37 offset:144
    v_mfma_f32_16x16x32_bf16 v[68:71], v[212:215], v[200:203], v[68:71]
    ds_read_b64_tr_b16 v[144:145], v37 offset:32
    ds_read_b64_tr_b16 v[146:147], v37 offset:176
    v_mfma_f32_16x16x32_bf16 v[88:91], v[212:215], v[204:207], v[88:91]
    ds_read_b64_tr_b16 v[148:149], v37 offset:64
    ds_read_b64_tr_b16 v[150:151], v37 offset:208
    v_mfma_f32_16x16x32_bf16 v[72:75], v[216:219], v[200:203], v[72:75]
    ds_read_b64_tr_b16 v[152:153], v37 offset:96
    ds_read_b64_tr_b16 v[154:155], v37 offset:240
    v_mfma_f32_16x16x32_bf16 v[92:95], v[216:219], v[204:207], v[92:95]
    ds_read_b64_tr_b16 v[156:157], v37 offset:128
    ds_read_b64_tr_b16 v[158:159], v37 offset:272
    v_mfma_f32_16x16x32_bf16 v[76:79], v[220:223], v[200:203], v[76:79]
    v_mfma_f32_16x16x32_bf16 v[96:99], v[220:223], v[204:207], v[96:99]
    v_mfma_f32_16x16x32_bf16 v[80:83], v[224:227], v[200:203], v[80:83]
    v_mfma_f32_16x16x32_bf16 v[100:103], v[224:227], v[204:207], v[100:103]
    s_waitcnt lgkmcnt(12)
    v_mfma_f32_16x16x32_bf16 v[64:67], v[112:115], v[104:107], v[64:67]
    ds_read_b128 v[200:203], v32 offset:24576
    ds_read_b128 v[204:207], v32 offset:24832
    v_mfma_f32_16x16x32_bf16 v[84:87], v[112:115], v[108:111], v[84:87]
    ds_read_b64_tr_b16 v[208:209], v37 offset:4608
    ds_read_b64_tr_b16 v[210:211], v37 offset:4752
    v_mfma_f32_16x16x32_bf16 v[68:71], v[116:119], v[104:107], v[68:71]
    ds_read_b64_tr_b16 v[212:213], v37 offset:4640
    ds_read_b64_tr_b16 v[214:215], v37 offset:4784
    v_mfma_f32_16x16x32_bf16 v[88:91], v[116:119], v[108:111], v[88:91]
    ds_read_b64_tr_b16 v[216:217], v37 offset:4672
    ds_read_b64_tr_b16 v[218:219], v37 offset:4816
    v_mfma_f32_16x16x32_bf16 v[72:75], v[120:123], v[104:107], v[72:75]
    ds_read_b64_tr_b16 v[220:221], v37 offset:4704
    ds_read_b64_tr_b16 v[222:223], v37 offset:4848
    v_mfma_f32_16x16x32_bf16 v[92:95], v[120:123], v[108:111], v[92:95]
    ds_read_b64_tr_b16 v[224:225], v37 offset:4736
    ds_read_b64_tr_b16 v[226:227], v37 offset:4880
    v_mfma_f32_16x16x32_bf16 v[76:79], v[124:127], v[104:107], v[76:79]
    v_mfma_f32_16x16x32_bf16 v[96:99], v[124:127], v[108:111], v[96:99]
    v_mfma_f32_16x16x32_bf16 v[80:83], v[128:131], v[104:107], v[80:83]
    v_mfma_f32_16x16x32_bf16 v[100:103], v[128:131], v[108:111], v[100:103]
    s_waitcnt lgkmcnt(10)
    s_barrier
    v_mfma_f32_16x16x32_bf16 v[64:67], v[140:143], v[132:135], v[64:67]
    ds_read_b128 v[104:107], v32 offset:32768
    ds_read_b128 v[108:111], v32 offset:33024
    v_mfma_f32_16x16x32_bf16 v[84:87], v[140:143], v[136:139], v[84:87]
    ds_read_b64_tr_b16 v[112:113], v37 offset:9216
    ds_read_b64_tr_b16 v[114:115], v37 offset:9360
    v_mfma_f32_16x16x32_bf16 v[68:71], v[144:147], v[132:135], v[68:71]
    ds_read_b64_tr_b16 v[116:117], v37 offset:9248
    ds_read_b64_tr_b16 v[118:119], v37 offset:9392
    v_mfma_f32_16x16x32_bf16 v[88:91], v[144:147], v[136:139], v[88:91]
    ds_read_b64_tr_b16 v[120:121], v37 offset:9280
    ds_read_b64_tr_b16 v[122:123], v37 offset:9424
    v_mfma_f32_16x16x32_bf16 v[72:75], v[148:151], v[132:135], v[72:75]
    ds_read_b64_tr_b16 v[124:125], v37 offset:9312
    ds_read_b64_tr_b16 v[126:127], v37 offset:9456
    v_mfma_f32_16x16x32_bf16 v[92:95], v[148:151], v[136:139], v[92:95]
    ds_read_b64_tr_b16 v[128:129], v37 offset:9344
    ds_read_b64_tr_b16 v[130:131], v37 offset:9488
    v_mfma_f32_16x16x32_bf16 v[76:79], v[152:155], v[132:135], v[76:79]
    v_mfma_f32_16x16x32_bf16 v[96:99], v[152:155], v[136:139], v[96:99]
    v_mfma_f32_16x16x32_bf16 v[80:83], v[156:159], v[132:135], v[80:83]
    v_mfma_f32_16x16x32_bf16 v[100:103], v[156:159], v[136:139], v[100:103]
    s_waitcnt lgkmcnt(12)
    v_mfma_f32_16x16x32_bf16 v[64:67], v[208:211], v[200:203], v[64:67]
    ds_read_b128 v[132:135], v32 offset:40960
    ds_read_b128 v[136:139], v32 offset:41216
    v_mfma_f32_16x16x32_bf16 v[84:87], v[208:211], v[204:207], v[84:87]
    ds_read_b64_tr_b16 v[140:141], v37 offset:13824
    ds_read_b64_tr_b16 v[142:143], v37 offset:13968
    v_mfma_f32_16x16x32_bf16 v[68:71], v[212:215], v[200:203], v[68:71]
    ds_read_b64_tr_b16 v[144:145], v37 offset:13856
    ds_read_b64_tr_b16 v[146:147], v37 offset:14000
    v_mfma_f32_16x16x32_bf16 v[88:91], v[212:215], v[204:207], v[88:91]
    ds_read_b64_tr_b16 v[148:149], v37 offset:13888
    ds_read_b64_tr_b16 v[150:151], v37 offset:14032
    v_mfma_f32_16x16x32_bf16 v[72:75], v[216:219], v[200:203], v[72:75]
    ds_read_b64_tr_b16 v[152:153], v37 offset:13920
    ds_read_b64_tr_b16 v[154:155], v37 offset:14064
    v_mfma_f32_16x16x32_bf16 v[92:95], v[216:219], v[204:207], v[92:95]
    ds_read_b64_tr_b16 v[156:157], v37 offset:13952
    ds_read_b64_tr_b16 v[158:159], v37 offset:14096
    v_mfma_f32_16x16x32_bf16 v[76:79], v[220:223], v[200:203], v[76:79]
    v_mfma_f32_16x16x32_bf16 v[96:99], v[220:223], v[204:207], v[96:99]
    v_mfma_f32_16x16x32_bf16 v[80:83], v[224:227], v[200:203], v[80:83]
    v_mfma_f32_16x16x32_bf16 v[100:103], v[224:227], v[204:207], v[100:103]
    s_waitcnt lgkmcnt(10)
    s_barrier
    v_mfma_f32_16x16x32_bf16 v[64:67], v[112:115], v[104:107], v[64:67]
    ds_read_b128 v[200:203], v32 offset:49152
    ds_read_b128 v[204:207], v32 offset:49408
    v_mfma_f32_16x16x32_bf16 v[84:87], v[112:115], v[108:111], v[84:87]
    ds_read_b64_tr_b16 v[208:209], v37 offset:18432
    ds_read_b64_tr_b16 v[210:211], v37 offset:18576
    v_mfma_f32_16x16x32_bf16 v[68:71], v[116:119], v[104:107], v[68:71]
    ds_read_b64_tr_b16 v[212:213], v37 offset:18464
    ds_read_b64_tr_b16 v[214:215], v37 offset:18608
    v_mfma_f32_16x16x32_bf16 v[88:91], v[116:119], v[108:111], v[88:91]
    ds_read_b64_tr_b16 v[216:217], v37 offset:18496
    ds_read_b64_tr_b16 v[218:219], v37 offset:18640
    v_mfma_f32_16x16x32_bf16 v[72:75], v[120:123], v[104:107], v[72:75]
    ds_read_b64_tr_b16 v[220:221], v37 offset:18528
    ds_read_b64_tr_b16 v[222:223], v37 offset:18672
    v_mfma_f32_16x16x32_bf16 v[92:95], v[120:123], v[108:111], v[92:95]
    ds_read_b64_tr_b16 v[224:225], v37 offset:18560
    ds_read_b64_tr_b16 v[226:227], v37 offset:18704
    v_mfma_f32_16x16x32_bf16 v[76:79], v[124:127], v[104:107], v[76:79]
    v_mfma_f32_16x16x32_bf16 v[96:99], v[124:127], v[108:111], v[96:99]
    v_mfma_f32_16x16x32_bf16 v[80:83], v[128:131], v[104:107], v[80:83]
    v_mfma_f32_16x16x32_bf16 v[100:103], v[128:131], v[108:111], v[100:103]
    s_waitcnt lgkmcnt(12)
    v_mfma_f32_16x16x32_bf16 v[64:67], v[140:143], v[132:135], v[64:67]
    ds_read_b128 v[104:107], v32 offset:57344
    ds_read_b128 v[108:111], v32 offset:57600
    v_mfma_f32_16x16x32_bf16 v[84:87], v[140:143], v[136:139], v[84:87]
    ds_read_b64_tr_b16 v[112:113], v37 offset:23040
    ds_read_b64_tr_b16 v[114:115], v37 offset:23184
    v_mfma_f32_16x16x32_bf16 v[68:71], v[144:147], v[132:135], v[68:71]
    ds_read_b64_tr_b16 v[116:117], v37 offset:23072
    ds_read_b64_tr_b16 v[118:119], v37 offset:23216
    v_mfma_f32_16x16x32_bf16 v[88:91], v[144:147], v[136:139], v[88:91]
    ds_read_b64_tr_b16 v[120:121], v37 offset:23104
    ds_read_b64_tr_b16 v[122:123], v37 offset:23248
    v_mfma_f32_16x16x32_bf16 v[72:75], v[148:151], v[132:135], v[72:75]
    ds_read_b64_tr_b16 v[124:125], v37 offset:23136
    ds_read_b64_tr_b16 v[126:127], v37 offset:23280
    v_mfma_f32_16x16x32_bf16 v[92:95], v[148:151], v[136:139], v[92:95]
    ds_read_b64_tr_b16 v[128:129], v37 offset:23168
    ds_read_b64_tr_b16 v[130:131], v37 offset:23312
    v_mfma_f32_16x16x32_bf16 v[76:79], v[152:155], v[132:135], v[76:79]
    v_mfma_f32_16x16x32_bf16 v[96:99], v[152:155], v[136:139], v[96:99]
    v_mfma_f32_16x16x32_bf16 v[80:83], v[156:159], v[132:135], v[80:83]
    v_mfma_f32_16x16x32_bf16 v[100:103], v[156:159], v[136:139], v[100:103]
    s_waitcnt lgkmcnt(10)
    s_barrier
    v_mfma_f32_16x16x32_bf16 v[64:67], v[208:211], v[200:203], v[64:67]
    ds_read2st64_b32 v[132:133], v40 offset0:0 offset1:2
    ds_read2st64_b32 v[134:135], v40 offset0:4 offset1:6
    v_mfma_f32_16x16x32_bf16 v[84:87], v[208:211], v[204:207], v[84:87]
    ds_read2st64_b32 v[136:137], v41 offset0:0 offset1:2
    ds_read2st64_b32 v[138:139], v41 offset0:4 offset1:6
    v_mfma_f32_16x16x32_bf16 v[68:71], v[212:215], v[200:203], v[68:71]
    ds_read_b64_tr_b16 v[140:141], v36 offset:0
    ds_read_b64_tr_b16 v[142:143], v36 offset:144
    v_mfma_f32_16x16x32_bf16 v[88:91], v[212:215], v[204:207], v[88:91]
    ds_read_b64_tr_b16 v[144:145], v36 offset:32
    ds_read_b64_tr_b16 v[146:147], v36 offset:176
    v_mfma_f32_16x16x32_bf16 v[72:75], v[216:219], v[200:203], v[72:75]
    ds_read_b64_tr_b16 v[148:149], v36 offset:64
    ds_read_b64_tr_b16 v[150:151], v36 offset:208
    v_mfma_f32_16x16x32_bf16 v[92:95], v[216:219], v[204:207], v[92:95]
    ds_read_b64_tr_b16 v[152:153], v36 offset:96
    ds_read_b64_tr_b16 v[154:155], v36 offset:240
    v_mfma_f32_16x16x32_bf16 v[76:79], v[220:223], v[200:203], v[76:79]
    ds_read_b64_tr_b16 v[156:157], v36 offset:128
    ds_read_b64_tr_b16 v[158:159], v36 offset:272
    v_mfma_f32_16x16x32_bf16 v[96:99], v[220:223], v[204:207], v[96:99]
    v_mfma_f32_16x16x32_bf16 v[80:83], v[224:227], v[200:203], v[80:83]
    v_mfma_f32_16x16x32_bf16 v[100:103], v[224:227], v[204:207], v[100:103]
    s_waitcnt lgkmcnt(14)
    v_mfma_f32_16x16x32_bf16 v[64:67], v[112:115], v[104:107], v[64:67]
    ds_read2st64_b32 v[200:201], v40 offset0:32 offset1:34
    ds_read2st64_b32 v[202:203], v40 offset0:36 offset1:38
    v_mfma_f32_16x16x32_bf16 v[84:87], v[112:115], v[108:111], v[84:87]
    ds_read2st64_b32 v[204:205], v41 offset0:32 offset1:34
    ds_read2st64_b32 v[206:207], v41 offset0:36 offset1:38
    v_mfma_f32_16x16x32_bf16 v[68:71], v[116:119], v[104:107], v[68:71]
    ds_read_b64_tr_b16 v[208:209], v36 offset:4608
    ds_read_b64_tr_b16 v[210:211], v36 offset:4752
    v_mfma_f32_16x16x32_bf16 v[88:91], v[116:119], v[108:111], v[88:91]
    ds_read_b64_tr_b16 v[212:213], v36 offset:4640
    ds_read_b64_tr_b16 v[214:215], v36 offset:4784
    v_mfma_f32_16x16x32_bf16 v[72:75], v[120:123], v[104:107], v[72:75]
    ds_read_b64_tr_b16 v[216:217], v36 offset:4672
    ds_read_b64_tr_b16 v[218:219], v36 offset:4816
    v_mfma_f32_16x16x32_bf16 v[92:95], v[120:123], v[108:111], v[92:95]
    ds_read_b64_tr_b16 v[220:221], v36 offset:4704
    ds_read_b64_tr_b16 v[222:223], v36 offset:4848
    v_mfma_f32_16x16x32_bf16 v[76:79], v[124:127], v[104:107], v[76:79]
    ds_read_b64_tr_b16 v[224:225], v36 offset:4736
    ds_read_b64_tr_b16 v[226:227], v36 offset:4880
    v_mfma_f32_16x16x32_bf16 v[96:99], v[124:127], v[108:111], v[96:99]
    v_mfma_f32_16x16x32_bf16 v[80:83], v[128:131], v[104:107], v[80:83]
    v_mfma_f32_16x16x32_bf16 v[100:103], v[128:131], v[108:111], v[100:103]
    s_waitcnt lgkmcnt(14)
    v_mfma_f32_16x16x32_bf16 v[64:67], v[140:143], v[132:135], v[64:67]
    v_mfma_f32_16x16x32_bf16 v[84:87], v[140:143], v[136:139], v[84:87]
    v_mfma_f32_16x16x32_bf16 v[68:71], v[144:147], v[132:135], v[68:71]
    v_mfma_f32_16x16x32_bf16 v[88:91], v[144:147], v[136:139], v[88:91]
    v_mfma_f32_16x16x32_bf16 v[72:75], v[148:151], v[132:135], v[72:75]
    v_mfma_f32_16x16x32_bf16 v[92:95], v[148:151], v[136:139], v[92:95]
    v_mfma_f32_16x16x32_bf16 v[76:79], v[152:155], v[132:135], v[76:79]
    v_mfma_f32_16x16x32_bf16 v[96:99], v[152:155], v[136:139], v[96:99]
    v_mfma_f32_16x16x32_bf16 v[80:83], v[156:159], v[132:135], v[80:83]
    v_mfma_f32_16x16x32_bf16 v[100:103], v[156:159], v[136:139], v[100:103]
    s_waitcnt lgkmcnt(0)
    v_mfma_f32_16x16x32_bf16 v[64:67], v[208:211], v[200:203], v[64:67]
    v_mfma_f32_16x16x32_bf16 v[84:87], v[208:211], v[204:207], v[84:87]
    v_mfma_f32_16x16x32_bf16 v[68:71], v[212:215], v[200:203], v[68:71]
    v_mfma_f32_16x16x32_bf16 v[88:91], v[212:215], v[204:207], v[88:91]
    v_mfma_f32_16x16x32_bf16 v[72:75], v[216:219], v[200:203], v[72:75]
    v_mfma_f32_16x16x32_bf16 v[92:95], v[216:219], v[204:207], v[92:95]
    v_mfma_f32_16x16x32_bf16 v[76:79], v[220:223], v[200:203], v[76:79]
    v_mfma_f32_16x16x32_bf16 v[96:99], v[220:223], v[204:207], v[96:99]
    v_mfma_f32_16x16x32_bf16 v[80:83], v[224:227], v[200:203], v[80:83]
    v_mfma_f32_16x16x32_bf16 v[100:103], v[224:227], v[204:207], v[100:103]
    ds_write_b128 v54, v[64:67] offset:0
    ds_write_b128 v54, v[68:71] offset:64
    s_nop 0
    ds_write_b128 v54, v[72:75] offset:128
    s_nop 0
    ds_write_b128 v54, v[76:79] offset:192
    s_mov_b32 exec_hi, 0
    ds_write_b128 v54, v[80:83] offset:256
    s_mov_b32 exec_hi, -1
    ds_write_b128 v54, v[84:87] offset:2304
    ds_write_b128 v54, v[88:91] offset:2368
    ds_write_b128 v54, v[92:95] offset:2432
    ds_write_b128 v54, v[96:99] offset:2496
    s_mov_b32 exec_hi, 0
    ds_write_b128 v54, v[100:103] offset:2560
    s_mov_b32 exec_hi, -1
    ds_read_b128 v[104:107], v55 offset:0
    ds_read_b128 v[108:111], v55 offset:1024
    ds_read_b128 v[112:115], v55 offset:2048
    ds_read_b128 v[116:119], v55 offset:3072
    ds_read_b128 v[120:123], v55 offset:4096
    ds_read_b128 v[124:127], v55 offset:5120
    ds_read_b128 v[128:131], v55 offset:6144
    ds_read_b128 v[132:135], v55 offset:7168
    ds_read_b128 v[136:139], v55 offset:8192
    s_waitcnt lgkmcnt(8)
    buffer_store_dwordx4 v[104:107], v44, s[56:59], s80 offen offset:0 nt
    s_waitcnt lgkmcnt(7)
    buffer_store_dwordx4 v[108:111], v45, s[56:59], s80 offen offset:0 nt
    s_waitcnt lgkmcnt(6)
    buffer_store_dwordx4 v[112:115], v46, s[56:59], s80 offen offset:0 nt
    s_waitcnt lgkmcnt(5)
    buffer_store_dwordx4 v[116:119], v47, s[56:59], s80 offen offset:0 nt
    s_waitcnt lgkmcnt(4)
    buffer_store_dwordx4 v[120:123], v48, s[56:59], s80 offen offset:0 nt
    s_waitcnt lgkmcnt(3)
    buffer_store_dwordx4 v[124:127], v49, s[56:59], s80 offen offset:0 nt
    s_waitcnt lgkmcnt(2)
    buffer_store_dwordx4 v[128:131], v50, s[56:59], s80 offen offset:0 nt
    s_waitcnt lgkmcnt(1)
    buffer_store_dwordx4 v[132:135], v51, s[56:59], s80 offen offset:0 nt
    s_waitcnt lgkmcnt(0)
    buffer_store_dwordx4 v[136:139], v52, s[56:59], s80 offen offset:0 nt
L_tail_end:
L_exit:
    s_endpgm
Ltslow_13:
    s_mov_b32 s96, 0x8000
Ltpoll_15:
    s_sleep 4
    buffer_load_dword v14, v253, s[60:63], 0 offen sc1
    s_waitcnt vmcnt(0)
    v_readfirstlane_b32 s67, v14
    s_nop 1
    s_cmp_lg_u32 s67, 0
    s_cbranch_scc1 Ltok_14
    s_sub_u32 s96, s96, 1
    s_cmp_lg_u32 s96, 0
    s_cbranch_scc1 Ltpoll_15
    s_branch Ltok_14
Lslow_16:
    s_mov_b32 s96, 0x8000
Lpoll_18:
    s_sleep 4
    buffer_load_dword v14, v15, s[52:55], 0 offen sc1
    s_waitcnt vmcnt(0)
    v_cmp_ne_u32 vcc, s67, v14
    s_nop 4
    s_cbranch_vccz Lok_17
    s_sub_u32 s96, s96, 1
    s_cmp_lg_u32 s96, 0
    s_cbranch_scc1 Lpoll_18
    s_branch Lok_17
Ltslow_21:
    s_mov_b32 s96, 0x8000
Ltpoll_23:
    s_sleep 4
    buffer_load_dword v14, v15, s[60:63], 0 offen sc1
    s_waitcnt vmcnt(0)
    v_readfirstlane_b32 s67, v14
    s_nop 1
    s_cmp_lg_u32 s67, 0
    s_cbranch_scc1 Ltok_22
    s_sub_u32 s96, s96, 1
    s_cmp_lg_u32 s96, 0
    s_cbranch_scc1 Ltpoll_23
    s_branch Ltok_22
Lslow_25:
    s_mov_b32 s96, 0x8000
Lpoll_27:
    s_sleep 4
    buffer_load_dword v14, v15, s[52:55], 0 offen sc1
    s_waitcnt vmcnt(0)
    v_cmp_ne_u32 vcc, s67, v14
    s_nop 4
    s_cbranch_vccz Lok_26
    s_sub_u32 s96, s96, 1
    s_cmp_lg_u32 s96, 0
    s_cbranch_scc1 Lpoll_27
    s_branch Lok_26
Ltslow_34:
    s_mov_b32 s96, 0x8000
Ltpoll_36:
    s_sleep 4
    buffer_load_dword v14, v253, s[60:63], 0 offen sc1
    s_waitcnt vmcnt(0)
    v_readfirstlane_b32 s67, v14
    s_nop 1
    s_cmp_lg_u32 s67, 0
    s_cbranch_scc1 Ltok_35
    s_sub_u32 s96, s96, 1
    s_cmp_lg_u32 s96, 0
    s_cbranch_scc1 Ltpoll_36
    s_branch Ltok_35
Lslow_37:
    s_mov_b32 s96, 0x8000
Lpoll_39:
    s_sleep 4
    buffer_load_dword v14, v15, s[52:55], 0 offen sc1
    s_waitcnt vmcnt(0)
    v_cmp_ne_u32 vcc, s67, v14
    s_nop 4
    s_cbranch_vccz Lok_38
    s_sub_u32 s96, s96, 1
    s_cmp_lg_u32 s96, 0
    s_cbranch_scc1 Lpoll_39
    s_branch Lok_38
Ltslow_42:
    s_mov_b32 s96, 0x8000
Ltpoll_44:
    s_sleep 4
    buffer_load_dword v14, v15, s[60:63], 0 offen sc1
    s_waitcnt vmcnt(0)
    v_readfirstlane_b32 s67, v14
    s_nop 1
    s_cmp_lg_u32 s67, 0
    s_cbranch_scc1 Ltok_43
    s_sub_u32 s96, s96, 1
    s_cmp_lg_u32 s96, 0
    s_cbranch_scc1 Ltpoll_44
    s_branch Ltok_43
Lslow_45:
    s_mov_b32 s96, 0x8000
Lpoll_47:
    s_sleep 4
    buffer_load_dword v14, v15, s[52:55], 0 offen sc1
    s_waitcnt vmcnt(0)
    v_cmp_ne_u32 vcc, s67, v14
    s_nop 4
    s_cbranch_vccz Lok_46
    s_sub_u32 s96, s96, 1
    s_cmp_lg_u32 s96, 0
    s_cbranch_scc1 Lpoll_47
    s_branch Lok_46
Lslow_48:
    s_mov_b32 s96, 0x8000
Lpoll_50:
    s_sleep 4
    buffer_load_dword v14, v15, s[52:55], 0 offen sc1
    s_waitcnt vmcnt(0)
    v_cmp_ne_u32 vcc, s67, v14
    s_nop 4
    s_cbranch_vccz Lok_49
    s_sub_u32 s96, s96, 1
    s_cmp_lg_u32 s96, 0
    s_cbranch_scc1 Lpoll_50
    s_branch Lok_49
Lslow_54:
    s_mov_b32 s96, 0x8000
Lpoll_56:
    s_sleep 4
    buffer_load_dword v14, v15, s[52:55], 0 offen sc1
    buffer_load_dword v253, v15, s[52:55], 0 offen offset:256 sc1
    s_waitcnt vmcnt(0)
    v_xor_b32 v253, v253, v14
    v_xor_b32 v14, s67, v14
    v_or_b32 v14, v14, v253
    v_cmp_ne_u32 vcc, 0, v14
    s_nop 4
    s_cbranch_vccz Lok_55
    s_sub_u32 s96, s96, 1
    s_cmp_lg_u32 s96, 0
    s_cbranch_scc1 Lpoll_56
    s_branch Lok_55
L_fallback0:
    s_cmp_lg_u32 s68, 0
    s_cbranch_scc1 L_att_fin0
    s_branch L_fallback
L_fallback1:
    s_cmp_lg_u32 s68, 0
    s_cbranch_scc1 L_att_fin1
    s_branch L_fallback
L_fallback:
    s_mov_b32 s68, 1
    s_waitcnt vmcnt(0) lgkmcnt(0)
    s_barrier
    s_lshl_b32 s72, s64, 10
    s_add_u32 s95, s72, 81920
L_fb_load:
    s_add_u32 s73, s95, s6
    s_mov_b32 m0, s72
    s_nop 0
    buffer_load_dwordx4 v19, s[52:55], s73 offen sc1 lds
    s_add_u32 s72, s72, 8192
    s_add_u32 s95, s95, 8192
    s_cmp_ge_u32 s95, 163840
    s_cselect_b32 s73, 163840, 0
    s_sub_u32 s95, s95, s73
    s_cmp_lt_u32 s72, 163840
    s_cbranch_scc1 L_fb_load
    v_mov_b32 v153, 0
    v_mov_b32 v4, 0xff800000
    v_mov_b32 v5, 0xff800000
    v_mov_b32 v6, v16
    v_mov_b32 v7, v17
    s_mov_b32 s72, 0
    s_waitcnt vmcnt(0)
    s_barrier
L_tm_loop:
    ds_read_b64 v[158:159], v7
    ds_read_b128 v[154:157], v6
    s_waitcnt lgkmcnt(0)
    v_mfma_f32_32x32x4_2b_bf16 v[64:95], v[158:159], v[152:153], 0
    s_nop 15
    s_nop 3
    v_mfma_f32_32x32x16_bf16 v[64:79], v[154:157], v[144:147], v[64:79]
    v_mfma_f32_32x32x16_bf16 v[80:95], v[154:157], v[148:151], v[80:95]
    s_nop 10
    v_max3_f32 v4, v4, v64, v65
    v_max3_f32 v4, v4, v66, v67
    v_max3_f32 v4, v4, v68, v69
    v_max3_f32 v4, v4, v70, v71
    v_max3_f32 v4, v4, v72, v73
    v_max3_f32 v4, v4, v74, v75
    v_max3_f32 v4, v4, v76, v77
    v_max3_f32 v4, v4, v78, v79
    v_max3_f32 v5, v5, v80, v81
    v_max3_f32 v5, v5, v82, v83
    v_max3_f32 v5, v5, v84, v85
    v_max3_f32 v5, v5, v86, v87
    v_max3_f32 v5, v5, v88, v89
    v_max3_f32 v5, v5, v90, v91
    v_max3_f32 v5, v5, v92, v93
    v_max3_f32 v5, v5, v94, v95
    s_add_u32 s72, s72, 1
    s_and_b32 s73, s72, 7
    s_cmp_eq_u32 s73, 0
    s_mov_b32 s73, 2560
    s_cselect_b32 s73, 23040, s73
    v_add_u32 v6, s73, v6
    v_add_u32 v7, s73, v7
    s_cmp_lt_u32 s72, 32
    s_cbranch_scc1 L_tm_loop
    v_permlane32_swap_b32 v4, v5
    v_max_f32 v4, v4, v5
    v_mul_u32_u24 v5, 2560, v3
    v_bfe_u32 v6, v1, 2, 2
    v_lshl_add_u32 v5, v6, 6, v5
    v_and_b32 v6, 3, v1
    v_lshl_add_u32 v5, v6, 2, v5
    s_mul_i32 s72, s64, 10240
    s_xor_b32 s73, s64, 4
    s_mul_i32 s73, s73, 10240
    v_add_u32 v6, s72, v5
    v_add_u32 v7, s73, v5
    ds_write_b32 v6, v4 offset:2352
    v_add_u32 v16, 81920, v16
    v_add_u32 v17, 81920, v17
    v_add_u32 v18, 81920, v18
    v_add_u32 v20, 81920, v20
    s_waitcnt lgkmcnt(0)
    s_barrier
    ds_read_b32 v5, v7 offset:2352
    ds_read_b64 v[158:159], v17
    ds_read_b128 v[154:157], v16
    s_waitcnt lgkmcnt(0)
    v_max_f32 v4, v4, v5
    s_branch L_have_max
Lslow_90:
    s_mov_b32 s96, 0x8000
Lpoll_92:
    s_sleep 4
    buffer_load_dword v14, v15, s[52:55], 0 offen sc1
    buffer_load_dword v253, v15, s[52:55], 0 offen offset:256 sc1
    s_waitcnt vmcnt(0)
    v_xor_b32 v253, v253, v14
    v_xor_b32 v14, s67, v14
    v_or_b32 v14, v14, v253
    v_cmp_ne_u32 vcc, 0, v14
    s_nop 4
    s_cbranch_vccz Lok_91
    s_sub_u32 s96, s96, 1
    s_cmp_lg_u32 s96, 0
    s_cbranch_scc1 Lpoll_92
    s_branch Lok_91
L_code_end:
.section .rodata,"a"
.p2align 6
.amdhsa_kernel concat_heads__mha_block__ssm_conv_s5__prompt_kernel
  .amdhsa_next_free_vgpr 256
  .amdhsa_next_free_sgpr 102
  .amdhsa_accum_offset 256
  .amdhsa_group_segment_fixed_size 0
  .amdhsa_kernarg_size 120
  .amdhsa_user_sgpr_count 2
  .amdhsa_user_sgpr_kernarg_segment_ptr 1
  .amdhsa_system_sgpr_workgroup_id_x 1
.end_amdhsa_kernel
```
